```python
import torch

def _softmax(x, axis=-1):
    return torch.softmax(x, dim=axis)
def _gelu(x):
    return torch.nn.functional.gelu(x, approximate="tanh")
def _silu(x):
    return torch.nn.functional.silu(x)
def _sigmoid(x):
    return torch.sigmoid(x)
def _layernorm(x, axis=-1, eps=1e-5):
    m = x.mean(dim=axis, keepdim=True)
    v = x.var(dim=axis, keepdim=True, unbiased=False)
    return (x - m) / torch.sqrt(v + eps)
def _scatter_add(tgt, idx, src, axis=0):
    return tgt.clone().index_add_(axis, idx, src)
def _segment_sum(src, seg, n):
    out = torch.zeros((n,) + src.shape[1:], dtype=src.dtype)
    return out.index_add_(0, seg, src)
def _pad(x, pw):
    flat = tuple(v for pair in reversed(pw) for v in pair)
    return torch.nn.functional.pad(x, flat)

kernel_name = 'sequential_preLN__softmax_full_mha__mixer_s_mlp__prompt'

def setup_inputs():

    _w = (lambda a: (lambda t: t.to(torch.bfloat16) if t.is_floating_point() else t)(torch.as_tensor(a)))
    def _A_setup():
        B, S, D = 1, 2048, 640
        return {
            "x": _w((lambda *s: torch.randn(*s, dtype=torch.bfloat16) * 0.05)(B, S, D)),
            "wqkv": _w((lambda *s: torch.randn(*s, dtype=torch.bfloat16) * 0.05)(D, 3 * D)),
            "wo": _w((lambda *s: torch.randn(*s, dtype=torch.bfloat16) * 0.05)(D, D)),
        }
    _A_in = _A_setup()

    def _B_setup():
        B, S, D, F = 1, 2048, 640, 1536
        return {
            "x":  _w((lambda *s: torch.randn(*s, dtype=torch.bfloat16) * 0.05)(B, S, D)),
            "w1": _w((lambda *s: torch.randn(*s, dtype=torch.bfloat16) * 3.2)(D, D) * (D ** -0.5)),
            "w2": _w((lambda *s: torch.randn(*s, dtype=torch.bfloat16) * 3.2)(D, D) * (D ** -0.5)),
            "w3": _w((lambda *s: torch.randn(*s, dtype=torch.bfloat16) * 3.2)(D, F) * (D ** -0.5)),
            "w4": _w((lambda *s: torch.randn(*s, dtype=torch.bfloat16) * 3.2)(F, D) * (F ** -0.5)),
        }
    _B_in = _B_setup()

    return {
        "A_x": _A_in["x"],
        "A_wqkv": _A_in["wqkv"],
        "A_wo": _A_in["wo"],
        "B_x": _B_in["x"],
        "B_w1": _B_in["w1"],
        "B_w2": _B_in["w2"],
        "B_w3": _B_in["w3"],
        "B_w4": _B_in["w4"],
    }

def reference(A_x, A_wqkv, A_wo, B_x, B_w1, B_w2, B_w3, B_w4):
    def _A_ref(x, wqkv, wo):
        B, S, D = x.shape
        H = 32; Dh = D // H
        qkv = (lambda x, *d: x.permute(*d))((x @ wqkv).reshape(B, S, 3, H, Dh), 2, 0, 3, 1, 4)
        q, k, v = qkv[0], qkv[1], qkv[2]
        scale = Dh ** -0.5
        scores = torch.einsum("bhqd,bhkd->bhqk", q, k) * scale
        p = _softmax(scores, axis=-1)
        o = torch.einsum("bhqk,bhkd->bhqd", p, v)
        return (lambda x, *d: x.permute(*d))(o, 0, 2, 1, 3).reshape(B, S, D) @ wo

    def _B_ref(x, w1, w2, w3, w4):
        B, S, D = x.shape
        h = _gelu(_layernorm(x, axis=-1) @ w1)
        c = D // 4
        g0 = _pad(h[:, :, 0*c:1*c], ((0, 0), (1, 0), (0, 0)))[:, :S, :]
        g1 = _pad(h[:, :, 1*c:2*c], ((0, 0), (0, 1), (0, 0)))[:, 1:, :]
        g2 = _pad(h[:, :, 2*c:3*c], ((0, 0), (2, 0), (0, 0)))[:, :S, :]
        g3 = _pad(h[:, :, 3*c:   ], ((0, 0), (0, 2), (0, 0)))[:, 2:, :]
        hs = torch.concatenate([g0, g1, g2, g3], axis=-1) @ w2
        x1 = x + hs
        h2 = _gelu(_layernorm(x1, axis=-1) @ w3) @ w4
        return x1 + h2

    x = A_x
    h = x + _A_ref(_layernorm(x, axis=-1), A_wqkv, A_wo)
    h2 = h + _B_ref(_layernorm(h, axis=-1), B_w1, B_w2, B_w3, B_w4)
    return h2
```

```asm
; @launch grid=(256,1,1) block=(256,1,1) lds=163840
.amdgcn_target "amdgcn-amd-amdhsa--gfx950"
.text
.globl sequential_preLN__softmax_full_mha__mixer_s_mlp__prompt_kernel
.p2align 12
.p2align 8
.type sequential_preLN__softmax_full_mha__mixer_s_mlp__prompt_kernel,@function
sequential_preLN__softmax_full_mha__mixer_s_mlp__prompt_kernel:
    s_cmp_ge_u32 s2, 256
    s_cbranch_scc1 L_exit
    s_getpc_b64 s[32:33]
L_pc:
    s_load_dwordx2 s[4:5], s[0:1], 0
    s_load_dwordx2 s[8:9], s[0:1], 8
    s_load_dwordx2 s[16:17], s[0:1], 64
    s_load_dwordx2 s[12:13], s[0:1], 80
    v_lshrrev_b32 v2, 6, v0
    v_and_b32 v1, 63, v0
    v_mov_b32 v31, v0
    v_readfirstlane_b32 s3, v2
    s_lshr_b32 s34, s2, 3
    s_lshl_b32 s35, s34, 2
    s_add_u32 s35, s35, s3
    s_mul_i32 s35, s35, 640
    v_lshl_add_u32 v2, v1, 7, s35
    v_min_u32 v2, L_end-L_pc-4, v2
    s_mov_b64 exec, 31
    global_load_dword v0, v2, s[32:33]
    s_mov_b64 exec, -1
    s_and_b32 s33, s2, 7
    s_lshr_b32 s25, s33, 1
    s_lshl_b32 s25, s25, 2
    s_lshr_b32 s35, s34, 3
    s_add_u32 s25, s25, s35
    s_and_b32 s26, s33, 1
    s_lshl_b32 s26, s26, 3
    s_and_b32 s35, s34, 7
    s_add_u32 s26, s26, s35
    s_lshl_b32 s27, s33, 2
    s_lshr_b32 s35, s34, 3
    s_add_u32 s27, s27, s35
    s_and_b32 s28, s34, 7
    s_mov_b32 s29, 0xffff0000
    s_mov_b32 s30, 0
    s_mov_b32 s31, -1
    s_mov_b32 s6, 2621440
    s_mov_b32 s7, 0x20000
    s_mov_b32 s10, 2457600
    s_mov_b32 s11, 0x20000
    s_mov_b32 s18, 2621440
    s_mov_b32 s19, 0x20000
    s_mov_b32 s14, 32079872
    s_mov_b32 s15, 0x20000
    s_lshr_b32 s42, s3, 1
    s_and_b32 s43, s3, 1
    s_add_u32 s36, s25, s26
    s_and_b32 s36, s36, 1
    s_mul_i32 s36, s36, 5
    s_lshl_b32 s44, s36, 7
    s_mul_i32 s41, s36, 245760
    s_lshl_b32 s37, s25, 2
    s_add_u32 s37, s37, s3
    s_mul_i32 s45, s37, 40960
    s_lshl_b32 s46, s3, 12
    v_lshrrev_b32 v2, 3, v1
    v_mul_u32_u24 v13, 1280, v2
    v_and_b32 v8, 7, v1
    v_lshrrev_b32 v12, 4, v1
    v_xor_b32 v14, v8, v12
    v_lshl_add_u32 v9, v14, 4, v13
    v_xor_b32 v14, 4, v14
    v_lshl_add_u32 v10, v14, 4, v13
    v_add_u32 v10, 9216, v10
    s_lshl_b32 s55, s26, 1
    s_add_u32 s55, s55, s43
    s_lshr_b32 s56, s37, 1
    s_mul_i32 s35, s42, 122880
    s_lshl_b32 s40, s43, 13
    s_lshl_b32 s38, s42, 12
    s_add_u32 s48, s40, s38
    s_add_u32 s40, s40, 16384
    s_add_u32 s48, s48, 16384
    s_mul_i32 s38, s43, 1228800
    s_lshl_b32 s39, s3, 15
    s_cmp_eq_u32 s26, 15
    s_cselect_b32 s56, s56, s55
    s_cselect_b32 s41, s38, s41
    s_cselect_b32 s35, 0, s35
    s_cselect_b32 s40, s39, s40
    s_lshl_b32 s34, s56, 7
    s_add_u32 s34, s34, s35
    s_cmp_ge_u32 s56, 30
    s_cselect_b32 s34, 0x80000000, s34
    v_mul_u32_u24 v11, 3840, v2
    v_and_b32 v12, 1, v12
    v_lshlrev_b32 v12, 2, v12
    v_xor_b32 v12, v8, v12
    v_lshl_add_u32 v11, v12, 4, v11
    v_add_u32 v11, s34, v11
    v_add_u32 v12, 29696, v11
    s_waitcnt lgkmcnt(0)
    s_load_dword s24, s[12:13], 0
    s_cmp_eq_u32 s26, 15
    s_cbranch_scc1 L_p1_s
    s_add_u32 m0, s46, 0
    s_add_u32 s47, s45, s44
    buffer_load_dwordx4 v9, s[4:7], s47 offen lds
    buffer_load_dwordx4 v10, s[4:7], s47 offen offset:1024 lds
    s_add_u32 m0, s48, 0
    s_nop 0
    buffer_load_dwordx4 v11, s[8:11], s41 offen lds
    buffer_load_dwordx4 v12, s[8:11], s41 offen offset:1024 lds
    s_add_u32 m0, s46, 2048
    s_add_u32 s47, s47, 20480
    buffer_load_dwordx4 v9, s[4:7], s47 offen lds
    buffer_load_dwordx4 v10, s[4:7], s47 offen offset:1024 lds
    s_add_u32 s44, s44, 128
    s_cmp_eq_u32 s44, 1280
    s_cselect_b32 s44, 0, s44
    s_add_u32 m0, s48, 2048
    s_add_u32 s41, s41, 61440
    buffer_load_dwordx4 v11, s[8:11], s41 offen lds
    buffer_load_dwordx4 v12, s[8:11], s41 offen offset:1024 lds
    s_add_u32 s41, s41, 184320
    s_cmp_eq_u32 s41, 2457600
    s_cselect_b32 s41, 0, s41
    s_lshl_b32 s32, s2, 2
    s_add_u32 s32, s32, s3
    s_mov_b32 s33, 16
    s_cmp_ge_u32 s32, 120
    s_cselect_b32 s33, 32, s33
    s_cmp_ge_u32 s32, 240
    s_cselect_b32 s33, 40, s33
    s_cmp_ge_u32 s32, 360
    s_cselect_b32 s33, 56, s33
    s_cmp_ge_u32 s32, 648
    s_cselect_b32 s33, 48, s33
    s_load_dwordx2 s[60:61], s[0:1], s33
    s_lshl_b32 s20, s3, 1
    s_lshr_b32 s20, 0x9c, s20
    s_and_b32 s20, s20, 3
    v_mov_b32 v2, 0x3f803f80
    v_and_b32 v13, 27, v1
    v_cmp_eq_u32 vcc, 18, v13
    v_mov_b32 v48, 0
    v_mov_b32 v49, 0
    v_mov_b32 v50, 0
    v_mov_b32 v51, 0
    v_cndmask_b32 v13, 0, v2, vcc
    v_accvgpr_write_b32 a64, v2
    v_accvgpr_write_b32 a65, v2
    v_accvgpr_write_b32 a66, v2
    v_accvgpr_write_b32 a67, v2
    v_accvgpr_write_b32 a68, v2
    v_accvgpr_write_b32 a69, v2
    v_accvgpr_write_b32 a70, v2
    v_accvgpr_write_b32 a71, v2
    v_accvgpr_write_b32 a72, v2
    v_accvgpr_write_b32 a73, v2
    v_accvgpr_write_b32 a74, v2
    v_accvgpr_write_b32 a75, v2
    v_accvgpr_write_b32 a76, v2
    v_accvgpr_write_b32 a77, v2
    v_accvgpr_write_b32 a78, v2
    v_accvgpr_write_b32 a79, v2
    v_accvgpr_write_b32 a96, v13
    v_accvgpr_write_b32 a97, v13
    v_accvgpr_write_b32 a98, v13
    v_accvgpr_write_b32 a99, v13
    v_accvgpr_write_b32 a100, v13
    v_accvgpr_write_b32 a101, v13
    v_accvgpr_write_b32 a102, v13
    v_accvgpr_write_b32 a103, v13
    v_accvgpr_write_b32 a104, v13
    v_accvgpr_write_b32 a105, v13
    v_accvgpr_write_b32 a106, v13
    v_accvgpr_write_b32 a107, v13
    v_accvgpr_write_b32 a108, v13
    v_accvgpr_write_b32 a109, v13
    v_accvgpr_write_b32 a110, v13
    v_accvgpr_write_b32 a111, v13
    v_mov_b32 v44, v2
    v_mov_b32 v45, v2
    v_mov_b32 v46, v2
    v_mov_b32 v47, v2
    s_lshl_b32 s32, s25, 7
    s_lshl_b32 s33, s26, 3
    v_mfma_f32_32x32x16_bf16 a[80:95], v[48:51], v[48:51], a[64:79]
    s_add_u32 s33, s33, s32
    s_lshl_b32 s34, s3, 1
    s_add_u32 s33, s33, s34
    s_mul_i32 s57, s33, 1280
    s_lshl_b32 s53, s33, 4
    s_add_u32 s53, s53, 655360
    v_mfma_f32_32x32x16_bf16 a[112:127], v[48:51], v[48:51], a[96:111]
    v_and_b32 v8, 31, v1
    v_lshrrev_b32 v2, 5, v1
    v_bfe_u32 v13, v1, 1, 3
    v_xor_b32 v13, v13, v2
    v_lshlrev_b32 v13, 4, v13
    v_lshl_add_u32 v24, v8, 7, v13
    v_mfma_f32_32x32x16_bf16 a[128:143], v[48:51], v[48:51], a[96:111]
    s_lshl_b32 s32, s42, 13
    v_add_u32 v24, s32, v24
    v_xor_b32 v25, 32, v24
    v_xor_b32 v26, 64, v24
    v_xor_b32 v27, 0x60, v24
    v_mfma_f32_32x32x16_bf16 a[144:159], v[48:51], v[48:51], a[96:111]
    v_mul_u32_u24 v7, 1280, v2
    v_lshl_add_u32 v6, v8, 3, v7
    v_lshl_add_u32 v7, v8, 4, v7
    v_bfe_u32 v16, v1, 2, 2
    v_lshl_add_u32 v16, v2, 3, v16
    v_lshlrev_b32 v16, 7, v16
    v_mfma_f32_32x32x16_bf16 a[160:175], v[48:51], v[48:51], a[96:111]
    v_add_u32 v16, s40, v16
    v_bfe_u32 v17, v1, 3, 1
    v_lshlrev_b32 v17, 6, v17
    v_bfe_u32 v18, v1, 4, 1
    v_lshlrev_b32 v18, 5, v18
    v_mfma_f32_32x32x16_bf16 a[176:191], v[48:51], v[48:51], a[96:111]
    v_and_b32 v19, 3, v1
    v_lshl_add_u32 v19, v19, 3, v18
    v_and_b32 v20, 1, v1
    v_lshl_add_u32 v20, v20, 4, v18
    v_bfe_u32 v21, v1, 1, 1
    v_lshl_add_u32 v20, v21, 3, v20
    v_mfma_f32_32x32x16_bf16 a[192:207], v[48:51], v[48:51], a[96:111]
    v_add_u32 v14, v16, v17
    v_xor_b32 v17, 64, v17
    v_add_u32 v15, v16, v17
    s_cmp_lt_u32 s56, 20
    s_cselect_b64 vcc, -1, 0
    v_lshlrev_b32 v21, 3, v1
    v_lshlrev_b32 v22, 4, v1
    v_mfma_f32_32x32x16_bf16 a[208:223], v[48:51], v[48:51], a[96:111]
    v_cndmask_b32 v19, v19, v20, vcc
    v_add_u32 v14, v14, v19
    v_add_u32 v15, v15, v19
    s_waitcnt lgkmcnt(0)
    s_mul_i32 s24, s24, 0x9e3779b1
    s_add_u32 s24, s24, 0x7f4a7c15
    s_lshl_b32 s32, s25, 4
    s_add_u32 s32, s32, s26
    s_lshl_b32 s33, s28, 5
    s_add_u32 s33, s33, s27
    s_add_u32 s33, s33, 255
    v_mov_b32 v3, s33
    v_mov_b32 v30, s32
    v_cmp_gt_u32 vcc, 8, v1
    s_not_b32 s32, s24
    s_nop 0
    v_cndmask_b32 v3, v3, v30, vcc
    v_lshl_add_u32 v30, v3, 7, v22
    v_cmp_gt_u32 vcc, 16, v31
    v_mov_b32 v3, 0x80000000
    s_nop 0
    v_cndmask_b32 v30, v3, v30, vcc
    v_mov_b32 v120, s32
    v_mov_b32 v121, s32
    v_mov_b32 v122, s32
    v_mov_b32 v123, s32
    buffer_load_dwordx4 v[32:35], v7, s[4:7], s57 offen
    buffer_load_dwordx4 v[36:39], v7, s[4:7], s57 offen offset:512
    buffer_load_dwordx2 v[40:41], v6, s[4:7], s57 offen offset:1024
    s_add_u32 m0, s46, 32768
    s_add_u32 s47, s45, s44
    buffer_load_dwordx4 v9, s[4:7], s47 offen lds
    buffer_load_dwordx4 v10, s[4:7], s47 offen offset:1024 lds
    s_add_u32 m0, s48, 32768
    s_nop 0
    buffer_load_dwordx4 v11, s[8:11], s41 offen lds
    buffer_load_dwordx4 v12, s[8:11], s41 offen offset:1024 lds
    s_add_u32 m0, s46, 34816
    s_add_u32 s47, s47, 20480
    buffer_load_dwordx4 v9, s[4:7], s47 offen lds
    buffer_load_dwordx4 v10, s[4:7], s47 offen offset:1024 lds
    s_add_u32 s44, s44, 128
    s_cmp_eq_u32 s44, 1280
    s_cselect_b32 s44, 0, s44
    s_add_u32 m0, s48, 34816
    s_add_u32 s41, s41, 61440
    buffer_load_dwordx4 v11, s[8:11], s41 offen lds
    buffer_load_dwordx4 v12, s[8:11], s41 offen offset:1024 lds
    s_add_u32 s41, s41, 184320
    s_cmp_eq_u32 s41, 2457600
    s_cselect_b32 s41, 0, s41
    s_cmp_ge_u32 s26, 10
    s_cbranch_scc1 L_p1_c
    s_waitcnt vmcnt(11)
    s_barrier
    ds_read_b128 v[128:131], v24 offset:0
    ds_read_b128 v[132:135], v24 offset:4096
    ds_read_b64_tr_b16 v[136:137], v14 offset:0
    ds_read_b64_tr_b16 v[138:139], v14 offset:512
    ds_read_b64_tr_b16 v[140:141], v15 offset:0
    ds_read_b64_tr_b16 v[142:143], v15 offset:512
    s_waitcnt lgkmcnt(0)
    v_mfma_f32_32x32x16_bf16 v[192:207], v[136:139], v[128:131], 0
    ds_read_b128 v[144:147], v25 offset:0
    ds_read_b64_tr_b16 v[152:153], v14 offset:2048
    ds_read_b64_tr_b16 v[154:155], v14 offset:2560
    v_mfma_f32_32x32x16_bf16 v[208:223], v[140:143], v[128:131], 0
    ds_read_b64_tr_b16 v[156:157], v15 offset:2048
    ds_read_b64_tr_b16 v[158:159], v15 offset:2560
    ds_read_b128 v[148:151], v25 offset:4096
    v_mfma_f32_32x32x16_bf16 v[224:239], v[136:139], v[132:135], 0
    s_add_u32 m0, s46, 65536
    s_add_u32 s47, s45, s44
    buffer_load_dwordx4 v9, s[4:7], s47 offen lds
    buffer_load_dwordx4 v10, s[4:7], s47 offen offset:1024 lds
    s_waitcnt vmcnt(10)
    v_dot2_f32_bf16 v48, v32, v44, 0
    v_dot2_f32_bf16 v49, v32, v32, 0
    v_dot2_f32_bf16 v48, v33, v44, v48
    v_dot2_f32_bf16 v49, v33, v33, v49
    v_dot2_f32_bf16 v48, v34, v44, v48
    v_dot2_f32_bf16 v49, v34, v34, v49
    v_dot2_f32_bf16 v48, v35, v44, v48
    v_dot2_f32_bf16 v49, v35, v35, v49
    v_mfma_f32_32x32x16_bf16 v[240:255], v[140:143], v[132:135], 0
    s_add_u32 m0, s48, 65536
    s_nop 0
    buffer_load_dwordx4 v11, s[8:11], s41 offen lds
    buffer_load_dwordx4 v12, s[8:11], s41 offen offset:1024 lds
    v_dot2_f32_bf16 v48, v36, v44, v48
    v_dot2_f32_bf16 v49, v36, v36, v49
    v_dot2_f32_bf16 v48, v37, v44, v48
    v_dot2_f32_bf16 v49, v37, v37, v49
    v_dot2_f32_bf16 v48, v38, v44, v48
    v_dot2_f32_bf16 v49, v38, v38, v49
    v_dot2_f32_bf16 v48, v39, v44, v48
    v_dot2_f32_bf16 v49, v39, v39, v49
    s_waitcnt lgkmcnt(0)
    v_mfma_f32_32x32x16_bf16 v[192:207], v[152:155], v[144:147], v[192:207]
    ds_read_b128 v[128:131], v26 offset:0
    ds_read_b64_tr_b16 v[136:137], v14 offset:4096
    ds_read_b64_tr_b16 v[138:139], v14 offset:4608
    v_mfma_f32_32x32x16_bf16 v[208:223], v[156:159], v[144:147], v[208:223]
    ds_read_b64_tr_b16 v[140:141], v15 offset:4096
    ds_read_b64_tr_b16 v[142:143], v15 offset:4608
    ds_read_b128 v[132:135], v26 offset:4096
    v_mfma_f32_32x32x16_bf16 v[224:239], v[152:155], v[148:151], v[224:239]
    s_add_u32 m0, s46, 67584
    s_add_u32 s47, s47, 20480
    buffer_load_dwordx4 v9, s[4:7], s47 offen lds
    v_dot2_f32_bf16 v48, v40, v44, v48
    v_dot2_f32_bf16 v49, v40, v40, v49
    v_dot2_f32_bf16 v48, v41, v44, v48
    v_dot2_f32_bf16 v49, v41, v41, v49
    s_nop 1
    v_add_f32_dpp v48, v48, v48 quad_perm:[1,0,3,2] row_mask:0xf bank_mask:0xf
    v_add_f32_dpp v49, v49, v49 quad_perm:[1,0,3,2] row_mask:0xf bank_mask:0xf
    s_nop 0
    v_add_f32_dpp v48, v48, v48 quad_perm:[2,3,0,1] row_mask:0xf bank_mask:0xf
    v_add_f32_dpp v49, v49, v49 quad_perm:[2,3,0,1] row_mask:0xf bank_mask:0xf
    v_mfma_f32_32x32x16_bf16 v[240:255], v[156:159], v[148:151], v[240:255]
    buffer_load_dwordx4 v10, s[4:7], s47 offen offset:1024 lds
    s_add_u32 s44, s44, 128
    s_cmp_eq_u32 s44, 1280
    s_cselect_b32 s44, 0, s44
    v_add_f32_dpp v48, v48, v48 row_half_mirror row_mask:0xf bank_mask:0xf
    v_add_f32_dpp v49, v49, v49 row_half_mirror row_mask:0xf bank_mask:0xf
    s_nop 0
    v_add_f32_dpp v48, v48, v48 row_mirror row_mask:0xf bank_mask:0xf
    v_add_f32_dpp v49, v49, v49 row_mirror row_mask:0xf bank_mask:0xf
    v_mov_b32 v50, v48
    v_mov_b32 v51, v49
    s_nop 0
    v_permlane16_swap_b32 v48, v50
    v_permlane16_swap_b32 v49, v51
    s_waitcnt lgkmcnt(0)
    v_mfma_f32_32x32x16_bf16 v[192:207], v[136:139], v[128:131], v[192:207]
    ds_read_b128 v[144:147], v27 offset:0
    ds_read_b64_tr_b16 v[152:153], v14 offset:6144
    ds_read_b64_tr_b16 v[154:155], v14 offset:6656
    v_mfma_f32_32x32x16_bf16 v[208:223], v[140:143], v[128:131], v[208:223]
    ds_read_b64_tr_b16 v[156:157], v15 offset:6144
    ds_read_b64_tr_b16 v[158:159], v15 offset:6656
    ds_read_b128 v[148:151], v27 offset:4096
    v_mfma_f32_32x32x16_bf16 v[224:239], v[136:139], v[132:135], v[224:239]
    s_add_u32 m0, s48, 67584
    s_add_u32 s41, s41, 61440
    buffer_load_dwordx4 v11, s[8:11], s41 offen lds
    v_add_f32 v48, v48, v50
    v_add_f32 v49, v49, v51
    v_mul_f32 v50, 0x3acccccd, v48
    v_mul_f32 v49, 0x3acccccd, v49
    v_fma_f32 v49, -v50, v50, v49
    v_max_f32 v49, 0, v49
    v_add_f32 v49, 0x3727c5ac, v49
    v_rsq_f32 v48, v49
    v_mfma_f32_32x32x16_bf16 v[240:255], v[140:143], v[132:135], v[240:255]
    buffer_load_dwordx4 v12, s[8:11], s41 offen offset:1024 lds
    s_add_u32 s41, s41, 184320
    s_cmp_eq_u32 s41, 2457600
    s_cselect_b32 s41, 0, s41
    v_mov_b32 v49, s24
    v_mov_b32 v51, s24
    v_mul_f32 v50, -v50, v48
    v_lshrrev_b32 v3, 1, v1
    s_mov_b32 exec_lo, 1
    s_mov_b32 exec_hi, 1
    buffer_store_dwordx4 v[48:51], v3, s[12:15], s53 offen sc1
    s_mov_b64 exec, -1
    s_waitcnt vmcnt(9) lgkmcnt(0)
    s_barrier
    v_mfma_f32_32x32x16_bf16 v[192:207], v[152:155], v[144:147], v[192:207]
    ds_read_b128 v[128:131], v24 offset:32768
    ds_read_b64_tr_b16 v[136:137], v14 offset:32768
    ds_read_b64_tr_b16 v[138:139], v14 offset:33280
    v_mfma_f32_32x32x16_bf16 v[208:223], v[156:159], v[144:147], v[208:223]
    ds_read_b64_tr_b16 v[140:141], v15 offset:32768
    ds_read_b64_tr_b16 v[142:143], v15 offset:33280
    ds_read_b128 v[132:135], v24 offset:36864
    v_mfma_f32_32x32x16_bf16 v[224:239], v[152:155], v[148:151], v[224:239]
    s_add_u32 m0, s46, 98304
    s_add_u32 s47, s45, s44
    buffer_load_dwordx4 v9, s[4:7], s47 offen lds
    v_mfma_f32_32x32x16_bf16 v[240:255], v[156:159], v[148:151], v[240:255]
    buffer_load_dwordx4 v10, s[4:7], s47 offen offset:1024 lds
    s_waitcnt lgkmcnt(0)
    v_mfma_f32_32x32x16_bf16 v[192:207], v[136:139], v[128:131], v[192:207]
    ds_read_b128 v[144:147], v25 offset:32768
    ds_read_b64_tr_b16 v[152:153], v14 offset:34816
    ds_read_b64_tr_b16 v[154:155], v14 offset:35328
    v_mfma_f32_32x32x16_bf16 v[208:223], v[140:143], v[128:131], v[208:223]
    ds_read_b64_tr_b16 v[156:157], v15 offset:34816
    ds_read_b64_tr_b16 v[158:159], v15 offset:35328
    ds_read_b128 v[148:151], v25 offset:36864
    v_mfma_f32_32x32x16_bf16 v[224:239], v[136:139], v[132:135], v[224:239]
    s_add_u32 m0, s48, 98304
    s_nop 0
    buffer_load_dwordx4 v11, s[8:11], s41 offen lds
    v_mfma_f32_32x32x16_bf16 v[240:255], v[140:143], v[132:135], v[240:255]
    buffer_load_dwordx4 v12, s[8:11], s41 offen offset:1024 lds
    s_waitcnt lgkmcnt(0)
    v_mfma_f32_32x32x16_bf16 v[192:207], v[152:155], v[144:147], v[192:207]
    ds_read_b128 v[128:131], v26 offset:32768
    ds_read_b64_tr_b16 v[136:137], v14 offset:36864
    ds_read_b64_tr_b16 v[138:139], v14 offset:37376
    v_mfma_f32_32x32x16_bf16 v[208:223], v[156:159], v[144:147], v[208:223]
    ds_read_b64_tr_b16 v[140:141], v15 offset:36864
    ds_read_b64_tr_b16 v[142:143], v15 offset:37376
    ds_read_b128 v[132:135], v26 offset:36864
    v_mfma_f32_32x32x16_bf16 v[224:239], v[152:155], v[148:151], v[224:239]
    s_add_u32 m0, s46, 100352
    s_add_u32 s47, s47, 20480
    buffer_load_dwordx4 v9, s[4:7], s47 offen lds
    v_mfma_f32_32x32x16_bf16 v[240:255], v[156:159], v[148:151], v[240:255]
    buffer_load_dwordx4 v10, s[4:7], s47 offen offset:1024 lds
    s_add_u32 s44, s44, 128
    s_cmp_eq_u32 s44, 1280
    s_cselect_b32 s44, 0, s44
    s_waitcnt lgkmcnt(0)
    v_mfma_f32_32x32x16_bf16 v[192:207], v[136:139], v[128:131], v[192:207]
    ds_read_b128 v[144:147], v27 offset:32768
    ds_read_b64_tr_b16 v[152:153], v14 offset:38912
    ds_read_b64_tr_b16 v[154:155], v14 offset:39424
    v_mfma_f32_32x32x16_bf16 v[208:223], v[140:143], v[128:131], v[208:223]
    ds_read_b64_tr_b16 v[156:157], v15 offset:38912
    ds_read_b64_tr_b16 v[158:159], v15 offset:39424
    ds_read_b128 v[148:151], v27 offset:36864
    v_mfma_f32_32x32x16_bf16 v[224:239], v[136:139], v[132:135], v[224:239]
    s_add_u32 m0, s48, 100352
    s_add_u32 s41, s41, 61440
    buffer_load_dwordx4 v11, s[8:11], s41 offen lds
    v_mfma_f32_32x32x16_bf16 v[240:255], v[140:143], v[132:135], v[240:255]
    buffer_load_dwordx4 v12, s[8:11], s41 offen offset:1024 lds
    s_add_u32 s41, s41, 184320
    s_cmp_eq_u32 s41, 2457600
    s_cselect_b32 s41, 0, s41
    s_waitcnt vmcnt(9) lgkmcnt(0)
    s_barrier
    v_mfma_f32_32x32x16_bf16 v[192:207], v[152:155], v[144:147], v[192:207]
    v_xor_b32 v24, 0x10000, v24
    v_xor_b32 v14, 0x10000, v14
    v_xor_b32 v15, 0x10000, v15
    ds_read_b128 v[128:131], v24 offset:0
    ds_read_b64_tr_b16 v[136:137], v14 offset:0
    ds_read_b64_tr_b16 v[138:139], v14 offset:512
    v_mfma_f32_32x32x16_bf16 v[208:223], v[156:159], v[144:147], v[208:223]
    ds_read_b64_tr_b16 v[140:141], v15 offset:0
    ds_read_b64_tr_b16 v[142:143], v15 offset:512
    ds_read_b128 v[132:135], v24 offset:4096
    v_mfma_f32_32x32x16_bf16 v[224:239], v[152:155], v[148:151], v[224:239]
    s_add_u32 m0, s46, 0
    s_add_u32 s47, s45, s44
    buffer_load_dwordx4 v9, s[4:7], s47 offen lds
    v_mfma_f32_32x32x16_bf16 v[240:255], v[156:159], v[148:151], v[240:255]
    buffer_load_dwordx4 v10, s[4:7], s47 offen offset:1024 lds
    s_waitcnt lgkmcnt(0)
    v_mfma_f32_32x32x16_bf16 v[192:207], v[136:139], v[128:131], v[192:207]
    v_xor_b32 v25, 0x10000, v25
    ds_read_b128 v[144:147], v25 offset:0
    ds_read_b64_tr_b16 v[152:153], v14 offset:2048
    ds_read_b64_tr_b16 v[154:155], v14 offset:2560
    v_mfma_f32_32x32x16_bf16 v[208:223], v[140:143], v[128:131], v[208:223]
    ds_read_b64_tr_b16 v[156:157], v15 offset:2048
    ds_read_b64_tr_b16 v[158:159], v15 offset:2560
    ds_read_b128 v[148:151], v25 offset:4096
    v_mfma_f32_32x32x16_bf16 v[224:239], v[136:139], v[132:135], v[224:239]
    s_add_u32 m0, s48, 0
    s_nop 0
    buffer_load_dwordx4 v11, s[8:11], s41 offen lds
    v_mfma_f32_32x32x16_bf16 v[240:255], v[140:143], v[132:135], v[240:255]
    buffer_load_dwordx4 v12, s[8:11], s41 offen offset:1024 lds
    s_waitcnt lgkmcnt(0)
    v_mfma_f32_32x32x16_bf16 v[192:207], v[152:155], v[144:147], v[192:207]
    v_xor_b32 v26, 0x10000, v26
    ds_read_b128 v[128:131], v26 offset:0
    ds_read_b64_tr_b16 v[136:137], v14 offset:4096
    ds_read_b64_tr_b16 v[138:139], v14 offset:4608
    v_mfma_f32_32x32x16_bf16 v[208:223], v[156:159], v[144:147], v[208:223]
    ds_read_b64_tr_b16 v[140:141], v15 offset:4096
    ds_read_b64_tr_b16 v[142:143], v15 offset:4608
    ds_read_b128 v[132:135], v26 offset:4096
    v_mfma_f32_32x32x16_bf16 v[224:239], v[152:155], v[148:151], v[224:239]
    s_add_u32 m0, s46, 2048
    s_add_u32 s47, s47, 20480
    buffer_load_dwordx4 v9, s[4:7], s47 offen lds
    v_mfma_f32_32x32x16_bf16 v[240:255], v[156:159], v[148:151], v[240:255]
    buffer_load_dwordx4 v10, s[4:7], s47 offen offset:1024 lds
    s_add_u32 s44, s44, 128
    s_cmp_eq_u32 s44, 1280
    s_cselect_b32 s44, 0, s44
    s_waitcnt lgkmcnt(0)
    v_mfma_f32_32x32x16_bf16 v[192:207], v[136:139], v[128:131], v[192:207]
    v_xor_b32 v27, 0x10000, v27
    ds_read_b128 v[144:147], v27 offset:0
    ds_read_b64_tr_b16 v[152:153], v14 offset:6144
    ds_read_b64_tr_b16 v[154:155], v14 offset:6656
    v_mfma_f32_32x32x16_bf16 v[208:223], v[140:143], v[128:131], v[208:223]
    ds_read_b64_tr_b16 v[156:157], v15 offset:6144
    ds_read_b64_tr_b16 v[158:159], v15 offset:6656
    ds_read_b128 v[148:151], v27 offset:4096
    v_mfma_f32_32x32x16_bf16 v[224:239], v[136:139], v[132:135], v[224:239]
    s_add_u32 m0, s48, 2048
    s_add_u32 s41, s41, 61440
    buffer_load_dwordx4 v11, s[8:11], s41 offen lds
    v_mfma_f32_32x32x16_bf16 v[240:255], v[140:143], v[132:135], v[240:255]
    buffer_load_dwordx4 v12, s[8:11], s41 offen offset:1024 lds
    s_add_u32 s41, s41, 184320
    s_cmp_eq_u32 s41, 2457600
    s_cselect_b32 s41, 0, s41
    s_waitcnt vmcnt(8) lgkmcnt(0)
    s_barrier
    v_mfma_f32_32x32x16_bf16 v[192:207], v[152:155], v[144:147], v[192:207]
    ds_read_b128 v[128:131], v24 offset:32768
    ds_read_b64_tr_b16 v[136:137], v14 offset:32768
    ds_read_b64_tr_b16 v[138:139], v14 offset:33280
    v_mfma_f32_32x32x16_bf16 v[208:223], v[156:159], v[144:147], v[208:223]
    ds_read_b64_tr_b16 v[140:141], v15 offset:32768
    ds_read_b64_tr_b16 v[142:143], v15 offset:33280
    ds_read_b128 v[132:135], v24 offset:36864
    v_mfma_f32_32x32x16_bf16 v[224:239], v[152:155], v[148:151], v[224:239]
    s_add_u32 m0, s46, 32768
    s_add_u32 s47, s45, s44
    buffer_load_dwordx4 v9, s[4:7], s47 offen lds
    v_mfma_f32_32x32x16_bf16 v[240:255], v[156:159], v[148:151], v[240:255]
    buffer_load_dwordx4 v10, s[4:7], s47 offen offset:1024 lds
    s_waitcnt lgkmcnt(0)
    v_mfma_f32_32x32x16_bf16 v[192:207], v[136:139], v[128:131], v[192:207]
    ds_read_b128 v[144:147], v25 offset:32768
    ds_read_b64_tr_b16 v[152:153], v14 offset:34816
    ds_read_b64_tr_b16 v[154:155], v14 offset:35328
    v_mfma_f32_32x32x16_bf16 v[208:223], v[140:143], v[128:131], v[208:223]
    ds_read_b64_tr_b16 v[156:157], v15 offset:34816
    ds_read_b64_tr_b16 v[158:159], v15 offset:35328
    ds_read_b128 v[148:151], v25 offset:36864
    v_mfma_f32_32x32x16_bf16 v[224:239], v[136:139], v[132:135], v[224:239]
    s_add_u32 m0, s48, 32768
    s_nop 0
    buffer_load_dwordx4 v11, s[8:11], s41 offen lds
    v_mfma_f32_32x32x16_bf16 v[240:255], v[140:143], v[132:135], v[240:255]
    buffer_load_dwordx4 v12, s[8:11], s41 offen offset:1024 lds
    s_waitcnt lgkmcnt(0)
    v_mfma_f32_32x32x16_bf16 v[192:207], v[152:155], v[144:147], v[192:207]
    ds_read_b128 v[128:131], v26 offset:32768
    ds_read_b64_tr_b16 v[136:137], v14 offset:36864
    ds_read_b64_tr_b16 v[138:139], v14 offset:37376
    v_mfma_f32_32x32x16_bf16 v[208:223], v[156:159], v[144:147], v[208:223]
    ds_read_b64_tr_b16 v[140:141], v15 offset:36864
    ds_read_b64_tr_b16 v[142:143], v15 offset:37376
    ds_read_b128 v[132:135], v26 offset:36864
    v_mfma_f32_32x32x16_bf16 v[224:239], v[152:155], v[148:151], v[224:239]
    s_add_u32 m0, s46, 34816
    s_add_u32 s47, s47, 20480
    buffer_load_dwordx4 v9, s[4:7], s47 offen lds
    v_mfma_f32_32x32x16_bf16 v[240:255], v[156:159], v[148:151], v[240:255]
    buffer_load_dwordx4 v10, s[4:7], s47 offen offset:1024 lds
    s_add_u32 s44, s44, 128
    s_cmp_eq_u32 s44, 1280
    s_cselect_b32 s44, 0, s44
    s_waitcnt lgkmcnt(0)
    v_mfma_f32_32x32x16_bf16 v[192:207], v[136:139], v[128:131], v[192:207]
    ds_read_b128 v[144:147], v27 offset:32768
    ds_read_b64_tr_b16 v[152:153], v14 offset:38912
    ds_read_b64_tr_b16 v[154:155], v14 offset:39424
    v_mfma_f32_32x32x16_bf16 v[208:223], v[140:143], v[128:131], v[208:223]
    ds_read_b64_tr_b16 v[156:157], v15 offset:38912
    ds_read_b64_tr_b16 v[158:159], v15 offset:39424
    ds_read_b128 v[148:151], v27 offset:36864
    v_mfma_f32_32x32x16_bf16 v[224:239], v[136:139], v[132:135], v[224:239]
    s_add_u32 m0, s48, 34816
    s_add_u32 s41, s41, 61440
    buffer_load_dwordx4 v11, s[8:11], s41 offen lds
    buffer_load_dwordx4 v12, s[8:11], s41 offen offset:1024 lds
    s_add_u32 s41, s41, 184320
    s_cmp_eq_u32 s41, 2457600
    s_cselect_b32 s41, 0, s41
    v_mfma_f32_32x32x16_bf16 v[240:255], v[140:143], v[132:135], v[240:255]
    s_mov_b32 s33, 4096
    buffer_store_dwordx4 v[120:123], v30, s[12:15], s33 offen sc1
    s_waitcnt vmcnt(9) lgkmcnt(0)
    s_barrier
    v_mfma_f32_32x32x16_bf16 v[192:207], v[152:155], v[144:147], v[192:207]
    v_xor_b32 v24, 0x10000, v24
    v_xor_b32 v14, 0x10000, v14
    v_xor_b32 v15, 0x10000, v15
    ds_read_b128 v[128:131], v24 offset:0
    ds_read_b64_tr_b16 v[136:137], v14 offset:0
    ds_read_b64_tr_b16 v[138:139], v14 offset:512
    v_mfma_f32_32x32x16_bf16 v[208:223], v[156:159], v[144:147], v[208:223]
    ds_read_b64_tr_b16 v[140:141], v15 offset:0
    ds_read_b64_tr_b16 v[142:143], v15 offset:512
    ds_read_b128 v[132:135], v24 offset:4096
    v_mfma_f32_32x32x16_bf16 v[224:239], v[152:155], v[148:151], v[224:239]
    s_add_u32 m0, s46, 65536
    s_add_u32 s47, s45, s44
    buffer_load_dwordx4 v9, s[4:7], s47 offen lds
    v_mfma_f32_32x32x16_bf16 v[240:255], v[156:159], v[148:151], v[240:255]
    buffer_load_dwordx4 v10, s[4:7], s47 offen offset:1024 lds
    s_waitcnt lgkmcnt(0)
    v_mfma_f32_32x32x16_bf16 v[192:207], v[136:139], v[128:131], v[192:207]
    v_xor_b32 v25, 0x10000, v25
    ds_read_b128 v[144:147], v25 offset:0
    ds_read_b64_tr_b16 v[152:153], v14 offset:2048
    ds_read_b64_tr_b16 v[154:155], v14 offset:2560
    v_mfma_f32_32x32x16_bf16 v[208:223], v[140:143], v[128:131], v[208:223]
    ds_read_b64_tr_b16 v[156:157], v15 offset:2048
    ds_read_b64_tr_b16 v[158:159], v15 offset:2560
    ds_read_b128 v[148:151], v25 offset:4096
    v_mfma_f32_32x32x16_bf16 v[224:239], v[136:139], v[132:135], v[224:239]
    s_add_u32 m0, s48, 65536
    s_nop 0
    buffer_load_dwordx4 v11, s[8:11], s41 offen lds
    v_mfma_f32_32x32x16_bf16 v[240:255], v[140:143], v[132:135], v[240:255]
    buffer_load_dwordx4 v12, s[8:11], s41 offen offset:1024 lds
    s_waitcnt lgkmcnt(0)
    v_mfma_f32_32x32x16_bf16 v[192:207], v[152:155], v[144:147], v[192:207]
    v_xor_b32 v26, 0x10000, v26
    ds_read_b128 v[128:131], v26 offset:0
    ds_read_b64_tr_b16 v[136:137], v14 offset:4096
    ds_read_b64_tr_b16 v[138:139], v14 offset:4608
    v_mfma_f32_32x32x16_bf16 v[208:223], v[156:159], v[144:147], v[208:223]
    ds_read_b64_tr_b16 v[140:141], v15 offset:4096
    ds_read_b64_tr_b16 v[142:143], v15 offset:4608
    ds_read_b128 v[132:135], v26 offset:4096
    v_mfma_f32_32x32x16_bf16 v[224:239], v[152:155], v[148:151], v[224:239]
    s_add_u32 m0, s46, 67584
    s_add_u32 s47, s47, 20480
    buffer_load_dwordx4 v9, s[4:7], s47 offen lds
    v_mfma_f32_32x32x16_bf16 v[240:255], v[156:159], v[148:151], v[240:255]
    buffer_load_dwordx4 v10, s[4:7], s47 offen offset:1024 lds
    s_add_u32 s44, s44, 128
    s_cmp_eq_u32 s44, 1280
    s_cselect_b32 s44, 0, s44
    s_waitcnt lgkmcnt(0)
    v_mfma_f32_32x32x16_bf16 v[192:207], v[136:139], v[128:131], v[192:207]
    v_xor_b32 v27, 0x10000, v27
    ds_read_b128 v[144:147], v27 offset:0
    ds_read_b64_tr_b16 v[152:153], v14 offset:6144
    ds_read_b64_tr_b16 v[154:155], v14 offset:6656
    v_mfma_f32_32x32x16_bf16 v[208:223], v[140:143], v[128:131], v[208:223]
    ds_read_b64_tr_b16 v[156:157], v15 offset:6144
    ds_read_b64_tr_b16 v[158:159], v15 offset:6656
    ds_read_b128 v[148:151], v27 offset:4096
    v_mfma_f32_32x32x16_bf16 v[224:239], v[136:139], v[132:135], v[224:239]
    s_add_u32 m0, s48, 67584
    s_add_u32 s41, s41, 61440
    buffer_load_dwordx4 v11, s[8:11], s41 offen lds
    v_mfma_f32_32x32x16_bf16 v[240:255], v[140:143], v[132:135], v[240:255]
    buffer_load_dwordx4 v12, s[8:11], s41 offen offset:1024 lds
    s_add_u32 s41, s41, 184320
    s_cmp_eq_u32 s41, 2457600
    s_cselect_b32 s41, 0, s41
    s_waitcnt vmcnt(9) lgkmcnt(0)
    s_barrier
    v_mfma_f32_32x32x16_bf16 v[192:207], v[152:155], v[144:147], v[192:207]
    ds_read_b128 v[128:131], v24 offset:32768
    ds_read_b64_tr_b16 v[136:137], v14 offset:32768
    ds_read_b64_tr_b16 v[138:139], v14 offset:33280
    v_mfma_f32_32x32x16_bf16 v[208:223], v[156:159], v[144:147], v[208:223]
    ds_read_b64_tr_b16 v[140:141], v15 offset:32768
    ds_read_b64_tr_b16 v[142:143], v15 offset:33280
    ds_read_b128 v[132:135], v24 offset:36864
    v_mfma_f32_32x32x16_bf16 v[224:239], v[152:155], v[148:151], v[224:239]
    s_add_u32 m0, s46, 98304
    s_add_u32 s47, s45, s44
    buffer_load_dwordx4 v9, s[4:7], s47 offen lds
    v_mfma_f32_32x32x16_bf16 v[240:255], v[156:159], v[148:151], v[240:255]
    buffer_load_dwordx4 v10, s[4:7], s47 offen offset:1024 lds
    s_waitcnt lgkmcnt(0)
    v_mfma_f32_32x32x16_bf16 v[192:207], v[136:139], v[128:131], v[192:207]
    ds_read_b128 v[144:147], v25 offset:32768
    ds_read_b64_tr_b16 v[152:153], v14 offset:34816
    ds_read_b64_tr_b16 v[154:155], v14 offset:35328
    v_mfma_f32_32x32x16_bf16 v[208:223], v[140:143], v[128:131], v[208:223]
    ds_read_b64_tr_b16 v[156:157], v15 offset:34816
    ds_read_b64_tr_b16 v[158:159], v15 offset:35328
    ds_read_b128 v[148:151], v25 offset:36864
    v_mfma_f32_32x32x16_bf16 v[224:239], v[136:139], v[132:135], v[224:239]
    s_add_u32 m0, s48, 98304
    s_nop 0
    buffer_load_dwordx4 v11, s[8:11], s41 offen lds
    v_mfma_f32_32x32x16_bf16 v[240:255], v[140:143], v[132:135], v[240:255]
    buffer_load_dwordx4 v12, s[8:11], s41 offen offset:1024 lds
    s_waitcnt lgkmcnt(0)
    v_mfma_f32_32x32x16_bf16 v[192:207], v[152:155], v[144:147], v[192:207]
    ds_read_b128 v[128:131], v26 offset:32768
    ds_read_b64_tr_b16 v[136:137], v14 offset:36864
    ds_read_b64_tr_b16 v[138:139], v14 offset:37376
    v_mfma_f32_32x32x16_bf16 v[208:223], v[156:159], v[144:147], v[208:223]
    ds_read_b64_tr_b16 v[140:141], v15 offset:36864
    ds_read_b64_tr_b16 v[142:143], v15 offset:37376
    ds_read_b128 v[132:135], v26 offset:36864
    v_mfma_f32_32x32x16_bf16 v[224:239], v[152:155], v[148:151], v[224:239]
    s_add_u32 m0, s46, 100352
    s_add_u32 s47, s47, 20480
    buffer_load_dwordx4 v9, s[4:7], s47 offen lds
    v_mfma_f32_32x32x16_bf16 v[240:255], v[156:159], v[148:151], v[240:255]
    buffer_load_dwordx4 v10, s[4:7], s47 offen offset:1024 lds
    s_add_u32 s44, s44, 128
    s_cmp_eq_u32 s44, 1280
    s_cselect_b32 s44, 0, s44
    s_waitcnt lgkmcnt(0)
    v_mfma_f32_32x32x16_bf16 v[192:207], v[136:139], v[128:131], v[192:207]
    ds_read_b128 v[144:147], v27 offset:32768
    ds_read_b64_tr_b16 v[152:153], v14 offset:38912
    ds_read_b64_tr_b16 v[154:155], v14 offset:39424
    v_mfma_f32_32x32x16_bf16 v[208:223], v[140:143], v[128:131], v[208:223]
    ds_read_b64_tr_b16 v[156:157], v15 offset:38912
    ds_read_b64_tr_b16 v[158:159], v15 offset:39424
    ds_read_b128 v[148:151], v27 offset:36864
    v_mfma_f32_32x32x16_bf16 v[224:239], v[136:139], v[132:135], v[224:239]
    s_add_u32 m0, s48, 100352
    s_add_u32 s41, s41, 61440
    buffer_load_dwordx4 v11, s[8:11], s41 offen lds
    v_mfma_f32_32x32x16_bf16 v[240:255], v[140:143], v[132:135], v[240:255]
    buffer_load_dwordx4 v12, s[8:11], s41 offen offset:1024 lds
    s_add_u32 s41, s41, 184320
    s_cmp_eq_u32 s41, 2457600
    s_cselect_b32 s41, 0, s41
    s_waitcnt vmcnt(8) lgkmcnt(0)
    s_barrier
    v_mfma_f32_32x32x16_bf16 v[192:207], v[152:155], v[144:147], v[192:207]
    v_xor_b32 v24, 0x10000, v24
    v_xor_b32 v14, 0x10000, v14
    v_xor_b32 v15, 0x10000, v15
    ds_read_b128 v[128:131], v24 offset:0
    ds_read_b64_tr_b16 v[136:137], v14 offset:0
    ds_read_b64_tr_b16 v[138:139], v14 offset:512
    v_mfma_f32_32x32x16_bf16 v[208:223], v[156:159], v[144:147], v[208:223]
    ds_read_b64_tr_b16 v[140:141], v15 offset:0
    ds_read_b64_tr_b16 v[142:143], v15 offset:512
    ds_read_b128 v[132:135], v24 offset:4096
    v_mfma_f32_32x32x16_bf16 v[224:239], v[152:155], v[148:151], v[224:239]
    s_add_u32 m0, s46, 0
    s_add_u32 s47, s45, s44
    buffer_load_dwordx4 v9, s[4:7], s47 offen lds
    v_mfma_f32_32x32x16_bf16 v[240:255], v[156:159], v[148:151], v[240:255]
    buffer_load_dwordx4 v10, s[4:7], s47 offen offset:1024 lds
    s_waitcnt lgkmcnt(0)
    v_mfma_f32_32x32x16_bf16 v[192:207], v[136:139], v[128:131], v[192:207]
    v_xor_b32 v25, 0x10000, v25
    ds_read_b128 v[144:147], v25 offset:0
    ds_read_b64_tr_b16 v[152:153], v14 offset:2048
    ds_read_b64_tr_b16 v[154:155], v14 offset:2560
    v_mfma_f32_32x32x16_bf16 v[208:223], v[140:143], v[128:131], v[208:223]
    ds_read_b64_tr_b16 v[156:157], v15 offset:2048
    ds_read_b64_tr_b16 v[158:159], v15 offset:2560
    ds_read_b128 v[148:151], v25 offset:4096
    v_mfma_f32_32x32x16_bf16 v[224:239], v[136:139], v[132:135], v[224:239]
    s_add_u32 m0, s48, 0
    s_nop 0
    buffer_load_dwordx4 v11, s[8:11], s41 offen lds
    v_mfma_f32_32x32x16_bf16 v[240:255], v[140:143], v[132:135], v[240:255]
    buffer_load_dwordx4 v12, s[8:11], s41 offen offset:1024 lds
    s_waitcnt lgkmcnt(0)
    v_mfma_f32_32x32x16_bf16 v[192:207], v[152:155], v[144:147], v[192:207]
    v_xor_b32 v26, 0x10000, v26
    ds_read_b128 v[128:131], v26 offset:0
    ds_read_b64_tr_b16 v[136:137], v14 offset:4096
    ds_read_b64_tr_b16 v[138:139], v14 offset:4608
    v_mfma_f32_32x32x16_bf16 v[208:223], v[156:159], v[144:147], v[208:223]
    ds_read_b64_tr_b16 v[140:141], v15 offset:4096
    ds_read_b64_tr_b16 v[142:143], v15 offset:4608
    ds_read_b128 v[132:135], v26 offset:4096
    v_mfma_f32_32x32x16_bf16 v[224:239], v[152:155], v[148:151], v[224:239]
    s_add_u32 m0, s46, 2048
    s_add_u32 s47, s47, 20480
    buffer_load_dwordx4 v9, s[4:7], s47 offen lds
    v_mfma_f32_32x32x16_bf16 v[240:255], v[156:159], v[148:151], v[240:255]
    buffer_load_dwordx4 v10, s[4:7], s47 offen offset:1024 lds
    s_add_u32 s44, s44, 128
    s_cmp_eq_u32 s44, 1280
    s_cselect_b32 s44, 0, s44
    s_waitcnt lgkmcnt(0)
    v_mfma_f32_32x32x16_bf16 v[192:207], v[136:139], v[128:131], v[192:207]
    v_xor_b32 v27, 0x10000, v27
    ds_read_b128 v[144:147], v27 offset:0
    ds_read_b64_tr_b16 v[152:153], v14 offset:6144
    ds_read_b64_tr_b16 v[154:155], v14 offset:6656
    v_mfma_f32_32x32x16_bf16 v[208:223], v[140:143], v[128:131], v[208:223]
    ds_read_b64_tr_b16 v[156:157], v15 offset:6144
    ds_read_b64_tr_b16 v[158:159], v15 offset:6656
    ds_read_b128 v[148:151], v27 offset:4096
    v_mfma_f32_32x32x16_bf16 v[224:239], v[136:139], v[132:135], v[224:239]
    s_add_u32 m0, s48, 2048
    s_add_u32 s41, s41, 61440
    buffer_load_dwordx4 v11, s[8:11], s41 offen lds
    v_mfma_f32_32x32x16_bf16 v[240:255], v[140:143], v[132:135], v[240:255]
    buffer_load_dwordx4 v12, s[8:11], s41 offen offset:1024 lds
    s_add_u32 s41, s41, 184320
    s_cmp_eq_u32 s41, 2457600
    s_cselect_b32 s41, 0, s41
    s_waitcnt vmcnt(8) lgkmcnt(0)
    s_barrier
    v_mfma_f32_32x32x16_bf16 v[192:207], v[152:155], v[144:147], v[192:207]
    ds_read_b128 v[128:131], v24 offset:32768
    ds_read_b64_tr_b16 v[136:137], v14 offset:32768
    ds_read_b64_tr_b16 v[138:139], v14 offset:33280
    v_mfma_f32_32x32x16_bf16 v[208:223], v[156:159], v[144:147], v[208:223]
    ds_read_b64_tr_b16 v[140:141], v15 offset:32768
    ds_read_b64_tr_b16 v[142:143], v15 offset:33280
    ds_read_b128 v[132:135], v24 offset:36864
    v_mfma_f32_32x32x16_bf16 v[224:239], v[152:155], v[148:151], v[224:239]
    s_add_u32 m0, s46, 32768
    s_add_u32 s47, s45, s44
    buffer_load_dwordx4 v9, s[4:7], s47 offen lds
    v_mfma_f32_32x32x16_bf16 v[240:255], v[156:159], v[148:151], v[240:255]
    buffer_load_dwordx4 v10, s[4:7], s47 offen offset:1024 lds
    s_waitcnt lgkmcnt(0)
    v_mfma_f32_32x32x16_bf16 v[192:207], v[136:139], v[128:131], v[192:207]
    ds_read_b128 v[144:147], v25 offset:32768
    ds_read_b64_tr_b16 v[152:153], v14 offset:34816
    ds_read_b64_tr_b16 v[154:155], v14 offset:35328
    v_mfma_f32_32x32x16_bf16 v[208:223], v[140:143], v[128:131], v[208:223]
    ds_read_b64_tr_b16 v[156:157], v15 offset:34816
    ds_read_b64_tr_b16 v[158:159], v15 offset:35328
    ds_read_b128 v[148:151], v25 offset:36864
    v_mfma_f32_32x32x16_bf16 v[224:239], v[136:139], v[132:135], v[224:239]
    s_add_u32 m0, s48, 32768
    s_nop 0
    buffer_load_dwordx4 v11, s[8:11], s41 offen lds
    v_mfma_f32_32x32x16_bf16 v[240:255], v[140:143], v[132:135], v[240:255]
    buffer_load_dwordx4 v12, s[8:11], s41 offen offset:1024 lds
    s_waitcnt lgkmcnt(0)
    v_mfma_f32_32x32x16_bf16 v[192:207], v[152:155], v[144:147], v[192:207]
    ds_read_b128 v[128:131], v26 offset:32768
    ds_read_b64_tr_b16 v[136:137], v14 offset:36864
    ds_read_b64_tr_b16 v[138:139], v14 offset:37376
    v_mfma_f32_32x32x16_bf16 v[208:223], v[156:159], v[144:147], v[208:223]
    ds_read_b64_tr_b16 v[140:141], v15 offset:36864
    ds_read_b64_tr_b16 v[142:143], v15 offset:37376
    ds_read_b128 v[132:135], v26 offset:36864
    v_mfma_f32_32x32x16_bf16 v[224:239], v[152:155], v[148:151], v[224:239]
    s_add_u32 m0, s46, 34816
    s_add_u32 s47, s47, 20480
    buffer_load_dwordx4 v9, s[4:7], s47 offen lds
    v_mfma_f32_32x32x16_bf16 v[240:255], v[156:159], v[148:151], v[240:255]
    buffer_load_dwordx4 v10, s[4:7], s47 offen offset:1024 lds
    s_add_u32 s44, s44, 128
    s_cmp_eq_u32 s44, 1280
    s_cselect_b32 s44, 0, s44
    s_waitcnt lgkmcnt(0)
    v_mfma_f32_32x32x16_bf16 v[192:207], v[136:139], v[128:131], v[192:207]
    ds_read_b128 v[144:147], v27 offset:32768
    ds_read_b64_tr_b16 v[152:153], v14 offset:38912
    ds_read_b64_tr_b16 v[154:155], v14 offset:39424
    v_mfma_f32_32x32x16_bf16 v[208:223], v[140:143], v[128:131], v[208:223]
    ds_read_b64_tr_b16 v[156:157], v15 offset:38912
    ds_read_b64_tr_b16 v[158:159], v15 offset:39424
    ds_read_b128 v[148:151], v27 offset:36864
    v_mfma_f32_32x32x16_bf16 v[224:239], v[136:139], v[132:135], v[224:239]
    s_add_u32 m0, s48, 34816
    s_add_u32 s41, s41, 61440
    buffer_load_dwordx4 v11, s[8:11], s41 offen lds
    buffer_load_dwordx4 v12, s[8:11], s41 offen offset:1024 lds
    s_add_u32 s41, s41, 184320
    s_cmp_eq_u32 s41, 2457600
    s_cselect_b32 s41, 0, s41
    v_mfma_f32_32x32x16_bf16 v[240:255], v[140:143], v[132:135], v[240:255]
    s_lshl_b32 s49, s55, 10
    s_add_u32 s49, s49, 720896
    s_lshl_b32 s51, s25, 1
    s_add_u32 s51, s51, s42
    s_lshl_b32 s50, s51, 10
    s_add_u32 s50, s50, 655360
    buffer_load_dwordx2 v[52:53], v21, s[12:15], s49 offen offset:0 sc1
    buffer_load_dwordx2 v[54:55], v21, s[12:15], s49 offen offset:512 sc1
    buffer_load_dwordx4 v[72:75], v22, s[12:15], s50 offen sc1
    s_waitcnt vmcnt(11) lgkmcnt(0)
    s_barrier
    v_mfma_f32_32x32x16_bf16 v[192:207], v[152:155], v[144:147], v[192:207]
    v_xor_b32 v24, 0x10000, v24
    v_xor_b32 v14, 0x10000, v14
    v_xor_b32 v15, 0x10000, v15
    ds_read_b128 v[128:131], v24 offset:0
    ds_read_b64_tr_b16 v[136:137], v14 offset:0
    ds_read_b64_tr_b16 v[138:139], v14 offset:512
    v_mfma_f32_32x32x16_bf16 v[208:223], v[156:159], v[144:147], v[208:223]
    ds_read_b64_tr_b16 v[140:141], v15 offset:0
    ds_read_b64_tr_b16 v[142:143], v15 offset:512
    ds_read_b128 v[132:135], v24 offset:4096
    v_mfma_f32_32x32x16_bf16 v[224:239], v[152:155], v[148:151], v[224:239]
    v_mfma_f32_32x32x16_bf16 v[240:255], v[156:159], v[148:151], v[240:255]
    s_waitcnt lgkmcnt(0)
    v_mfma_f32_32x32x16_bf16 v[192:207], v[136:139], v[128:131], v[192:207]
    v_xor_b32 v25, 0x10000, v25
    ds_read_b128 v[144:147], v25 offset:0
    ds_read_b64_tr_b16 v[152:153], v14 offset:2048
    ds_read_b64_tr_b16 v[154:155], v14 offset:2560
    v_mfma_f32_32x32x16_bf16 v[208:223], v[140:143], v[128:131], v[208:223]
    ds_read_b64_tr_b16 v[156:157], v15 offset:2048
    ds_read_b64_tr_b16 v[158:159], v15 offset:2560
    ds_read_b128 v[148:151], v25 offset:4096
    v_mfma_f32_32x32x16_bf16 v[224:239], v[136:139], v[132:135], v[224:239]
    v_mfma_f32_32x32x16_bf16 v[240:255], v[140:143], v[132:135], v[240:255]
    s_waitcnt lgkmcnt(0)
    v_mfma_f32_32x32x16_bf16 v[192:207], v[152:155], v[144:147], v[192:207]
    v_xor_b32 v26, 0x10000, v26
    ds_read_b128 v[128:131], v26 offset:0
    ds_read_b64_tr_b16 v[136:137], v14 offset:4096
    ds_read_b64_tr_b16 v[138:139], v14 offset:4608
    v_mfma_f32_32x32x16_bf16 v[208:223], v[156:159], v[144:147], v[208:223]
    ds_read_b64_tr_b16 v[140:141], v15 offset:4096
    ds_read_b64_tr_b16 v[142:143], v15 offset:4608
    ds_read_b128 v[132:135], v26 offset:4096
    v_mfma_f32_32x32x16_bf16 v[224:239], v[152:155], v[148:151], v[224:239]
    v_mfma_f32_32x32x16_bf16 v[240:255], v[156:159], v[148:151], v[240:255]
    s_waitcnt lgkmcnt(0)
    v_mfma_f32_32x32x16_bf16 v[192:207], v[136:139], v[128:131], v[192:207]
    v_xor_b32 v27, 0x10000, v27
    ds_read_b128 v[144:147], v27 offset:0
    ds_read_b64_tr_b16 v[152:153], v14 offset:6144
    ds_read_b64_tr_b16 v[154:155], v14 offset:6656
    v_mfma_f32_32x32x16_bf16 v[208:223], v[140:143], v[128:131], v[208:223]
    ds_read_b64_tr_b16 v[156:157], v15 offset:6144
    ds_read_b64_tr_b16 v[158:159], v15 offset:6656
    ds_read_b128 v[148:151], v27 offset:4096
    v_mfma_f32_32x32x16_bf16 v[224:239], v[136:139], v[132:135], v[224:239]
    v_mfma_f32_32x32x16_bf16 v[240:255], v[140:143], v[132:135], v[240:255]
    s_waitcnt vmcnt(3) lgkmcnt(0)
    s_barrier
    v_mfma_f32_32x32x16_bf16 v[192:207], v[152:155], v[144:147], v[192:207]
    ds_read_b128 v[128:131], v24 offset:32768
    ds_read_b64_tr_b16 v[136:137], v14 offset:32768
    ds_read_b64_tr_b16 v[138:139], v14 offset:33280
    v_mfma_f32_32x32x16_bf16 v[208:223], v[156:159], v[144:147], v[208:223]
    ds_read_b64_tr_b16 v[140:141], v15 offset:32768
    ds_read_b64_tr_b16 v[142:143], v15 offset:33280
    ds_read_b128 v[132:135], v24 offset:36864
    v_mfma_f32_32x32x16_bf16 v[224:239], v[152:155], v[148:151], v[224:239]
    s_lshl_b32 s32, s3, 10
    s_add_u32 s32, s32, 131072
    v_lshl_add_u32 v13, v1, 2, s32
    v_lshl_add_u32 v23, v2, 4, s32
    v_mfma_f32_32x32x16_bf16 v[240:255], v[156:159], v[148:151], v[240:255]
    s_waitcnt vmcnt(0)
    s_mov_b32 s67, 131072
L_p1chk_1:
    v_xor_b32 v53, s24, v53
    v_xor_b32 v55, s24, v55
    v_xor_b32 v73, s24, v73
    v_xor_b32 v75, s24, v75
    v_or3_b32 v53, v53, v55, v73
    v_or_b32 v53, v53, v75
    v_cmp_ne_u32 vcc, 0, v53
    s_sub_u32 s67, s67, 1
    s_cbranch_scc1 L_p1ok_2
    s_nop 2
    s_cbranch_vccz L_p1ok_2
    buffer_load_dwordx2 v[52:53], v21, s[12:15], s49 offen offset:0 sc1
    buffer_load_dwordx2 v[54:55], v21, s[12:15], s49 offen offset:512 sc1
    buffer_load_dwordx4 v[72:75], v22, s[12:15], s50 offen sc1
    s_waitcnt vmcnt(0)
    s_branch L_p1chk_1
L_p1ok_2:
    v_add_f32 v52, v52, v54
    ds_write_b32 v13, v52
    s_cmp_lt_u32 s55, 10
    s_cselect_b32 s32, 0x3ea52b5c, 1.0
    s_waitcnt lgkmcnt(1)
    v_mfma_f32_32x32x16_bf16 v[192:207], v[136:139], v[128:131], v[192:207]
    ds_read_b128 v[144:147], v25 offset:32768
    ds_read_b64_tr_b16 v[152:153], v14 offset:34816
    ds_read_b64_tr_b16 v[154:155], v14 offset:35328
    v_mfma_f32_32x32x16_bf16 v[208:223], v[140:143], v[128:131], v[208:223]
    ds_read_b64_tr_b16 v[156:157], v15 offset:34816
    ds_read_b64_tr_b16 v[158:159], v15 offset:35328
    ds_read_b128 v[148:151], v25 offset:36864
    v_mfma_f32_32x32x16_bf16 v[224:239], v[136:139], v[132:135], v[224:239]
    v_mul_f32 v108, s32, v72
    v_mul_f32 v109, s32, v74
    v_mov_b32 v110, v108
    v_mov_b32 v111, v109
    v_mfma_f32_32x32x16_bf16 v[240:255], v[140:143], v[132:135], v[240:255]
    v_mul_u32_u24 v16, 32768, v2
    v_lshl_add_u32 v16, v8, 4, v16
    v_permlane32_swap_b32 v108, v110
    v_permlane32_swap_b32 v109, v111
    s_waitcnt lgkmcnt(0)
    v_mfma_f32_32x32x16_bf16 v[192:207], v[152:155], v[144:147], v[192:207]
    ds_read_b128 v[128:131], v26 offset:32768
    ds_read_b64_tr_b16 v[136:137], v14 offset:36864
    ds_read_b64_tr_b16 v[138:139], v14 offset:37376
    v_mfma_f32_32x32x16_bf16 v[208:223], v[156:159], v[144:147], v[208:223]
    ds_read_b64_tr_b16 v[140:141], v15 offset:36864
    ds_read_b64_tr_b16 v[142:143], v15 offset:37376
    ds_read_b128 v[132:135], v26 offset:36864
    v_mfma_f32_32x32x16_bf16 v[224:239], v[152:155], v[148:151], v[224:239]
    ds_read_b128 v[76:79], v23 offset:0
    ds_read_b128 v[80:83], v23 offset:32
    ds_read_b128 v[84:87], v23 offset:64
    ds_read_b128 v[88:91], v23 offset:96
    v_mfma_f32_32x32x16_bf16 v[240:255], v[156:159], v[148:151], v[240:255]
    ds_read_b128 v[92:95], v23 offset:128
    ds_read_b128 v[96:99], v23 offset:160
    ds_read_b128 v[100:103], v23 offset:192
    ds_read_b128 v[104:107], v23 offset:224
    s_waitcnt lgkmcnt(8)
    v_mfma_f32_32x32x16_bf16 v[192:207], v[136:139], v[128:131], v[192:207]
    ds_read_b128 v[144:147], v27 offset:32768
    ds_read_b64_tr_b16 v[152:153], v14 offset:38912
    ds_read_b64_tr_b16 v[154:155], v14 offset:39424
    v_mfma_f32_32x32x16_bf16 v[208:223], v[140:143], v[128:131], v[208:223]
    ds_read_b64_tr_b16 v[156:157], v15 offset:38912
    ds_read_b64_tr_b16 v[158:159], v15 offset:39424
    ds_read_b128 v[148:151], v27 offset:36864
    v_mfma_f32_32x32x16_bf16 v[224:239], v[136:139], v[132:135], v[224:239]
    s_mul_i32 s34, s55, 262144
    s_lshl_b32 s35, s51, 10
    s_add_u32 s34, s34, s35
    s_add_u32 s34, s34, 786432
    v_mfma_f32_32x32x16_bf16 v[240:255], v[140:143], v[132:135], v[240:255]
    s_waitcnt lgkmcnt(0)
    v_mfma_f32_32x32x16_bf16 v[192:207], v[152:155], v[144:147], v[192:207]
    v_mfma_f32_32x32x16_bf16 v[208:223], v[156:159], v[144:147], v[208:223]
    v_mfma_f32_32x32x16_bf16 v[224:239], v[152:155], v[148:151], v[224:239]
    v_mfma_f32_32x32x16_bf16 v[240:255], v[156:159], v[148:151], v[240:255]
    s_nop 8
    v_pk_mul_f32 v[192:193], v[192:193], v[108:109] op_sel_hi:[1,0]
    v_pk_mul_f32 v[194:195], v[194:195], v[108:109] op_sel_hi:[1,0]
    v_pk_mul_f32 v[196:197], v[196:197], v[108:109] op_sel_hi:[1,0]
    v_pk_mul_f32 v[198:199], v[198:199], v[108:109] op_sel_hi:[1,0]
    v_pk_fma_f32 v[192:193], v[76:77], v[108:109], v[192:193] op_sel:[0,1,0] op_sel_hi:[1,1,1]
    v_pk_fma_f32 v[194:195], v[78:79], v[108:109], v[194:195] op_sel:[0,1,0] op_sel_hi:[1,1,1]
    v_pk_fma_f32 v[196:197], v[80:81], v[108:109], v[196:197] op_sel:[0,1,0] op_sel_hi:[1,1,1]
    v_pk_fma_f32 v[198:199], v[82:83], v[108:109], v[198:199] op_sel:[0,1,0] op_sel_hi:[1,1,1]
    v_cvt_pk_bf16_f32 v192, v192, v193
    v_cvt_pk_bf16_f32 v193, v194, v195
    v_cvt_pk_bf16_f32 v194, v196, v197
    v_cvt_pk_bf16_f32 v195, v198, v199
    s_add_u32 s35, s34, 0
    buffer_store_dwordx4 v[192:195], v16, s[12:15], s35 offen offset:0 sc1
    v_pk_mul_f32 v[200:201], v[200:201], v[108:109] op_sel_hi:[1,0]
    v_pk_mul_f32 v[202:203], v[202:203], v[108:109] op_sel_hi:[1,0]
    v_pk_mul_f32 v[204:205], v[204:205], v[108:109] op_sel_hi:[1,0]
    v_pk_mul_f32 v[206:207], v[206:207], v[108:109] op_sel_hi:[1,0]
    v_pk_fma_f32 v[200:201], v[84:85], v[108:109], v[200:201] op_sel:[0,1,0] op_sel_hi:[1,1,1]
    v_pk_fma_f32 v[202:203], v[86:87], v[108:109], v[202:203] op_sel:[0,1,0] op_sel_hi:[1,1,1]
    v_pk_fma_f32 v[204:205], v[88:89], v[108:109], v[204:205] op_sel:[0,1,0] op_sel_hi:[1,1,1]
    v_pk_fma_f32 v[206:207], v[90:91], v[108:109], v[206:207] op_sel:[0,1,0] op_sel_hi:[1,1,1]
    v_cvt_pk_bf16_f32 v200, v200, v201
    v_cvt_pk_bf16_f32 v201, v202, v203
    v_cvt_pk_bf16_f32 v202, v204, v205
    v_cvt_pk_bf16_f32 v203, v206, v207
    s_add_u32 s35, s34, 65536
    buffer_store_dwordx4 v[200:203], v16, s[12:15], s35 offen offset:0 sc1
    v_pk_mul_f32 v[208:209], v[208:209], v[108:109] op_sel_hi:[1,0]
    v_pk_mul_f32 v[210:211], v[210:211], v[108:109] op_sel_hi:[1,0]
    v_pk_mul_f32 v[212:213], v[212:213], v[108:109] op_sel_hi:[1,0]
    v_pk_mul_f32 v[214:215], v[214:215], v[108:109] op_sel_hi:[1,0]
    v_pk_fma_f32 v[208:209], v[92:93], v[108:109], v[208:209] op_sel:[0,1,0] op_sel_hi:[1,1,1]
    v_pk_fma_f32 v[210:211], v[94:95], v[108:109], v[210:211] op_sel:[0,1,0] op_sel_hi:[1,1,1]
    v_pk_fma_f32 v[212:213], v[96:97], v[108:109], v[212:213] op_sel:[0,1,0] op_sel_hi:[1,1,1]
    v_pk_fma_f32 v[214:215], v[98:99], v[108:109], v[214:215] op_sel:[0,1,0] op_sel_hi:[1,1,1]
    v_cvt_pk_bf16_f32 v208, v208, v209
    v_cvt_pk_bf16_f32 v209, v210, v211
    v_cvt_pk_bf16_f32 v210, v212, v213
    v_cvt_pk_bf16_f32 v211, v214, v215
    s_add_u32 s35, s34, 131072
    buffer_store_dwordx4 v[208:211], v16, s[12:15], s35 offen offset:0 sc1
    v_pk_mul_f32 v[216:217], v[216:217], v[108:109] op_sel_hi:[1,0]
    v_pk_mul_f32 v[218:219], v[218:219], v[108:109] op_sel_hi:[1,0]
    v_pk_mul_f32 v[220:221], v[220:221], v[108:109] op_sel_hi:[1,0]
    v_pk_mul_f32 v[222:223], v[222:223], v[108:109] op_sel_hi:[1,0]
    v_pk_fma_f32 v[216:217], v[100:101], v[108:109], v[216:217] op_sel:[0,1,0] op_sel_hi:[1,1,1]
    v_pk_fma_f32 v[218:219], v[102:103], v[108:109], v[218:219] op_sel:[0,1,0] op_sel_hi:[1,1,1]
    v_pk_fma_f32 v[220:221], v[104:105], v[108:109], v[220:221] op_sel:[0,1,0] op_sel_hi:[1,1,1]
    v_pk_fma_f32 v[222:223], v[106:107], v[108:109], v[222:223] op_sel:[0,1,0] op_sel_hi:[1,1,1]
    v_cvt_pk_bf16_f32 v216, v216, v217
    v_cvt_pk_bf16_f32 v217, v218, v219
    v_cvt_pk_bf16_f32 v218, v220, v221
    v_cvt_pk_bf16_f32 v219, v222, v223
    s_add_u32 s35, s34, 196608
    buffer_store_dwordx4 v[216:219], v16, s[12:15], s35 offen offset:0 sc1
    v_pk_mul_f32 v[224:225], v[224:225], v[110:111] op_sel_hi:[1,0]
    v_pk_mul_f32 v[226:227], v[226:227], v[110:111] op_sel_hi:[1,0]
    v_pk_mul_f32 v[228:229], v[228:229], v[110:111] op_sel_hi:[1,0]
    v_pk_mul_f32 v[230:231], v[230:231], v[110:111] op_sel_hi:[1,0]
    v_pk_fma_f32 v[224:225], v[76:77], v[110:111], v[224:225] op_sel:[0,1,0] op_sel_hi:[1,1,1]
    v_pk_fma_f32 v[226:227], v[78:79], v[110:111], v[226:227] op_sel:[0,1,0] op_sel_hi:[1,1,1]
    v_pk_fma_f32 v[228:229], v[80:81], v[110:111], v[228:229] op_sel:[0,1,0] op_sel_hi:[1,1,1]
    v_pk_fma_f32 v[230:231], v[82:83], v[110:111], v[230:231] op_sel:[0,1,0] op_sel_hi:[1,1,1]
    v_cvt_pk_bf16_f32 v224, v224, v225
    v_cvt_pk_bf16_f32 v225, v226, v227
    v_cvt_pk_bf16_f32 v226, v228, v229
    v_cvt_pk_bf16_f32 v227, v230, v231
    s_add_u32 s35, s34, 0
    buffer_store_dwordx4 v[224:227], v16, s[12:15], s35 offen offset:512 sc1
    v_pk_mul_f32 v[232:233], v[232:233], v[110:111] op_sel_hi:[1,0]
    v_pk_mul_f32 v[234:235], v[234:235], v[110:111] op_sel_hi:[1,0]
    v_pk_mul_f32 v[236:237], v[236:237], v[110:111] op_sel_hi:[1,0]
    v_pk_mul_f32 v[238:239], v[238:239], v[110:111] op_sel_hi:[1,0]
    v_pk_fma_f32 v[232:233], v[84:85], v[110:111], v[232:233] op_sel:[0,1,0] op_sel_hi:[1,1,1]
    v_pk_fma_f32 v[234:235], v[86:87], v[110:111], v[234:235] op_sel:[0,1,0] op_sel_hi:[1,1,1]
    v_pk_fma_f32 v[236:237], v[88:89], v[110:111], v[236:237] op_sel:[0,1,0] op_sel_hi:[1,1,1]
    v_pk_fma_f32 v[238:239], v[90:91], v[110:111], v[238:239] op_sel:[0,1,0] op_sel_hi:[1,1,1]
    v_cvt_pk_bf16_f32 v232, v232, v233
    v_cvt_pk_bf16_f32 v233, v234, v235
    v_cvt_pk_bf16_f32 v234, v236, v237
    v_cvt_pk_bf16_f32 v235, v238, v239
    s_add_u32 s35, s34, 65536
    buffer_store_dwordx4 v[232:235], v16, s[12:15], s35 offen offset:512 sc1
    v_pk_mul_f32 v[240:241], v[240:241], v[110:111] op_sel_hi:[1,0]
    v_pk_mul_f32 v[242:243], v[242:243], v[110:111] op_sel_hi:[1,0]
    v_pk_mul_f32 v[244:245], v[244:245], v[110:111] op_sel_hi:[1,0]
    v_pk_mul_f32 v[246:247], v[246:247], v[110:111] op_sel_hi:[1,0]
    v_pk_fma_f32 v[240:241], v[92:93], v[110:111], v[240:241] op_sel:[0,1,0] op_sel_hi:[1,1,1]
    v_pk_fma_f32 v[242:243], v[94:95], v[110:111], v[242:243] op_sel:[0,1,0] op_sel_hi:[1,1,1]
    v_pk_fma_f32 v[244:245], v[96:97], v[110:111], v[244:245] op_sel:[0,1,0] op_sel_hi:[1,1,1]
    v_pk_fma_f32 v[246:247], v[98:99], v[110:111], v[246:247] op_sel:[0,1,0] op_sel_hi:[1,1,1]
    v_cvt_pk_bf16_f32 v240, v240, v241
    v_cvt_pk_bf16_f32 v241, v242, v243
    v_cvt_pk_bf16_f32 v242, v244, v245
    v_cvt_pk_bf16_f32 v243, v246, v247
    s_add_u32 s35, s34, 131072
    buffer_store_dwordx4 v[240:243], v16, s[12:15], s35 offen offset:512 sc1
    v_pk_mul_f32 v[248:249], v[248:249], v[110:111] op_sel_hi:[1,0]
    v_pk_mul_f32 v[250:251], v[250:251], v[110:111] op_sel_hi:[1,0]
    v_pk_mul_f32 v[252:253], v[252:253], v[110:111] op_sel_hi:[1,0]
    v_pk_mul_f32 v[254:255], v[254:255], v[110:111] op_sel_hi:[1,0]
    v_pk_fma_f32 v[248:249], v[100:101], v[110:111], v[248:249] op_sel:[0,1,0] op_sel_hi:[1,1,1]
    v_pk_fma_f32 v[250:251], v[102:103], v[110:111], v[250:251] op_sel:[0,1,0] op_sel_hi:[1,1,1]
    v_pk_fma_f32 v[252:253], v[104:105], v[110:111], v[252:253] op_sel:[0,1,0] op_sel_hi:[1,1,1]
    v_pk_fma_f32 v[254:255], v[106:107], v[110:111], v[254:255] op_sel:[0,1,0] op_sel_hi:[1,1,1]
    v_cvt_pk_bf16_f32 v248, v248, v249
    v_cvt_pk_bf16_f32 v249, v250, v251
    v_cvt_pk_bf16_f32 v250, v252, v253
    v_cvt_pk_bf16_f32 v251, v254, v255
    s_add_u32 s35, s34, 196608
    buffer_store_dwordx4 v[248:251], v16, s[12:15], s35 offen offset:512 sc1
    s_branch L_p1_done
L_p1_s:
    s_add_u32 m0, s40, 0
    s_nop 0
    buffer_load_dwordx4 v11, s[8:11], s41 offen lds
    buffer_load_dwordx4 v12, s[8:11], s41 offen offset:1024 lds
    s_add_u32 s41, s41, 61440
    s_add_u32 m0, s40, 2048
    s_nop 0
    buffer_load_dwordx4 v11, s[8:11], s41 offen lds
    buffer_load_dwordx4 v12, s[8:11], s41 offen offset:1024 lds
    s_add_u32 s41, s41, 61440
    s_add_u32 m0, s40, 4096
    s_nop 0
    buffer_load_dwordx4 v11, s[8:11], s41 offen lds
    buffer_load_dwordx4 v12, s[8:11], s41 offen offset:1024 lds
    s_add_u32 s41, s41, 61440
    s_add_u32 m0, s40, 6144
    s_nop 0
    buffer_load_dwordx4 v11, s[8:11], s41 offen lds
    buffer_load_dwordx4 v12, s[8:11], s41 offen offset:1024 lds
    s_add_u32 s41, s41, 61440
    s_add_u32 m0, s40, 8192
    s_nop 0
    buffer_load_dwordx4 v11, s[8:11], s41 offen lds
    buffer_load_dwordx4 v12, s[8:11], s41 offen offset:1024 lds
    s_add_u32 s41, s41, 61440
    s_add_u32 m0, s40, 10240
    s_nop 0
    buffer_load_dwordx4 v11, s[8:11], s41 offen lds
    buffer_load_dwordx4 v12, s[8:11], s41 offen offset:1024 lds
    s_add_u32 s41, s41, 61440
    s_lshl_b32 s32, s2, 2
    s_add_u32 s32, s32, s3
    s_mov_b32 s33, 16
    s_cmp_ge_u32 s32, 120
    s_cselect_b32 s33, 32, s33
    s_cmp_ge_u32 s32, 240
    s_cselect_b32 s33, 40, s33
    s_cmp_ge_u32 s32, 360
    s_cselect_b32 s33, 56, s33
    s_cmp_ge_u32 s32, 648
    s_cselect_b32 s33, 48, s33
    s_load_dwordx2 s[60:61], s[0:1], s33
    s_lshl_b32 s20, s3, 1
    s_lshr_b32 s20, 0x9c, s20
    s_and_b32 s20, s20, 3
    v_mov_b32 v2, 0x3f803f80
    v_and_b32 v13, 27, v1
    v_cmp_eq_u32 vcc, 18, v13
    v_mov_b32 v48, 0
    v_mov_b32 v49, 0
    v_mov_b32 v50, 0
    v_mov_b32 v51, 0
    v_cndmask_b32 v13, 0, v2, vcc
    v_accvgpr_write_b32 a64, v2
    v_accvgpr_write_b32 a65, v2
    v_accvgpr_write_b32 a66, v2
    v_accvgpr_write_b32 a67, v2
    v_accvgpr_write_b32 a68, v2
    v_accvgpr_write_b32 a69, v2
    v_accvgpr_write_b32 a70, v2
    v_accvgpr_write_b32 a71, v2
    v_accvgpr_write_b32 a72, v2
    v_accvgpr_write_b32 a73, v2
    v_accvgpr_write_b32 a74, v2
    v_accvgpr_write_b32 a75, v2
    v_accvgpr_write_b32 a76, v2
    v_accvgpr_write_b32 a77, v2
    v_accvgpr_write_b32 a78, v2
    v_accvgpr_write_b32 a79, v2
    v_accvgpr_write_b32 a96, v13
    v_accvgpr_write_b32 a97, v13
    v_accvgpr_write_b32 a98, v13
    v_accvgpr_write_b32 a99, v13
    v_accvgpr_write_b32 a100, v13
    v_accvgpr_write_b32 a101, v13
    v_accvgpr_write_b32 a102, v13
    v_accvgpr_write_b32 a103, v13
    v_accvgpr_write_b32 a104, v13
    v_accvgpr_write_b32 a105, v13
    v_accvgpr_write_b32 a106, v13
    v_accvgpr_write_b32 a107, v13
    v_accvgpr_write_b32 a108, v13
    v_accvgpr_write_b32 a109, v13
    v_accvgpr_write_b32 a110, v13
    v_accvgpr_write_b32 a111, v13
    v_mov_b32 v44, v2
    v_mov_b32 v45, v2
    v_mov_b32 v46, v2
    v_mov_b32 v47, v2
    s_lshl_b32 s32, s25, 7
    s_lshl_b32 s33, s26, 3
    v_mfma_f32_32x32x16_bf16 a[80:95], v[48:51], v[48:51], a[64:79]
    s_add_u32 s33, s33, s32
    s_lshl_b32 s34, s3, 1
    s_add_u32 s33, s33, s34
    s_mul_i32 s57, s33, 1280
    s_lshl_b32 s53, s33, 4
    s_add_u32 s53, s53, 655360
    v_mfma_f32_32x32x16_bf16 a[112:127], v[48:51], v[48:51], a[96:111]
    v_and_b32 v8, 31, v1
    v_lshrrev_b32 v2, 5, v1
    v_bfe_u32 v13, v1, 1, 3
    v_xor_b32 v13, v13, v2
    v_lshlrev_b32 v13, 4, v13
    v_lshl_add_u32 v24, v8, 7, v13
    v_mfma_f32_32x32x16_bf16 a[128:143], v[48:51], v[48:51], a[96:111]
    s_lshl_b32 s32, s42, 13
    v_add_u32 v24, s32, v24
    v_xor_b32 v25, 32, v24
    v_xor_b32 v26, 64, v24
    v_xor_b32 v27, 0x60, v24
    v_mfma_f32_32x32x16_bf16 a[144:159], v[48:51], v[48:51], a[96:111]
    v_mul_u32_u24 v7, 1280, v2
    v_lshl_add_u32 v6, v8, 3, v7
    v_lshl_add_u32 v7, v8, 4, v7
    v_bfe_u32 v16, v1, 2, 2
    v_lshl_add_u32 v16, v2, 3, v16
    v_lshlrev_b32 v16, 7, v16
    v_mfma_f32_32x32x16_bf16 a[160:175], v[48:51], v[48:51], a[96:111]
    v_add_u32 v16, s40, v16
    v_bfe_u32 v17, v1, 3, 1
    v_lshlrev_b32 v17, 6, v17
    v_bfe_u32 v18, v1, 4, 1
    v_lshlrev_b32 v18, 5, v18
    v_mfma_f32_32x32x16_bf16 a[176:191], v[48:51], v[48:51], a[96:111]
    v_and_b32 v19, 3, v1
    v_lshl_add_u32 v19, v19, 3, v18
    v_and_b32 v20, 1, v1
    v_lshl_add_u32 v20, v20, 4, v18
    v_bfe_u32 v21, v1, 1, 1
    v_lshl_add_u32 v20, v21, 3, v20
    v_mfma_f32_32x32x16_bf16 a[192:207], v[48:51], v[48:51], a[96:111]
    v_add_u32 v14, v16, v17
    v_xor_b32 v17, 64, v17
    v_add_u32 v15, v16, v17
    s_cmp_lt_u32 s56, 20
    s_cselect_b64 vcc, -1, 0
    v_lshlrev_b32 v21, 3, v1
    v_lshlrev_b32 v22, 4, v1
    v_mfma_f32_32x32x16_bf16 a[208:223], v[48:51], v[48:51], a[96:111]
    v_cndmask_b32 v19, v19, v20, vcc
    v_add_u32 v14, v14, v19
    v_add_u32 v15, v15, v19
    s_waitcnt lgkmcnt(0)
    s_mul_i32 s24, s24, 0x9e3779b1
    s_add_u32 s24, s24, 0x7f4a7c15
    s_lshl_b32 s32, s25, 4
    s_add_u32 s32, s32, s26
    s_lshl_b32 s33, s28, 5
    s_add_u32 s33, s33, s27
    s_add_u32 s33, s33, 255
    v_mov_b32 v3, s33
    v_mov_b32 v30, s32
    v_cmp_gt_u32 vcc, 8, v1
    s_not_b32 s32, s24
    s_nop 0
    v_cndmask_b32 v3, v3, v30, vcc
    v_lshl_add_u32 v30, v3, 7, v22
    v_cmp_gt_u32 vcc, 16, v31
    v_mov_b32 v3, 0x80000000
    s_nop 0
    v_cndmask_b32 v30, v3, v30, vcc
    v_mov_b32 v120, s32
    v_mov_b32 v121, s32
    v_mov_b32 v122, s32
    v_mov_b32 v123, s32
    buffer_load_dwordx4 v[32:35], v7, s[4:7], s57 offen
    buffer_load_dwordx4 v[36:39], v7, s[4:7], s57 offen offset:512
    buffer_load_dwordx2 v[40:41], v6, s[4:7], s57 offen offset:1024
    s_mov_b32 s33, 4096
    buffer_store_dwordx4 v[120:123], v30, s[12:15], s33 offen sc1
    s_add_u32 m0, s40, 12288
    s_nop 0
    buffer_load_dwordx4 v11, s[8:11], s41 offen lds
    buffer_load_dwordx4 v12, s[8:11], s41 offen offset:1024 lds
    s_add_u32 s41, s41, 61440
    s_add_u32 m0, s40, 14336
    s_nop 0
    buffer_load_dwordx4 v11, s[8:11], s41 offen lds
    buffer_load_dwordx4 v12, s[8:11], s41 offen offset:1024 lds
    s_add_u32 s41, s41, 61440
    s_add_u32 m0, s40, 16384
    s_nop 0
    buffer_load_dwordx4 v11, s[8:11], s41 offen lds
    buffer_load_dwordx4 v12, s[8:11], s41 offen offset:1024 lds
    s_add_u32 s41, s41, 61440
    s_add_u32 m0, s40, 18432
    s_nop 0
    buffer_load_dwordx4 v11, s[8:11], s41 offen lds
    buffer_load_dwordx4 v12, s[8:11], s41 offen offset:1024 lds
    s_add_u32 s41, s41, 61440
    s_add_u32 m0, s40, 20480
    s_nop 0
    buffer_load_dwordx4 v11, s[8:11], s41 offen lds
    buffer_load_dwordx4 v12, s[8:11], s41 offen offset:1024 lds
    s_add_u32 s41, s41, 61440
    s_add_u32 m0, s40, 22528
    s_nop 0
    buffer_load_dwordx4 v11, s[8:11], s41 offen lds
    buffer_load_dwordx4 v12, s[8:11], s41 offen offset:1024 lds
    s_add_u32 s41, s41, 61440
    s_add_u32 m0, s40, 24576
    s_nop 0
    buffer_load_dwordx4 v11, s[8:11], s41 offen lds
    buffer_load_dwordx4 v12, s[8:11], s41 offen offset:1024 lds
    s_add_u32 s41, s41, 61440
    s_add_u32 m0, s40, 26624
    s_nop 0
    buffer_load_dwordx4 v11, s[8:11], s41 offen lds
    buffer_load_dwordx4 v12, s[8:11], s41 offen offset:1024 lds
    s_add_u32 s41, s41, 61440
    s_add_u32 m0, s40, 28672
    s_nop 0
    buffer_load_dwordx4 v11, s[8:11], s41 offen lds
    buffer_load_dwordx4 v12, s[8:11], s41 offen offset:1024 lds
    s_add_u32 s41, s41, 61440
    s_add_u32 m0, s40, 30720
    s_nop 0
    buffer_load_dwordx4 v11, s[8:11], s41 offen lds
    buffer_load_dwordx4 v12, s[8:11], s41 offen offset:1024 lds
    s_add_u32 s41, s41, 61440
    s_waitcnt vmcnt(21)
    v_dot2_f32_bf16 v48, v32, v44, 0
    v_dot2_f32_bf16 v49, v32, v32, 0
    v_dot2_f32_bf16 v48, v33, v44, v48
    v_dot2_f32_bf16 v49, v33, v33, v49
    v_dot2_f32_bf16 v48, v34, v44, v48
    v_dot2_f32_bf16 v49, v34, v34, v49
    v_dot2_f32_bf16 v48, v35, v44, v48
    v_dot2_f32_bf16 v49, v35, v35, v49
    v_dot2_f32_bf16 v48, v36, v44, v48
    v_dot2_f32_bf16 v49, v36, v36, v49
    v_dot2_f32_bf16 v48, v37, v44, v48
    v_dot2_f32_bf16 v49, v37, v37, v49
    v_dot2_f32_bf16 v48, v38, v44, v48
    v_dot2_f32_bf16 v49, v38, v38, v49
    v_dot2_f32_bf16 v48, v39, v44, v48
    v_dot2_f32_bf16 v49, v39, v39, v49
    v_dot2_f32_bf16 v48, v40, v44, v48
    v_dot2_f32_bf16 v49, v40, v40, v49
    v_dot2_f32_bf16 v48, v41, v44, v48
    v_dot2_f32_bf16 v49, v41, v41, v49
    s_nop 1
    v_add_f32_dpp v48, v48, v48 quad_perm:[1,0,3,2] row_mask:0xf bank_mask:0xf
    v_add_f32_dpp v49, v49, v49 quad_perm:[1,0,3,2] row_mask:0xf bank_mask:0xf
    s_nop 0
    v_add_f32_dpp v48, v48, v48 quad_perm:[2,3,0,1] row_mask:0xf bank_mask:0xf
    v_add_f32_dpp v49, v49, v49 quad_perm:[2,3,0,1] row_mask:0xf bank_mask:0xf
    s_nop 0
    v_add_f32_dpp v48, v48, v48 row_half_mirror row_mask:0xf bank_mask:0xf
    v_add_f32_dpp v49, v49, v49 row_half_mirror row_mask:0xf bank_mask:0xf
    s_nop 0
    v_add_f32_dpp v48, v48, v48 row_mirror row_mask:0xf bank_mask:0xf
    v_add_f32_dpp v49, v49, v49 row_mirror row_mask:0xf bank_mask:0xf
    v_mov_b32 v50, v48
    v_mov_b32 v51, v49
    s_nop 0
    v_permlane16_swap_b32 v48, v50
    v_permlane16_swap_b32 v49, v51
    v_add_f32 v48, v48, v50
    v_add_f32 v49, v49, v51
    v_mul_f32 v50, 0x3acccccd, v48
    v_mul_f32 v49, 0x3acccccd, v49
    v_fma_f32 v49, -v50, v50, v49
    v_max_f32 v49, 0, v49
    v_add_f32 v49, 0x3727c5ac, v49
    v_rsq_f32 v48, v49
    v_mov_b32 v49, s24
    v_mov_b32 v51, s24
    v_mul_f32 v50, -v50, v48
    v_lshrrev_b32 v3, 1, v1
    s_mov_b32 exec_lo, 1
    s_mov_b32 exec_hi, 1
    buffer_store_dwordx4 v[48:51], v3, s[12:15], s53 offen sc1
    s_mov_b64 exec, -1
    ds_read_b64_tr_b16 v[128:129], v14 offset:0
    ds_read_b64_tr_b16 v[130:131], v14 offset:512
    ds_read_b64_tr_b16 v[132:133], v15 offset:0
    ds_read_b64_tr_b16 v[134:135], v15 offset:512
    s_waitcnt lgkmcnt(0)
    s_add_u32 m0, s40, 0
    s_nop 0
    buffer_load_dwordx4 v11, s[8:11], s41 offen lds
    buffer_load_dwordx4 v12, s[8:11], s41 offen offset:1024 lds
    s_add_u32 s41, s41, 61440
    v_mfma_f32_32x32x16_bf16 v[160:175], v[44:47], v[128:131], 0
    v_mfma_f32_32x32x16_bf16 v[176:191], v[44:47], v[132:135], 0
    ds_read_b64_tr_b16 v[136:137], v14 offset:2048
    ds_read_b64_tr_b16 v[138:139], v14 offset:2560
    ds_read_b64_tr_b16 v[140:141], v15 offset:2048
    ds_read_b64_tr_b16 v[142:143], v15 offset:2560
    s_waitcnt lgkmcnt(0)
    s_add_u32 m0, s40, 2048
    s_nop 0
    buffer_load_dwordx4 v11, s[8:11], s41 offen lds
    buffer_load_dwordx4 v12, s[8:11], s41 offen offset:1024 lds
    s_add_u32 s41, s41, 61440
    v_mfma_f32_32x32x16_bf16 v[160:175], v[44:47], v[136:139], v[160:175]
    v_mfma_f32_32x32x16_bf16 v[176:191], v[44:47], v[140:143], v[176:191]
    ds_read_b64_tr_b16 v[128:129], v14 offset:4096
    ds_read_b64_tr_b16 v[130:131], v14 offset:4608
    ds_read_b64_tr_b16 v[132:133], v15 offset:4096
    ds_read_b64_tr_b16 v[134:135], v15 offset:4608
    s_waitcnt lgkmcnt(0)
    s_add_u32 m0, s40, 4096
    s_nop 0
    buffer_load_dwordx4 v11, s[8:11], s41 offen lds
    buffer_load_dwordx4 v12, s[8:11], s41 offen offset:1024 lds
    s_add_u32 s41, s41, 61440
    v_mfma_f32_32x32x16_bf16 v[160:175], v[44:47], v[128:131], v[160:175]
    v_mfma_f32_32x32x16_bf16 v[176:191], v[44:47], v[132:135], v[176:191]
    ds_read_b64_tr_b16 v[136:137], v14 offset:6144
    ds_read_b64_tr_b16 v[138:139], v14 offset:6656
    ds_read_b64_tr_b16 v[140:141], v15 offset:6144
    ds_read_b64_tr_b16 v[142:143], v15 offset:6656
    s_waitcnt lgkmcnt(0)
    s_add_u32 m0, s40, 6144
    s_nop 0
    buffer_load_dwordx4 v11, s[8:11], s41 offen lds
    buffer_load_dwordx4 v12, s[8:11], s41 offen offset:1024 lds
    s_add_u32 s41, s41, 61440
    v_mfma_f32_32x32x16_bf16 v[160:175], v[44:47], v[136:139], v[160:175]
    v_mfma_f32_32x32x16_bf16 v[176:191], v[44:47], v[140:143], v[176:191]
    ds_read_b64_tr_b16 v[128:129], v14 offset:8192
    ds_read_b64_tr_b16 v[130:131], v14 offset:8704
    ds_read_b64_tr_b16 v[132:133], v15 offset:8192
    ds_read_b64_tr_b16 v[134:135], v15 offset:8704
    s_waitcnt lgkmcnt(0)
    v_mfma_f32_32x32x16_bf16 v[160:175], v[44:47], v[128:131], v[160:175]
    v_mfma_f32_32x32x16_bf16 v[176:191], v[44:47], v[132:135], v[176:191]
    ds_read_b64_tr_b16 v[136:137], v14 offset:10240
    ds_read_b64_tr_b16 v[138:139], v14 offset:10752
    ds_read_b64_tr_b16 v[140:141], v15 offset:10240
    ds_read_b64_tr_b16 v[142:143], v15 offset:10752
    s_waitcnt lgkmcnt(0)
    v_mfma_f32_32x32x16_bf16 v[160:175], v[44:47], v[136:139], v[160:175]
    v_mfma_f32_32x32x16_bf16 v[176:191], v[44:47], v[140:143], v[176:191]
    s_waitcnt vmcnt(27)
    ds_read_b64_tr_b16 v[128:129], v14 offset:12288
    ds_read_b64_tr_b16 v[130:131], v14 offset:12800
    ds_read_b64_tr_b16 v[132:133], v15 offset:12288
    ds_read_b64_tr_b16 v[134:135], v15 offset:12800
    s_waitcnt lgkmcnt(0)
    v_mfma_f32_32x32x16_bf16 v[160:175], v[44:47], v[128:131], v[160:175]
    v_mfma_f32_32x32x16_bf16 v[176:191], v[44:47], v[132:135], v[176:191]
    s_waitcnt vmcnt(25)
    ds_read_b64_tr_b16 v[136:137], v14 offset:14336
    ds_read_b64_tr_b16 v[138:139], v14 offset:14848
    ds_read_b64_tr_b16 v[140:141], v15 offset:14336
    ds_read_b64_tr_b16 v[142:143], v15 offset:14848
    s_waitcnt lgkmcnt(0)
    v_mfma_f32_32x32x16_bf16 v[160:175], v[44:47], v[136:139], v[160:175]
    v_mfma_f32_32x32x16_bf16 v[176:191], v[44:47], v[140:143], v[176:191]
    s_waitcnt vmcnt(23)
    ds_read_b64_tr_b16 v[128:129], v14 offset:16384
    ds_read_b64_tr_b16 v[130:131], v14 offset:16896
    ds_read_b64_tr_b16 v[132:133], v15 offset:16384
    ds_read_b64_tr_b16 v[134:135], v15 offset:16896
    s_waitcnt lgkmcnt(0)
    v_mfma_f32_32x32x16_bf16 v[160:175], v[44:47], v[128:131], v[160:175]
    v_mfma_f32_32x32x16_bf16 v[176:191], v[44:47], v[132:135], v[176:191]
    s_waitcnt vmcnt(21)
    ds_read_b64_tr_b16 v[136:137], v14 offset:18432
    ds_read_b64_tr_b16 v[138:139], v14 offset:18944
    ds_read_b64_tr_b16 v[140:141], v15 offset:18432
    ds_read_b64_tr_b16 v[142:143], v15 offset:18944
    s_waitcnt lgkmcnt(0)
    v_mfma_f32_32x32x16_bf16 v[160:175], v[44:47], v[136:139], v[160:175]
    v_mfma_f32_32x32x16_bf16 v[176:191], v[44:47], v[140:143], v[176:191]
    s_waitcnt vmcnt(19)
    ds_read_b64_tr_b16 v[128:129], v14 offset:20480
    ds_read_b64_tr_b16 v[130:131], v14 offset:20992
    ds_read_b64_tr_b16 v[132:133], v15 offset:20480
    ds_read_b64_tr_b16 v[134:135], v15 offset:20992
    s_waitcnt lgkmcnt(0)
    v_mfma_f32_32x32x16_bf16 v[160:175], v[44:47], v[128:131], v[160:175]
    v_mfma_f32_32x32x16_bf16 v[176:191], v[44:47], v[132:135], v[176:191]
    s_waitcnt vmcnt(17)
    ds_read_b64_tr_b16 v[136:137], v14 offset:22528
    ds_read_b64_tr_b16 v[138:139], v14 offset:23040
    ds_read_b64_tr_b16 v[140:141], v15 offset:22528
    ds_read_b64_tr_b16 v[142:143], v15 offset:23040
    s_waitcnt lgkmcnt(0)
    v_mfma_f32_32x32x16_bf16 v[160:175], v[44:47], v[136:139], v[160:175]
    v_mfma_f32_32x32x16_bf16 v[176:191], v[44:47], v[140:143], v[176:191]
    s_waitcnt vmcnt(15)
    ds_read_b64_tr_b16 v[128:129], v14 offset:24576
    ds_read_b64_tr_b16 v[130:131], v14 offset:25088
    ds_read_b64_tr_b16 v[132:133], v15 offset:24576
    ds_read_b64_tr_b16 v[134:135], v15 offset:25088
    s_waitcnt lgkmcnt(0)
    v_mfma_f32_32x32x16_bf16 v[160:175], v[44:47], v[128:131], v[160:175]
    v_mfma_f32_32x32x16_bf16 v[176:191], v[44:47], v[132:135], v[176:191]
    s_waitcnt vmcnt(13)
    ds_read_b64_tr_b16 v[136:137], v14 offset:26624
    ds_read_b64_tr_b16 v[138:139], v14 offset:27136
    ds_read_b64_tr_b16 v[140:141], v15 offset:26624
    ds_read_b64_tr_b16 v[142:143], v15 offset:27136
    s_waitcnt lgkmcnt(0)
    v_mfma_f32_32x32x16_bf16 v[160:175], v[44:47], v[136:139], v[160:175]
    v_mfma_f32_32x32x16_bf16 v[176:191], v[44:47], v[140:143], v[176:191]
    s_waitcnt vmcnt(11)
    ds_read_b64_tr_b16 v[128:129], v14 offset:28672
    ds_read_b64_tr_b16 v[130:131], v14 offset:29184
    ds_read_b64_tr_b16 v[132:133], v15 offset:28672
    ds_read_b64_tr_b16 v[134:135], v15 offset:29184
    s_waitcnt lgkmcnt(0)
    v_mfma_f32_32x32x16_bf16 v[160:175], v[44:47], v[128:131], v[160:175]
    v_mfma_f32_32x32x16_bf16 v[176:191], v[44:47], v[132:135], v[176:191]
    s_waitcnt vmcnt(9)
    ds_read_b64_tr_b16 v[136:137], v14 offset:30720
    ds_read_b64_tr_b16 v[138:139], v14 offset:31232
    ds_read_b64_tr_b16 v[140:141], v15 offset:30720
    ds_read_b64_tr_b16 v[142:143], v15 offset:31232
    s_waitcnt lgkmcnt(0)
    v_mfma_f32_32x32x16_bf16 v[160:175], v[44:47], v[136:139], v[160:175]
    v_mfma_f32_32x32x16_bf16 v[176:191], v[44:47], v[140:143], v[176:191]
    s_waitcnt vmcnt(6)
    ds_read_b64_tr_b16 v[128:129], v14 offset:0
    ds_read_b64_tr_b16 v[130:131], v14 offset:512
    ds_read_b64_tr_b16 v[132:133], v15 offset:0
    ds_read_b64_tr_b16 v[134:135], v15 offset:512
    s_waitcnt lgkmcnt(0)
    v_mfma_f32_32x32x16_bf16 v[160:175], v[44:47], v[128:131], v[160:175]
    v_mfma_f32_32x32x16_bf16 v[176:191], v[44:47], v[132:135], v[176:191]
    s_waitcnt vmcnt(4)
    ds_read_b64_tr_b16 v[136:137], v14 offset:2048
    ds_read_b64_tr_b16 v[138:139], v14 offset:2560
    ds_read_b64_tr_b16 v[140:141], v15 offset:2048
    ds_read_b64_tr_b16 v[142:143], v15 offset:2560
    s_waitcnt lgkmcnt(0)
    v_mfma_f32_32x32x16_bf16 v[160:175], v[44:47], v[136:139], v[160:175]
    v_mfma_f32_32x32x16_bf16 v[176:191], v[44:47], v[140:143], v[176:191]
    s_waitcnt vmcnt(2)
    ds_read_b64_tr_b16 v[128:129], v14 offset:4096
    ds_read_b64_tr_b16 v[130:131], v14 offset:4608
    ds_read_b64_tr_b16 v[132:133], v15 offset:4096
    ds_read_b64_tr_b16 v[134:135], v15 offset:4608
    s_waitcnt lgkmcnt(0)
    v_mfma_f32_32x32x16_bf16 v[160:175], v[44:47], v[128:131], v[160:175]
    v_mfma_f32_32x32x16_bf16 v[176:191], v[44:47], v[132:135], v[176:191]
    s_waitcnt vmcnt(0)
    ds_read_b64_tr_b16 v[136:137], v14 offset:6144
    ds_read_b64_tr_b16 v[138:139], v14 offset:6656
    ds_read_b64_tr_b16 v[140:141], v15 offset:6144
    ds_read_b64_tr_b16 v[142:143], v15 offset:6656
    s_waitcnt lgkmcnt(0)
    v_mfma_f32_32x32x16_bf16 v[160:175], v[44:47], v[136:139], v[160:175]
    v_mfma_f32_32x32x16_bf16 v[176:191], v[44:47], v[140:143], v[176:191]
    s_nop 11
    v_cndmask_b32 v160, v160, v176, s[30:31]
    v_mov_b32 v161, s24
    s_lshl_b32 s49, s56, 10
    s_lshl_b32 s50, s43, 9
    s_add_u32 s49, s49, s50
    s_add_u32 s49, s49, 720896
    buffer_store_dwordx2 v[160:161], v21, s[12:15], s49 offen sc1
    s_branch L_p1_done
L_p1_c:
    s_waitcnt vmcnt(11)
    s_barrier
    ds_read_b128 v[128:131], v24 offset:0
    ds_read_b128 v[132:135], v24 offset:4096
    ds_read_b64_tr_b16 v[136:137], v14 offset:0
    ds_read_b64_tr_b16 v[138:139], v14 offset:512
    ds_read_b64_tr_b16 v[140:141], v15 offset:0
    ds_read_b64_tr_b16 v[142:143], v15 offset:512
    s_waitcnt lgkmcnt(0)
    v_mfma_f32_32x32x16_bf16 v[192:207], v[128:131], v[136:139], 0
    ds_read_b128 v[144:147], v25 offset:0
    ds_read_b64_tr_b16 v[152:153], v14 offset:2048
    ds_read_b64_tr_b16 v[154:155], v14 offset:2560
    v_mfma_f32_32x32x16_bf16 v[208:223], v[128:131], v[140:143], 0
    ds_read_b64_tr_b16 v[156:157], v15 offset:2048
    ds_read_b64_tr_b16 v[158:159], v15 offset:2560
    ds_read_b128 v[148:151], v25 offset:4096
    v_mfma_f32_32x32x16_bf16 v[224:239], v[132:135], v[136:139], 0
    s_add_u32 m0, s46, 65536
    s_add_u32 s47, s45, s44
    buffer_load_dwordx4 v9, s[4:7], s47 offen lds
    buffer_load_dwordx4 v10, s[4:7], s47 offen offset:1024 lds
    s_waitcnt vmcnt(10)
    v_dot2_f32_bf16 v48, v32, v44, 0
    v_dot2_f32_bf16 v49, v32, v32, 0
    v_dot2_f32_bf16 v48, v33, v44, v48
    v_dot2_f32_bf16 v49, v33, v33, v49
    v_dot2_f32_bf16 v48, v34, v44, v48
    v_dot2_f32_bf16 v49, v34, v34, v49
    v_dot2_f32_bf16 v48, v35, v44, v48
    v_dot2_f32_bf16 v49, v35, v35, v49
    v_mfma_f32_32x32x16_bf16 v[240:255], v[132:135], v[140:143], 0
    s_add_u32 m0, s48, 65536
    s_nop 0
    buffer_load_dwordx4 v11, s[8:11], s41 offen lds
    buffer_load_dwordx4 v12, s[8:11], s41 offen offset:1024 lds
    v_dot2_f32_bf16 v48, v36, v44, v48
    v_dot2_f32_bf16 v49, v36, v36, v49
    v_dot2_f32_bf16 v48, v37, v44, v48
    v_dot2_f32_bf16 v49, v37, v37, v49
    v_dot2_f32_bf16 v48, v38, v44, v48
    v_dot2_f32_bf16 v49, v38, v38, v49
    v_dot2_f32_bf16 v48, v39, v44, v48
    v_dot2_f32_bf16 v49, v39, v39, v49
    s_waitcnt lgkmcnt(0)
    v_mfma_f32_32x32x16_bf16 v[192:207], v[144:147], v[152:155], v[192:207]
    ds_read_b128 v[128:131], v26 offset:0
    ds_read_b64_tr_b16 v[136:137], v14 offset:4096
    ds_read_b64_tr_b16 v[138:139], v14 offset:4608
    v_mfma_f32_32x32x16_bf16 v[208:223], v[144:147], v[156:159], v[208:223]
    ds_read_b64_tr_b16 v[140:141], v15 offset:4096
    ds_read_b64_tr_b16 v[142:143], v15 offset:4608
    ds_read_b128 v[132:135], v26 offset:4096
    v_mfma_f32_32x32x16_bf16 v[224:239], v[148:151], v[152:155], v[224:239]
    s_add_u32 m0, s46, 67584
    s_add_u32 s47, s47, 20480
    buffer_load_dwordx4 v9, s[4:7], s47 offen lds
    v_dot2_f32_bf16 v48, v40, v44, v48
    v_dot2_f32_bf16 v49, v40, v40, v49
    v_dot2_f32_bf16 v48, v41, v44, v48
    v_dot2_f32_bf16 v49, v41, v41, v49
    s_nop 1
    v_add_f32_dpp v48, v48, v48 quad_perm:[1,0,3,2] row_mask:0xf bank_mask:0xf
    v_add_f32_dpp v49, v49, v49 quad_perm:[1,0,3,2] row_mask:0xf bank_mask:0xf
    s_nop 0
    v_add_f32_dpp v48, v48, v48 quad_perm:[2,3,0,1] row_mask:0xf bank_mask:0xf
    v_add_f32_dpp v49, v49, v49 quad_perm:[2,3,0,1] row_mask:0xf bank_mask:0xf
    v_mfma_f32_32x32x16_bf16 v[240:255], v[148:151], v[156:159], v[240:255]
    buffer_load_dwordx4 v10, s[4:7], s47 offen offset:1024 lds
    s_add_u32 s44, s44, 128
    s_cmp_eq_u32 s44, 1280
    s_cselect_b32 s44, 0, s44
    v_add_f32_dpp v48, v48, v48 row_half_mirror row_mask:0xf bank_mask:0xf
    v_add_f32_dpp v49, v49, v49 row_half_mirror row_mask:0xf bank_mask:0xf
    s_nop 0
    v_add_f32_dpp v48, v48, v48 row_mirror row_mask:0xf bank_mask:0xf
    v_add_f32_dpp v49, v49, v49 row_mirror row_mask:0xf bank_mask:0xf
    v_mov_b32 v50, v48
    v_mov_b32 v51, v49
    s_nop 0
    v_permlane16_swap_b32 v48, v50
    v_permlane16_swap_b32 v49, v51
    s_waitcnt lgkmcnt(0)
    v_mfma_f32_32x32x16_bf16 v[192:207], v[128:131], v[136:139], v[192:207]
    ds_read_b128 v[144:147], v27 offset:0
    ds_read_b64_tr_b16 v[152:153], v14 offset:6144
    ds_read_b64_tr_b16 v[154:155], v14 offset:6656
    v_mfma_f32_32x32x16_bf16 v[208:223], v[128:131], v[140:143], v[208:223]
    ds_read_b64_tr_b16 v[156:157], v15 offset:6144
    ds_read_b64_tr_b16 v[158:159], v15 offset:6656
    ds_read_b128 v[148:151], v27 offset:4096
    v_mfma_f32_32x32x16_bf16 v[224:239], v[132:135], v[136:139], v[224:239]
    s_add_u32 m0, s48, 67584
    s_add_u32 s41, s41, 61440
    buffer_load_dwordx4 v11, s[8:11], s41 offen lds
    v_add_f32 v48, v48, v50
    v_add_f32 v49, v49, v51
    v_mul_f32 v50, 0x3acccccd, v48
    v_mul_f32 v49, 0x3acccccd, v49
    v_fma_f32 v49, -v50, v50, v49
    v_max_f32 v49, 0, v49
    v_add_f32 v49, 0x3727c5ac, v49
    v_rsq_f32 v48, v49
    v_mfma_f32_32x32x16_bf16 v[240:255], v[132:135], v[140:143], v[240:255]
    buffer_load_dwordx4 v12, s[8:11], s41 offen offset:1024 lds
    s_add_u32 s41, s41, 184320
    s_cmp_eq_u32 s41, 2457600
    s_cselect_b32 s41, 0, s41
    v_mov_b32 v49, s24
    v_mov_b32 v51, s24
    v_mul_f32 v50, -v50, v48
    v_lshrrev_b32 v3, 1, v1
    s_mov_b32 exec_lo, 1
    s_mov_b32 exec_hi, 1
    buffer_store_dwordx4 v[48:51], v3, s[12:15], s53 offen sc1
    s_mov_b64 exec, -1
    s_waitcnt vmcnt(9) lgkmcnt(0)
    s_barrier
    v_mfma_f32_32x32x16_bf16 v[192:207], v[144:147], v[152:155], v[192:207]
    ds_read_b128 v[128:131], v24 offset:32768
    ds_read_b64_tr_b16 v[136:137], v14 offset:32768
    ds_read_b64_tr_b16 v[138:139], v14 offset:33280
    v_mfma_f32_32x32x16_bf16 v[208:223], v[144:147], v[156:159], v[208:223]
    ds_read_b64_tr_b16 v[140:141], v15 offset:32768
    ds_read_b64_tr_b16 v[142:143], v15 offset:33280
    ds_read_b128 v[132:135], v24 offset:36864
    v_mfma_f32_32x32x16_bf16 v[224:239], v[148:151], v[152:155], v[224:239]
    s_add_u32 m0, s46, 98304
    s_add_u32 s47, s45, s44
    buffer_load_dwordx4 v9, s[4:7], s47 offen lds
    v_mfma_f32_32x32x16_bf16 v[240:255], v[148:151], v[156:159], v[240:255]
    buffer_load_dwordx4 v10, s[4:7], s47 offen offset:1024 lds
    s_waitcnt lgkmcnt(0)
    v_mfma_f32_32x32x16_bf16 v[192:207], v[128:131], v[136:139], v[192:207]
    ds_read_b128 v[144:147], v25 offset:32768
    ds_read_b64_tr_b16 v[152:153], v14 offset:34816
    ds_read_b64_tr_b16 v[154:155], v14 offset:35328
    v_mfma_f32_32x32x16_bf16 v[208:223], v[128:131], v[140:143], v[208:223]
    ds_read_b64_tr_b16 v[156:157], v15 offset:34816
    ds_read_b64_tr_b16 v[158:159], v15 offset:35328
    ds_read_b128 v[148:151], v25 offset:36864
    v_mfma_f32_32x32x16_bf16 v[224:239], v[132:135], v[136:139], v[224:239]
    s_add_u32 m0, s48, 98304
    s_nop 0
    buffer_load_dwordx4 v11, s[8:11], s41 offen lds
    v_mfma_f32_32x32x16_bf16 v[240:255], v[132:135], v[140:143], v[240:255]
    buffer_load_dwordx4 v12, s[8:11], s41 offen offset:1024 lds
    s_waitcnt lgkmcnt(0)
    v_mfma_f32_32x32x16_bf16 v[192:207], v[144:147], v[152:155], v[192:207]
    ds_read_b128 v[128:131], v26 offset:32768
    ds_read_b64_tr_b16 v[136:137], v14 offset:36864
    ds_read_b64_tr_b16 v[138:139], v14 offset:37376
    v_mfma_f32_32x32x16_bf16 v[208:223], v[144:147], v[156:159], v[208:223]
    ds_read_b64_tr_b16 v[140:141], v15 offset:36864
    ds_read_b64_tr_b16 v[142:143], v15 offset:37376
    ds_read_b128 v[132:135], v26 offset:36864
    v_mfma_f32_32x32x16_bf16 v[224:239], v[148:151], v[152:155], v[224:239]
    s_add_u32 m0, s46, 100352
    s_add_u32 s47, s47, 20480
    buffer_load_dwordx4 v9, s[4:7], s47 offen lds
    v_mfma_f32_32x32x16_bf16 v[240:255], v[148:151], v[156:159], v[240:255]
    buffer_load_dwordx4 v10, s[4:7], s47 offen offset:1024 lds
    s_add_u32 s44, s44, 128
    s_cmp_eq_u32 s44, 1280
    s_cselect_b32 s44, 0, s44
    s_waitcnt lgkmcnt(0)
    v_mfma_f32_32x32x16_bf16 v[192:207], v[128:131], v[136:139], v[192:207]
    ds_read_b128 v[144:147], v27 offset:32768
    ds_read_b64_tr_b16 v[152:153], v14 offset:38912
    ds_read_b64_tr_b16 v[154:155], v14 offset:39424
    v_mfma_f32_32x32x16_bf16 v[208:223], v[128:131], v[140:143], v[208:223]
    ds_read_b64_tr_b16 v[156:157], v15 offset:38912
    ds_read_b64_tr_b16 v[158:159], v15 offset:39424
    ds_read_b128 v[148:151], v27 offset:36864
    v_mfma_f32_32x32x16_bf16 v[224:239], v[132:135], v[136:139], v[224:239]
    s_add_u32 m0, s48, 100352
    s_add_u32 s41, s41, 61440
    buffer_load_dwordx4 v11, s[8:11], s41 offen lds
    v_mfma_f32_32x32x16_bf16 v[240:255], v[132:135], v[140:143], v[240:255]
    buffer_load_dwordx4 v12, s[8:11], s41 offen offset:1024 lds
    s_add_u32 s41, s41, 184320
    s_cmp_eq_u32 s41, 2457600
    s_cselect_b32 s41, 0, s41
    s_waitcnt vmcnt(9) lgkmcnt(0)
    s_barrier
    v_mfma_f32_32x32x16_bf16 v[192:207], v[144:147], v[152:155], v[192:207]
    v_xor_b32 v24, 0x10000, v24
    v_xor_b32 v14, 0x10000, v14
    v_xor_b32 v15, 0x10000, v15
    ds_read_b128 v[128:131], v24 offset:0
    ds_read_b64_tr_b16 v[136:137], v14 offset:0
    ds_read_b64_tr_b16 v[138:139], v14 offset:512
    v_mfma_f32_32x32x16_bf16 v[208:223], v[144:147], v[156:159], v[208:223]
    ds_read_b64_tr_b16 v[140:141], v15 offset:0
    ds_read_b64_tr_b16 v[142:143], v15 offset:512
    ds_read_b128 v[132:135], v24 offset:4096
    v_mfma_f32_32x32x16_bf16 v[224:239], v[148:151], v[152:155], v[224:239]
    s_add_u32 m0, s46, 0
    s_add_u32 s47, s45, s44
    buffer_load_dwordx4 v9, s[4:7], s47 offen lds
    v_mfma_f32_32x32x16_bf16 v[240:255], v[148:151], v[156:159], v[240:255]
    buffer_load_dwordx4 v10, s[4:7], s47 offen offset:1024 lds
    s_waitcnt lgkmcnt(0)
    v_mfma_f32_32x32x16_bf16 v[192:207], v[128:131], v[136:139], v[192:207]
    v_xor_b32 v25, 0x10000, v25
    ds_read_b128 v[144:147], v25 offset:0
    ds_read_b64_tr_b16 v[152:153], v14 offset:2048
    ds_read_b64_tr_b16 v[154:155], v14 offset:2560
    v_mfma_f32_32x32x16_bf16 v[208:223], v[128:131], v[140:143], v[208:223]
    ds_read_b64_tr_b16 v[156:157], v15 offset:2048
    ds_read_b64_tr_b16 v[158:159], v15 offset:2560
    ds_read_b128 v[148:151], v25 offset:4096
    v_mfma_f32_32x32x16_bf16 v[224:239], v[132:135], v[136:139], v[224:239]
    s_add_u32 m0, s48, 0
    s_nop 0
    buffer_load_dwordx4 v11, s[8:11], s41 offen lds
    v_mfma_f32_32x32x16_bf16 v[240:255], v[132:135], v[140:143], v[240:255]
    buffer_load_dwordx4 v12, s[8:11], s41 offen offset:1024 lds
    s_waitcnt lgkmcnt(0)
    v_mfma_f32_32x32x16_bf16 v[192:207], v[144:147], v[152:155], v[192:207]
    v_xor_b32 v26, 0x10000, v26
    ds_read_b128 v[128:131], v26 offset:0
    ds_read_b64_tr_b16 v[136:137], v14 offset:4096
    ds_read_b64_tr_b16 v[138:139], v14 offset:4608
    v_mfma_f32_32x32x16_bf16 v[208:223], v[144:147], v[156:159], v[208:223]
    ds_read_b64_tr_b16 v[140:141], v15 offset:4096
    ds_read_b64_tr_b16 v[142:143], v15 offset:4608
    ds_read_b128 v[132:135], v26 offset:4096
    v_mfma_f32_32x32x16_bf16 v[224:239], v[148:151], v[152:155], v[224:239]
    s_add_u32 m0, s46, 2048
    s_add_u32 s47, s47, 20480
    buffer_load_dwordx4 v9, s[4:7], s47 offen lds
    v_mfma_f32_32x32x16_bf16 v[240:255], v[148:151], v[156:159], v[240:255]
    buffer_load_dwordx4 v10, s[4:7], s47 offen offset:1024 lds
    s_add_u32 s44, s44, 128
    s_cmp_eq_u32 s44, 1280
    s_cselect_b32 s44, 0, s44
    s_waitcnt lgkmcnt(0)
    v_mfma_f32_32x32x16_bf16 v[192:207], v[128:131], v[136:139], v[192:207]
    v_xor_b32 v27, 0x10000, v27
    ds_read_b128 v[144:147], v27 offset:0
    ds_read_b64_tr_b16 v[152:153], v14 offset:6144
    ds_read_b64_tr_b16 v[154:155], v14 offset:6656
    v_mfma_f32_32x32x16_bf16 v[208:223], v[128:131], v[140:143], v[208:223]
    ds_read_b64_tr_b16 v[156:157], v15 offset:6144
    ds_read_b64_tr_b16 v[158:159], v15 offset:6656
    ds_read_b128 v[148:151], v27 offset:4096
    v_mfma_f32_32x32x16_bf16 v[224:239], v[132:135], v[136:139], v[224:239]
    s_add_u32 m0, s48, 2048
    s_add_u32 s41, s41, 61440
    buffer_load_dwordx4 v11, s[8:11], s41 offen lds
    v_mfma_f32_32x32x16_bf16 v[240:255], v[132:135], v[140:143], v[240:255]
    buffer_load_dwordx4 v12, s[8:11], s41 offen offset:1024 lds
    s_add_u32 s41, s41, 184320
    s_cmp_eq_u32 s41, 2457600
    s_cselect_b32 s41, 0, s41
    s_waitcnt vmcnt(8) lgkmcnt(0)
    s_barrier
    v_mfma_f32_32x32x16_bf16 v[192:207], v[144:147], v[152:155], v[192:207]
    ds_read_b128 v[128:131], v24 offset:32768
    ds_read_b64_tr_b16 v[136:137], v14 offset:32768
    ds_read_b64_tr_b16 v[138:139], v14 offset:33280
    v_mfma_f32_32x32x16_bf16 v[208:223], v[144:147], v[156:159], v[208:223]
    ds_read_b64_tr_b16 v[140:141], v15 offset:32768
    ds_read_b64_tr_b16 v[142:143], v15 offset:33280
    ds_read_b128 v[132:135], v24 offset:36864
    v_mfma_f32_32x32x16_bf16 v[224:239], v[148:151], v[152:155], v[224:239]
    s_add_u32 m0, s46, 32768
    s_add_u32 s47, s45, s44
    buffer_load_dwordx4 v9, s[4:7], s47 offen lds
    v_mfma_f32_32x32x16_bf16 v[240:255], v[148:151], v[156:159], v[240:255]
    buffer_load_dwordx4 v10, s[4:7], s47 offen offset:1024 lds
    s_waitcnt lgkmcnt(0)
    v_mfma_f32_32x32x16_bf16 v[192:207], v[128:131], v[136:139], v[192:207]
    ds_read_b128 v[144:147], v25 offset:32768
    ds_read_b64_tr_b16 v[152:153], v14 offset:34816
    ds_read_b64_tr_b16 v[154:155], v14 offset:35328
    v_mfma_f32_32x32x16_bf16 v[208:223], v[128:131], v[140:143], v[208:223]
    ds_read_b64_tr_b16 v[156:157], v15 offset:34816
    ds_read_b64_tr_b16 v[158:159], v15 offset:35328
    ds_read_b128 v[148:151], v25 offset:36864
    v_mfma_f32_32x32x16_bf16 v[224:239], v[132:135], v[136:139], v[224:239]
    s_add_u32 m0, s48, 32768
    s_nop 0
    buffer_load_dwordx4 v11, s[8:11], s41 offen lds
    v_mfma_f32_32x32x16_bf16 v[240:255], v[132:135], v[140:143], v[240:255]
    buffer_load_dwordx4 v12, s[8:11], s41 offen offset:1024 lds
    s_waitcnt lgkmcnt(0)
    v_mfma_f32_32x32x16_bf16 v[192:207], v[144:147], v[152:155], v[192:207]
    ds_read_b128 v[128:131], v26 offset:32768
    ds_read_b64_tr_b16 v[136:137], v14 offset:36864
    ds_read_b64_tr_b16 v[138:139], v14 offset:37376
    v_mfma_f32_32x32x16_bf16 v[208:223], v[144:147], v[156:159], v[208:223]
    ds_read_b64_tr_b16 v[140:141], v15 offset:36864
    ds_read_b64_tr_b16 v[142:143], v15 offset:37376
    ds_read_b128 v[132:135], v26 offset:36864
    v_mfma_f32_32x32x16_bf16 v[224:239], v[148:151], v[152:155], v[224:239]
    s_add_u32 m0, s46, 34816
    s_add_u32 s47, s47, 20480
    buffer_load_dwordx4 v9, s[4:7], s47 offen lds
    v_mfma_f32_32x32x16_bf16 v[240:255], v[148:151], v[156:159], v[240:255]
    buffer_load_dwordx4 v10, s[4:7], s47 offen offset:1024 lds
    s_add_u32 s44, s44, 128
    s_cmp_eq_u32 s44, 1280
    s_cselect_b32 s44, 0, s44
    s_waitcnt lgkmcnt(0)
    v_mfma_f32_32x32x16_bf16 v[192:207], v[128:131], v[136:139], v[192:207]
    ds_read_b128 v[144:147], v27 offset:32768
    ds_read_b64_tr_b16 v[152:153], v14 offset:38912
    ds_read_b64_tr_b16 v[154:155], v14 offset:39424
    v_mfma_f32_32x32x16_bf16 v[208:223], v[128:131], v[140:143], v[208:223]
    ds_read_b64_tr_b16 v[156:157], v15 offset:38912
    ds_read_b64_tr_b16 v[158:159], v15 offset:39424
    ds_read_b128 v[148:151], v27 offset:36864
    v_mfma_f32_32x32x16_bf16 v[224:239], v[132:135], v[136:139], v[224:239]
    s_add_u32 m0, s48, 34816
    s_add_u32 s41, s41, 61440
    buffer_load_dwordx4 v11, s[8:11], s41 offen lds
    buffer_load_dwordx4 v12, s[8:11], s41 offen offset:1024 lds
    s_add_u32 s41, s41, 184320
    s_cmp_eq_u32 s41, 2457600
    s_cselect_b32 s41, 0, s41
    v_mfma_f32_32x32x16_bf16 v[240:255], v[132:135], v[140:143], v[240:255]
    s_mov_b32 s33, 4096
    buffer_store_dwordx4 v[120:123], v30, s[12:15], s33 offen sc1
    s_waitcnt vmcnt(9) lgkmcnt(0)
    s_barrier
    v_mfma_f32_32x32x16_bf16 v[192:207], v[144:147], v[152:155], v[192:207]
    v_xor_b32 v24, 0x10000, v24
    v_xor_b32 v14, 0x10000, v14
    v_xor_b32 v15, 0x10000, v15
    ds_read_b128 v[128:131], v24 offset:0
    ds_read_b64_tr_b16 v[136:137], v14 offset:0
    ds_read_b64_tr_b16 v[138:139], v14 offset:512
    v_mfma_f32_32x32x16_bf16 v[208:223], v[144:147], v[156:159], v[208:223]
    ds_read_b64_tr_b16 v[140:141], v15 offset:0
    ds_read_b64_tr_b16 v[142:143], v15 offset:512
    ds_read_b128 v[132:135], v24 offset:4096
    v_mfma_f32_32x32x16_bf16 v[224:239], v[148:151], v[152:155], v[224:239]
    s_add_u32 m0, s46, 65536
    s_add_u32 s47, s45, s44
    buffer_load_dwordx4 v9, s[4:7], s47 offen lds
    v_mfma_f32_32x32x16_bf16 v[240:255], v[148:151], v[156:159], v[240:255]
    buffer_load_dwordx4 v10, s[4:7], s47 offen offset:1024 lds
    s_waitcnt lgkmcnt(0)
    v_mfma_f32_32x32x16_bf16 v[192:207], v[128:131], v[136:139], v[192:207]
    v_xor_b32 v25, 0x10000, v25
    ds_read_b128 v[144:147], v25 offset:0
    ds_read_b64_tr_b16 v[152:153], v14 offset:2048
    ds_read_b64_tr_b16 v[154:155], v14 offset:2560
    v_mfma_f32_32x32x16_bf16 v[208:223], v[128:131], v[140:143], v[208:223]
    ds_read_b64_tr_b16 v[156:157], v15 offset:2048
    ds_read_b64_tr_b16 v[158:159], v15 offset:2560
    ds_read_b128 v[148:151], v25 offset:4096
    v_mfma_f32_32x32x16_bf16 v[224:239], v[132:135], v[136:139], v[224:239]
    s_add_u32 m0, s48, 65536
    s_nop 0
    buffer_load_dwordx4 v11, s[8:11], s41 offen lds
    v_mfma_f32_32x32x16_bf16 v[240:255], v[132:135], v[140:143], v[240:255]
    buffer_load_dwordx4 v12, s[8:11], s41 offen offset:1024 lds
    s_waitcnt lgkmcnt(0)
    v_mfma_f32_32x32x16_bf16 v[192:207], v[144:147], v[152:155], v[192:207]
    v_xor_b32 v26, 0x10000, v26
    ds_read_b128 v[128:131], v26 offset:0
    ds_read_b64_tr_b16 v[136:137], v14 offset:4096
    ds_read_b64_tr_b16 v[138:139], v14 offset:4608
    v_mfma_f32_32x32x16_bf16 v[208:223], v[144:147], v[156:159], v[208:223]
    ds_read_b64_tr_b16 v[140:141], v15 offset:4096
    ds_read_b64_tr_b16 v[142:143], v15 offset:4608
    ds_read_b128 v[132:135], v26 offset:4096
    v_mfma_f32_32x32x16_bf16 v[224:239], v[148:151], v[152:155], v[224:239]
    s_add_u32 m0, s46, 67584
    s_add_u32 s47, s47, 20480
    buffer_load_dwordx4 v9, s[4:7], s47 offen lds
    v_mfma_f32_32x32x16_bf16 v[240:255], v[148:151], v[156:159], v[240:255]
    buffer_load_dwordx4 v10, s[4:7], s47 offen offset:1024 lds
    s_add_u32 s44, s44, 128
    s_cmp_eq_u32 s44, 1280
    s_cselect_b32 s44, 0, s44
    s_waitcnt lgkmcnt(0)
    v_mfma_f32_32x32x16_bf16 v[192:207], v[128:131], v[136:139], v[192:207]
    v_xor_b32 v27, 0x10000, v27
    ds_read_b128 v[144:147], v27 offset:0
    ds_read_b64_tr_b16 v[152:153], v14 offset:6144
    ds_read_b64_tr_b16 v[154:155], v14 offset:6656
    v_mfma_f32_32x32x16_bf16 v[208:223], v[128:131], v[140:143], v[208:223]
    ds_read_b64_tr_b16 v[156:157], v15 offset:6144
    ds_read_b64_tr_b16 v[158:159], v15 offset:6656
    ds_read_b128 v[148:151], v27 offset:4096
    v_mfma_f32_32x32x16_bf16 v[224:239], v[132:135], v[136:139], v[224:239]
    s_add_u32 m0, s48, 67584
    s_add_u32 s41, s41, 61440
    buffer_load_dwordx4 v11, s[8:11], s41 offen lds
    v_mfma_f32_32x32x16_bf16 v[240:255], v[132:135], v[140:143], v[240:255]
    buffer_load_dwordx4 v12, s[8:11], s41 offen offset:1024 lds
    s_add_u32 s41, s41, 184320
    s_cmp_eq_u32 s41, 2457600
    s_cselect_b32 s41, 0, s41
    s_waitcnt vmcnt(9) lgkmcnt(0)
    s_barrier
    v_mfma_f32_32x32x16_bf16 v[192:207], v[144:147], v[152:155], v[192:207]
    ds_read_b128 v[128:131], v24 offset:32768
    ds_read_b64_tr_b16 v[136:137], v14 offset:32768
    ds_read_b64_tr_b16 v[138:139], v14 offset:33280
    v_mfma_f32_32x32x16_bf16 v[208:223], v[144:147], v[156:159], v[208:223]
    ds_read_b64_tr_b16 v[140:141], v15 offset:32768
    ds_read_b64_tr_b16 v[142:143], v15 offset:33280
    ds_read_b128 v[132:135], v24 offset:36864
    v_mfma_f32_32x32x16_bf16 v[224:239], v[148:151], v[152:155], v[224:239]
    s_add_u32 m0, s46, 98304
    s_add_u32 s47, s45, s44
    buffer_load_dwordx4 v9, s[4:7], s47 offen lds
    v_mfma_f32_32x32x16_bf16 v[240:255], v[148:151], v[156:159], v[240:255]
    buffer_load_dwordx4 v10, s[4:7], s47 offen offset:1024 lds
    s_waitcnt lgkmcnt(0)
    v_mfma_f32_32x32x16_bf16 v[192:207], v[128:131], v[136:139], v[192:207]
    ds_read_b128 v[144:147], v25 offset:32768
    ds_read_b64_tr_b16 v[152:153], v14 offset:34816
    ds_read_b64_tr_b16 v[154:155], v14 offset:35328
    v_mfma_f32_32x32x16_bf16 v[208:223], v[128:131], v[140:143], v[208:223]
    ds_read_b64_tr_b16 v[156:157], v15 offset:34816
    ds_read_b64_tr_b16 v[158:159], v15 offset:35328
    ds_read_b128 v[148:151], v25 offset:36864
    v_mfma_f32_32x32x16_bf16 v[224:239], v[132:135], v[136:139], v[224:239]
    s_add_u32 m0, s48, 98304
    s_nop 0
    buffer_load_dwordx4 v11, s[8:11], s41 offen lds
    v_mfma_f32_32x32x16_bf16 v[240:255], v[132:135], v[140:143], v[240:255]
    buffer_load_dwordx4 v12, s[8:11], s41 offen offset:1024 lds
    s_waitcnt lgkmcnt(0)
    v_mfma_f32_32x32x16_bf16 v[192:207], v[144:147], v[152:155], v[192:207]
    ds_read_b128 v[128:131], v26 offset:32768
    ds_read_b64_tr_b16 v[136:137], v14 offset:36864
    ds_read_b64_tr_b16 v[138:139], v14 offset:37376
    v_mfma_f32_32x32x16_bf16 v[208:223], v[144:147], v[156:159], v[208:223]
    ds_read_b64_tr_b16 v[140:141], v15 offset:36864
    ds_read_b64_tr_b16 v[142:143], v15 offset:37376
    ds_read_b128 v[132:135], v26 offset:36864
    v_mfma_f32_32x32x16_bf16 v[224:239], v[148:151], v[152:155], v[224:239]
    s_add_u32 m0, s46, 100352
    s_add_u32 s47, s47, 20480
    buffer_load_dwordx4 v9, s[4:7], s47 offen lds
    v_mfma_f32_32x32x16_bf16 v[240:255], v[148:151], v[156:159], v[240:255]
    buffer_load_dwordx4 v10, s[4:7], s47 offen offset:1024 lds
    s_add_u32 s44, s44, 128
    s_cmp_eq_u32 s44, 1280
    s_cselect_b32 s44, 0, s44
    s_waitcnt lgkmcnt(0)
    v_mfma_f32_32x32x16_bf16 v[192:207], v[128:131], v[136:139], v[192:207]
    ds_read_b128 v[144:147], v27 offset:32768
    ds_read_b64_tr_b16 v[152:153], v14 offset:38912
    ds_read_b64_tr_b16 v[154:155], v14 offset:39424
    v_mfma_f32_32x32x16_bf16 v[208:223], v[128:131], v[140:143], v[208:223]
    ds_read_b64_tr_b16 v[156:157], v15 offset:38912
    ds_read_b64_tr_b16 v[158:159], v15 offset:39424
    ds_read_b128 v[148:151], v27 offset:36864
    v_mfma_f32_32x32x16_bf16 v[224:239], v[132:135], v[136:139], v[224:239]
    s_add_u32 m0, s48, 100352
    s_add_u32 s41, s41, 61440
    buffer_load_dwordx4 v11, s[8:11], s41 offen lds
    v_mfma_f32_32x32x16_bf16 v[240:255], v[132:135], v[140:143], v[240:255]
    buffer_load_dwordx4 v12, s[8:11], s41 offen offset:1024 lds
    s_add_u32 s41, s41, 184320
    s_cmp_eq_u32 s41, 2457600
    s_cselect_b32 s41, 0, s41
    s_waitcnt vmcnt(8) lgkmcnt(0)
    s_barrier
    v_mfma_f32_32x32x16_bf16 v[192:207], v[144:147], v[152:155], v[192:207]
    v_xor_b32 v24, 0x10000, v24
    v_xor_b32 v14, 0x10000, v14
    v_xor_b32 v15, 0x10000, v15
    ds_read_b128 v[128:131], v24 offset:0
    ds_read_b64_tr_b16 v[136:137], v14 offset:0
    ds_read_b64_tr_b16 v[138:139], v14 offset:512
    v_mfma_f32_32x32x16_bf16 v[208:223], v[144:147], v[156:159], v[208:223]
    ds_read_b64_tr_b16 v[140:141], v15 offset:0
    ds_read_b64_tr_b16 v[142:143], v15 offset:512
    ds_read_b128 v[132:135], v24 offset:4096
    v_mfma_f32_32x32x16_bf16 v[224:239], v[148:151], v[152:155], v[224:239]
    s_add_u32 m0, s46, 0
    s_add_u32 s47, s45, s44
    buffer_load_dwordx4 v9, s[4:7], s47 offen lds
    v_mfma_f32_32x32x16_bf16 v[240:255], v[148:151], v[156:159], v[240:255]
    buffer_load_dwordx4 v10, s[4:7], s47 offen offset:1024 lds
    s_waitcnt lgkmcnt(0)
    v_mfma_f32_32x32x16_bf16 v[192:207], v[128:131], v[136:139], v[192:207]
    v_xor_b32 v25, 0x10000, v25
    ds_read_b128 v[144:147], v25 offset:0
    ds_read_b64_tr_b16 v[152:153], v14 offset:2048
    ds_read_b64_tr_b16 v[154:155], v14 offset:2560
    v_mfma_f32_32x32x16_bf16 v[208:223], v[128:131], v[140:143], v[208:223]
    ds_read_b64_tr_b16 v[156:157], v15 offset:2048
    ds_read_b64_tr_b16 v[158:159], v15 offset:2560
    ds_read_b128 v[148:151], v25 offset:4096
    v_mfma_f32_32x32x16_bf16 v[224:239], v[132:135], v[136:139], v[224:239]
    s_add_u32 m0, s48, 0
    s_nop 0
    buffer_load_dwordx4 v11, s[8:11], s41 offen lds
    v_mfma_f32_32x32x16_bf16 v[240:255], v[132:135], v[140:143], v[240:255]
    buffer_load_dwordx4 v12, s[8:11], s41 offen offset:1024 lds
    s_waitcnt lgkmcnt(0)
    v_mfma_f32_32x32x16_bf16 v[192:207], v[144:147], v[152:155], v[192:207]
    v_xor_b32 v26, 0x10000, v26
    ds_read_b128 v[128:131], v26 offset:0
    ds_read_b64_tr_b16 v[136:137], v14 offset:4096
    ds_read_b64_tr_b16 v[138:139], v14 offset:4608
    v_mfma_f32_32x32x16_bf16 v[208:223], v[144:147], v[156:159], v[208:223]
    ds_read_b64_tr_b16 v[140:141], v15 offset:4096
    ds_read_b64_tr_b16 v[142:143], v15 offset:4608
    ds_read_b128 v[132:135], v26 offset:4096
    v_mfma_f32_32x32x16_bf16 v[224:239], v[148:151], v[152:155], v[224:239]
    s_add_u32 m0, s46, 2048
    s_add_u32 s47, s47, 20480
    buffer_load_dwordx4 v9, s[4:7], s47 offen lds
    v_mfma_f32_32x32x16_bf16 v[240:255], v[148:151], v[156:159], v[240:255]
    buffer_load_dwordx4 v10, s[4:7], s47 offen offset:1024 lds
    s_add_u32 s44, s44, 128
    s_cmp_eq_u32 s44, 1280
    s_cselect_b32 s44, 0, s44
    s_waitcnt lgkmcnt(0)
    v_mfma_f32_32x32x16_bf16 v[192:207], v[128:131], v[136:139], v[192:207]
    v_xor_b32 v27, 0x10000, v27
    ds_read_b128 v[144:147], v27 offset:0
    ds_read_b64_tr_b16 v[152:153], v14 offset:6144
    ds_read_b64_tr_b16 v[154:155], v14 offset:6656
    v_mfma_f32_32x32x16_bf16 v[208:223], v[128:131], v[140:143], v[208:223]
    ds_read_b64_tr_b16 v[156:157], v15 offset:6144
    ds_read_b64_tr_b16 v[158:159], v15 offset:6656
    ds_read_b128 v[148:151], v27 offset:4096
    v_mfma_f32_32x32x16_bf16 v[224:239], v[132:135], v[136:139], v[224:239]
    s_add_u32 m0, s48, 2048
    s_add_u32 s41, s41, 61440
    buffer_load_dwordx4 v11, s[8:11], s41 offen lds
    v_mfma_f32_32x32x16_bf16 v[240:255], v[132:135], v[140:143], v[240:255]
    buffer_load_dwordx4 v12, s[8:11], s41 offen offset:1024 lds
    s_add_u32 s41, s41, 184320
    s_cmp_eq_u32 s41, 2457600
    s_cselect_b32 s41, 0, s41
    s_waitcnt vmcnt(8) lgkmcnt(0)
    s_barrier
    v_mfma_f32_32x32x16_bf16 v[192:207], v[144:147], v[152:155], v[192:207]
    ds_read_b128 v[128:131], v24 offset:32768
    ds_read_b64_tr_b16 v[136:137], v14 offset:32768
    ds_read_b64_tr_b16 v[138:139], v14 offset:33280
    v_mfma_f32_32x32x16_bf16 v[208:223], v[144:147], v[156:159], v[208:223]
    ds_read_b64_tr_b16 v[140:141], v15 offset:32768
    ds_read_b64_tr_b16 v[142:143], v15 offset:33280
    ds_read_b128 v[132:135], v24 offset:36864
    v_mfma_f32_32x32x16_bf16 v[224:239], v[148:151], v[152:155], v[224:239]
    s_add_u32 m0, s46, 32768
    s_add_u32 s47, s45, s44
    buffer_load_dwordx4 v9, s[4:7], s47 offen lds
    v_mfma_f32_32x32x16_bf16 v[240:255], v[148:151], v[156:159], v[240:255]
    buffer_load_dwordx4 v10, s[4:7], s47 offen offset:1024 lds
    s_waitcnt lgkmcnt(0)
    v_mfma_f32_32x32x16_bf16 v[192:207], v[128:131], v[136:139], v[192:207]
    ds_read_b128 v[144:147], v25 offset:32768
    ds_read_b64_tr_b16 v[152:153], v14 offset:34816
    ds_read_b64_tr_b16 v[154:155], v14 offset:35328
    v_mfma_f32_32x32x16_bf16 v[208:223], v[128:131], v[140:143], v[208:223]
    ds_read_b64_tr_b16 v[156:157], v15 offset:34816
    ds_read_b64_tr_b16 v[158:159], v15 offset:35328
    ds_read_b128 v[148:151], v25 offset:36864
    v_mfma_f32_32x32x16_bf16 v[224:239], v[132:135], v[136:139], v[224:239]
    s_add_u32 m0, s48, 32768
    s_nop 0
    buffer_load_dwordx4 v11, s[8:11], s41 offen lds
    v_mfma_f32_32x32x16_bf16 v[240:255], v[132:135], v[140:143], v[240:255]
    buffer_load_dwordx4 v12, s[8:11], s41 offen offset:1024 lds
    s_waitcnt lgkmcnt(0)
    v_mfma_f32_32x32x16_bf16 v[192:207], v[144:147], v[152:155], v[192:207]
    ds_read_b128 v[128:131], v26 offset:32768
    ds_read_b64_tr_b16 v[136:137], v14 offset:36864
    ds_read_b64_tr_b16 v[138:139], v14 offset:37376
    v_mfma_f32_32x32x16_bf16 v[208:223], v[144:147], v[156:159], v[208:223]
    ds_read_b64_tr_b16 v[140:141], v15 offset:36864
    ds_read_b64_tr_b16 v[142:143], v15 offset:37376
    ds_read_b128 v[132:135], v26 offset:36864
    v_mfma_f32_32x32x16_bf16 v[224:239], v[148:151], v[152:155], v[224:239]
    s_add_u32 m0, s46, 34816
    s_add_u32 s47, s47, 20480
    buffer_load_dwordx4 v9, s[4:7], s47 offen lds
    v_mfma_f32_32x32x16_bf16 v[240:255], v[148:151], v[156:159], v[240:255]
    buffer_load_dwordx4 v10, s[4:7], s47 offen offset:1024 lds
    s_add_u32 s44, s44, 128
    s_cmp_eq_u32 s44, 1280
    s_cselect_b32 s44, 0, s44
    s_waitcnt lgkmcnt(0)
    v_mfma_f32_32x32x16_bf16 v[192:207], v[128:131], v[136:139], v[192:207]
    ds_read_b128 v[144:147], v27 offset:32768
    ds_read_b64_tr_b16 v[152:153], v14 offset:38912
    ds_read_b64_tr_b16 v[154:155], v14 offset:39424
    v_mfma_f32_32x32x16_bf16 v[208:223], v[128:131], v[140:143], v[208:223]
    ds_read_b64_tr_b16 v[156:157], v15 offset:38912
    ds_read_b64_tr_b16 v[158:159], v15 offset:39424
    ds_read_b128 v[148:151], v27 offset:36864
    v_mfma_f32_32x32x16_bf16 v[224:239], v[132:135], v[136:139], v[224:239]
    s_add_u32 m0, s48, 34816
    s_add_u32 s41, s41, 61440
    buffer_load_dwordx4 v11, s[8:11], s41 offen lds
    buffer_load_dwordx4 v12, s[8:11], s41 offen offset:1024 lds
    s_add_u32 s41, s41, 184320
    s_cmp_eq_u32 s41, 2457600
    s_cselect_b32 s41, 0, s41
    v_mfma_f32_32x32x16_bf16 v[240:255], v[132:135], v[140:143], v[240:255]
    s_lshl_b32 s49, s55, 10
    s_add_u32 s49, s49, 720896
    s_lshl_b32 s51, s25, 1
    s_add_u32 s51, s51, s42
    s_lshl_b32 s50, s51, 10
    s_add_u32 s50, s50, 655360
    buffer_load_dwordx2 v[52:53], v21, s[12:15], s49 offen offset:0 sc1
    buffer_load_dwordx2 v[54:55], v21, s[12:15], s49 offen offset:512 sc1
    buffer_load_dwordx4 v[72:75], v22, s[12:15], s50 offen sc1
    s_waitcnt vmcnt(11) lgkmcnt(0)
    s_barrier
    v_mfma_f32_32x32x16_bf16 v[192:207], v[144:147], v[152:155], v[192:207]
    v_xor_b32 v24, 0x10000, v24
    v_xor_b32 v14, 0x10000, v14
    v_xor_b32 v15, 0x10000, v15
    ds_read_b128 v[128:131], v24 offset:0
    ds_read_b64_tr_b16 v[136:137], v14 offset:0
    ds_read_b64_tr_b16 v[138:139], v14 offset:512
    v_mfma_f32_32x32x16_bf16 v[208:223], v[144:147], v[156:159], v[208:223]
    ds_read_b64_tr_b16 v[140:141], v15 offset:0
    ds_read_b64_tr_b16 v[142:143], v15 offset:512
    ds_read_b128 v[132:135], v24 offset:4096
    v_mfma_f32_32x32x16_bf16 v[224:239], v[148:151], v[152:155], v[224:239]
    v_mfma_f32_32x32x16_bf16 v[240:255], v[148:151], v[156:159], v[240:255]
    s_waitcnt lgkmcnt(0)
    v_mfma_f32_32x32x16_bf16 v[192:207], v[128:131], v[136:139], v[192:207]
    v_xor_b32 v25, 0x10000, v25
    ds_read_b128 v[144:147], v25 offset:0
    ds_read_b64_tr_b16 v[152:153], v14 offset:2048
    ds_read_b64_tr_b16 v[154:155], v14 offset:2560
    v_mfma_f32_32x32x16_bf16 v[208:223], v[128:131], v[140:143], v[208:223]
    ds_read_b64_tr_b16 v[156:157], v15 offset:2048
    ds_read_b64_tr_b16 v[158:159], v15 offset:2560
    ds_read_b128 v[148:151], v25 offset:4096
    v_mfma_f32_32x32x16_bf16 v[224:239], v[132:135], v[136:139], v[224:239]
    v_mfma_f32_32x32x16_bf16 v[240:255], v[132:135], v[140:143], v[240:255]
    s_waitcnt lgkmcnt(0)
    v_mfma_f32_32x32x16_bf16 v[192:207], v[144:147], v[152:155], v[192:207]
    v_xor_b32 v26, 0x10000, v26
    ds_read_b128 v[128:131], v26 offset:0
    ds_read_b64_tr_b16 v[136:137], v14 offset:4096
    ds_read_b64_tr_b16 v[138:139], v14 offset:4608
    v_mfma_f32_32x32x16_bf16 v[208:223], v[144:147], v[156:159], v[208:223]
    ds_read_b64_tr_b16 v[140:141], v15 offset:4096
    ds_read_b64_tr_b16 v[142:143], v15 offset:4608
    ds_read_b128 v[132:135], v26 offset:4096
    v_mfma_f32_32x32x16_bf16 v[224:239], v[148:151], v[152:155], v[224:239]
    v_mfma_f32_32x32x16_bf16 v[240:255], v[148:151], v[156:159], v[240:255]
    s_waitcnt lgkmcnt(0)
    v_mfma_f32_32x32x16_bf16 v[192:207], v[128:131], v[136:139], v[192:207]
    v_xor_b32 v27, 0x10000, v27
    ds_read_b128 v[144:147], v27 offset:0
    ds_read_b64_tr_b16 v[152:153], v14 offset:6144
    ds_read_b64_tr_b16 v[154:155], v14 offset:6656
    v_mfma_f32_32x32x16_bf16 v[208:223], v[128:131], v[140:143], v[208:223]
    ds_read_b64_tr_b16 v[156:157], v15 offset:6144
    ds_read_b64_tr_b16 v[158:159], v15 offset:6656
    ds_read_b128 v[148:151], v27 offset:4096
    v_mfma_f32_32x32x16_bf16 v[224:239], v[132:135], v[136:139], v[224:239]
    v_mfma_f32_32x32x16_bf16 v[240:255], v[132:135], v[140:143], v[240:255]
    s_waitcnt vmcnt(3) lgkmcnt(0)
    s_barrier
    v_mfma_f32_32x32x16_bf16 v[192:207], v[144:147], v[152:155], v[192:207]
    ds_read_b128 v[128:131], v24 offset:32768
    ds_read_b64_tr_b16 v[136:137], v14 offset:32768
    ds_read_b64_tr_b16 v[138:139], v14 offset:33280
    v_mfma_f32_32x32x16_bf16 v[208:223], v[144:147], v[156:159], v[208:223]
    ds_read_b64_tr_b16 v[140:141], v15 offset:32768
    ds_read_b64_tr_b16 v[142:143], v15 offset:33280
    ds_read_b128 v[132:135], v24 offset:36864
    v_mfma_f32_32x32x16_bf16 v[224:239], v[148:151], v[152:155], v[224:239]
    s_lshl_b32 s32, s3, 10
    s_add_u32 s32, s32, 131072
    v_lshl_add_u32 v13, v1, 2, s32
    v_lshl_add_u32 v23, v2, 4, s32
    v_mfma_f32_32x32x16_bf16 v[240:255], v[148:151], v[156:159], v[240:255]
    s_waitcnt vmcnt(0)
    s_mov_b32 s67, 131072
L_p1chk_3:
    v_xor_b32 v53, s24, v53
    v_xor_b32 v55, s24, v55
    v_xor_b32 v73, s24, v73
    v_xor_b32 v75, s24, v75
    v_or3_b32 v53, v53, v55, v73
    v_or_b32 v53, v53, v75
    v_cmp_ne_u32 vcc, 0, v53
    s_sub_u32 s67, s67, 1
    s_cbranch_scc1 L_p1ok_4
    s_nop 2
    s_cbranch_vccz L_p1ok_4
    buffer_load_dwordx2 v[52:53], v21, s[12:15], s49 offen offset:0 sc1
    buffer_load_dwordx2 v[54:55], v21, s[12:15], s49 offen offset:512 sc1
    buffer_load_dwordx4 v[72:75], v22, s[12:15], s50 offen sc1
    s_waitcnt vmcnt(0)
    s_branch L_p1chk_3
L_p1ok_4:
    v_add_f32 v52, v52, v54
    ds_write_b32 v13, v72 offset:256
    ds_write_b32 v13, v74 offset:512
    s_waitcnt lgkmcnt(2)
    v_mfma_f32_32x32x16_bf16 v[192:207], v[128:131], v[136:139], v[192:207]
    ds_read_b128 v[144:147], v25 offset:32768
    ds_read_b64_tr_b16 v[152:153], v14 offset:34816
    ds_read_b64_tr_b16 v[154:155], v14 offset:35328
    v_mfma_f32_32x32x16_bf16 v[208:223], v[128:131], v[140:143], v[208:223]
    ds_read_b64_tr_b16 v[156:157], v15 offset:34816
    ds_read_b64_tr_b16 v[158:159], v15 offset:35328
    ds_read_b128 v[148:151], v25 offset:36864
    v_mfma_f32_32x32x16_bf16 v[224:239], v[132:135], v[136:139], v[224:239]
    v_mov_b32 v110, v52
    v_mov_b32 v111, v52
    v_mul_u32_u24 v16, 10240, v2
    v_lshl_add_u32 v16, v8, 4, v16
    v_mfma_f32_32x32x16_bf16 v[240:255], v[132:135], v[140:143], v[240:255]
    v_permlane32_swap_b32 v110, v111
    ds_read_b128 v[160:163], v23 offset:256
    ds_read_b128 v[164:167], v23 offset:288
    ds_read_b128 v[168:171], v23 offset:320
    s_waitcnt lgkmcnt(3)
    v_mfma_f32_32x32x16_bf16 v[192:207], v[144:147], v[152:155], v[192:207]
    ds_read_b128 v[128:131], v26 offset:32768
    ds_read_b64_tr_b16 v[136:137], v14 offset:36864
    ds_read_b64_tr_b16 v[138:139], v14 offset:37376
    v_mfma_f32_32x32x16_bf16 v[208:223], v[144:147], v[156:159], v[208:223]
    ds_read_b64_tr_b16 v[140:141], v15 offset:36864
    ds_read_b64_tr_b16 v[142:143], v15 offset:37376
    ds_read_b128 v[132:135], v26 offset:36864
    v_mfma_f32_32x32x16_bf16 v[224:239], v[148:151], v[152:155], v[224:239]
    ds_read_b128 v[172:175], v23 offset:352
    ds_read_b128 v[76:79], v23 offset:512
    ds_read_b128 v[80:83], v23 offset:544
    ds_read_b128 v[84:87], v23 offset:576
    v_mfma_f32_32x32x16_bf16 v[240:255], v[148:151], v[156:159], v[240:255]
    ds_read_b128 v[88:91], v23 offset:608
    ds_read_b128 v[176:179], v23 offset:384
    ds_read_b128 v[180:183], v23 offset:416
    ds_read_b128 v[184:187], v23 offset:448
    s_waitcnt lgkmcnt(8)
    v_mfma_f32_32x32x16_bf16 v[192:207], v[128:131], v[136:139], v[192:207]
    ds_read_b128 v[144:147], v27 offset:32768
    ds_read_b64_tr_b16 v[152:153], v14 offset:38912
    ds_read_b64_tr_b16 v[154:155], v14 offset:39424
    v_mfma_f32_32x32x16_bf16 v[208:223], v[128:131], v[140:143], v[208:223]
    ds_read_b64_tr_b16 v[156:157], v15 offset:38912
    ds_read_b64_tr_b16 v[158:159], v15 offset:39424
    ds_read_b128 v[148:151], v27 offset:36864
    v_mfma_f32_32x32x16_bf16 v[224:239], v[132:135], v[136:139], v[224:239]
    ds_read_b128 v[188:191], v23 offset:480
    ds_read_b128 v[92:95], v23 offset:640
    ds_read_b128 v[96:99], v23 offset:672
    ds_read_b128 v[100:103], v23 offset:704
    v_mfma_f32_32x32x16_bf16 v[240:255], v[132:135], v[140:143], v[240:255]
    ds_read_b128 v[104:107], v23 offset:736
    s_mul_i32 s34, s51, 81920
    s_lshl_b32 s35, s55, 10
    s_add_u32 s34, s34, s35
    s_waitcnt lgkmcnt(5)
    v_mfma_f32_32x32x16_bf16 v[192:207], v[144:147], v[152:155], v[192:207]
    v_mfma_f32_32x32x16_bf16 v[208:223], v[144:147], v[156:159], v[208:223]
    v_mfma_f32_32x32x16_bf16 v[224:239], v[148:151], v[152:155], v[224:239]
    s_add_u32 s34, s34, 6270976
    v_mfma_f32_32x32x16_bf16 v[240:255], v[148:151], v[156:159], v[240:255]
    s_waitcnt lgkmcnt(0)
    s_nop 6
    v_pk_mul_f32 v[192:193], v[192:193], v[160:161]
    v_pk_mul_f32 v[194:195], v[194:195], v[162:163]
    v_pk_mul_f32 v[196:197], v[196:197], v[164:165]
    v_pk_mul_f32 v[198:199], v[198:199], v[166:167]
    v_pk_fma_f32 v[192:193], v[76:77], v[110:111], v[192:193] op_sel:[0,0,0] op_sel_hi:[1,0,1]
    v_pk_fma_f32 v[194:195], v[78:79], v[110:111], v[194:195] op_sel:[0,0,0] op_sel_hi:[1,0,1]
    v_pk_fma_f32 v[196:197], v[80:81], v[110:111], v[196:197] op_sel:[0,0,0] op_sel_hi:[1,0,1]
    v_pk_fma_f32 v[198:199], v[82:83], v[110:111], v[198:199] op_sel:[0,0,0] op_sel_hi:[1,0,1]
    v_cvt_pk_bf16_f32 v192, v192, v193
    v_cvt_pk_bf16_f32 v193, v194, v195
    v_cvt_pk_bf16_f32 v194, v196, v197
    v_cvt_pk_bf16_f32 v195, v198, v199
    s_add_u32 s35, s34, 0
    buffer_store_dwordx4 v[192:195], v16, s[12:15], s35 offen offset:0 sc1
    v_pk_mul_f32 v[200:201], v[200:201], v[168:169]
    v_pk_mul_f32 v[202:203], v[202:203], v[170:171]
    v_pk_mul_f32 v[204:205], v[204:205], v[172:173]
    v_pk_mul_f32 v[206:207], v[206:207], v[174:175]
    v_pk_fma_f32 v[200:201], v[84:85], v[110:111], v[200:201] op_sel:[0,0,0] op_sel_hi:[1,0,1]
    v_pk_fma_f32 v[202:203], v[86:87], v[110:111], v[202:203] op_sel:[0,0,0] op_sel_hi:[1,0,1]
    v_pk_fma_f32 v[204:205], v[88:89], v[110:111], v[204:205] op_sel:[0,0,0] op_sel_hi:[1,0,1]
    v_pk_fma_f32 v[206:207], v[90:91], v[110:111], v[206:207] op_sel:[0,0,0] op_sel_hi:[1,0,1]
    v_cvt_pk_bf16_f32 v200, v200, v201
    v_cvt_pk_bf16_f32 v201, v202, v203
    v_cvt_pk_bf16_f32 v202, v204, v205
    v_cvt_pk_bf16_f32 v203, v206, v207
    s_add_u32 s35, s34, 20480
    buffer_store_dwordx4 v[200:203], v16, s[12:15], s35 offen offset:0 sc1
    v_pk_mul_f32 v[208:209], v[208:209], v[160:161]
    v_pk_mul_f32 v[210:211], v[210:211], v[162:163]
    v_pk_mul_f32 v[212:213], v[212:213], v[164:165]
    v_pk_mul_f32 v[214:215], v[214:215], v[166:167]
    v_pk_fma_f32 v[208:209], v[76:77], v[110:111], v[208:209] op_sel:[0,1,0] op_sel_hi:[1,1,1]
    v_pk_fma_f32 v[210:211], v[78:79], v[110:111], v[210:211] op_sel:[0,1,0] op_sel_hi:[1,1,1]
    v_pk_fma_f32 v[212:213], v[80:81], v[110:111], v[212:213] op_sel:[0,1,0] op_sel_hi:[1,1,1]
    v_pk_fma_f32 v[214:215], v[82:83], v[110:111], v[214:215] op_sel:[0,1,0] op_sel_hi:[1,1,1]
    v_cvt_pk_bf16_f32 v208, v208, v209
    v_cvt_pk_bf16_f32 v209, v210, v211
    v_cvt_pk_bf16_f32 v210, v212, v213
    v_cvt_pk_bf16_f32 v211, v214, v215
    s_add_u32 s35, s34, 0
    buffer_store_dwordx4 v[208:211], v16, s[12:15], s35 offen offset:512 sc1
    v_pk_mul_f32 v[216:217], v[216:217], v[168:169]
    v_pk_mul_f32 v[218:219], v[218:219], v[170:171]
    v_pk_mul_f32 v[220:221], v[220:221], v[172:173]
    v_pk_mul_f32 v[222:223], v[222:223], v[174:175]
    v_pk_fma_f32 v[216:217], v[84:85], v[110:111], v[216:217] op_sel:[0,1,0] op_sel_hi:[1,1,1]
    v_pk_fma_f32 v[218:219], v[86:87], v[110:111], v[218:219] op_sel:[0,1,0] op_sel_hi:[1,1,1]
    v_pk_fma_f32 v[220:221], v[88:89], v[110:111], v[220:221] op_sel:[0,1,0] op_sel_hi:[1,1,1]
    v_pk_fma_f32 v[222:223], v[90:91], v[110:111], v[222:223] op_sel:[0,1,0] op_sel_hi:[1,1,1]
    v_cvt_pk_bf16_f32 v216, v216, v217
    v_cvt_pk_bf16_f32 v217, v218, v219
    v_cvt_pk_bf16_f32 v218, v220, v221
    v_cvt_pk_bf16_f32 v219, v222, v223
    s_add_u32 s35, s34, 20480
    buffer_store_dwordx4 v[216:219], v16, s[12:15], s35 offen offset:512 sc1
    v_pk_mul_f32 v[224:225], v[224:225], v[176:177]
    v_pk_mul_f32 v[226:227], v[226:227], v[178:179]
    v_pk_mul_f32 v[228:229], v[228:229], v[180:181]
    v_pk_mul_f32 v[230:231], v[230:231], v[182:183]
    v_pk_fma_f32 v[224:225], v[92:93], v[110:111], v[224:225] op_sel:[0,0,0] op_sel_hi:[1,0,1]
    v_pk_fma_f32 v[226:227], v[94:95], v[110:111], v[226:227] op_sel:[0,0,0] op_sel_hi:[1,0,1]
    v_pk_fma_f32 v[228:229], v[96:97], v[110:111], v[228:229] op_sel:[0,0,0] op_sel_hi:[1,0,1]
    v_pk_fma_f32 v[230:231], v[98:99], v[110:111], v[230:231] op_sel:[0,0,0] op_sel_hi:[1,0,1]
    v_cvt_pk_bf16_f32 v224, v224, v225
    v_cvt_pk_bf16_f32 v225, v226, v227
    v_cvt_pk_bf16_f32 v226, v228, v229
    v_cvt_pk_bf16_f32 v227, v230, v231
    s_add_u32 s35, s34, 40960
    buffer_store_dwordx4 v[224:227], v16, s[12:15], s35 offen offset:0 sc1
    v_pk_mul_f32 v[232:233], v[232:233], v[184:185]
    v_pk_mul_f32 v[234:235], v[234:235], v[186:187]
    v_pk_mul_f32 v[236:237], v[236:237], v[188:189]
    v_pk_mul_f32 v[238:239], v[238:239], v[190:191]
    v_pk_fma_f32 v[232:233], v[100:101], v[110:111], v[232:233] op_sel:[0,0,0] op_sel_hi:[1,0,1]
    v_pk_fma_f32 v[234:235], v[102:103], v[110:111], v[234:235] op_sel:[0,0,0] op_sel_hi:[1,0,1]
    v_pk_fma_f32 v[236:237], v[104:105], v[110:111], v[236:237] op_sel:[0,0,0] op_sel_hi:[1,0,1]
    v_pk_fma_f32 v[238:239], v[106:107], v[110:111], v[238:239] op_sel:[0,0,0] op_sel_hi:[1,0,1]
    v_cvt_pk_bf16_f32 v232, v232, v233
    v_cvt_pk_bf16_f32 v233, v234, v235
    v_cvt_pk_bf16_f32 v234, v236, v237
    v_cvt_pk_bf16_f32 v235, v238, v239
    s_add_u32 s35, s34, 61440
    buffer_store_dwordx4 v[232:235], v16, s[12:15], s35 offen offset:0 sc1
    v_pk_mul_f32 v[240:241], v[240:241], v[176:177]
    v_pk_mul_f32 v[242:243], v[242:243], v[178:179]
    v_pk_mul_f32 v[244:245], v[244:245], v[180:181]
    v_pk_mul_f32 v[246:247], v[246:247], v[182:183]
    v_pk_fma_f32 v[240:241], v[92:93], v[110:111], v[240:241] op_sel:[0,1,0] op_sel_hi:[1,1,1]
    v_pk_fma_f32 v[242:243], v[94:95], v[110:111], v[242:243] op_sel:[0,1,0] op_sel_hi:[1,1,1]
    v_pk_fma_f32 v[244:245], v[96:97], v[110:111], v[244:245] op_sel:[0,1,0] op_sel_hi:[1,1,1]
    v_pk_fma_f32 v[246:247], v[98:99], v[110:111], v[246:247] op_sel:[0,1,0] op_sel_hi:[1,1,1]
    v_cvt_pk_bf16_f32 v240, v240, v241
    v_cvt_pk_bf16_f32 v241, v242, v243
    v_cvt_pk_bf16_f32 v242, v244, v245
    v_cvt_pk_bf16_f32 v243, v246, v247
    s_add_u32 s35, s34, 40960
    buffer_store_dwordx4 v[240:243], v16, s[12:15], s35 offen offset:512 sc1
    v_pk_mul_f32 v[248:249], v[248:249], v[184:185]
    v_pk_mul_f32 v[250:251], v[250:251], v[186:187]
    v_pk_mul_f32 v[252:253], v[252:253], v[188:189]
    v_pk_mul_f32 v[254:255], v[254:255], v[190:191]
    v_pk_fma_f32 v[248:249], v[100:101], v[110:111], v[248:249] op_sel:[0,1,0] op_sel_hi:[1,1,1]
    v_pk_fma_f32 v[250:251], v[102:103], v[110:111], v[250:251] op_sel:[0,1,0] op_sel_hi:[1,1,1]
    v_pk_fma_f32 v[252:253], v[104:105], v[110:111], v[252:253] op_sel:[0,1,0] op_sel_hi:[1,1,1]
    v_pk_fma_f32 v[254:255], v[106:107], v[110:111], v[254:255] op_sel:[0,1,0] op_sel_hi:[1,1,1]
    v_cvt_pk_bf16_f32 v248, v248, v249
    v_cvt_pk_bf16_f32 v249, v250, v251
    v_cvt_pk_bf16_f32 v250, v252, v253
    v_cvt_pk_bf16_f32 v251, v254, v255
    s_add_u32 s35, s34, 61440
    buffer_store_dwordx4 v[248:251], v16, s[12:15], s35 offen offset:512 sc1
L_p1_done:
    s_lshl_b32 s33, s25, 4
    s_add_u32 s33, s33, s26
    s_lshl_b32 s32, s33, 7
    s_add_u32 s32, s32, 4096
    v_lshl_add_u32 v112, v1, 2, s32
    v_mov_b32 v113, s24
    s_lshr_b32 s32, s27, 1
    s_mul_i32 s32, s32, 5
    s_and_b32 s33, s27, 1
    s_mul_i32 s46, s33, 3
    s_add_u32 s46, s46, s32
    s_mul_i32 s47, s46, 32768
    s_add_u32 s48, s32, 2
    s_mul_i32 s48, s48, 32768
    s_lshl_b32 s49, s33, 3
    s_add_u32 s48, s48, s49
    s_lshl_b32 s49, s3, 13
    s_add_u32 s49, s49, 3407872
    s_add_u32 s34, s47, s49
    s_add_u32 s35, s34, 4096
    s_add_u32 s36, s48, s49
    s_add_u32 s37, s36, 4096
    s_lshl_b32 s49, s28, 12
    s_add_u32 s49, s49, 786432
    s_add_u32 s39, s47, s49
    s_add_u32 s40, s48, s49
    s_mul_i32 s41, s27, 320
    s_mul_i32 s49, s3, 655360
    s_add_u32 s41, s41, s49
    s_add_u32 s41, s41, 6291456
    s_mov_b32 s42, 0x0033ffff
    s_mov_b32 s43, 0x0033ffff
    s_mov_b32 s44, -1
    s_mov_b32 s45, 0
    v_lshrrev_b32 v2, 5, v1
    v_and_b32 v3, 31, v1
    v_mul_u32_u24 v7, 32768, v2
    v_lshl_add_u32 v7, v3, 4, v7
    v_lshlrev_b32 v22, 4, v1
    v_bfe_u32 v9, v1, 2, 1
    v_bfe_u32 v10, v1, 3, 1
    v_and_b32 v11, 3, v1
    v_lshl_add_u32 v12, v9, 3, v11
    v_lshl_add_u32 v12, v10, 2, v12
    v_lshl_add_u32 v13, v9, 1, v11
    v_add_u32 v13, 16, v13
    v_cmp_gt_u32 vcc, 16, v3
    s_nop 1
    v_cndmask_b32 v12, v13, v12, vcc
    v_mul_u32_u24 v13, 10240, v2
    v_lshl_add_u32 v8, v12, 4, v13
    v_add_u32 v6, 20480, v8
    s_mul_i32 s49, s27, 20
    v_lshrrev_b32 v9, 3, v1
    v_add_u32 v10, 1, v9
    v_mul_u32_u24 v10, 640, v10
    v_cmp_gt_u32 vcc, 2, v9
    s_nop 1
    v_cndmask_b32 v10, 0, v10, vcc
    v_bfe_u32 v11, v1, 2, 1
    v_mad_u32_u24 v10, v11, 19, v10
    v_add_u32 v10, s49, v10
    v_lshrrev_b32 v10, 7, v10
    s_lshl_b32 s50, s3, 2
    s_lshl_b32 s51, s28, 1
    v_and_b32 v11, 3, v1
    v_add_u32 v11, s50, v11
    v_and_b32 v12, 1, v1
    v_add_u32 v12, s51, v12
    v_cndmask_b32 v11, v12, v11, vcc
    v_lshl_add_u32 v9, v11, 4, v10
    v_lshlrev_b32 v9, 7, v9
    v_add_u32 v23, 4096, v9
    v_mov_b32 v148, 0
    v_mov_b32 v149, 0
    v_mov_b32 v150, 0
    v_mov_b32 v151, 0
    v_mov_b32 v152, 0
    v_mov_b32 v153, 0
    v_mov_b32 v154, 0
    v_mov_b32 v155, 0
    v_mov_b32 v156, 0
    v_mov_b32 v157, 0
    v_mov_b32 v158, 0
    v_mov_b32 v159, 0
    v_mov_b32 v160, 0
    v_mov_b32 v161, 0
    v_mov_b32 v162, 0
    v_mov_b32 v163, 0
    v_mov_b32 v252, 0
    s_mul_i32 s49, s3, 3072
    v_add_u32 v14, s49, v22
    v_add_u32 v15, 49152, v14
    s_lshl_b32 s49, s2, 2
    s_add_u32 s49, s49, s3
    s_mul_i32 s50, s49, 10923
    s_lshr_b32 s50, s50, 16
    s_mul_i32 s51, s50, 6
    s_sub_u32 s51, s49, s51
    s_lshl_b32 s51, s51, 2
    s_mul_i32 s53, s51, 43
    s_lshr_b32 s53, s53, 7
    s_mul_i32 s54, s53, 3
    s_sub_u32 s54, s51, s54
    s_mov_b32 s66, 25690112
    s_mov_b32 s55, 100
    s_mov_b32 s10, 819200
    s_mov_b32 s56, s50
    s_sub_u32 s57, s50, 20
    s_cmp_ge_u32 s50, 20
    s_cselect_b32 s66, 26099712, s66
    s_cselect_b32 s56, s57, s56
    s_sub_u32 s57, s50, 40
    s_cmp_ge_u32 s50, 40
    s_cselect_b32 s66, 26509312, s66
    s_cselect_b32 s56, s57, s56
    s_sub_u32 s57, s50, 60
    s_cmp_ge_u32 s50, 60
    s_cselect_b32 s66, 27901952, s66
    s_cselect_b32 s56, s57, s56
    s_cselect_b32 s55, 240, s55
    s_cselect_b32 s10, 1966080, s10
    s_mov_b32 s22, 2785280
    s_cselect_b32 s22, 2211840, s22
    s_sub_u32 s57, s49, 648
    s_lshr_b32 s58, s57, 4
    s_and_b32 s57, s57, 15
    s_lshl_b32 s57, s57, 1
    s_mov_b32 s59, 1280
    s_mov_b32 s51, 160
    s_cmp_ge_u32 s49, 648
    s_cselect_b32 s56, s58, s56
    s_cselect_b32 s53, s57, s53
    s_cselect_b32 s54, 0, s54
    s_cselect_b32 s66, 26918912, s66
    s_cselect_b32 s55, 60, s55
    s_cselect_b32 s23, 16, 4
    s_cselect_b32 s57, 2, 3
    s_cselect_b32 s58, 96, s51
    s_cselect_b32 s59, 3072, s59
    s_cselect_b32 s62, 3, 5
    s_cmp_ge_u32 s49, 968
    s_cselect_b32 s21, 0x80000000, 0
    s_cselect_b32 s56, 0, s56
    s_mov_b32 s8, s60
    s_mov_b32 s9, s61
    s_lshl_b32 s63, s56, 5
    s_mov_b32 s64, 4
    s_mov_b32 s65, 4
    s_mul_i32 s60, s56, 52
    s_lshr_b32 s60, s60, 8
    s_mul_i32 s61, s60, 5
    s_sub_u32 s61, s56, s61
    s_mul_i32 s60, s60, 160
    s_lshl_b32 s52, s61, 2
    s_mul_i32 s51, s56, 52
    s_lshr_b32 s51, s51, 8
    s_add_u32 s52, s52, s51
    s_cmp_ge_u32 s49, 648
    s_cselect_b32 s56, s52, s56
    s_mul_i32 s52, s61, 40
    s_cmp_eq_u32 s61, 4
    s_cselect_b32 s52, 16, s52
    s_cselect_b32 s61, 20, 4
    s_cselect_b32 s51, 20, 8
    s_add_u32 s60, s60, s52
    s_cmp_lt_u32 s49, 120
    s_cselect_b32 s63, s60, s63
    s_cselect_b32 s64, s61, s64
    s_cselect_b32 s65, s51, s65
    s_mul_i32 s63, s63, s59
    s_mul_i32 s64, s64, s59
    s_mul_i32 s65, s65, s59
    s_mul_i32 s60, s53, s58
    s_lshl_b32 s61, s54, 6
    s_add_u32 s60, s60, s61
    s_add_u32 s63, s63, s60
    s_mul_i32 s56, s56, s62
    s_lshl_b32 s52, s3, 13
    s_add_u32 s52, s52, 98304
    v_lshrrev_b32 v9, 4, v1
    v_and_b32 v10, 15, v1
    v_lshlrev_b32 v11, 2, v9
    v_xor_b32 v10, v10, v11
    v_mul_u32_u24 v4, s59, v9
    v_cmp_gt_u32 vcc, 14, v10
    v_lshl_add_u32 v4, v10, 4, v4
    v_mov_b32 v5, 0x80000000
    v_cndmask_b32 v4, v5, v4, vcc
    v_or_b32 v4, s21, v4
    v_bfe_u32 v10, v1, 2, 2
    v_lshlrev_b32 v9, 11, v9
    v_lshl_add_u32 v9, v10, 8, v9
    v_add_u32 v9, s52, v9
    v_lshlrev_b32 v10, 6, v10
    v_and_b32 v11, 3, v1
    s_mul_i32 s49, s53, s58
    s_lshl_b32 s50, s54, 6
    s_add_u32 s49, s49, s50
    s_sub_u32 s49, s49, s60
    s_mul_i32 s50, s53, s55
    s_add_u32 s50, s50, s56
    s_lshl_b32 s51, s54, 1
    s_add_u32 s50, s50, s51
    s_lshl_b32 s50, s50, 10
    s_or_b32 s50, s50, s21
    s_cmp_ge_u32 s53, s23
    s_cselect_b32 s51, s22, 0
    s_add_u32 s50, s50, s51
    s_add_u32 s54, s54, 1
    s_cmp_lt_u32 s54, s57
    s_cselect_b32 s51, 4, 3
    s_cselect_b32 s61, 0, 0x80000000
    s_cselect_b32 s54, s54, 0
    s_cselect_b32 s62, 0, 1
    s_add_u32 s53, s53, s62
    v_lshlrev_b32 v12, s51, v11
    v_add_u32 v12, s49, v12
    v_xor_b32 v12, v12, v10
    v_add_u32 v96, v9, v12
    v_add_u32 v104, s50, v22
    v_add_u32 v105, 1024, v104
    v_or_b32 v105, s61, v105
    s_waitcnt vmcnt(0) lgkmcnt(0)
    s_cmp_lg_u32 s3, 0
    s_mov_b32 exec_hi, 0
    s_barrier
    s_cbranch_scc1 L_post_5
    buffer_store_dword v113, v112, s[12:15], 0 offen sc1
L_post_5:
    s_mov_b64 exec, -1
    s_mul_i32 s49, s53, s58
    s_lshl_b32 s50, s54, 6
    s_add_u32 s49, s49, s50
    s_sub_u32 s49, s49, s60
    s_mul_i32 s50, s53, s55
    s_add_u32 s50, s50, s56
    s_lshl_b32 s51, s54, 1
    s_add_u32 s50, s50, s51
    s_lshl_b32 s50, s50, 10
    s_or_b32 s50, s50, s21
    s_cmp_ge_u32 s53, s23
    s_cselect_b32 s51, s22, 0
    s_add_u32 s50, s50, s51
    s_add_u32 s54, s54, 1
    s_cmp_lt_u32 s54, s57
    s_cselect_b32 s51, 4, 3
    s_cselect_b32 s61, 0, 0x80000000
    s_cselect_b32 s54, s54, 0
    s_cselect_b32 s62, 0, 1
    s_add_u32 s53, s53, s62
    v_lshlrev_b32 v12, s51, v11
    v_add_u32 v12, s49, v12
    v_xor_b32 v12, v12, v10
    v_add_u32 v97, v9, v12
    v_add_u32 v106, s50, v22
    v_add_u32 v107, 1024, v106
    v_or_b32 v107, s61, v107
    s_mul_i32 s49, s53, s58
    s_lshl_b32 s50, s54, 6
    s_add_u32 s49, s49, s50
    s_sub_u32 s49, s49, s60
    s_mul_i32 s50, s53, s55
    s_add_u32 s50, s50, s56
    s_lshl_b32 s51, s54, 1
    s_add_u32 s50, s50, s51
    s_lshl_b32 s50, s50, 10
    s_or_b32 s50, s50, s21
    s_cmp_ge_u32 s53, s23
    s_cselect_b32 s51, s22, 0
    s_add_u32 s50, s50, s51
    s_add_u32 s54, s54, 1
    s_cmp_lt_u32 s54, s57
    s_cselect_b32 s51, 4, 3
    s_cselect_b32 s61, 0, 0x80000000
    s_cselect_b32 s54, s54, 0
    s_cselect_b32 s62, 0, 1
    s_add_u32 s53, s53, s62
    v_lshlrev_b32 v12, s51, v11
    v_add_u32 v12, s49, v12
    v_xor_b32 v12, v12, v10
    v_add_u32 v98, v9, v12
    v_add_u32 v108, s50, v22
    v_add_u32 v109, 1024, v108
    v_or_b32 v109, s61, v109
    s_mul_i32 s49, s53, s58
    s_lshl_b32 s50, s54, 6
    s_add_u32 s49, s49, s50
    s_sub_u32 s49, s49, s60
    s_mul_i32 s50, s53, s55
    s_add_u32 s50, s50, s56
    s_lshl_b32 s51, s54, 1
    s_add_u32 s50, s50, s51
    s_lshl_b32 s50, s50, 10
    s_or_b32 s50, s50, s21
    s_cmp_ge_u32 s53, s23
    s_cselect_b32 s51, s22, 0
    s_add_u32 s50, s50, s51
    s_add_u32 s54, s54, 1
    s_cmp_lt_u32 s54, s57
    s_cselect_b32 s51, 4, 3
    s_cselect_b32 s61, 0, 0x80000000
    s_cselect_b32 s54, s54, 0
    s_cselect_b32 s62, 0, 1
    s_add_u32 s53, s53, s62
    v_lshlrev_b32 v12, s51, v11
    v_add_u32 v12, s49, v12
    v_xor_b32 v12, v12, v10
    v_add_u32 v99, v9, v12
    v_add_u32 v110, s50, v22
    v_add_u32 v111, 1024, v110
    v_or_b32 v111, s61, v111
    s_mov_b32 s67, 131072
    s_mov_b32 exec_lo, 0x3fffff
    s_mov_b32 exec_hi, 0x0
L_poll_6:
    buffer_load_dword v13, v23, s[12:15], 0 offen sc1
    s_waitcnt vmcnt(0)
    v_cmp_ne_u32 vcc, s24, v13
    s_sub_u32 s67, s67, 1
    s_cbranch_scc1 L_polld_7
    s_nop 2
    s_cbranch_vccz L_polld_7
    s_mov_b64 exec, vcc
    s_sleep 1
    s_branch L_poll_6
L_polld_7:
    s_mov_b64 exec, -1
    buffer_load_dwordx4 a[0:3], v7, s[12:15], s34 offen offset:0 sc1
    buffer_load_dwordx4 v[116:119], v7, s[12:15], s39 offen offset:0 sc1
    buffer_load_dwordx4 v[120:123], v7, s[12:15], s39 offen offset:512 sc1
    s_mov_b64 exec, s[44:45]
    buffer_load_dwordx2 a[64:65], v7, s[12:15], s36 offen offset:0 sc1
    buffer_load_dwordx2 v[148:149], v7, s[12:15], s40 offen offset:0 sc1
    buffer_load_dwordx2 v[150:151], v7, s[12:15], s40 offen offset:512 sc1
    s_mov_b64 exec, s[42:43]
    s_add_u32 s38, s41, 0
    buffer_load_dwordx4 a[96:99], v8, s[12:15], s38 offen sc1
    buffer_load_dwordx4 a[100:103], v6, s[12:15], s38 offen sc1
    s_mov_b64 exec, -1
    buffer_load_dwordx4 a[4:7], v7, s[12:15], s34 offen offset:512 sc1
    s_mov_b64 exec, s[44:45]
    buffer_load_dwordx2 a[66:67], v7, s[12:15], s36 offen offset:512 sc1
    s_mov_b64 exec, s[42:43]
    s_add_u32 s38, s41, 40960
    buffer_load_dwordx4 a[104:107], v8, s[12:15], s38 offen sc1
    buffer_load_dwordx4 a[108:111], v6, s[12:15], s38 offen sc1
    s_mov_b64 exec, -1
    v_bfe_u32 v18, v1, 4, 1
    v_mul_u32_u24 v18, 20480, v18
    v_and_b32 v21, 15, v1
    v_lshl_add_u32 v17, v21, 4, v18
    v_lshl_add_u32 v18, v21, 3, v18
    v_lshrrev_b32 v21, 5, v1
    v_lshl_add_u32 v17, v21, 8, v17
    v_mov_b32 v21, 0x80000000
    v_cndmask_b32 v18, v18, v21, s[30:31]
    s_lshl_b32 s49, s28, 2
    s_add_u32 s49, s49, s3
    s_mul_i32 s49, s49, 81920
    s_add_u32 s49, s49, 8912896
    s_lshr_b32 s48, s27, 3
    s_mul_i32 s48, s48, 5120
    s_add_u32 s49, s49, s48
    s_and_b32 s48, s27, 7
    s_lshl_b32 s46, s48, 9
    s_add_u32 s46, s46, s49
    s_lshl_b32 s47, s48, 7
    s_add_u32 s47, s47, s49
    s_add_u32 s47, s47, 4096
    v_cndmask_b32 v19, v22, v21, s[30:31]
    s_mov_b32 s21, 0x7fffffff
    v_mov_b32 v100, s21
    v_mov_b32 v101, s21
    v_mov_b32 v102, s21
    v_mov_b32 v103, s21
    s_lshl_b32 s48, s27, 2
    s_add_u32 s48, s48, s3
    s_mul_i32 s55, s48, 20480
    s_mul_i32 s49, s28, 2560
    s_add_u32 s55, s55, s49
    s_mul_i32 s56, s48, 49152
    s_mul_i32 s49, s28, 6144
    s_add_u32 s56, s56, s49
    s_lshl_b32 s57, s48, 10
    s_lshl_b32 s49, s28, 7
    s_add_u32 s57, s57, s49
    v_lshrrev_b32 v27, 4, v1
    v_mul_u32_u24 v27, 20480, v27
    v_and_b32 v28, 15, v1
    v_lshl_add_u32 v27, v28, 3, v27
    v_lshrrev_b32 v21, 5, v1
    v_mul_u32_u24 v28, 2620928, v21
    v_add_u32 v28, v28, v22
    v_mul_u32_u24 v20, 130944, v21
    v_lshl_add_u32 v20, v1, 2, v20
    s_lshl_b32 s49, s2, 2
    s_add_u32 s49, s49, s3
    s_lshl_b32 s49, s49, 2
    s_add_u32 s49, s49, 204800
    v_mov_b32 v25, s49
    v_mov_b32 v26, s24
    s_and_b32 s50, s28, 3
    s_lshl_b32 s50, s50, 2
    s_add_u32 s50, s50, s3
    s_mul_i32 s22, s50, 61440
    s_mul_i32 s50, s50, 25600
    s_lshr_b32 s51, s28, 2
    s_mul_i32 s23, s51, 3194880
    s_add_u32 s50, s50, s23
    s_add_u32 s22, s22, s23
    s_add_u32 s51, s50, 25690112
    s_lshr_b32 s49, s2, 3
    s_lshl_b32 s49, s49, 2
    s_add_u32 s49, s49, s3
    s_lshr_b32 s23, s49, 6
    s_mul_i32 s23, s23, 3194880
    s_and_b32 s49, s49, 63
    s_lshl_b32 s62, s49, 13
    v_lshl_add_u32 v114, v1, 7, s62
    s_lshr_b32 s49, s49, 2
    s_mul_i32 s49, s49, 28672
    s_add_u32 s62, s23, s49
    s_add_u32 s62, s62, 26947584
    s_add_u32 s23, s23, 26509312
    v_cmp_gt_u32 vcc, 409600, v114
    v_mov_b32 v115, 0x80000000
    s_nop 0
    v_cndmask_b32 v115, v115, v114, vcc
    v_and_b32 v9, 15, v1
    v_mul_u32_u24 v9, 1280, v9
    v_lshrrev_b32 v10, 4, v1
    v_lshl_add_u32 v23, v10, 4, v9
    v_lshl_add_u32 v24, v10, 3, v9
    s_lshl_b32 s53, s27, 2
    s_add_u32 s53, s53, s20
    s_mul_i32 s53, s53, 20480
    s_mul_i32 s54, s28, 160
    s_add_u32 s54, s54, s53
    s_lshr_b32 s49, s2, 3
    s_lshl_b32 s49, s49, 2
    s_add_u32 s49, s49, s3
    s_lshl_b32 s49, s49, 8
    v_lshl_add_u32 v30, v1, 7, s49
    s_waitcnt vmcnt(9)
    v_mfma_f32_32x32x16_bf16 v[164:179], a[0:3], v[116:119], 0
    v_mfma_f32_32x32x16_bf16 v[180:195], a[0:3], v[120:123], 0
    buffer_load_dwordx4 a[8:11], v7, s[12:15], s34 offen offset:1024 sc1
    s_mov_b64 exec, s[44:45]
    buffer_load_dwordx2 a[68:69], v7, s[12:15], s36 offen offset:1024 sc1
    s_mov_b64 exec, s[42:43]
    s_add_u32 s38, s41, 81920
    buffer_load_dwordx4 a[112:115], v8, s[12:15], s38 offen sc1
    buffer_load_dwordx4 a[116:119], v6, s[12:15], s38 offen sc1
    s_mov_b64 exec, -1
    s_nop 2
    v_max3_f32 v164, v164, v165, v166
    v_max3_f32 v164, v164, v167, v168
    v_cvt_pk_bf16_f32 v165, -v164, 0
    v_lshlrev_b32 v244, 16, v165
    s_waitcnt vmcnt(10)
    v_cndmask_b32 v148, v148, v165, s[30:31]
    s_nop 1
    v_mfma_f32_32x32x8_bf16 v[164:179], a[64:65], v[148:149], 0
    v_mfma_f32_32x32x16_bf16 v[164:179], a[0:3], v[116:119], v[164:179]
    v_max3_f32 v180, v180, v181, v182
    v_max3_f32 v180, v180, v183, v184
    v_cvt_pk_bf16_f32 v181, -v180, 0
    v_lshlrev_b32 v245, 16, v181
    v_cndmask_b32 v150, v150, v181, s[30:31]
    buffer_load_dwordx4 a[12:15], v7, s[12:15], s34 offen offset:1536 sc1
    s_mov_b64 exec, s[44:45]
    buffer_load_dwordx2 a[70:71], v7, s[12:15], s36 offen offset:1536 sc1
    s_mov_b64 exec, s[42:43]
    s_add_u32 s38, s41, 122880
    buffer_load_dwordx4 a[120:123], v8, s[12:15], s38 offen sc1
    buffer_load_dwordx4 a[124:127], v6, s[12:15], s38 offen sc1
    s_mov_b64 exec, -1
    v_mfma_f32_32x32x8_bf16 v[180:195], a[64:65], v[150:151], 0
    v_exp_f32 v164, v164
    v_exp_f32 v165, v165
    v_exp_f32 v166, v166
    v_exp_f32 v167, v167
    v_cvt_pk_bf16_f32 v196, v164, v165
    v_cvt_pk_bf16_f32 v197, v166, v167
    v_mfma_f32_32x32x16_bf16 v[180:195], a[0:3], v[120:123], v[180:195]
    buffer_load_dwordx4 a[16:19], v7, s[12:15], s34 offen offset:2048 sc1
    s_mov_b64 exec, s[44:45]
    buffer_load_dwordx2 a[72:73], v7, s[12:15], s36 offen offset:2048 sc1
    s_mov_b64 exec, s[42:43]
    s_add_u32 s38, s41, 163840
    buffer_load_dwordx4 a[128:131], v8, s[12:15], s38 offen sc1
    buffer_load_dwordx4 a[132:135], v6, s[12:15], s38 offen sc1
    s_mov_b64 exec, -1
    v_exp_f32 v168, v168
    v_exp_f32 v169, v169
    v_exp_f32 v170, v170
    v_exp_f32 v171, v171
    v_cvt_pk_bf16_f32 v198, v168, v169
    v_cvt_pk_bf16_f32 v199, v170, v171
    v_exp_f32 v172, v172
    v_exp_f32 v173, v173
    v_exp_f32 v174, v174
    v_exp_f32 v175, v175
    v_cvt_pk_bf16_f32 v200, v172, v173
    v_cvt_pk_bf16_f32 v201, v174, v175
    v_exp_f32 v176, v176
    v_exp_f32 v177, v177
    v_exp_f32 v178, v178
    v_exp_f32 v179, v179
    v_cvt_pk_bf16_f32 v202, v176, v177
    v_cvt_pk_bf16_f32 v203, v178, v179
    s_waitcnt vmcnt(14)
    v_mfma_f32_32x32x8_bf16 v[164:179], a[66:67], v[148:149], 0
    v_exp_f32 v180, v180
    v_exp_f32 v181, v181
    v_exp_f32 v182, v182
    v_exp_f32 v183, v183
    v_cvt_pk_bf16_f32 v204, v180, v181
    v_cvt_pk_bf16_f32 v205, v182, v183
    v_mfma_f32_32x32x16_bf16 v[164:179], a[4:7], v[116:119], v[164:179]
    v_exp_f32 v184, v184
    v_exp_f32 v185, v185
    v_exp_f32 v186, v186
    v_exp_f32 v187, v187
    v_cvt_pk_bf16_f32 v206, v184, v185
    v_cvt_pk_bf16_f32 v207, v186, v187
    v_mfma_f32_32x32x16_bf16 v[212:227], a[96:99], v[196:199], 0
    v_exp_f32 v188, v188
    v_exp_f32 v189, v189
    v_exp_f32 v190, v190
    v_exp_f32 v191, v191
    v_cvt_pk_bf16_f32 v208, v188, v189
    v_cvt_pk_bf16_f32 v209, v190, v191
    v_mfma_f32_32x32x16_bf16 v[212:227], a[100:103], v[200:203], v[212:227]
    v_exp_f32 v192, v192
    v_exp_f32 v193, v193
    v_exp_f32 v194, v194
    v_exp_f32 v195, v195
    v_cvt_pk_bf16_f32 v210, v192, v193
    v_cvt_pk_bf16_f32 v211, v194, v195
    v_mfma_f32_32x32x8_bf16 v[180:195], a[66:67], v[150:151], 0
    v_exp_f32 v164, v164
    v_exp_f32 v165, v165
    v_exp_f32 v166, v166
    v_exp_f32 v167, v167
    v_cvt_pk_bf16_f32 v196, v164, v165
    v_cvt_pk_bf16_f32 v197, v166, v167
    v_mfma_f32_32x32x16_bf16 v[180:195], a[4:7], v[120:123], v[180:195]
    buffer_load_dwordx4 a[20:23], v7, s[12:15], s34 offen offset:2560 sc1
    s_mov_b64 exec, s[44:45]
    buffer_load_dwordx2 a[74:75], v7, s[12:15], s36 offen offset:2560 sc1
    s_mov_b64 exec, s[42:43]
    s_add_u32 s38, s41, 204800
    buffer_load_dwordx4 a[136:139], v8, s[12:15], s38 offen sc1
    buffer_load_dwordx4 a[140:143], v6, s[12:15], s38 offen sc1
    s_mov_b64 exec, -1
    v_exp_f32 v168, v168
    v_exp_f32 v169, v169
    v_exp_f32 v170, v170
    v_exp_f32 v171, v171
    v_cvt_pk_bf16_f32 v198, v168, v169
    v_cvt_pk_bf16_f32 v199, v170, v171
    v_mfma_f32_32x32x16_bf16 v[228:243], a[96:99], v[204:207], 0
    v_exp_f32 v172, v172
    v_exp_f32 v173, v173
    v_exp_f32 v174, v174
    v_exp_f32 v175, v175
    v_cvt_pk_bf16_f32 v200, v172, v173
    v_cvt_pk_bf16_f32 v201, v174, v175
    v_mfma_f32_32x32x16_bf16 v[228:243], a[100:103], v[208:211], v[228:243]
    v_exp_f32 v176, v176
    v_exp_f32 v177, v177
    v_exp_f32 v178, v178
    v_exp_f32 v179, v179
    v_cvt_pk_bf16_f32 v202, v176, v177
    v_cvt_pk_bf16_f32 v203, v178, v179
    s_waitcnt vmcnt(14)
    v_mfma_f32_32x32x8_bf16 v[164:179], a[68:69], v[148:149], 0
    v_exp_f32 v180, v180
    v_exp_f32 v181, v181
    v_exp_f32 v182, v182
    v_exp_f32 v183, v183
    v_cvt_pk_bf16_f32 v204, v180, v181
    v_cvt_pk_bf16_f32 v205, v182, v183
    v_mfma_f32_32x32x16_bf16 v[164:179], a[8:11], v[116:119], v[164:179]
    v_exp_f32 v184, v184
    v_exp_f32 v185, v185
    v_exp_f32 v186, v186
    v_exp_f32 v187, v187
    v_cvt_pk_bf16_f32 v206, v184, v185
    v_cvt_pk_bf16_f32 v207, v186, v187
    v_mfma_f32_32x32x16_bf16 v[212:227], a[104:107], v[196:199], v[212:227]
    v_exp_f32 v188, v188
    v_exp_f32 v189, v189
    v_exp_f32 v190, v190
    v_exp_f32 v191, v191
    v_cvt_pk_bf16_f32 v208, v188, v189
    v_cvt_pk_bf16_f32 v209, v190, v191
    v_mfma_f32_32x32x16_bf16 v[212:227], a[108:111], v[200:203], v[212:227]
    v_exp_f32 v192, v192
    v_exp_f32 v193, v193
    v_exp_f32 v194, v194
    v_exp_f32 v195, v195
    v_cvt_pk_bf16_f32 v210, v192, v193
    v_cvt_pk_bf16_f32 v211, v194, v195
    v_mfma_f32_32x32x8_bf16 v[180:195], a[68:69], v[150:151], 0
    v_exp_f32 v164, v164
    v_exp_f32 v165, v165
    v_exp_f32 v166, v166
    v_exp_f32 v167, v167
    v_cvt_pk_bf16_f32 v196, v164, v165
    v_cvt_pk_bf16_f32 v197, v166, v167
    v_mfma_f32_32x32x16_bf16 v[180:195], a[8:11], v[120:123], v[180:195]
    buffer_load_dwordx4 a[24:27], v7, s[12:15], s34 offen offset:3072 sc1
    s_mov_b64 exec, s[44:45]
    buffer_load_dwordx2 a[76:77], v7, s[12:15], s36 offen offset:3072 sc1
    s_mov_b64 exec, s[42:43]
    s_add_u32 s38, s41, 245760
    buffer_load_dwordx4 a[144:147], v8, s[12:15], s38 offen sc1
    buffer_load_dwordx4 a[148:151], v6, s[12:15], s38 offen sc1
    s_mov_b64 exec, -1
    v_exp_f32 v168, v168
    v_exp_f32 v169, v169
    v_exp_f32 v170, v170
    v_exp_f32 v171, v171
    v_cvt_pk_bf16_f32 v198, v168, v169
    v_cvt_pk_bf16_f32 v199, v170, v171
    v_mfma_f32_32x32x16_bf16 v[228:243], a[104:107], v[204:207], v[228:243]
    v_exp_f32 v172, v172
    v_exp_f32 v173, v173
    v_exp_f32 v174, v174
    v_exp_f32 v175, v175
    v_cvt_pk_bf16_f32 v200, v172, v173
    v_cvt_pk_bf16_f32 v201, v174, v175
    v_mfma_f32_32x32x16_bf16 v[228:243], a[108:111], v[208:211], v[228:243]
    v_exp_f32 v176, v176
    v_exp_f32 v177, v177
    v_exp_f32 v178, v178
    v_exp_f32 v179, v179
    v_cvt_pk_bf16_f32 v202, v176, v177
    v_cvt_pk_bf16_f32 v203, v178, v179
    s_waitcnt vmcnt(12)
    v_mfma_f32_32x32x8_bf16 v[164:179], a[70:71], v[148:149], 0
    v_exp_f32 v180, v180
    v_exp_f32 v181, v181
    v_exp_f32 v182, v182
    v_exp_f32 v183, v183
    v_cvt_pk_bf16_f32 v204, v180, v181
    v_cvt_pk_bf16_f32 v205, v182, v183
    v_mfma_f32_32x32x16_bf16 v[164:179], a[12:15], v[116:119], v[164:179]
    v_exp_f32 v184, v184
    v_exp_f32 v185, v185
    v_exp_f32 v186, v186
    v_exp_f32 v187, v187
    v_cvt_pk_bf16_f32 v206, v184, v185
    v_cvt_pk_bf16_f32 v207, v186, v187
    v_mfma_f32_32x32x16_bf16 v[212:227], a[112:115], v[196:199], v[212:227]
    v_exp_f32 v188, v188
    v_exp_f32 v189, v189
    v_exp_f32 v190, v190
    v_exp_f32 v191, v191
    v_cvt_pk_bf16_f32 v208, v188, v189
    v_cvt_pk_bf16_f32 v209, v190, v191
    v_mfma_f32_32x32x16_bf16 v[212:227], a[116:119], v[200:203], v[212:227]
    v_exp_f32 v192, v192
    v_exp_f32 v193, v193
    v_exp_f32 v194, v194
    v_exp_f32 v195, v195
    v_cvt_pk_bf16_f32 v210, v192, v193
    v_cvt_pk_bf16_f32 v211, v194, v195
    v_mfma_f32_32x32x8_bf16 v[180:195], a[70:71], v[150:151], 0
    v_exp_f32 v164, v164
    v_exp_f32 v165, v165
    v_exp_f32 v166, v166
    v_exp_f32 v167, v167
    v_cvt_pk_bf16_f32 v196, v164, v165
    v_cvt_pk_bf16_f32 v197, v166, v167
    v_mfma_f32_32x32x16_bf16 v[180:195], a[12:15], v[120:123], v[180:195]
    buffer_load_dwordx4 a[28:31], v7, s[12:15], s34 offen offset:3584 sc1
    s_mov_b64 exec, s[44:45]
    buffer_load_dwordx2 a[78:79], v7, s[12:15], s36 offen offset:3584 sc1
    s_mov_b64 exec, s[42:43]
    s_add_u32 s38, s41, 286720
    buffer_load_dwordx4 a[152:155], v8, s[12:15], s38 offen sc1
    buffer_load_dwordx4 a[156:159], v6, s[12:15], s38 offen sc1
    s_mov_b64 exec, -1
    v_exp_f32 v168, v168
    v_exp_f32 v169, v169
    v_exp_f32 v170, v170
    v_exp_f32 v171, v171
    v_cvt_pk_bf16_f32 v198, v168, v169
    v_cvt_pk_bf16_f32 v199, v170, v171
    v_mfma_f32_32x32x16_bf16 v[228:243], a[112:115], v[204:207], v[228:243]
    v_exp_f32 v172, v172
    v_exp_f32 v173, v173
    v_exp_f32 v174, v174
    v_exp_f32 v175, v175
    v_cvt_pk_bf16_f32 v200, v172, v173
    v_cvt_pk_bf16_f32 v201, v174, v175
    v_mfma_f32_32x32x16_bf16 v[228:243], a[116:119], v[208:211], v[228:243]
    v_exp_f32 v176, v176
    v_exp_f32 v177, v177
    v_exp_f32 v178, v178
    v_exp_f32 v179, v179
    v_cvt_pk_bf16_f32 v202, v176, v177
    v_cvt_pk_bf16_f32 v203, v178, v179
    s_waitcnt vmcnt(12)
    v_mfma_f32_32x32x8_bf16 v[164:179], a[72:73], v[148:149], 0
    v_exp_f32 v180, v180
    v_exp_f32 v181, v181
    v_exp_f32 v182, v182
    v_exp_f32 v183, v183
    v_cvt_pk_bf16_f32 v204, v180, v181
    v_cvt_pk_bf16_f32 v205, v182, v183
    v_mfma_f32_32x32x16_bf16 v[164:179], a[16:19], v[116:119], v[164:179]
    v_exp_f32 v184, v184
    v_exp_f32 v185, v185
    v_exp_f32 v186, v186
    v_exp_f32 v187, v187
    v_cvt_pk_bf16_f32 v206, v184, v185
    v_cvt_pk_bf16_f32 v207, v186, v187
    v_mfma_f32_32x32x16_bf16 v[212:227], a[120:123], v[196:199], v[212:227]
    v_exp_f32 v188, v188
    v_exp_f32 v189, v189
    v_exp_f32 v190, v190
    v_exp_f32 v191, v191
    v_cvt_pk_bf16_f32 v208, v188, v189
    v_cvt_pk_bf16_f32 v209, v190, v191
    v_mfma_f32_32x32x16_bf16 v[212:227], a[124:127], v[200:203], v[212:227]
    v_exp_f32 v192, v192
    v_exp_f32 v193, v193
    v_exp_f32 v194, v194
    v_exp_f32 v195, v195
    v_cvt_pk_bf16_f32 v210, v192, v193
    v_cvt_pk_bf16_f32 v211, v194, v195
    v_mfma_f32_32x32x8_bf16 v[180:195], a[72:73], v[150:151], 0
    v_exp_f32 v164, v164
    v_exp_f32 v165, v165
    v_exp_f32 v166, v166
    v_exp_f32 v167, v167
    v_cvt_pk_bf16_f32 v196, v164, v165
    v_cvt_pk_bf16_f32 v197, v166, v167
    v_mfma_f32_32x32x16_bf16 v[180:195], a[16:19], v[120:123], v[180:195]
    buffer_load_dwordx4 a[32:35], v7, s[12:15], s35 offen offset:0 sc1
    s_mov_b64 exec, s[44:45]
    buffer_load_dwordx2 a[80:81], v7, s[12:15], s37 offen offset:0 sc1
    s_mov_b64 exec, s[42:43]
    s_add_u32 s38, s41, 327680
    buffer_load_dwordx4 a[160:163], v8, s[12:15], s38 offen sc1
    buffer_load_dwordx4 a[164:167], v6, s[12:15], s38 offen sc1
    s_mov_b64 exec, -1
    v_exp_f32 v168, v168
    v_exp_f32 v169, v169
    v_exp_f32 v170, v170
    v_exp_f32 v171, v171
    v_cvt_pk_bf16_f32 v198, v168, v169
    v_cvt_pk_bf16_f32 v199, v170, v171
    v_mfma_f32_32x32x16_bf16 v[228:243], a[120:123], v[204:207], v[228:243]
    v_exp_f32 v172, v172
    v_exp_f32 v173, v173
    v_exp_f32 v174, v174
    v_exp_f32 v175, v175
    v_cvt_pk_bf16_f32 v200, v172, v173
    v_cvt_pk_bf16_f32 v201, v174, v175
    v_mfma_f32_32x32x16_bf16 v[228:243], a[124:127], v[208:211], v[228:243]
    v_exp_f32 v176, v176
    v_exp_f32 v177, v177
    v_exp_f32 v178, v178
    v_exp_f32 v179, v179
    v_cvt_pk_bf16_f32 v202, v176, v177
    v_cvt_pk_bf16_f32 v203, v178, v179
    s_waitcnt vmcnt(12)
    v_mfma_f32_32x32x8_bf16 v[164:179], a[74:75], v[148:149], 0
    v_exp_f32 v180, v180
    v_exp_f32 v181, v181
    v_exp_f32 v182, v182
    v_exp_f32 v183, v183
    v_cvt_pk_bf16_f32 v204, v180, v181
    v_cvt_pk_bf16_f32 v205, v182, v183
    v_mfma_f32_32x32x16_bf16 v[164:179], a[20:23], v[116:119], v[164:179]
    v_exp_f32 v184, v184
    v_exp_f32 v185, v185
    v_exp_f32 v186, v186
    v_exp_f32 v187, v187
    v_cvt_pk_bf16_f32 v206, v184, v185
    v_cvt_pk_bf16_f32 v207, v186, v187
    v_mfma_f32_32x32x16_bf16 v[212:227], a[128:131], v[196:199], v[212:227]
    v_exp_f32 v188, v188
    v_exp_f32 v189, v189
    v_exp_f32 v190, v190
    v_exp_f32 v191, v191
    v_cvt_pk_bf16_f32 v208, v188, v189
    v_cvt_pk_bf16_f32 v209, v190, v191
    v_mfma_f32_32x32x16_bf16 v[212:227], a[132:135], v[200:203], v[212:227]
    v_exp_f32 v192, v192
    v_exp_f32 v193, v193
    v_exp_f32 v194, v194
    v_exp_f32 v195, v195
    v_cvt_pk_bf16_f32 v210, v192, v193
    v_cvt_pk_bf16_f32 v211, v194, v195
    v_mfma_f32_32x32x8_bf16 v[180:195], a[74:75], v[150:151], 0
    v_exp_f32 v164, v164
    v_exp_f32 v165, v165
    v_exp_f32 v166, v166
    v_exp_f32 v167, v167
    v_cvt_pk_bf16_f32 v196, v164, v165
    v_cvt_pk_bf16_f32 v197, v166, v167
    v_mfma_f32_32x32x16_bf16 v[180:195], a[20:23], v[120:123], v[180:195]
    buffer_load_dwordx4 a[36:39], v7, s[12:15], s35 offen offset:512 sc1
    s_mov_b64 exec, s[44:45]
    buffer_load_dwordx2 a[82:83], v7, s[12:15], s37 offen offset:512 sc1
    s_mov_b64 exec, s[42:43]
    s_add_u32 s38, s41, 368640
    buffer_load_dwordx4 a[168:171], v8, s[12:15], s38 offen sc1
    buffer_load_dwordx4 a[172:175], v6, s[12:15], s38 offen sc1
    s_mov_b64 exec, -1
    v_exp_f32 v168, v168
    v_exp_f32 v169, v169
    v_exp_f32 v170, v170
    v_exp_f32 v171, v171
    v_cvt_pk_bf16_f32 v198, v168, v169
    v_cvt_pk_bf16_f32 v199, v170, v171
    v_mfma_f32_32x32x16_bf16 v[228:243], a[128:131], v[204:207], v[228:243]
    v_exp_f32 v172, v172
    v_exp_f32 v173, v173
    v_exp_f32 v174, v174
    v_exp_f32 v175, v175
    v_cvt_pk_bf16_f32 v200, v172, v173
    v_cvt_pk_bf16_f32 v201, v174, v175
    v_mfma_f32_32x32x16_bf16 v[228:243], a[132:135], v[208:211], v[228:243]
    v_exp_f32 v176, v176
    v_exp_f32 v177, v177
    v_exp_f32 v178, v178
    v_exp_f32 v179, v179
    v_cvt_pk_bf16_f32 v202, v176, v177
    v_cvt_pk_bf16_f32 v203, v178, v179
    s_waitcnt vmcnt(12)
    v_mfma_f32_32x32x8_bf16 v[164:179], a[76:77], v[148:149], 0
    v_exp_f32 v180, v180
    v_exp_f32 v181, v181
    v_exp_f32 v182, v182
    v_exp_f32 v183, v183
    v_cvt_pk_bf16_f32 v204, v180, v181
    v_cvt_pk_bf16_f32 v205, v182, v183
    v_mfma_f32_32x32x16_bf16 v[164:179], a[24:27], v[116:119], v[164:179]
    v_exp_f32 v184, v184
    v_exp_f32 v185, v185
    v_exp_f32 v186, v186
    v_exp_f32 v187, v187
    v_cvt_pk_bf16_f32 v206, v184, v185
    v_cvt_pk_bf16_f32 v207, v186, v187
    v_mfma_f32_32x32x16_bf16 v[212:227], a[136:139], v[196:199], v[212:227]
    v_exp_f32 v188, v188
    v_exp_f32 v189, v189
    v_exp_f32 v190, v190
    v_exp_f32 v191, v191
    v_cvt_pk_bf16_f32 v208, v188, v189
    v_cvt_pk_bf16_f32 v209, v190, v191
    v_mfma_f32_32x32x16_bf16 v[212:227], a[140:143], v[200:203], v[212:227]
    v_exp_f32 v192, v192
    v_exp_f32 v193, v193
    v_exp_f32 v194, v194
    v_exp_f32 v195, v195
    v_cvt_pk_bf16_f32 v210, v192, v193
    v_cvt_pk_bf16_f32 v211, v194, v195
    v_mfma_f32_32x32x8_bf16 v[180:195], a[76:77], v[150:151], 0
    v_exp_f32 v164, v164
    v_exp_f32 v165, v165
    v_exp_f32 v166, v166
    v_exp_f32 v167, v167
    v_cvt_pk_bf16_f32 v196, v164, v165
    v_cvt_pk_bf16_f32 v197, v166, v167
    v_mfma_f32_32x32x16_bf16 v[180:195], a[24:27], v[120:123], v[180:195]
    buffer_load_dwordx4 a[40:43], v7, s[12:15], s35 offen offset:1024 sc1
    s_mov_b64 exec, s[44:45]
    buffer_load_dwordx2 a[84:85], v7, s[12:15], s37 offen offset:1024 sc1
    s_mov_b64 exec, s[42:43]
    s_add_u32 s38, s41, 409600
    buffer_load_dwordx4 a[176:179], v8, s[12:15], s38 offen sc1
    buffer_load_dwordx4 a[180:183], v6, s[12:15], s38 offen sc1
    s_mov_b64 exec, -1
    v_exp_f32 v168, v168
    v_exp_f32 v169, v169
    v_exp_f32 v170, v170
    v_exp_f32 v171, v171
    v_cvt_pk_bf16_f32 v198, v168, v169
    v_cvt_pk_bf16_f32 v199, v170, v171
    v_mfma_f32_32x32x16_bf16 v[228:243], a[136:139], v[204:207], v[228:243]
    v_exp_f32 v172, v172
    v_exp_f32 v173, v173
    v_exp_f32 v174, v174
    v_exp_f32 v175, v175
    v_cvt_pk_bf16_f32 v200, v172, v173
    v_cvt_pk_bf16_f32 v201, v174, v175
    v_mfma_f32_32x32x16_bf16 v[228:243], a[140:143], v[208:211], v[228:243]
    v_exp_f32 v176, v176
    v_exp_f32 v177, v177
    v_exp_f32 v178, v178
    v_exp_f32 v179, v179
    v_cvt_pk_bf16_f32 v202, v176, v177
    v_cvt_pk_bf16_f32 v203, v178, v179
    s_waitcnt vmcnt(12)
    v_mfma_f32_32x32x8_bf16 v[164:179], a[78:79], v[148:149], 0
    v_exp_f32 v180, v180
    v_exp_f32 v181, v181
    v_exp_f32 v182, v182
    v_exp_f32 v183, v183
    v_cvt_pk_bf16_f32 v204, v180, v181
    v_cvt_pk_bf16_f32 v205, v182, v183
    v_mfma_f32_32x32x16_bf16 v[164:179], a[28:31], v[116:119], v[164:179]
    v_exp_f32 v184, v184
    v_exp_f32 v185, v185
    v_exp_f32 v186, v186
    v_exp_f32 v187, v187
    v_cvt_pk_bf16_f32 v206, v184, v185
    v_cvt_pk_bf16_f32 v207, v186, v187
    v_mfma_f32_32x32x16_bf16 v[212:227], a[144:147], v[196:199], v[212:227]
    v_exp_f32 v188, v188
    v_exp_f32 v189, v189
    v_exp_f32 v190, v190
    v_exp_f32 v191, v191
    v_cvt_pk_bf16_f32 v208, v188, v189
    v_cvt_pk_bf16_f32 v209, v190, v191
    v_mfma_f32_32x32x16_bf16 v[212:227], a[148:151], v[200:203], v[212:227]
    v_exp_f32 v192, v192
    v_exp_f32 v193, v193
    v_exp_f32 v194, v194
    v_exp_f32 v195, v195
    v_cvt_pk_bf16_f32 v210, v192, v193
    v_cvt_pk_bf16_f32 v211, v194, v195
    v_mfma_f32_32x32x8_bf16 v[180:195], a[78:79], v[150:151], 0
    v_exp_f32 v164, v164
    v_exp_f32 v165, v165
    v_exp_f32 v166, v166
    v_exp_f32 v167, v167
    v_cvt_pk_bf16_f32 v196, v164, v165
    v_cvt_pk_bf16_f32 v197, v166, v167
    v_mfma_f32_32x32x16_bf16 v[180:195], a[28:31], v[120:123], v[180:195]
    buffer_load_dwordx4 a[44:47], v7, s[12:15], s35 offen offset:1536 sc1
    s_mov_b64 exec, s[44:45]
    buffer_load_dwordx2 a[86:87], v7, s[12:15], s37 offen offset:1536 sc1
    s_mov_b64 exec, s[42:43]
    s_add_u32 s38, s41, 450560
    buffer_load_dwordx4 a[184:187], v8, s[12:15], s38 offen sc1
    buffer_load_dwordx4 a[188:191], v6, s[12:15], s38 offen sc1
    s_mov_b64 exec, -1
    v_exp_f32 v168, v168
    v_exp_f32 v169, v169
    v_exp_f32 v170, v170
    v_exp_f32 v171, v171
    v_cvt_pk_bf16_f32 v198, v168, v169
    v_cvt_pk_bf16_f32 v199, v170, v171
    v_mfma_f32_32x32x16_bf16 v[228:243], a[144:147], v[204:207], v[228:243]
    v_exp_f32 v172, v172
    v_exp_f32 v173, v173
    v_exp_f32 v174, v174
    v_exp_f32 v175, v175
    v_cvt_pk_bf16_f32 v200, v172, v173
    v_cvt_pk_bf16_f32 v201, v174, v175
    v_mfma_f32_32x32x16_bf16 v[228:243], a[148:151], v[208:211], v[228:243]
    v_exp_f32 v176, v176
    v_exp_f32 v177, v177
    v_exp_f32 v178, v178
    v_exp_f32 v179, v179
    v_cvt_pk_bf16_f32 v202, v176, v177
    v_cvt_pk_bf16_f32 v203, v178, v179
    s_waitcnt vmcnt(12)
    v_mfma_f32_32x32x8_bf16 v[164:179], a[80:81], v[148:149], 0
    v_exp_f32 v180, v180
    v_exp_f32 v181, v181
    v_exp_f32 v182, v182
    v_exp_f32 v183, v183
    v_cvt_pk_bf16_f32 v204, v180, v181
    v_cvt_pk_bf16_f32 v205, v182, v183
    v_mfma_f32_32x32x16_bf16 v[164:179], a[32:35], v[116:119], v[164:179]
    v_exp_f32 v184, v184
    v_exp_f32 v185, v185
    v_exp_f32 v186, v186
    v_exp_f32 v187, v187
    v_cvt_pk_bf16_f32 v206, v184, v185
    v_cvt_pk_bf16_f32 v207, v186, v187
    v_mfma_f32_32x32x16_bf16 v[212:227], a[152:155], v[196:199], v[212:227]
    v_exp_f32 v188, v188
    v_exp_f32 v189, v189
    v_exp_f32 v190, v190
    v_exp_f32 v191, v191
    v_cvt_pk_bf16_f32 v208, v188, v189
    v_cvt_pk_bf16_f32 v209, v190, v191
    v_mfma_f32_32x32x16_bf16 v[212:227], a[156:159], v[200:203], v[212:227]
    v_exp_f32 v192, v192
    v_exp_f32 v193, v193
    v_exp_f32 v194, v194
    v_exp_f32 v195, v195
    v_cvt_pk_bf16_f32 v210, v192, v193
    v_cvt_pk_bf16_f32 v211, v194, v195
    v_mfma_f32_32x32x8_bf16 v[180:195], a[80:81], v[150:151], 0
    v_exp_f32 v164, v164
    v_exp_f32 v165, v165
    v_exp_f32 v166, v166
    v_exp_f32 v167, v167
    v_cvt_pk_bf16_f32 v196, v164, v165
    v_cvt_pk_bf16_f32 v197, v166, v167
    v_mfma_f32_32x32x16_bf16 v[180:195], a[32:35], v[120:123], v[180:195]
    buffer_load_dwordx4 a[48:51], v7, s[12:15], s35 offen offset:2048 sc1
    s_mov_b64 exec, s[44:45]
    buffer_load_dwordx2 a[88:89], v7, s[12:15], s37 offen offset:2048 sc1
    s_mov_b64 exec, s[42:43]
    s_add_u32 s38, s41, 491520
    buffer_load_dwordx4 a[192:195], v8, s[12:15], s38 offen sc1
    buffer_load_dwordx4 a[196:199], v6, s[12:15], s38 offen sc1
    s_mov_b64 exec, -1
    v_exp_f32 v168, v168
    v_exp_f32 v169, v169
    v_exp_f32 v170, v170
    v_exp_f32 v171, v171
    v_cvt_pk_bf16_f32 v198, v168, v169
    v_cvt_pk_bf16_f32 v199, v170, v171
    v_mfma_f32_32x32x16_bf16 v[228:243], a[152:155], v[204:207], v[228:243]
    v_exp_f32 v172, v172
    v_exp_f32 v173, v173
    v_exp_f32 v174, v174
    v_exp_f32 v175, v175
    v_cvt_pk_bf16_f32 v200, v172, v173
    v_cvt_pk_bf16_f32 v201, v174, v175
    v_mfma_f32_32x32x16_bf16 v[228:243], a[156:159], v[208:211], v[228:243]
    v_exp_f32 v176, v176
    v_exp_f32 v177, v177
    v_exp_f32 v178, v178
    v_exp_f32 v179, v179
    v_cvt_pk_bf16_f32 v202, v176, v177
    v_cvt_pk_bf16_f32 v203, v178, v179
    s_waitcnt vmcnt(12)
    v_mfma_f32_32x32x8_bf16 v[164:179], a[82:83], v[148:149], 0
    v_exp_f32 v180, v180
    v_exp_f32 v181, v181
    v_exp_f32 v182, v182
    v_exp_f32 v183, v183
    v_cvt_pk_bf16_f32 v204, v180, v181
    v_cvt_pk_bf16_f32 v205, v182, v183
    v_mfma_f32_32x32x16_bf16 v[164:179], a[36:39], v[116:119], v[164:179]
    v_exp_f32 v184, v184
    v_exp_f32 v185, v185
    v_exp_f32 v186, v186
    v_exp_f32 v187, v187
    v_cvt_pk_bf16_f32 v206, v184, v185
    v_cvt_pk_bf16_f32 v207, v186, v187
    v_mfma_f32_32x32x16_bf16 v[212:227], a[160:163], v[196:199], v[212:227]
    v_exp_f32 v188, v188
    v_exp_f32 v189, v189
    v_exp_f32 v190, v190
    v_exp_f32 v191, v191
    v_cvt_pk_bf16_f32 v208, v188, v189
    v_cvt_pk_bf16_f32 v209, v190, v191
    v_mfma_f32_32x32x16_bf16 v[212:227], a[164:167], v[200:203], v[212:227]
    v_exp_f32 v192, v192
    v_exp_f32 v193, v193
    v_exp_f32 v194, v194
    v_exp_f32 v195, v195
    v_cvt_pk_bf16_f32 v210, v192, v193
    v_cvt_pk_bf16_f32 v211, v194, v195
    v_mfma_f32_32x32x8_bf16 v[180:195], a[82:83], v[150:151], 0
    v_exp_f32 v164, v164
    v_exp_f32 v165, v165
    v_exp_f32 v166, v166
    v_exp_f32 v167, v167
    v_cvt_pk_bf16_f32 v196, v164, v165
    v_cvt_pk_bf16_f32 v197, v166, v167
    v_mfma_f32_32x32x16_bf16 v[180:195], a[36:39], v[120:123], v[180:195]
    buffer_load_dwordx4 a[52:55], v7, s[12:15], s35 offen offset:2560 sc1
    s_mov_b64 exec, s[44:45]
    buffer_load_dwordx2 a[90:91], v7, s[12:15], s37 offen offset:2560 sc1
    s_mov_b64 exec, s[42:43]
    s_add_u32 s38, s41, 532480
    buffer_load_dwordx4 a[200:203], v8, s[12:15], s38 offen sc1
    buffer_load_dwordx4 a[204:207], v6, s[12:15], s38 offen sc1
    s_mov_b64 exec, -1
    v_exp_f32 v168, v168
    v_exp_f32 v169, v169
    v_exp_f32 v170, v170
    v_exp_f32 v171, v171
    v_cvt_pk_bf16_f32 v198, v168, v169
    v_cvt_pk_bf16_f32 v199, v170, v171
    v_mfma_f32_32x32x16_bf16 v[228:243], a[160:163], v[204:207], v[228:243]
    v_exp_f32 v172, v172
    v_exp_f32 v173, v173
    v_exp_f32 v174, v174
    v_exp_f32 v175, v175
    v_cvt_pk_bf16_f32 v200, v172, v173
    v_cvt_pk_bf16_f32 v201, v174, v175
    v_mfma_f32_32x32x16_bf16 v[228:243], a[164:167], v[208:211], v[228:243]
    v_exp_f32 v176, v176
    v_exp_f32 v177, v177
    v_exp_f32 v178, v178
    v_exp_f32 v179, v179
    v_cvt_pk_bf16_f32 v202, v176, v177
    v_cvt_pk_bf16_f32 v203, v178, v179
    s_waitcnt vmcnt(12)
    v_mfma_f32_32x32x8_bf16 v[164:179], a[84:85], v[148:149], 0
    v_exp_f32 v180, v180
    v_exp_f32 v181, v181
    v_exp_f32 v182, v182
    v_exp_f32 v183, v183
    v_cvt_pk_bf16_f32 v204, v180, v181
    v_cvt_pk_bf16_f32 v205, v182, v183
    v_mfma_f32_32x32x16_bf16 v[164:179], a[40:43], v[116:119], v[164:179]
    v_exp_f32 v184, v184
    v_exp_f32 v185, v185
    v_exp_f32 v186, v186
    v_exp_f32 v187, v187
    v_cvt_pk_bf16_f32 v206, v184, v185
    v_cvt_pk_bf16_f32 v207, v186, v187
    v_mfma_f32_32x32x16_bf16 v[212:227], a[168:171], v[196:199], v[212:227]
    v_exp_f32 v188, v188
    v_exp_f32 v189, v189
    v_exp_f32 v190, v190
    v_exp_f32 v191, v191
    v_cvt_pk_bf16_f32 v208, v188, v189
    v_cvt_pk_bf16_f32 v209, v190, v191
    v_mfma_f32_32x32x16_bf16 v[212:227], a[172:175], v[200:203], v[212:227]
    v_exp_f32 v192, v192
    v_exp_f32 v193, v193
    v_exp_f32 v194, v194
    v_exp_f32 v195, v195
    v_cvt_pk_bf16_f32 v210, v192, v193
    v_cvt_pk_bf16_f32 v211, v194, v195
    v_mfma_f32_32x32x8_bf16 v[180:195], a[84:85], v[150:151], 0
    v_exp_f32 v164, v164
    v_exp_f32 v165, v165
    v_exp_f32 v166, v166
    v_exp_f32 v167, v167
    v_cvt_pk_bf16_f32 v196, v164, v165
    v_cvt_pk_bf16_f32 v197, v166, v167
    v_mfma_f32_32x32x16_bf16 v[180:195], a[40:43], v[120:123], v[180:195]
    buffer_load_dwordx4 a[56:59], v7, s[12:15], s35 offen offset:3072 sc1
    s_mov_b64 exec, s[44:45]
    buffer_load_dwordx2 a[92:93], v7, s[12:15], s37 offen offset:3072 sc1
    s_mov_b64 exec, s[42:43]
    s_add_u32 s38, s41, 573440
    buffer_load_dwordx4 a[208:211], v8, s[12:15], s38 offen sc1
    buffer_load_dwordx4 a[212:215], v6, s[12:15], s38 offen sc1
    s_mov_b64 exec, -1
    v_exp_f32 v168, v168
    v_exp_f32 v169, v169
    v_exp_f32 v170, v170
    v_exp_f32 v171, v171
    v_cvt_pk_bf16_f32 v198, v168, v169
    v_cvt_pk_bf16_f32 v199, v170, v171
    v_mfma_f32_32x32x16_bf16 v[228:243], a[168:171], v[204:207], v[228:243]
    v_exp_f32 v172, v172
    v_exp_f32 v173, v173
    v_exp_f32 v174, v174
    v_exp_f32 v175, v175
    v_cvt_pk_bf16_f32 v200, v172, v173
    v_cvt_pk_bf16_f32 v201, v174, v175
    v_mfma_f32_32x32x16_bf16 v[228:243], a[172:175], v[208:211], v[228:243]
    v_exp_f32 v176, v176
    v_exp_f32 v177, v177
    v_exp_f32 v178, v178
    v_exp_f32 v179, v179
    v_cvt_pk_bf16_f32 v202, v176, v177
    v_cvt_pk_bf16_f32 v203, v178, v179
    s_waitcnt vmcnt(12)
    v_mfma_f32_32x32x8_bf16 v[164:179], a[86:87], v[148:149], 0
    v_exp_f32 v180, v180
    v_exp_f32 v181, v181
    v_exp_f32 v182, v182
    v_exp_f32 v183, v183
    v_cvt_pk_bf16_f32 v204, v180, v181
    v_cvt_pk_bf16_f32 v205, v182, v183
    v_mfma_f32_32x32x16_bf16 v[164:179], a[44:47], v[116:119], v[164:179]
    buffer_load_dwordx4 v[124:127], v7, s[12:15], s39 offen offset:1024 sc1
    buffer_load_dwordx4 v[128:131], v7, s[12:15], s39 offen offset:1536 sc1
    s_mov_b64 exec, s[44:45]
    buffer_load_dwordx2 v[152:153], v7, s[12:15], s40 offen offset:1024 sc1
    buffer_load_dwordx2 v[154:155], v7, s[12:15], s40 offen offset:1536 sc1
    s_mov_b64 exec, -1
    v_exp_f32 v184, v184
    v_exp_f32 v185, v185
    v_exp_f32 v186, v186
    v_exp_f32 v187, v187
    v_cvt_pk_bf16_f32 v206, v184, v185
    v_cvt_pk_bf16_f32 v207, v186, v187
    v_mfma_f32_32x32x16_bf16 v[212:227], a[176:179], v[196:199], v[212:227]
    v_exp_f32 v188, v188
    v_exp_f32 v189, v189
    v_exp_f32 v190, v190
    v_exp_f32 v191, v191
    v_cvt_pk_bf16_f32 v208, v188, v189
    v_cvt_pk_bf16_f32 v209, v190, v191
    v_mfma_f32_32x32x16_bf16 v[212:227], a[180:183], v[200:203], v[212:227]
    v_exp_f32 v192, v192
    v_exp_f32 v193, v193
    v_exp_f32 v194, v194
    v_exp_f32 v195, v195
    v_cvt_pk_bf16_f32 v210, v192, v193
    v_cvt_pk_bf16_f32 v211, v194, v195
    v_mfma_f32_32x32x8_bf16 v[180:195], a[86:87], v[150:151], 0
    v_exp_f32 v164, v164
    v_exp_f32 v165, v165
    v_exp_f32 v166, v166
    v_exp_f32 v167, v167
    v_cvt_pk_bf16_f32 v196, v164, v165
    v_cvt_pk_bf16_f32 v197, v166, v167
    v_mfma_f32_32x32x16_bf16 v[180:195], a[44:47], v[120:123], v[180:195]
    buffer_load_dwordx4 a[60:63], v7, s[12:15], s35 offen offset:3584 sc1
    s_mov_b64 exec, s[44:45]
    buffer_load_dwordx2 a[94:95], v7, s[12:15], s37 offen offset:3584 sc1
    s_mov_b64 exec, s[42:43]
    s_add_u32 s38, s41, 614400
    buffer_load_dwordx4 a[216:219], v8, s[12:15], s38 offen sc1
    buffer_load_dwordx4 a[220:223], v6, s[12:15], s38 offen sc1
    s_mov_b64 exec, -1
    v_exp_f32 v168, v168
    v_exp_f32 v169, v169
    v_exp_f32 v170, v170
    v_exp_f32 v171, v171
    v_cvt_pk_bf16_f32 v198, v168, v169
    v_cvt_pk_bf16_f32 v199, v170, v171
    v_mfma_f32_32x32x16_bf16 v[228:243], a[176:179], v[204:207], v[228:243]
    v_exp_f32 v172, v172
    v_exp_f32 v173, v173
    v_exp_f32 v174, v174
    v_exp_f32 v175, v175
    v_cvt_pk_bf16_f32 v200, v172, v173
    v_cvt_pk_bf16_f32 v201, v174, v175
    v_mfma_f32_32x32x16_bf16 v[228:243], a[180:183], v[208:211], v[228:243]
    v_exp_f32 v176, v176
    v_exp_f32 v177, v177
    v_exp_f32 v178, v178
    v_exp_f32 v179, v179
    v_cvt_pk_bf16_f32 v202, v176, v177
    v_cvt_pk_bf16_f32 v203, v178, v179
    s_waitcnt vmcnt(16)
    v_mfma_f32_32x32x8_bf16 v[164:179], a[88:89], v[148:149], 0
    v_exp_f32 v180, v180
    v_exp_f32 v181, v181
    v_exp_f32 v182, v182
    v_exp_f32 v183, v183
    v_cvt_pk_bf16_f32 v204, v180, v181
    v_cvt_pk_bf16_f32 v205, v182, v183
    v_mfma_f32_32x32x16_bf16 v[164:179], a[48:51], v[116:119], v[164:179]
    v_exp_f32 v184, v184
    v_exp_f32 v185, v185
    v_exp_f32 v186, v186
    v_exp_f32 v187, v187
    v_cvt_pk_bf16_f32 v206, v184, v185
    v_cvt_pk_bf16_f32 v207, v186, v187
    v_mfma_f32_32x32x16_bf16 v[212:227], a[184:187], v[196:199], v[212:227]
    v_exp_f32 v188, v188
    v_exp_f32 v189, v189
    v_exp_f32 v190, v190
    v_exp_f32 v191, v191
    v_cvt_pk_bf16_f32 v208, v188, v189
    v_cvt_pk_bf16_f32 v209, v190, v191
    v_mfma_f32_32x32x16_bf16 v[212:227], a[188:191], v[200:203], v[212:227]
    v_exp_f32 v192, v192
    v_exp_f32 v193, v193
    v_exp_f32 v194, v194
    v_exp_f32 v195, v195
    v_cvt_pk_bf16_f32 v210, v192, v193
    v_cvt_pk_bf16_f32 v211, v194, v195
    v_mfma_f32_32x32x8_bf16 v[180:195], a[88:89], v[150:151], 0
    v_exp_f32 v164, v164
    v_exp_f32 v165, v165
    v_exp_f32 v166, v166
    v_exp_f32 v167, v167
    v_cvt_pk_bf16_f32 v196, v164, v165
    v_cvt_pk_bf16_f32 v197, v166, v167
    v_mfma_f32_32x32x16_bf16 v[180:195], a[48:51], v[120:123], v[180:195]
    buffer_load_dwordx4 v[132:135], v7, s[12:15], s39 offen offset:2048 sc1
    buffer_load_dwordx4 v[136:139], v7, s[12:15], s39 offen offset:2560 sc1
    s_mov_b64 exec, s[44:45]
    buffer_load_dwordx2 v[156:157], v7, s[12:15], s40 offen offset:2048 sc1
    buffer_load_dwordx2 v[158:159], v7, s[12:15], s40 offen offset:2560 sc1
    s_mov_b64 exec, -1
    v_exp_f32 v168, v168
    v_exp_f32 v169, v169
    v_exp_f32 v170, v170
    v_exp_f32 v171, v171
    v_cvt_pk_bf16_f32 v198, v168, v169
    v_cvt_pk_bf16_f32 v199, v170, v171
    v_mfma_f32_32x32x16_bf16 v[228:243], a[184:187], v[204:207], v[228:243]
    v_exp_f32 v172, v172
    v_exp_f32 v173, v173
    v_exp_f32 v174, v174
    v_exp_f32 v175, v175
    v_cvt_pk_bf16_f32 v200, v172, v173
    v_cvt_pk_bf16_f32 v201, v174, v175
    v_mfma_f32_32x32x16_bf16 v[228:243], a[188:191], v[208:211], v[228:243]
    v_exp_f32 v176, v176
    v_exp_f32 v177, v177
    v_exp_f32 v178, v178
    v_exp_f32 v179, v179
    v_cvt_pk_bf16_f32 v202, v176, v177
    v_cvt_pk_bf16_f32 v203, v178, v179
    s_waitcnt vmcnt(16)
    v_mfma_f32_32x32x8_bf16 v[164:179], a[90:91], v[148:149], 0
    v_exp_f32 v180, v180
    v_exp_f32 v181, v181
    v_exp_f32 v182, v182
    v_exp_f32 v183, v183
    v_cvt_pk_bf16_f32 v204, v180, v181
    v_cvt_pk_bf16_f32 v205, v182, v183
    v_mfma_f32_32x32x16_bf16 v[164:179], a[52:55], v[116:119], v[164:179]
    v_exp_f32 v184, v184
    v_exp_f32 v185, v185
    v_exp_f32 v186, v186
    v_exp_f32 v187, v187
    v_cvt_pk_bf16_f32 v206, v184, v185
    v_cvt_pk_bf16_f32 v207, v186, v187
    v_mfma_f32_32x32x16_bf16 v[212:227], a[192:195], v[196:199], v[212:227]
    v_exp_f32 v188, v188
    v_exp_f32 v189, v189
    v_exp_f32 v190, v190
    v_exp_f32 v191, v191
    v_cvt_pk_bf16_f32 v208, v188, v189
    v_cvt_pk_bf16_f32 v209, v190, v191
    v_mfma_f32_32x32x16_bf16 v[212:227], a[196:199], v[200:203], v[212:227]
    v_exp_f32 v192, v192
    v_exp_f32 v193, v193
    v_exp_f32 v194, v194
    v_exp_f32 v195, v195
    v_cvt_pk_bf16_f32 v210, v192, v193
    v_cvt_pk_bf16_f32 v211, v194, v195
    v_mfma_f32_32x32x8_bf16 v[180:195], a[90:91], v[150:151], 0
    v_exp_f32 v164, v164
    v_exp_f32 v165, v165
    v_exp_f32 v166, v166
    v_exp_f32 v167, v167
    v_cvt_pk_bf16_f32 v196, v164, v165
    v_cvt_pk_bf16_f32 v197, v166, v167
    v_mfma_f32_32x32x16_bf16 v[180:195], a[52:55], v[120:123], v[180:195]
    buffer_load_dwordx4 v[140:143], v7, s[12:15], s39 offen offset:3072 sc1
    buffer_load_dwordx4 v[144:147], v7, s[12:15], s39 offen offset:3584 sc1
    s_mov_b64 exec, s[44:45]
    buffer_load_dwordx2 v[160:161], v7, s[12:15], s40 offen offset:3072 sc1
    buffer_load_dwordx2 v[162:163], v7, s[12:15], s40 offen offset:3584 sc1
    s_mov_b64 exec, -1
    v_exp_f32 v168, v168
    v_exp_f32 v169, v169
    v_exp_f32 v170, v170
    v_exp_f32 v171, v171
    v_cvt_pk_bf16_f32 v198, v168, v169
    v_cvt_pk_bf16_f32 v199, v170, v171
    v_mfma_f32_32x32x16_bf16 v[228:243], a[192:195], v[204:207], v[228:243]
    v_exp_f32 v172, v172
    v_exp_f32 v173, v173
    v_exp_f32 v174, v174
    v_exp_f32 v175, v175
    v_cvt_pk_bf16_f32 v200, v172, v173
    v_cvt_pk_bf16_f32 v201, v174, v175
    v_mfma_f32_32x32x16_bf16 v[228:243], a[196:199], v[208:211], v[228:243]
    v_exp_f32 v176, v176
    v_exp_f32 v177, v177
    v_exp_f32 v178, v178
    v_exp_f32 v179, v179
    v_cvt_pk_bf16_f32 v202, v176, v177
    v_cvt_pk_bf16_f32 v203, v178, v179
    s_waitcnt vmcnt(16)
    v_mfma_f32_32x32x8_bf16 v[164:179], a[92:93], v[148:149], 0
    v_exp_f32 v180, v180
    v_exp_f32 v181, v181
    v_exp_f32 v182, v182
    v_exp_f32 v183, v183
    v_cvt_pk_bf16_f32 v204, v180, v181
    v_cvt_pk_bf16_f32 v205, v182, v183
    v_mfma_f32_32x32x16_bf16 v[164:179], a[56:59], v[116:119], v[164:179]
    v_exp_f32 v184, v184
    v_exp_f32 v185, v185
    v_exp_f32 v186, v186
    v_exp_f32 v187, v187
    v_cvt_pk_bf16_f32 v206, v184, v185
    v_cvt_pk_bf16_f32 v207, v186, v187
    v_mfma_f32_32x32x16_bf16 v[212:227], a[200:203], v[196:199], v[212:227]
    v_exp_f32 v188, v188
    v_exp_f32 v189, v189
    v_exp_f32 v190, v190
    v_exp_f32 v191, v191
    v_cvt_pk_bf16_f32 v208, v188, v189
    v_cvt_pk_bf16_f32 v209, v190, v191
    v_mfma_f32_32x32x16_bf16 v[212:227], a[204:207], v[200:203], v[212:227]
    s_getpc_b64 s[58:59]
L_pc_10:
    v_min_u32 v31, L_end-L_pc_10-4, v30
    s_mov_b64 exec, 3
    global_load_dword v0, v31, s[58:59]
    s_mov_b64 exec, -1
    v_exp_f32 v192, v192
    v_exp_f32 v193, v193
    v_exp_f32 v194, v194
    v_exp_f32 v195, v195
    v_cvt_pk_bf16_f32 v210, v192, v193
    v_cvt_pk_bf16_f32 v211, v194, v195
    v_mfma_f32_32x32x8_bf16 v[180:195], a[92:93], v[150:151], 0
    v_exp_f32 v164, v164
    v_exp_f32 v165, v165
    v_exp_f32 v166, v166
    v_exp_f32 v167, v167
    v_cvt_pk_bf16_f32 v196, v164, v165
    v_cvt_pk_bf16_f32 v197, v166, v167
    v_mfma_f32_32x32x16_bf16 v[180:195], a[56:59], v[120:123], v[180:195]
    s_waitcnt vmcnt(15)
    v_mfma_f32_32x32x16_bf16 v[80:95], a[0:3], v[124:127], 0
    s_add_u32 m0, s52, 0
    s_nop 0
    buffer_load_dwordx4 v4, s[8:11], s63 offen lds
    s_add_u32 s63, s63, s64
    v_exp_f32 v168, v168
    v_exp_f32 v169, v169
    v_exp_f32 v170, v170
    v_exp_f32 v171, v171
    v_cvt_pk_bf16_f32 v198, v168, v169
    v_cvt_pk_bf16_f32 v199, v170, v171
    v_mfma_f32_32x32x16_bf16 v[228:243], a[200:203], v[204:207], v[228:243]
    v_exp_f32 v172, v172
    v_exp_f32 v173, v173
    v_exp_f32 v174, v174
    v_exp_f32 v175, v175
    v_cvt_pk_bf16_f32 v200, v172, v173
    v_cvt_pk_bf16_f32 v201, v174, v175
    v_mfma_f32_32x32x16_bf16 v[228:243], a[204:207], v[208:211], v[228:243]
    v_exp_f32 v176, v176
    v_exp_f32 v177, v177
    v_exp_f32 v178, v178
    v_exp_f32 v179, v179
    v_cvt_pk_bf16_f32 v202, v176, v177
    v_cvt_pk_bf16_f32 v203, v178, v179
    v_max3_f32 v80, v80, v81, v82
    v_max3_f32 v80, v80, v83, v84
    v_cvt_pk_bf16_f32 v81, -v80, 0
    v_lshlrev_b32 v246, 16, v81
    s_waitcnt vmcnt(14)
    v_cndmask_b32 v152, v152, v81, s[30:31]
    s_waitcnt vmcnt(10)
    v_mfma_f32_32x32x8_bf16 v[164:179], a[94:95], v[148:149], 0
    v_exp_f32 v180, v180
    v_exp_f32 v181, v181
    v_exp_f32 v182, v182
    v_exp_f32 v183, v183
    v_cvt_pk_bf16_f32 v204, v180, v181
    v_cvt_pk_bf16_f32 v205, v182, v183
    v_mfma_f32_32x32x16_bf16 v[164:179], a[60:63], v[116:119], v[164:179]
    v_mfma_f32_32x32x16_bf16 v[80:95], a[0:3], v[128:131], 0
    s_add_u32 m0, s52, 1024
    s_nop 0
    buffer_load_dwordx4 v4, s[8:11], s63 offen lds
    s_add_u32 s63, s63, s64
    v_exp_f32 v184, v184
    v_exp_f32 v185, v185
    v_exp_f32 v186, v186
    v_exp_f32 v187, v187
    v_cvt_pk_bf16_f32 v206, v184, v185
    v_cvt_pk_bf16_f32 v207, v186, v187
    v_mfma_f32_32x32x16_bf16 v[212:227], a[208:211], v[196:199], v[212:227]
    v_exp_f32 v188, v188
    v_exp_f32 v189, v189
    v_exp_f32 v190, v190
    v_exp_f32 v191, v191
    v_cvt_pk_bf16_f32 v208, v188, v189
    v_cvt_pk_bf16_f32 v209, v190, v191
    v_mfma_f32_32x32x16_bf16 v[212:227], a[212:215], v[200:203], v[212:227]
    v_exp_f32 v192, v192
    v_exp_f32 v193, v193
    v_exp_f32 v194, v194
    v_exp_f32 v195, v195
    v_cvt_pk_bf16_f32 v210, v192, v193
    v_cvt_pk_bf16_f32 v211, v194, v195
    v_max3_f32 v80, v80, v81, v82
    v_max3_f32 v80, v80, v83, v84
    v_cvt_pk_bf16_f32 v81, -v80, 0
    v_lshlrev_b32 v247, 16, v81
    v_cndmask_b32 v154, v154, v81, s[30:31]
    v_mfma_f32_32x32x8_bf16 v[180:195], a[94:95], v[150:151], 0
    v_exp_f32 v164, v164
    v_exp_f32 v165, v165
    v_exp_f32 v166, v166
    v_exp_f32 v167, v167
    v_cvt_pk_bf16_f32 v196, v164, v165
    v_cvt_pk_bf16_f32 v197, v166, v167
    v_mfma_f32_32x32x16_bf16 v[180:195], a[60:63], v[120:123], v[180:195]
    s_add_u32 m0, s52, 2048
    s_nop 0
    buffer_load_dwordx4 v4, s[8:11], s63 offen lds
    s_add_u32 s63, s63, s64
    v_exp_f32 v168, v168
    v_exp_f32 v169, v169
    v_exp_f32 v170, v170
    v_exp_f32 v171, v171
    v_cvt_pk_bf16_f32 v198, v168, v169
    v_cvt_pk_bf16_f32 v199, v170, v171
    v_mfma_f32_32x32x16_bf16 v[228:243], a[208:211], v[204:207], v[228:243]
    v_exp_f32 v172, v172
    v_exp_f32 v173, v173
    v_exp_f32 v174, v174
    v_exp_f32 v175, v175
    v_cvt_pk_bf16_f32 v200, v172, v173
    v_cvt_pk_bf16_f32 v201, v174, v175
    v_mfma_f32_32x32x16_bf16 v[228:243], a[212:215], v[208:211], v[228:243]
    v_exp_f32 v176, v176
    v_exp_f32 v177, v177
    v_exp_f32 v178, v178
    v_exp_f32 v179, v179
    v_cvt_pk_bf16_f32 v202, v176, v177
    v_cvt_pk_bf16_f32 v203, v178, v179
    v_mfma_f32_32x32x8_bf16 v[164:179], a[64:65], v[152:153], 0
    v_exp_f32 v180, v180
    v_exp_f32 v181, v181
    v_exp_f32 v182, v182
    v_exp_f32 v183, v183
    v_cvt_pk_bf16_f32 v204, v180, v181
    v_cvt_pk_bf16_f32 v205, v182, v183
    v_mfma_f32_32x32x16_bf16 v[164:179], a[0:3], v[124:127], v[164:179]
    s_add_u32 m0, s52, 3072
    s_nop 0
    buffer_load_dwordx4 v4, s[8:11], s63 offen lds
    s_add_u32 s63, s63, s65
    v_exp_f32 v184, v184
    v_exp_f32 v185, v185
    v_exp_f32 v186, v186
    v_exp_f32 v187, v187
    v_cvt_pk_bf16_f32 v206, v184, v185
    v_cvt_pk_bf16_f32 v207, v186, v187
    v_mfma_f32_32x32x16_bf16 v[212:227], a[216:219], v[196:199], v[212:227]
    v_exp_f32 v188, v188
    v_exp_f32 v189, v189
    v_exp_f32 v190, v190
    v_exp_f32 v191, v191
    v_cvt_pk_bf16_f32 v208, v188, v189
    v_cvt_pk_bf16_f32 v209, v190, v191
    v_mfma_f32_32x32x16_bf16 v[212:227], a[220:223], v[200:203], v[212:227]
    v_exp_f32 v192, v192
    v_exp_f32 v193, v193
    v_exp_f32 v194, v194
    v_exp_f32 v195, v195
    v_cvt_pk_bf16_f32 v210, v192, v193
    v_cvt_pk_bf16_f32 v211, v194, v195
    v_mfma_f32_32x32x8_bf16 v[180:195], a[64:65], v[154:155], 0
    v_exp_f32 v164, v164
    v_exp_f32 v165, v165
    v_exp_f32 v166, v166
    v_exp_f32 v167, v167
    v_cvt_pk_bf16_f32 v196, v164, v165
    v_cvt_pk_bf16_f32 v197, v166, v167
    v_mfma_f32_32x32x16_bf16 v[180:195], a[0:3], v[128:131], v[180:195]
    s_add_u32 m0, s52, 4096
    s_nop 0
    buffer_load_dwordx4 v4, s[8:11], s63 offen lds
    s_add_u32 s63, s63, s64
    v_exp_f32 v168, v168
    v_exp_f32 v169, v169
    v_exp_f32 v170, v170
    v_exp_f32 v171, v171
    v_cvt_pk_bf16_f32 v198, v168, v169
    v_cvt_pk_bf16_f32 v199, v170, v171
    v_mfma_f32_32x32x16_bf16 v[228:243], a[216:219], v[204:207], v[228:243]
    v_mov_b32 v223, v244
    v_subrev_u32 v224, 0x2b800000, v222
    v_max_u32 v252, v252, v224
    ds_write_b128 v14, v[212:215] offset:0
    ds_write_b128 v14, v[216:219] offset:1024
    ds_write_b128 v14, v[220:223] offset:2048
    v_exp_f32 v172, v172
    v_exp_f32 v173, v173
    v_exp_f32 v174, v174
    v_exp_f32 v175, v175
    v_cvt_pk_bf16_f32 v200, v172, v173
    v_cvt_pk_bf16_f32 v201, v174, v175
    v_mfma_f32_32x32x16_bf16 v[228:243], a[220:223], v[208:211], v[228:243]
    v_exp_f32 v176, v176
    v_exp_f32 v177, v177
    v_exp_f32 v178, v178
    v_exp_f32 v179, v179
    v_cvt_pk_bf16_f32 v202, v176, v177
    v_cvt_pk_bf16_f32 v203, v178, v179
    v_mfma_f32_32x32x8_bf16 v[164:179], a[66:67], v[152:153], 0
    v_exp_f32 v180, v180
    v_exp_f32 v181, v181
    v_exp_f32 v182, v182
    v_exp_f32 v183, v183
    v_cvt_pk_bf16_f32 v204, v180, v181
    v_cvt_pk_bf16_f32 v205, v182, v183
    v_mfma_f32_32x32x16_bf16 v[164:179], a[4:7], v[124:127], v[164:179]
    s_add_u32 m0, s52, 5120
    s_nop 0
    buffer_load_dwordx4 v4, s[8:11], s63 offen lds
    s_add_u32 s63, s63, s64
    v_exp_f32 v184, v184
    v_exp_f32 v185, v185
    v_exp_f32 v186, v186
    v_exp_f32 v187, v187
    v_cvt_pk_bf16_f32 v206, v184, v185
    v_cvt_pk_bf16_f32 v207, v186, v187
    v_mfma_f32_32x32x16_bf16 v[212:227], a[96:99], v[196:199], 0
    v_mov_b32 v239, v245
    v_subrev_u32 v240, 0x2b800000, v238
    v_max_u32 v252, v252, v240
    ds_write_b128 v14, v[228:231] offset:12288
    ds_write_b128 v14, v[232:235] offset:13312
    ds_write_b128 v14, v[236:239] offset:14336
    v_exp_f32 v188, v188
    v_exp_f32 v189, v189
    v_exp_f32 v190, v190
    v_exp_f32 v191, v191
    v_cvt_pk_bf16_f32 v208, v188, v189
    v_cvt_pk_bf16_f32 v209, v190, v191
    v_mfma_f32_32x32x16_bf16 v[212:227], a[100:103], v[200:203], v[212:227]
    v_exp_f32 v192, v192
    v_exp_f32 v193, v193
    v_exp_f32 v194, v194
    v_exp_f32 v195, v195
    v_cvt_pk_bf16_f32 v210, v192, v193
    v_cvt_pk_bf16_f32 v211, v194, v195
    v_mfma_f32_32x32x8_bf16 v[180:195], a[66:67], v[154:155], 0
    v_exp_f32 v164, v164
    v_exp_f32 v165, v165
    v_exp_f32 v166, v166
    v_exp_f32 v167, v167
    v_cvt_pk_bf16_f32 v196, v164, v165
    v_cvt_pk_bf16_f32 v197, v166, v167
    v_mfma_f32_32x32x16_bf16 v[180:195], a[4:7], v[128:131], v[180:195]
    s_add_u32 m0, s52, 6144
    s_nop 0
    buffer_load_dwordx4 v4, s[8:11], s63 offen lds
    s_add_u32 s63, s63, s64
    v_exp_f32 v168, v168
    v_exp_f32 v169, v169
    v_exp_f32 v170, v170
    v_exp_f32 v171, v171
    v_cvt_pk_bf16_f32 v198, v168, v169
    v_cvt_pk_bf16_f32 v199, v170, v171
    v_mfma_f32_32x32x16_bf16 v[228:243], a[96:99], v[204:207], 0
    v_exp_f32 v172, v172
    v_exp_f32 v173, v173
    v_exp_f32 v174, v174
    v_exp_f32 v175, v175
    v_cvt_pk_bf16_f32 v200, v172, v173
    v_cvt_pk_bf16_f32 v201, v174, v175
    v_mfma_f32_32x32x16_bf16 v[228:243], a[100:103], v[208:211], v[228:243]
    v_exp_f32 v176, v176
    v_exp_f32 v177, v177
    v_exp_f32 v178, v178
    v_exp_f32 v179, v179
    v_cvt_pk_bf16_f32 v202, v176, v177
    v_cvt_pk_bf16_f32 v203, v178, v179
    v_mfma_f32_32x32x8_bf16 v[164:179], a[68:69], v[152:153], 0
    v_exp_f32 v180, v180
    v_exp_f32 v181, v181
    v_exp_f32 v182, v182
    v_exp_f32 v183, v183
    v_cvt_pk_bf16_f32 v204, v180, v181
    v_cvt_pk_bf16_f32 v205, v182, v183
    v_mfma_f32_32x32x16_bf16 v[164:179], a[8:11], v[124:127], v[164:179]
    s_add_u32 m0, s52, 7168
    s_nop 0
    buffer_load_dwordx4 v4, s[8:11], s63 offen lds
    s_add_u32 s63, s63, s64
    v_exp_f32 v184, v184
    v_exp_f32 v185, v185
    v_exp_f32 v186, v186
    v_exp_f32 v187, v187
    v_cvt_pk_bf16_f32 v206, v184, v185
    v_cvt_pk_bf16_f32 v207, v186, v187
    v_mfma_f32_32x32x16_bf16 v[212:227], a[104:107], v[196:199], v[212:227]
    v_exp_f32 v188, v188
    v_exp_f32 v189, v189
    v_exp_f32 v190, v190
    v_exp_f32 v191, v191
    v_cvt_pk_bf16_f32 v208, v188, v189
    v_cvt_pk_bf16_f32 v209, v190, v191
    v_mfma_f32_32x32x16_bf16 v[212:227], a[108:111], v[200:203], v[212:227]
    v_exp_f32 v192, v192
    v_exp_f32 v193, v193
    v_exp_f32 v194, v194
    v_exp_f32 v195, v195
    v_cvt_pk_bf16_f32 v210, v192, v193
    v_cvt_pk_bf16_f32 v211, v194, v195
    v_mfma_f32_32x32x8_bf16 v[180:195], a[68:69], v[154:155], 0
    v_exp_f32 v164, v164
    v_exp_f32 v165, v165
    v_exp_f32 v166, v166
    v_exp_f32 v167, v167
    v_cvt_pk_bf16_f32 v196, v164, v165
    v_cvt_pk_bf16_f32 v197, v166, v167
    v_mfma_f32_32x32x16_bf16 v[180:195], a[8:11], v[128:131], v[180:195]
    v_exp_f32 v168, v168
    v_exp_f32 v169, v169
    v_exp_f32 v170, v170
    v_exp_f32 v171, v171
    v_cvt_pk_bf16_f32 v198, v168, v169
    v_cvt_pk_bf16_f32 v199, v170, v171
    v_mfma_f32_32x32x16_bf16 v[228:243], a[104:107], v[204:207], v[228:243]
    v_exp_f32 v172, v172
    v_exp_f32 v173, v173
    v_exp_f32 v174, v174
    v_exp_f32 v175, v175
    v_cvt_pk_bf16_f32 v200, v172, v173
    v_cvt_pk_bf16_f32 v201, v174, v175
    v_mfma_f32_32x32x16_bf16 v[228:243], a[108:111], v[208:211], v[228:243]
    v_exp_f32 v176, v176
    v_exp_f32 v177, v177
    v_exp_f32 v178, v178
    v_exp_f32 v179, v179
    v_cvt_pk_bf16_f32 v202, v176, v177
    v_cvt_pk_bf16_f32 v203, v178, v179
    v_mfma_f32_32x32x8_bf16 v[164:179], a[70:71], v[152:153], 0
    v_exp_f32 v180, v180
    v_exp_f32 v181, v181
    v_exp_f32 v182, v182
    v_exp_f32 v183, v183
    v_cvt_pk_bf16_f32 v204, v180, v181
    v_cvt_pk_bf16_f32 v205, v182, v183
    v_mfma_f32_32x32x16_bf16 v[164:179], a[12:15], v[124:127], v[164:179]
    v_exp_f32 v184, v184
    v_exp_f32 v185, v185
    v_exp_f32 v186, v186
    v_exp_f32 v187, v187
    v_cvt_pk_bf16_f32 v206, v184, v185
    v_cvt_pk_bf16_f32 v207, v186, v187
    v_mfma_f32_32x32x16_bf16 v[212:227], a[112:115], v[196:199], v[212:227]
    v_exp_f32 v188, v188
    v_exp_f32 v189, v189
    v_exp_f32 v190, v190
    v_exp_f32 v191, v191
    v_cvt_pk_bf16_f32 v208, v188, v189
    v_cvt_pk_bf16_f32 v209, v190, v191
    v_mfma_f32_32x32x16_bf16 v[212:227], a[116:119], v[200:203], v[212:227]
    v_exp_f32 v192, v192
    v_exp_f32 v193, v193
    v_exp_f32 v194, v194
    v_exp_f32 v195, v195
    v_cvt_pk_bf16_f32 v210, v192, v193
    v_cvt_pk_bf16_f32 v211, v194, v195
    v_mfma_f32_32x32x8_bf16 v[180:195], a[70:71], v[154:155], 0
    v_exp_f32 v164, v164
    v_exp_f32 v165, v165
    v_exp_f32 v166, v166
    v_exp_f32 v167, v167
    v_cvt_pk_bf16_f32 v196, v164, v165
    v_cvt_pk_bf16_f32 v197, v166, v167
    v_mfma_f32_32x32x16_bf16 v[180:195], a[12:15], v[128:131], v[180:195]
    v_exp_f32 v168, v168
    v_exp_f32 v169, v169
    v_exp_f32 v170, v170
    v_exp_f32 v171, v171
    v_cvt_pk_bf16_f32 v198, v168, v169
    v_cvt_pk_bf16_f32 v199, v170, v171
    v_mfma_f32_32x32x16_bf16 v[228:243], a[112:115], v[204:207], v[228:243]
    s_add_u32 s48, s46, 0
    buffer_store_dwordx4 v[100:103], v17, s[12:15], s48 offen offset:0 sc1
    v_exp_f32 v172, v172
    v_exp_f32 v173, v173
    v_exp_f32 v174, v174
    v_exp_f32 v175, v175
    v_cvt_pk_bf16_f32 v200, v172, v173
    v_cvt_pk_bf16_f32 v201, v174, v175
    v_mfma_f32_32x32x16_bf16 v[228:243], a[116:119], v[208:211], v[228:243]
    v_exp_f32 v176, v176
    v_exp_f32 v177, v177
    v_exp_f32 v178, v178
    v_exp_f32 v179, v179
    v_cvt_pk_bf16_f32 v202, v176, v177
    v_cvt_pk_bf16_f32 v203, v178, v179
    v_mfma_f32_32x32x8_bf16 v[164:179], a[72:73], v[152:153], 0
    v_exp_f32 v180, v180
    v_exp_f32 v181, v181
    v_exp_f32 v182, v182
    v_exp_f32 v183, v183
    v_cvt_pk_bf16_f32 v204, v180, v181
    v_cvt_pk_bf16_f32 v205, v182, v183
    v_mfma_f32_32x32x16_bf16 v[164:179], a[16:19], v[124:127], v[164:179]
    v_exp_f32 v184, v184
    v_exp_f32 v185, v185
    v_exp_f32 v186, v186
    v_exp_f32 v187, v187
    v_cvt_pk_bf16_f32 v206, v184, v185
    v_cvt_pk_bf16_f32 v207, v186, v187
    v_mfma_f32_32x32x16_bf16 v[212:227], a[120:123], v[196:199], v[212:227]
    v_exp_f32 v188, v188
    v_exp_f32 v189, v189
    v_exp_f32 v190, v190
    v_exp_f32 v191, v191
    v_cvt_pk_bf16_f32 v208, v188, v189
    v_cvt_pk_bf16_f32 v209, v190, v191
    v_mfma_f32_32x32x16_bf16 v[212:227], a[124:127], v[200:203], v[212:227]
    v_exp_f32 v192, v192
    v_exp_f32 v193, v193
    v_exp_f32 v194, v194
    v_exp_f32 v195, v195
    v_cvt_pk_bf16_f32 v210, v192, v193
    v_cvt_pk_bf16_f32 v211, v194, v195
    v_mfma_f32_32x32x8_bf16 v[180:195], a[72:73], v[154:155], 0
    v_exp_f32 v164, v164
    v_exp_f32 v165, v165
    v_exp_f32 v166, v166
    v_exp_f32 v167, v167
    v_cvt_pk_bf16_f32 v196, v164, v165
    v_cvt_pk_bf16_f32 v197, v166, v167
    v_mfma_f32_32x32x16_bf16 v[180:195], a[16:19], v[128:131], v[180:195]
    v_exp_f32 v168, v168
    v_exp_f32 v169, v169
    v_exp_f32 v170, v170
    v_exp_f32 v171, v171
    v_cvt_pk_bf16_f32 v198, v168, v169
    v_cvt_pk_bf16_f32 v199, v170, v171
    v_mfma_f32_32x32x16_bf16 v[228:243], a[120:123], v[204:207], v[228:243]
    v_exp_f32 v172, v172
    v_exp_f32 v173, v173
    v_exp_f32 v174, v174
    v_exp_f32 v175, v175
    v_cvt_pk_bf16_f32 v200, v172, v173
    v_cvt_pk_bf16_f32 v201, v174, v175
    v_mfma_f32_32x32x16_bf16 v[228:243], a[124:127], v[208:211], v[228:243]
    v_exp_f32 v176, v176
    v_exp_f32 v177, v177
    v_exp_f32 v178, v178
    v_exp_f32 v179, v179
    v_cvt_pk_bf16_f32 v202, v176, v177
    v_cvt_pk_bf16_f32 v203, v178, v179
    v_mfma_f32_32x32x8_bf16 v[164:179], a[74:75], v[152:153], 0
    v_exp_f32 v180, v180
    v_exp_f32 v181, v181
    v_exp_f32 v182, v182
    v_exp_f32 v183, v183
    v_cvt_pk_bf16_f32 v204, v180, v181
    v_cvt_pk_bf16_f32 v205, v182, v183
    v_mfma_f32_32x32x16_bf16 v[164:179], a[20:23], v[124:127], v[164:179]
    v_exp_f32 v184, v184
    v_exp_f32 v185, v185
    v_exp_f32 v186, v186
    v_exp_f32 v187, v187
    v_cvt_pk_bf16_f32 v206, v184, v185
    v_cvt_pk_bf16_f32 v207, v186, v187
    v_mfma_f32_32x32x16_bf16 v[212:227], a[128:131], v[196:199], v[212:227]
    s_add_u32 s48, s46, 40960
    buffer_store_dwordx4 v[100:103], v17, s[12:15], s48 offen offset:0 sc1
    v_exp_f32 v188, v188
    v_exp_f32 v189, v189
    v_exp_f32 v190, v190
    v_exp_f32 v191, v191
    v_cvt_pk_bf16_f32 v208, v188, v189
    v_cvt_pk_bf16_f32 v209, v190, v191
    v_mfma_f32_32x32x16_bf16 v[212:227], a[132:135], v[200:203], v[212:227]
    v_exp_f32 v192, v192
    v_exp_f32 v193, v193
    v_exp_f32 v194, v194
    v_exp_f32 v195, v195
    v_cvt_pk_bf16_f32 v210, v192, v193
    v_cvt_pk_bf16_f32 v211, v194, v195
    v_mfma_f32_32x32x8_bf16 v[180:195], a[74:75], v[154:155], 0
    v_exp_f32 v164, v164
    v_exp_f32 v165, v165
    v_exp_f32 v166, v166
    v_exp_f32 v167, v167
    v_cvt_pk_bf16_f32 v196, v164, v165
    v_cvt_pk_bf16_f32 v197, v166, v167
    v_mfma_f32_32x32x16_bf16 v[180:195], a[20:23], v[128:131], v[180:195]
    v_exp_f32 v168, v168
    v_exp_f32 v169, v169
    v_exp_f32 v170, v170
    v_exp_f32 v171, v171
    v_cvt_pk_bf16_f32 v198, v168, v169
    v_cvt_pk_bf16_f32 v199, v170, v171
    v_mfma_f32_32x32x16_bf16 v[228:243], a[128:131], v[204:207], v[228:243]
    v_exp_f32 v172, v172
    v_exp_f32 v173, v173
    v_exp_f32 v174, v174
    v_exp_f32 v175, v175
    v_cvt_pk_bf16_f32 v200, v172, v173
    v_cvt_pk_bf16_f32 v201, v174, v175
    v_mfma_f32_32x32x16_bf16 v[228:243], a[132:135], v[208:211], v[228:243]
    v_exp_f32 v176, v176
    v_exp_f32 v177, v177
    v_exp_f32 v178, v178
    v_exp_f32 v179, v179
    v_cvt_pk_bf16_f32 v202, v176, v177
    v_cvt_pk_bf16_f32 v203, v178, v179
    v_mfma_f32_32x32x8_bf16 v[164:179], a[76:77], v[152:153], 0
    v_exp_f32 v180, v180
    v_exp_f32 v181, v181
    v_exp_f32 v182, v182
    v_exp_f32 v183, v183
    v_cvt_pk_bf16_f32 v204, v180, v181
    v_cvt_pk_bf16_f32 v205, v182, v183
    v_mfma_f32_32x32x16_bf16 v[164:179], a[24:27], v[124:127], v[164:179]
    v_exp_f32 v184, v184
    v_exp_f32 v185, v185
    v_exp_f32 v186, v186
    v_exp_f32 v187, v187
    v_cvt_pk_bf16_f32 v206, v184, v185
    v_cvt_pk_bf16_f32 v207, v186, v187
    v_mfma_f32_32x32x16_bf16 v[212:227], a[136:139], v[196:199], v[212:227]
    v_exp_f32 v188, v188
    v_exp_f32 v189, v189
    v_exp_f32 v190, v190
    v_exp_f32 v191, v191
    v_cvt_pk_bf16_f32 v208, v188, v189
    v_cvt_pk_bf16_f32 v209, v190, v191
    v_mfma_f32_32x32x16_bf16 v[212:227], a[140:143], v[200:203], v[212:227]
    v_exp_f32 v192, v192
    v_exp_f32 v193, v193
    v_exp_f32 v194, v194
    v_exp_f32 v195, v195
    v_cvt_pk_bf16_f32 v210, v192, v193
    v_cvt_pk_bf16_f32 v211, v194, v195
    v_mfma_f32_32x32x8_bf16 v[180:195], a[76:77], v[154:155], 0
    v_exp_f32 v164, v164
    v_exp_f32 v165, v165
    v_exp_f32 v166, v166
    v_exp_f32 v167, v167
    v_cvt_pk_bf16_f32 v196, v164, v165
    v_cvt_pk_bf16_f32 v197, v166, v167
    v_mfma_f32_32x32x16_bf16 v[180:195], a[24:27], v[128:131], v[180:195]
    s_waitcnt vmcnt(17)
    v_mfma_f32_32x32x16_bf16 v[80:95], a[0:3], v[132:135], 0
    v_exp_f32 v168, v168
    v_exp_f32 v169, v169
    v_exp_f32 v170, v170
    v_exp_f32 v171, v171
    v_cvt_pk_bf16_f32 v198, v168, v169
    v_cvt_pk_bf16_f32 v199, v170, v171
    v_mfma_f32_32x32x16_bf16 v[228:243], a[136:139], v[204:207], v[228:243]
    buffer_store_dwordx2 v[100:101], v27, s[12:15], s47 offen sc1
    v_exp_f32 v172, v172
    v_exp_f32 v173, v173
    v_exp_f32 v174, v174
    v_exp_f32 v175, v175
    v_cvt_pk_bf16_f32 v200, v172, v173
    v_cvt_pk_bf16_f32 v201, v174, v175
    v_mfma_f32_32x32x16_bf16 v[228:243], a[140:143], v[208:211], v[228:243]
    v_exp_f32 v176, v176
    v_exp_f32 v177, v177
    v_exp_f32 v178, v178
    v_exp_f32 v179, v179
    v_cvt_pk_bf16_f32 v202, v176, v177
    v_cvt_pk_bf16_f32 v203, v178, v179
    v_max3_f32 v80, v80, v81, v82
    v_max3_f32 v80, v80, v83, v84
    v_cvt_pk_bf16_f32 v81, -v80, 0
    v_lshlrev_b32 v248, 16, v81
    s_waitcnt vmcnt(16)
    v_cndmask_b32 v156, v156, v81, s[30:31]
    v_mfma_f32_32x32x8_bf16 v[164:179], a[78:79], v[152:153], 0
    v_exp_f32 v180, v180
    v_exp_f32 v181, v181
    v_exp_f32 v182, v182
    v_exp_f32 v183, v183
    v_cvt_pk_bf16_f32 v204, v180, v181
    v_cvt_pk_bf16_f32 v205, v182, v183
    v_mfma_f32_32x32x16_bf16 v[164:179], a[28:31], v[124:127], v[164:179]
    v_exp_f32 v184, v184
    v_exp_f32 v185, v185
    v_exp_f32 v186, v186
    v_exp_f32 v187, v187
    v_cvt_pk_bf16_f32 v206, v184, v185
    v_cvt_pk_bf16_f32 v207, v186, v187
    v_mfma_f32_32x32x16_bf16 v[212:227], a[144:147], v[196:199], v[212:227]
    v_exp_f32 v188, v188
    v_exp_f32 v189, v189
    v_exp_f32 v190, v190
    v_exp_f32 v191, v191
    v_cvt_pk_bf16_f32 v208, v188, v189
    v_cvt_pk_bf16_f32 v209, v190, v191
    v_mfma_f32_32x32x16_bf16 v[212:227], a[148:151], v[200:203], v[212:227]
    v_exp_f32 v192, v192
    v_exp_f32 v193, v193
    v_exp_f32 v194, v194
    v_exp_f32 v195, v195
    v_cvt_pk_bf16_f32 v210, v192, v193
    v_cvt_pk_bf16_f32 v211, v194, v195
    v_mfma_f32_32x32x8_bf16 v[180:195], a[78:79], v[154:155], 0
    v_exp_f32 v164, v164
    v_exp_f32 v165, v165
    v_exp_f32 v166, v166
    v_exp_f32 v167, v167
    v_cvt_pk_bf16_f32 v196, v164, v165
    v_cvt_pk_bf16_f32 v197, v166, v167
    v_mfma_f32_32x32x16_bf16 v[180:195], a[28:31], v[128:131], v[180:195]
    v_mfma_f32_32x32x16_bf16 v[80:95], a[0:3], v[136:139], 0
    s_waitcnt vmcnt(3)
    ds_read_b64_tr_b16 v[32:33], v96 offset:0
    ds_read_b64_tr_b16 v[34:35], v96 offset:1024
    v_exp_f32 v168, v168
    v_exp_f32 v169, v169
    v_exp_f32 v170, v170
    v_exp_f32 v171, v171
    v_cvt_pk_bf16_f32 v198, v168, v169
    v_cvt_pk_bf16_f32 v199, v170, v171
    v_mfma_f32_32x32x16_bf16 v[228:243], a[144:147], v[204:207], v[228:243]
    v_exp_f32 v172, v172
    v_exp_f32 v173, v173
    v_exp_f32 v174, v174
    v_exp_f32 v175, v175
    v_cvt_pk_bf16_f32 v200, v172, v173
    v_cvt_pk_bf16_f32 v201, v174, v175
    v_mfma_f32_32x32x16_bf16 v[228:243], a[148:151], v[208:211], v[228:243]
    v_exp_f32 v176, v176
    v_exp_f32 v177, v177
    v_exp_f32 v178, v178
    v_exp_f32 v179, v179
    v_cvt_pk_bf16_f32 v202, v176, v177
    v_cvt_pk_bf16_f32 v203, v178, v179
    v_max3_f32 v80, v80, v81, v82
    v_max3_f32 v80, v80, v83, v84
    v_cvt_pk_bf16_f32 v81, -v80, 0
    v_lshlrev_b32 v249, 16, v81
    v_cndmask_b32 v158, v158, v81, s[30:31]
    v_mfma_f32_32x32x8_bf16 v[164:179], a[80:81], v[152:153], 0
    v_exp_f32 v180, v180
    v_exp_f32 v181, v181
    v_exp_f32 v182, v182
    v_exp_f32 v183, v183
    v_cvt_pk_bf16_f32 v204, v180, v181
    v_cvt_pk_bf16_f32 v205, v182, v183
    v_mfma_f32_32x32x16_bf16 v[164:179], a[32:35], v[124:127], v[164:179]
    ds_read_b64_tr_b16 v[36:37], v96 offset:8
    ds_read_b64_tr_b16 v[38:39], v96 offset:1032
    v_exp_f32 v184, v184
    v_exp_f32 v185, v185
    v_exp_f32 v186, v186
    v_exp_f32 v187, v187
    v_cvt_pk_bf16_f32 v206, v184, v185
    v_cvt_pk_bf16_f32 v207, v186, v187
    v_mfma_f32_32x32x16_bf16 v[212:227], a[152:155], v[196:199], v[212:227]
    s_add_u32 s48, s55, 11534336
    buffer_store_dwordx4 v[100:103], v22, s[12:15], s48 offen offset:0 sc1
    v_exp_f32 v188, v188
    v_exp_f32 v189, v189
    v_exp_f32 v190, v190
    v_exp_f32 v191, v191
    v_cvt_pk_bf16_f32 v208, v188, v189
    v_cvt_pk_bf16_f32 v209, v190, v191
    v_mfma_f32_32x32x16_bf16 v[212:227], a[156:159], v[200:203], v[212:227]
    v_exp_f32 v192, v192
    v_exp_f32 v193, v193
    v_exp_f32 v194, v194
    v_exp_f32 v195, v195
    v_cvt_pk_bf16_f32 v210, v192, v193
    v_cvt_pk_bf16_f32 v211, v194, v195
    v_mfma_f32_32x32x8_bf16 v[180:195], a[80:81], v[154:155], 0
    v_exp_f32 v164, v164
    v_exp_f32 v165, v165
    v_exp_f32 v166, v166
    v_exp_f32 v167, v167
    v_cvt_pk_bf16_f32 v196, v164, v165
    v_cvt_pk_bf16_f32 v197, v166, v167
    v_mfma_f32_32x32x16_bf16 v[180:195], a[32:35], v[128:131], v[180:195]
    v_mfma_f32_32x32x16_bf16 v[80:95], a[0:3], v[140:143], 0
    ds_read_b64_tr_b16 v[40:41], v97 offset:0
    ds_read_b64_tr_b16 v[42:43], v97 offset:1024
    v_exp_f32 v168, v168
    v_exp_f32 v169, v169
    v_exp_f32 v170, v170
    v_exp_f32 v171, v171
    v_cvt_pk_bf16_f32 v198, v168, v169
    v_cvt_pk_bf16_f32 v199, v170, v171
    v_mfma_f32_32x32x16_bf16 v[228:243], a[152:155], v[204:207], v[228:243]
    v_exp_f32 v172, v172
    v_exp_f32 v173, v173
    v_exp_f32 v174, v174
    v_exp_f32 v175, v175
    v_cvt_pk_bf16_f32 v200, v172, v173
    v_cvt_pk_bf16_f32 v201, v174, v175
    v_mfma_f32_32x32x16_bf16 v[228:243], a[156:159], v[208:211], v[228:243]
    s_waitcnt lgkmcnt(4)
    buffer_store_dwordx4 v[32:35], v104, s[12:15], s66 offen sc1
    v_exp_f32 v176, v176
    v_exp_f32 v177, v177
    v_exp_f32 v178, v178
    v_exp_f32 v179, v179
    v_cvt_pk_bf16_f32 v202, v176, v177
    v_cvt_pk_bf16_f32 v203, v178, v179
    v_max3_f32 v80, v80, v81, v82
    v_max3_f32 v80, v80, v83, v84
    v_cvt_pk_bf16_f32 v81, -v80, 0
    v_lshlrev_b32 v250, 16, v81
    v_cndmask_b32 v160, v160, v81, s[30:31]
    v_mfma_f32_32x32x8_bf16 v[164:179], a[82:83], v[152:153], 0
    v_exp_f32 v180, v180
    v_exp_f32 v181, v181
    v_exp_f32 v182, v182
    v_exp_f32 v183, v183
    v_cvt_pk_bf16_f32 v204, v180, v181
    v_cvt_pk_bf16_f32 v205, v182, v183
    v_mfma_f32_32x32x16_bf16 v[164:179], a[36:39], v[124:127], v[164:179]
    ds_read_b64_tr_b16 v[44:45], v97 offset:8
    ds_read_b64_tr_b16 v[46:47], v97 offset:1032
    v_exp_f32 v184, v184
    v_exp_f32 v185, v185
    v_exp_f32 v186, v186
    v_exp_f32 v187, v187
    v_cvt_pk_bf16_f32 v206, v184, v185
    v_cvt_pk_bf16_f32 v207, v186, v187
    v_mfma_f32_32x32x16_bf16 v[212:227], a[160:163], v[196:199], v[212:227]
    v_exp_f32 v188, v188
    v_exp_f32 v189, v189
    v_exp_f32 v190, v190
    v_exp_f32 v191, v191
    v_cvt_pk_bf16_f32 v208, v188, v189
    v_cvt_pk_bf16_f32 v209, v190, v191
    v_mfma_f32_32x32x16_bf16 v[212:227], a[164:167], v[200:203], v[212:227]
    s_waitcnt lgkmcnt(4)
    buffer_store_dwordx4 v[36:39], v105, s[12:15], s66 offen sc1
    v_exp_f32 v192, v192
    v_exp_f32 v193, v193
    v_exp_f32 v194, v194
    v_exp_f32 v195, v195
    v_cvt_pk_bf16_f32 v210, v192, v193
    v_cvt_pk_bf16_f32 v211, v194, v195
    v_mfma_f32_32x32x8_bf16 v[180:195], a[82:83], v[154:155], 0
    v_exp_f32 v164, v164
    v_exp_f32 v165, v165
    v_exp_f32 v166, v166
    v_exp_f32 v167, v167
    v_cvt_pk_bf16_f32 v196, v164, v165
    v_cvt_pk_bf16_f32 v197, v166, v167
    v_mfma_f32_32x32x16_bf16 v[180:195], a[36:39], v[128:131], v[180:195]
    v_mfma_f32_32x32x16_bf16 v[80:95], a[0:3], v[144:147], 0
    ds_read_b64_tr_b16 v[48:49], v98 offset:0
    ds_read_b64_tr_b16 v[50:51], v98 offset:1024
    v_exp_f32 v168, v168
    v_exp_f32 v169, v169
    v_exp_f32 v170, v170
    v_exp_f32 v171, v171
    v_cvt_pk_bf16_f32 v198, v168, v169
    v_cvt_pk_bf16_f32 v199, v170, v171
    v_mfma_f32_32x32x16_bf16 v[228:243], a[160:163], v[204:207], v[228:243]
    buffer_store_dwordx4 v[100:103], v22, s[12:15], s48 offen offset:1024 sc1
    v_exp_f32 v172, v172
    v_exp_f32 v173, v173
    v_exp_f32 v174, v174
    v_exp_f32 v175, v175
    v_cvt_pk_bf16_f32 v200, v172, v173
    v_cvt_pk_bf16_f32 v201, v174, v175
    v_mfma_f32_32x32x16_bf16 v[228:243], a[164:167], v[208:211], v[228:243]
    s_waitcnt lgkmcnt(4)
    buffer_store_dwordx4 v[40:43], v106, s[12:15], s66 offen sc1
    v_exp_f32 v176, v176
    v_exp_f32 v177, v177
    v_exp_f32 v178, v178
    v_exp_f32 v179, v179
    v_cvt_pk_bf16_f32 v202, v176, v177
    v_cvt_pk_bf16_f32 v203, v178, v179
    v_max3_f32 v80, v80, v81, v82
    v_max3_f32 v80, v80, v83, v84
    v_cvt_pk_bf16_f32 v81, -v80, 0
    v_lshlrev_b32 v251, 16, v81
    v_cndmask_b32 v162, v162, v81, s[30:31]
    v_mfma_f32_32x32x8_bf16 v[164:179], a[84:85], v[152:153], 0
    v_exp_f32 v180, v180
    v_exp_f32 v181, v181
    v_exp_f32 v182, v182
    v_exp_f32 v183, v183
    v_cvt_pk_bf16_f32 v204, v180, v181
    v_cvt_pk_bf16_f32 v205, v182, v183
    v_mfma_f32_32x32x16_bf16 v[164:179], a[40:43], v[124:127], v[164:179]
    ds_read_b64_tr_b16 v[52:53], v98 offset:8
    ds_read_b64_tr_b16 v[54:55], v98 offset:1032
    v_exp_f32 v184, v184
    v_exp_f32 v185, v185
    v_exp_f32 v186, v186
    v_exp_f32 v187, v187
    v_cvt_pk_bf16_f32 v206, v184, v185
    v_cvt_pk_bf16_f32 v207, v186, v187
    v_mfma_f32_32x32x16_bf16 v[212:227], a[168:171], v[196:199], v[212:227]
    v_exp_f32 v188, v188
    v_exp_f32 v189, v189
    v_exp_f32 v190, v190
    v_exp_f32 v191, v191
    v_cvt_pk_bf16_f32 v208, v188, v189
    v_cvt_pk_bf16_f32 v209, v190, v191
    v_mfma_f32_32x32x16_bf16 v[212:227], a[172:175], v[200:203], v[212:227]
    s_waitcnt lgkmcnt(4)
    buffer_store_dwordx4 v[44:47], v107, s[12:15], s66 offen sc1
    v_exp_f32 v192, v192
    v_exp_f32 v193, v193
    v_exp_f32 v194, v194
    v_exp_f32 v195, v195
    v_cvt_pk_bf16_f32 v210, v192, v193
    v_cvt_pk_bf16_f32 v211, v194, v195
    v_mfma_f32_32x32x8_bf16 v[180:195], a[84:85], v[154:155], 0
    v_exp_f32 v164, v164
    v_exp_f32 v165, v165
    v_exp_f32 v166, v166
    v_exp_f32 v167, v167
    v_cvt_pk_bf16_f32 v196, v164, v165
    v_cvt_pk_bf16_f32 v197, v166, v167
    v_mfma_f32_32x32x16_bf16 v[180:195], a[40:43], v[128:131], v[180:195]
    ds_read_b64_tr_b16 v[56:57], v99 offset:0
    ds_read_b64_tr_b16 v[58:59], v99 offset:1024
    v_exp_f32 v168, v168
    v_exp_f32 v169, v169
    v_exp_f32 v170, v170
    v_exp_f32 v171, v171
    v_cvt_pk_bf16_f32 v198, v168, v169
    v_cvt_pk_bf16_f32 v199, v170, v171
    v_mfma_f32_32x32x16_bf16 v[228:243], a[168:171], v[204:207], v[228:243]
    v_exp_f32 v172, v172
    v_exp_f32 v173, v173
    v_exp_f32 v174, v174
    v_exp_f32 v175, v175
    v_cvt_pk_bf16_f32 v200, v172, v173
    v_cvt_pk_bf16_f32 v201, v174, v175
    v_mfma_f32_32x32x16_bf16 v[228:243], a[172:175], v[208:211], v[228:243]
    s_waitcnt lgkmcnt(4)
    buffer_store_dwordx4 v[48:51], v108, s[12:15], s66 offen sc1
    v_exp_f32 v176, v176
    v_exp_f32 v177, v177
    v_exp_f32 v178, v178
    v_exp_f32 v179, v179
    v_cvt_pk_bf16_f32 v202, v176, v177
    v_cvt_pk_bf16_f32 v203, v178, v179
    v_mfma_f32_32x32x8_bf16 v[164:179], a[86:87], v[152:153], 0
    v_exp_f32 v180, v180
    v_exp_f32 v181, v181
    v_exp_f32 v182, v182
    v_exp_f32 v183, v183
    v_cvt_pk_bf16_f32 v204, v180, v181
    v_cvt_pk_bf16_f32 v205, v182, v183
    v_mfma_f32_32x32x16_bf16 v[164:179], a[44:47], v[124:127], v[164:179]
    ds_read_b64_tr_b16 v[60:61], v99 offset:8
    ds_read_b64_tr_b16 v[62:63], v99 offset:1032
    v_exp_f32 v184, v184
    v_exp_f32 v185, v185
    v_exp_f32 v186, v186
    v_exp_f32 v187, v187
    v_cvt_pk_bf16_f32 v206, v184, v185
    v_cvt_pk_bf16_f32 v207, v186, v187
    v_mfma_f32_32x32x16_bf16 v[212:227], a[176:179], v[196:199], v[212:227]
    buffer_store_dwordx4 v[100:103], v28, s[12:15], s48 offen offset:2048 sc1
    v_exp_f32 v188, v188
    v_exp_f32 v189, v189
    v_exp_f32 v190, v190
    v_exp_f32 v191, v191
    v_cvt_pk_bf16_f32 v208, v188, v189
    v_cvt_pk_bf16_f32 v209, v190, v191
    v_mfma_f32_32x32x16_bf16 v[212:227], a[180:183], v[200:203], v[212:227]
    s_waitcnt lgkmcnt(4)
    buffer_store_dwordx4 v[52:55], v109, s[12:15], s66 offen sc1
    v_exp_f32 v192, v192
    v_exp_f32 v193, v193
    v_exp_f32 v194, v194
    v_exp_f32 v195, v195
    v_cvt_pk_bf16_f32 v210, v192, v193
    v_cvt_pk_bf16_f32 v211, v194, v195
    v_mfma_f32_32x32x8_bf16 v[180:195], a[86:87], v[154:155], 0
    v_exp_f32 v164, v164
    v_exp_f32 v165, v165
    v_exp_f32 v166, v166
    v_exp_f32 v167, v167
    v_cvt_pk_bf16_f32 v196, v164, v165
    v_cvt_pk_bf16_f32 v197, v166, v167
    v_mfma_f32_32x32x16_bf16 v[180:195], a[44:47], v[128:131], v[180:195]
    v_exp_f32 v168, v168
    v_exp_f32 v169, v169
    v_exp_f32 v170, v170
    v_exp_f32 v171, v171
    v_cvt_pk_bf16_f32 v198, v168, v169
    v_cvt_pk_bf16_f32 v199, v170, v171
    v_mfma_f32_32x32x16_bf16 v[228:243], a[176:179], v[204:207], v[228:243]
    v_exp_f32 v172, v172
    v_exp_f32 v173, v173
    v_exp_f32 v174, v174
    v_exp_f32 v175, v175
    v_cvt_pk_bf16_f32 v200, v172, v173
    v_cvt_pk_bf16_f32 v201, v174, v175
    v_mfma_f32_32x32x16_bf16 v[228:243], a[180:183], v[208:211], v[228:243]
    s_waitcnt lgkmcnt(2)
    buffer_store_dwordx4 v[56:59], v110, s[12:15], s66 offen sc1
    v_exp_f32 v176, v176
    v_exp_f32 v177, v177
    v_exp_f32 v178, v178
    v_exp_f32 v179, v179
    v_cvt_pk_bf16_f32 v202, v176, v177
    v_cvt_pk_bf16_f32 v203, v178, v179
    v_mfma_f32_32x32x8_bf16 v[164:179], a[88:89], v[152:153], 0
    v_exp_f32 v180, v180
    v_exp_f32 v181, v181
    v_exp_f32 v182, v182
    v_exp_f32 v183, v183
    v_cvt_pk_bf16_f32 v204, v180, v181
    v_cvt_pk_bf16_f32 v205, v182, v183
    v_mfma_f32_32x32x16_bf16 v[164:179], a[48:51], v[124:127], v[164:179]
    v_exp_f32 v184, v184
    v_exp_f32 v185, v185
    v_exp_f32 v186, v186
    v_exp_f32 v187, v187
    v_cvt_pk_bf16_f32 v206, v184, v185
    v_cvt_pk_bf16_f32 v207, v186, v187
    v_mfma_f32_32x32x16_bf16 v[212:227], a[184:187], v[196:199], v[212:227]
    v_exp_f32 v188, v188
    v_exp_f32 v189, v189
    v_exp_f32 v190, v190
    v_exp_f32 v191, v191
    v_cvt_pk_bf16_f32 v208, v188, v189
    v_cvt_pk_bf16_f32 v209, v190, v191
    v_mfma_f32_32x32x16_bf16 v[212:227], a[188:191], v[200:203], v[212:227]
    s_waitcnt lgkmcnt(0)
    buffer_store_dwordx4 v[60:63], v111, s[12:15], s66 offen sc1
    v_exp_f32 v192, v192
    v_exp_f32 v193, v193
    v_exp_f32 v194, v194
    v_exp_f32 v195, v195
    v_cvt_pk_bf16_f32 v210, v192, v193
    v_cvt_pk_bf16_f32 v211, v194, v195
    v_mfma_f32_32x32x8_bf16 v[180:195], a[88:89], v[154:155], 0
    v_exp_f32 v164, v164
    v_exp_f32 v165, v165
    v_exp_f32 v166, v166
    v_exp_f32 v167, v167
    v_cvt_pk_bf16_f32 v196, v164, v165
    v_cvt_pk_bf16_f32 v197, v166, v167
    v_mfma_f32_32x32x16_bf16 v[180:195], a[48:51], v[128:131], v[180:195]
    v_exp_f32 v168, v168
    v_exp_f32 v169, v169
    v_exp_f32 v170, v170
    v_exp_f32 v171, v171
    v_cvt_pk_bf16_f32 v198, v168, v169
    v_cvt_pk_bf16_f32 v199, v170, v171
    v_mfma_f32_32x32x16_bf16 v[228:243], a[184:187], v[204:207], v[228:243]
    s_add_u32 s48, s55, 14155776
    buffer_store_dwordx4 v[100:103], v22, s[12:15], s48 offen offset:0 sc1
    v_exp_f32 v172, v172
    v_exp_f32 v173, v173
    v_exp_f32 v174, v174
    v_exp_f32 v175, v175
    v_cvt_pk_bf16_f32 v200, v172, v173
    v_cvt_pk_bf16_f32 v201, v174, v175
    v_mfma_f32_32x32x16_bf16 v[228:243], a[188:191], v[208:211], v[228:243]
    v_exp_f32 v176, v176
    v_exp_f32 v177, v177
    v_exp_f32 v178, v178
    v_exp_f32 v179, v179
    v_cvt_pk_bf16_f32 v202, v176, v177
    v_cvt_pk_bf16_f32 v203, v178, v179
    v_mfma_f32_32x32x8_bf16 v[164:179], a[90:91], v[152:153], 0
    v_exp_f32 v180, v180
    v_exp_f32 v181, v181
    v_exp_f32 v182, v182
    v_exp_f32 v183, v183
    v_cvt_pk_bf16_f32 v204, v180, v181
    v_cvt_pk_bf16_f32 v205, v182, v183
    v_mfma_f32_32x32x16_bf16 v[164:179], a[52:55], v[124:127], v[164:179]
    v_exp_f32 v184, v184
    v_exp_f32 v185, v185
    v_exp_f32 v186, v186
    v_exp_f32 v187, v187
    v_cvt_pk_bf16_f32 v206, v184, v185
    v_cvt_pk_bf16_f32 v207, v186, v187
    v_mfma_f32_32x32x16_bf16 v[212:227], a[192:195], v[196:199], v[212:227]
    v_exp_f32 v188, v188
    v_exp_f32 v189, v189
    v_exp_f32 v190, v190
    v_exp_f32 v191, v191
    v_cvt_pk_bf16_f32 v208, v188, v189
    v_cvt_pk_bf16_f32 v209, v190, v191
    v_mfma_f32_32x32x16_bf16 v[212:227], a[196:199], v[200:203], v[212:227]
    v_exp_f32 v192, v192
    v_exp_f32 v193, v193
    v_exp_f32 v194, v194
    v_exp_f32 v195, v195
    v_cvt_pk_bf16_f32 v210, v192, v193
    v_cvt_pk_bf16_f32 v211, v194, v195
    v_mfma_f32_32x32x8_bf16 v[180:195], a[90:91], v[154:155], 0
    v_exp_f32 v164, v164
    v_exp_f32 v165, v165
    v_exp_f32 v166, v166
    v_exp_f32 v167, v167
    v_cvt_pk_bf16_f32 v196, v164, v165
    v_cvt_pk_bf16_f32 v197, v166, v167
    v_mfma_f32_32x32x16_bf16 v[180:195], a[52:55], v[128:131], v[180:195]
    v_exp_f32 v168, v168
    v_exp_f32 v169, v169
    v_exp_f32 v170, v170
    v_exp_f32 v171, v171
    v_cvt_pk_bf16_f32 v198, v168, v169
    v_cvt_pk_bf16_f32 v199, v170, v171
    v_mfma_f32_32x32x16_bf16 v[228:243], a[192:195], v[204:207], v[228:243]
    v_exp_f32 v172, v172
    v_exp_f32 v173, v173
    v_exp_f32 v174, v174
    v_exp_f32 v175, v175
    v_cvt_pk_bf16_f32 v200, v172, v173
    v_cvt_pk_bf16_f32 v201, v174, v175
    v_mfma_f32_32x32x16_bf16 v[228:243], a[196:199], v[208:211], v[228:243]
    v_exp_f32 v176, v176
    v_exp_f32 v177, v177
    v_exp_f32 v178, v178
    v_exp_f32 v179, v179
    v_cvt_pk_bf16_f32 v202, v176, v177
    v_cvt_pk_bf16_f32 v203, v178, v179
    v_mfma_f32_32x32x8_bf16 v[164:179], a[92:93], v[152:153], 0
    v_exp_f32 v180, v180
    v_exp_f32 v181, v181
    v_exp_f32 v182, v182
    v_exp_f32 v183, v183
    v_cvt_pk_bf16_f32 v204, v180, v181
    v_cvt_pk_bf16_f32 v205, v182, v183
    v_mfma_f32_32x32x16_bf16 v[164:179], a[56:59], v[124:127], v[164:179]
    v_exp_f32 v184, v184
    v_exp_f32 v185, v185
    v_exp_f32 v186, v186
    v_exp_f32 v187, v187
    v_cvt_pk_bf16_f32 v206, v184, v185
    v_cvt_pk_bf16_f32 v207, v186, v187
    v_mfma_f32_32x32x16_bf16 v[212:227], a[200:203], v[196:199], v[212:227]
    buffer_store_dwordx4 v[100:103], v22, s[12:15], s48 offen offset:1024 sc1
    v_exp_f32 v188, v188
    v_exp_f32 v189, v189
    v_exp_f32 v190, v190
    v_exp_f32 v191, v191
    v_cvt_pk_bf16_f32 v208, v188, v189
    v_cvt_pk_bf16_f32 v209, v190, v191
    v_mfma_f32_32x32x16_bf16 v[212:227], a[204:207], v[200:203], v[212:227]
    v_exp_f32 v192, v192
    v_exp_f32 v193, v193
    v_exp_f32 v194, v194
    v_exp_f32 v195, v195
    v_cvt_pk_bf16_f32 v210, v192, v193
    v_cvt_pk_bf16_f32 v211, v194, v195
    v_mfma_f32_32x32x8_bf16 v[180:195], a[92:93], v[154:155], 0
    v_exp_f32 v164, v164
    v_exp_f32 v165, v165
    v_exp_f32 v166, v166
    v_exp_f32 v167, v167
    v_cvt_pk_bf16_f32 v196, v164, v165
    v_cvt_pk_bf16_f32 v197, v166, v167
    v_mfma_f32_32x32x16_bf16 v[180:195], a[56:59], v[128:131], v[180:195]
    v_exp_f32 v168, v168
    v_exp_f32 v169, v169
    v_exp_f32 v170, v170
    v_exp_f32 v171, v171
    v_cvt_pk_bf16_f32 v198, v168, v169
    v_cvt_pk_bf16_f32 v199, v170, v171
    v_mfma_f32_32x32x16_bf16 v[228:243], a[200:203], v[204:207], v[228:243]
    v_exp_f32 v172, v172
    v_exp_f32 v173, v173
    v_exp_f32 v174, v174
    v_exp_f32 v175, v175
    v_cvt_pk_bf16_f32 v200, v172, v173
    v_cvt_pk_bf16_f32 v201, v174, v175
    v_mfma_f32_32x32x16_bf16 v[228:243], a[204:207], v[208:211], v[228:243]
    v_exp_f32 v176, v176
    v_exp_f32 v177, v177
    v_exp_f32 v178, v178
    v_exp_f32 v179, v179
    v_cvt_pk_bf16_f32 v202, v176, v177
    v_cvt_pk_bf16_f32 v203, v178, v179
    v_mfma_f32_32x32x8_bf16 v[164:179], a[94:95], v[152:153], 0
    v_exp_f32 v180, v180
    v_exp_f32 v181, v181
    v_exp_f32 v182, v182
    v_exp_f32 v183, v183
    v_cvt_pk_bf16_f32 v204, v180, v181
    v_cvt_pk_bf16_f32 v205, v182, v183
    v_mfma_f32_32x32x16_bf16 v[164:179], a[60:63], v[124:127], v[164:179]
    v_exp_f32 v184, v184
    v_exp_f32 v185, v185
    v_exp_f32 v186, v186
    v_exp_f32 v187, v187
    v_cvt_pk_bf16_f32 v206, v184, v185
    v_cvt_pk_bf16_f32 v207, v186, v187
    v_mfma_f32_32x32x16_bf16 v[212:227], a[208:211], v[196:199], v[212:227]
    v_exp_f32 v188, v188
    v_exp_f32 v189, v189
    v_exp_f32 v190, v190
    v_exp_f32 v191, v191
    v_cvt_pk_bf16_f32 v208, v188, v189
    v_cvt_pk_bf16_f32 v209, v190, v191
    v_mfma_f32_32x32x16_bf16 v[212:227], a[212:215], v[200:203], v[212:227]
    v_exp_f32 v192, v192
    v_exp_f32 v193, v193
    v_exp_f32 v194, v194
    v_exp_f32 v195, v195
    v_cvt_pk_bf16_f32 v210, v192, v193
    v_cvt_pk_bf16_f32 v211, v194, v195
    v_mfma_f32_32x32x8_bf16 v[180:195], a[94:95], v[154:155], 0
    v_exp_f32 v164, v164
    v_exp_f32 v165, v165
    v_exp_f32 v166, v166
    v_exp_f32 v167, v167
    v_cvt_pk_bf16_f32 v196, v164, v165
    v_cvt_pk_bf16_f32 v197, v166, v167
    v_mfma_f32_32x32x16_bf16 v[180:195], a[60:63], v[128:131], v[180:195]
    v_exp_f32 v168, v168
    v_exp_f32 v169, v169
    v_exp_f32 v170, v170
    v_exp_f32 v171, v171
    v_cvt_pk_bf16_f32 v198, v168, v169
    v_cvt_pk_bf16_f32 v199, v170, v171
    v_mfma_f32_32x32x16_bf16 v[228:243], a[208:211], v[204:207], v[228:243]
    s_add_u32 s48, s55, 16777216
    buffer_store_dwordx4 v[100:103], v22, s[12:15], s48 offen offset:0 sc1
    v_exp_f32 v172, v172
    v_exp_f32 v173, v173
    v_exp_f32 v174, v174
    v_exp_f32 v175, v175
    v_cvt_pk_bf16_f32 v200, v172, v173
    v_cvt_pk_bf16_f32 v201, v174, v175
    v_mfma_f32_32x32x16_bf16 v[228:243], a[212:215], v[208:211], v[228:243]
    v_exp_f32 v176, v176
    v_exp_f32 v177, v177
    v_exp_f32 v178, v178
    v_exp_f32 v179, v179
    v_cvt_pk_bf16_f32 v202, v176, v177
    v_cvt_pk_bf16_f32 v203, v178, v179
    v_mfma_f32_32x32x8_bf16 v[164:179], a[64:65], v[156:157], 0
    v_exp_f32 v180, v180
    v_exp_f32 v181, v181
    v_exp_f32 v182, v182
    v_exp_f32 v183, v183
    v_cvt_pk_bf16_f32 v204, v180, v181
    v_cvt_pk_bf16_f32 v205, v182, v183
    v_mfma_f32_32x32x16_bf16 v[164:179], a[0:3], v[132:135], v[164:179]
    v_exp_f32 v184, v184
    v_exp_f32 v185, v185
    v_exp_f32 v186, v186
    v_exp_f32 v187, v187
    v_cvt_pk_bf16_f32 v206, v184, v185
    v_cvt_pk_bf16_f32 v207, v186, v187
    v_mfma_f32_32x32x16_bf16 v[212:227], a[216:219], v[196:199], v[212:227]
    v_exp_f32 v188, v188
    v_exp_f32 v189, v189
    v_exp_f32 v190, v190
    v_exp_f32 v191, v191
    v_cvt_pk_bf16_f32 v208, v188, v189
    v_cvt_pk_bf16_f32 v209, v190, v191
    v_mfma_f32_32x32x16_bf16 v[212:227], a[220:223], v[200:203], v[212:227]
    v_exp_f32 v192, v192
    v_exp_f32 v193, v193
    v_exp_f32 v194, v194
    v_exp_f32 v195, v195
    v_cvt_pk_bf16_f32 v210, v192, v193
    v_cvt_pk_bf16_f32 v211, v194, v195
    v_mfma_f32_32x32x8_bf16 v[180:195], a[64:65], v[158:159], 0
    v_exp_f32 v164, v164
    v_exp_f32 v165, v165
    v_exp_f32 v166, v166
    v_exp_f32 v167, v167
    v_cvt_pk_bf16_f32 v196, v164, v165
    v_cvt_pk_bf16_f32 v197, v166, v167
    v_mfma_f32_32x32x16_bf16 v[180:195], a[0:3], v[136:139], v[180:195]
    v_exp_f32 v168, v168
    v_exp_f32 v169, v169
    v_exp_f32 v170, v170
    v_exp_f32 v171, v171
    v_cvt_pk_bf16_f32 v198, v168, v169
    v_cvt_pk_bf16_f32 v199, v170, v171
    v_mfma_f32_32x32x16_bf16 v[228:243], a[216:219], v[204:207], v[228:243]
    v_mov_b32 v223, v246
    v_subrev_u32 v224, 0x2b800000, v222
    v_max_u32 v252, v252, v224
    ds_write_b128 v14, v[212:215] offset:24576
    ds_write_b128 v14, v[216:219] offset:25600
    ds_write_b128 v14, v[220:223] offset:26624
    v_exp_f32 v172, v172
    v_exp_f32 v173, v173
    v_exp_f32 v174, v174
    v_exp_f32 v175, v175
    v_cvt_pk_bf16_f32 v200, v172, v173
    v_cvt_pk_bf16_f32 v201, v174, v175
    v_mfma_f32_32x32x16_bf16 v[228:243], a[220:223], v[208:211], v[228:243]
    v_exp_f32 v176, v176
    v_exp_f32 v177, v177
    v_exp_f32 v178, v178
    v_exp_f32 v179, v179
    v_cvt_pk_bf16_f32 v202, v176, v177
    v_cvt_pk_bf16_f32 v203, v178, v179
    v_mfma_f32_32x32x8_bf16 v[164:179], a[66:67], v[156:157], 0
    v_exp_f32 v180, v180
    v_exp_f32 v181, v181
    v_exp_f32 v182, v182
    v_exp_f32 v183, v183
    v_cvt_pk_bf16_f32 v204, v180, v181
    v_cvt_pk_bf16_f32 v205, v182, v183
    v_mfma_f32_32x32x16_bf16 v[164:179], a[4:7], v[132:135], v[164:179]
    v_exp_f32 v184, v184
    v_exp_f32 v185, v185
    v_exp_f32 v186, v186
    v_exp_f32 v187, v187
    v_cvt_pk_bf16_f32 v206, v184, v185
    v_cvt_pk_bf16_f32 v207, v186, v187
    v_mfma_f32_32x32x16_bf16 v[212:227], a[96:99], v[196:199], 0
    buffer_store_dwordx4 v[100:103], v22, s[12:15], s48 offen offset:1024 sc1
    v_mov_b32 v239, v247
    v_subrev_u32 v240, 0x2b800000, v238
    v_max_u32 v252, v252, v240
    ds_write_b128 v14, v[228:231] offset:36864
    ds_write_b128 v14, v[232:235] offset:37888
    ds_write_b128 v14, v[236:239] offset:38912
    v_exp_f32 v188, v188
    v_exp_f32 v189, v189
    v_exp_f32 v190, v190
    v_exp_f32 v191, v191
    v_cvt_pk_bf16_f32 v208, v188, v189
    v_cvt_pk_bf16_f32 v209, v190, v191
    v_mfma_f32_32x32x16_bf16 v[212:227], a[100:103], v[200:203], v[212:227]
    v_exp_f32 v192, v192
    v_exp_f32 v193, v193
    v_exp_f32 v194, v194
    v_exp_f32 v195, v195
    v_cvt_pk_bf16_f32 v210, v192, v193
    v_cvt_pk_bf16_f32 v211, v194, v195
    v_mfma_f32_32x32x8_bf16 v[180:195], a[66:67], v[158:159], 0
    v_exp_f32 v164, v164
    v_exp_f32 v165, v165
    v_exp_f32 v166, v166
    v_exp_f32 v167, v167
    v_cvt_pk_bf16_f32 v196, v164, v165
    v_cvt_pk_bf16_f32 v197, v166, v167
    v_mfma_f32_32x32x16_bf16 v[180:195], a[4:7], v[136:139], v[180:195]
    v_exp_f32 v168, v168
    v_exp_f32 v169, v169
    v_exp_f32 v170, v170
    v_exp_f32 v171, v171
    v_cvt_pk_bf16_f32 v198, v168, v169
    v_cvt_pk_bf16_f32 v199, v170, v171
    v_mfma_f32_32x32x16_bf16 v[228:243], a[96:99], v[204:207], 0
    v_exp_f32 v172, v172
    v_exp_f32 v173, v173
    v_exp_f32 v174, v174
    v_exp_f32 v175, v175
    v_cvt_pk_bf16_f32 v200, v172, v173
    v_cvt_pk_bf16_f32 v201, v174, v175
    v_mfma_f32_32x32x16_bf16 v[228:243], a[100:103], v[208:211], v[228:243]
    v_exp_f32 v176, v176
    v_exp_f32 v177, v177
    v_exp_f32 v178, v178
    v_exp_f32 v179, v179
    v_cvt_pk_bf16_f32 v202, v176, v177
    v_cvt_pk_bf16_f32 v203, v178, v179
    v_mfma_f32_32x32x8_bf16 v[164:179], a[68:69], v[156:157], 0
    v_exp_f32 v180, v180
    v_exp_f32 v181, v181
    v_exp_f32 v182, v182
    v_exp_f32 v183, v183
    v_cvt_pk_bf16_f32 v204, v180, v181
    v_cvt_pk_bf16_f32 v205, v182, v183
    v_mfma_f32_32x32x16_bf16 v[164:179], a[8:11], v[132:135], v[164:179]
    v_exp_f32 v184, v184
    v_exp_f32 v185, v185
    v_exp_f32 v186, v186
    v_exp_f32 v187, v187
    v_cvt_pk_bf16_f32 v206, v184, v185
    v_cvt_pk_bf16_f32 v207, v186, v187
    v_mfma_f32_32x32x16_bf16 v[212:227], a[104:107], v[196:199], v[212:227]
    v_exp_f32 v188, v188
    v_exp_f32 v189, v189
    v_exp_f32 v190, v190
    v_exp_f32 v191, v191
    v_cvt_pk_bf16_f32 v208, v188, v189
    v_cvt_pk_bf16_f32 v209, v190, v191
    v_mfma_f32_32x32x16_bf16 v[212:227], a[108:111], v[200:203], v[212:227]
    v_exp_f32 v192, v192
    v_exp_f32 v193, v193
    v_exp_f32 v194, v194
    v_exp_f32 v195, v195
    v_cvt_pk_bf16_f32 v210, v192, v193
    v_cvt_pk_bf16_f32 v211, v194, v195
    v_mfma_f32_32x32x8_bf16 v[180:195], a[68:69], v[158:159], 0
    v_exp_f32 v164, v164
    v_exp_f32 v165, v165
    v_exp_f32 v166, v166
    v_exp_f32 v167, v167
    v_cvt_pk_bf16_f32 v196, v164, v165
    v_cvt_pk_bf16_f32 v197, v166, v167
    v_mfma_f32_32x32x16_bf16 v[180:195], a[8:11], v[136:139], v[180:195]
    s_waitcnt vmcnt(4)
    s_mov_b64 exec, 1
    buffer_store_dword v26, v25, s[12:15], 0 offen sc1
    s_mov_b64 exec, -1
    v_exp_f32 v168, v168
    v_exp_f32 v169, v169
    v_exp_f32 v170, v170
    v_exp_f32 v171, v171
    v_cvt_pk_bf16_f32 v198, v168, v169
    v_cvt_pk_bf16_f32 v199, v170, v171
    v_mfma_f32_32x32x16_bf16 v[228:243], a[104:107], v[204:207], v[228:243]
    buffer_store_dwordx4 v[100:103], v19, s[12:15], s48 offen offset:2048 sc1
    v_exp_f32 v172, v172
    v_exp_f32 v173, v173
    v_exp_f32 v174, v174
    v_exp_f32 v175, v175
    v_cvt_pk_bf16_f32 v200, v172, v173
    v_cvt_pk_bf16_f32 v201, v174, v175
    v_mfma_f32_32x32x16_bf16 v[228:243], a[108:111], v[208:211], v[228:243]
    v_exp_f32 v176, v176
    v_exp_f32 v177, v177
    v_exp_f32 v178, v178
    v_exp_f32 v179, v179
    v_cvt_pk_bf16_f32 v202, v176, v177
    v_cvt_pk_bf16_f32 v203, v178, v179
    v_mfma_f32_32x32x8_bf16 v[164:179], a[70:71], v[156:157], 0
    v_exp_f32 v180, v180
    v_exp_f32 v181, v181
    v_exp_f32 v182, v182
    v_exp_f32 v183, v183
    v_cvt_pk_bf16_f32 v204, v180, v181
    v_cvt_pk_bf16_f32 v205, v182, v183
    v_mfma_f32_32x32x16_bf16 v[164:179], a[12:15], v[132:135], v[164:179]
    v_exp_f32 v184, v184
    v_exp_f32 v185, v185
    v_exp_f32 v186, v186
    v_exp_f32 v187, v187
    v_cvt_pk_bf16_f32 v206, v184, v185
    v_cvt_pk_bf16_f32 v207, v186, v187
    v_mfma_f32_32x32x16_bf16 v[212:227], a[112:115], v[196:199], v[212:227]
    v_exp_f32 v188, v188
    v_exp_f32 v189, v189
    v_exp_f32 v190, v190
    v_exp_f32 v191, v191
    v_cvt_pk_bf16_f32 v208, v188, v189
    v_cvt_pk_bf16_f32 v209, v190, v191
    v_mfma_f32_32x32x16_bf16 v[212:227], a[116:119], v[200:203], v[212:227]
    v_exp_f32 v192, v192
    v_exp_f32 v193, v193
    v_exp_f32 v194, v194
    v_exp_f32 v195, v195
    v_cvt_pk_bf16_f32 v210, v192, v193
    v_cvt_pk_bf16_f32 v211, v194, v195
    v_mfma_f32_32x32x8_bf16 v[180:195], a[70:71], v[158:159], 0
    v_exp_f32 v164, v164
    v_exp_f32 v165, v165
    v_exp_f32 v166, v166
    v_exp_f32 v167, v167
    v_cvt_pk_bf16_f32 v196, v164, v165
    v_cvt_pk_bf16_f32 v197, v166, v167
    v_mfma_f32_32x32x16_bf16 v[180:195], a[12:15], v[136:139], v[180:195]
    v_exp_f32 v168, v168
    v_exp_f32 v169, v169
    v_exp_f32 v170, v170
    v_exp_f32 v171, v171
    v_cvt_pk_bf16_f32 v198, v168, v169
    v_cvt_pk_bf16_f32 v199, v170, v171
    v_mfma_f32_32x32x16_bf16 v[228:243], a[112:115], v[204:207], v[228:243]
    v_exp_f32 v172, v172
    v_exp_f32 v173, v173
    v_exp_f32 v174, v174
    v_exp_f32 v175, v175
    v_cvt_pk_bf16_f32 v200, v172, v173
    v_cvt_pk_bf16_f32 v201, v174, v175
    v_mfma_f32_32x32x16_bf16 v[228:243], a[116:119], v[208:211], v[228:243]
    v_exp_f32 v176, v176
    v_exp_f32 v177, v177
    v_exp_f32 v178, v178
    v_exp_f32 v179, v179
    v_cvt_pk_bf16_f32 v202, v176, v177
    v_cvt_pk_bf16_f32 v203, v178, v179
    v_mfma_f32_32x32x8_bf16 v[164:179], a[72:73], v[156:157], 0
    v_exp_f32 v180, v180
    v_exp_f32 v181, v181
    v_exp_f32 v182, v182
    v_exp_f32 v183, v183
    v_cvt_pk_bf16_f32 v204, v180, v181
    v_cvt_pk_bf16_f32 v205, v182, v183
    v_mfma_f32_32x32x16_bf16 v[164:179], a[16:19], v[132:135], v[164:179]
    v_exp_f32 v184, v184
    v_exp_f32 v185, v185
    v_exp_f32 v186, v186
    v_exp_f32 v187, v187
    v_cvt_pk_bf16_f32 v206, v184, v185
    v_cvt_pk_bf16_f32 v207, v186, v187
    v_mfma_f32_32x32x16_bf16 v[212:227], a[120:123], v[196:199], v[212:227]
    s_add_u32 s48, s57, 393216
    buffer_store_dword v100, v20, s[12:15], s48 offen sc1
    v_exp_f32 v188, v188
    v_exp_f32 v189, v189
    v_exp_f32 v190, v190
    v_exp_f32 v191, v191
    v_cvt_pk_bf16_f32 v208, v188, v189
    v_cvt_pk_bf16_f32 v209, v190, v191
    v_mfma_f32_32x32x16_bf16 v[212:227], a[124:127], v[200:203], v[212:227]
    v_exp_f32 v192, v192
    v_exp_f32 v193, v193
    v_exp_f32 v194, v194
    v_exp_f32 v195, v195
    v_cvt_pk_bf16_f32 v210, v192, v193
    v_cvt_pk_bf16_f32 v211, v194, v195
    v_mfma_f32_32x32x8_bf16 v[180:195], a[72:73], v[158:159], 0
    v_exp_f32 v164, v164
    v_exp_f32 v165, v165
    v_exp_f32 v166, v166
    v_exp_f32 v167, v167
    v_cvt_pk_bf16_f32 v196, v164, v165
    v_cvt_pk_bf16_f32 v197, v166, v167
    v_mfma_f32_32x32x16_bf16 v[180:195], a[16:19], v[136:139], v[180:195]
    v_exp_f32 v168, v168
    v_exp_f32 v169, v169
    v_exp_f32 v170, v170
    v_exp_f32 v171, v171
    v_cvt_pk_bf16_f32 v198, v168, v169
    v_cvt_pk_bf16_f32 v199, v170, v171
    v_mfma_f32_32x32x16_bf16 v[228:243], a[120:123], v[204:207], v[228:243]
    v_exp_f32 v172, v172
    v_exp_f32 v173, v173
    v_exp_f32 v174, v174
    v_exp_f32 v175, v175
    v_cvt_pk_bf16_f32 v200, v172, v173
    v_cvt_pk_bf16_f32 v201, v174, v175
    v_mfma_f32_32x32x16_bf16 v[228:243], a[124:127], v[208:211], v[228:243]
    v_exp_f32 v176, v176
    v_exp_f32 v177, v177
    v_exp_f32 v178, v178
    v_exp_f32 v179, v179
    v_cvt_pk_bf16_f32 v202, v176, v177
    v_cvt_pk_bf16_f32 v203, v178, v179
    v_mfma_f32_32x32x8_bf16 v[164:179], a[74:75], v[156:157], 0
    v_exp_f32 v180, v180
    v_exp_f32 v181, v181
    v_exp_f32 v182, v182
    v_exp_f32 v183, v183
    v_cvt_pk_bf16_f32 v204, v180, v181
    v_cvt_pk_bf16_f32 v205, v182, v183
    v_mfma_f32_32x32x16_bf16 v[164:179], a[20:23], v[132:135], v[164:179]
    v_exp_f32 v184, v184
    v_exp_f32 v185, v185
    v_exp_f32 v186, v186
    v_exp_f32 v187, v187
    v_cvt_pk_bf16_f32 v206, v184, v185
    v_cvt_pk_bf16_f32 v207, v186, v187
    v_mfma_f32_32x32x16_bf16 v[212:227], a[128:131], v[196:199], v[212:227]
    v_exp_f32 v188, v188
    v_exp_f32 v189, v189
    v_exp_f32 v190, v190
    v_exp_f32 v191, v191
    v_cvt_pk_bf16_f32 v208, v188, v189
    v_cvt_pk_bf16_f32 v209, v190, v191
    v_mfma_f32_32x32x16_bf16 v[212:227], a[132:135], v[200:203], v[212:227]
    v_exp_f32 v192, v192
    v_exp_f32 v193, v193
    v_exp_f32 v194, v194
    v_exp_f32 v195, v195
    v_cvt_pk_bf16_f32 v210, v192, v193
    v_cvt_pk_bf16_f32 v211, v194, v195
    v_mfma_f32_32x32x8_bf16 v[180:195], a[74:75], v[158:159], 0
    v_exp_f32 v164, v164
    v_exp_f32 v165, v165
    v_exp_f32 v166, v166
    v_exp_f32 v167, v167
    v_cvt_pk_bf16_f32 v196, v164, v165
    v_cvt_pk_bf16_f32 v197, v166, v167
    v_mfma_f32_32x32x16_bf16 v[180:195], a[20:23], v[136:139], v[180:195]
    v_exp_f32 v168, v168
    v_exp_f32 v169, v169
    v_exp_f32 v170, v170
    v_exp_f32 v171, v171
    v_cvt_pk_bf16_f32 v198, v168, v169
    v_cvt_pk_bf16_f32 v199, v170, v171
    v_mfma_f32_32x32x16_bf16 v[228:243], a[128:131], v[204:207], v[228:243]
    s_add_u32 s48, s56, 19398656
    buffer_store_dwordx4 v[100:103], v22, s[12:15], s48 offen offset:0 sc1
    v_exp_f32 v172, v172
    v_exp_f32 v173, v173
    v_exp_f32 v174, v174
    v_exp_f32 v175, v175
    v_cvt_pk_bf16_f32 v200, v172, v173
    v_cvt_pk_bf16_f32 v201, v174, v175
    v_mfma_f32_32x32x16_bf16 v[228:243], a[132:135], v[208:211], v[228:243]
    v_exp_f32 v176, v176
    v_exp_f32 v177, v177
    v_exp_f32 v178, v178
    v_exp_f32 v179, v179
    v_cvt_pk_bf16_f32 v202, v176, v177
    v_cvt_pk_bf16_f32 v203, v178, v179
    v_mfma_f32_32x32x8_bf16 v[164:179], a[76:77], v[156:157], 0
    v_exp_f32 v180, v180
    v_exp_f32 v181, v181
    v_exp_f32 v182, v182
    v_exp_f32 v183, v183
    v_cvt_pk_bf16_f32 v204, v180, v181
    v_cvt_pk_bf16_f32 v205, v182, v183
    v_mfma_f32_32x32x16_bf16 v[164:179], a[24:27], v[132:135], v[164:179]
    v_exp_f32 v184, v184
    v_exp_f32 v185, v185
    v_exp_f32 v186, v186
    v_exp_f32 v187, v187
    v_cvt_pk_bf16_f32 v206, v184, v185
    v_cvt_pk_bf16_f32 v207, v186, v187
    v_mfma_f32_32x32x16_bf16 v[212:227], a[136:139], v[196:199], v[212:227]
    v_exp_f32 v188, v188
    v_exp_f32 v189, v189
    v_exp_f32 v190, v190
    v_exp_f32 v191, v191
    v_cvt_pk_bf16_f32 v208, v188, v189
    v_cvt_pk_bf16_f32 v209, v190, v191
    v_mfma_f32_32x32x16_bf16 v[212:227], a[140:143], v[200:203], v[212:227]
    v_exp_f32 v192, v192
    v_exp_f32 v193, v193
    v_exp_f32 v194, v194
    v_exp_f32 v195, v195
    v_cvt_pk_bf16_f32 v210, v192, v193
    v_cvt_pk_bf16_f32 v211, v194, v195
    v_mfma_f32_32x32x8_bf16 v[180:195], a[76:77], v[158:159], 0
    v_exp_f32 v164, v164
    v_exp_f32 v165, v165
    v_exp_f32 v166, v166
    v_exp_f32 v167, v167
    v_cvt_pk_bf16_f32 v196, v164, v165
    v_cvt_pk_bf16_f32 v197, v166, v167
    v_mfma_f32_32x32x16_bf16 v[180:195], a[24:27], v[136:139], v[180:195]
    v_exp_f32 v168, v168
    v_exp_f32 v169, v169
    v_exp_f32 v170, v170
    v_exp_f32 v171, v171
    v_cvt_pk_bf16_f32 v198, v168, v169
    v_cvt_pk_bf16_f32 v199, v170, v171
    v_mfma_f32_32x32x16_bf16 v[228:243], a[136:139], v[204:207], v[228:243]
    v_exp_f32 v172, v172
    v_exp_f32 v173, v173
    v_exp_f32 v174, v174
    v_exp_f32 v175, v175
    v_cvt_pk_bf16_f32 v200, v172, v173
    v_cvt_pk_bf16_f32 v201, v174, v175
    v_mfma_f32_32x32x16_bf16 v[228:243], a[140:143], v[208:211], v[228:243]
    v_exp_f32 v176, v176
    v_exp_f32 v177, v177
    v_exp_f32 v178, v178
    v_exp_f32 v179, v179
    v_cvt_pk_bf16_f32 v202, v176, v177
    v_cvt_pk_bf16_f32 v203, v178, v179
    v_mfma_f32_32x32x8_bf16 v[164:179], a[78:79], v[156:157], 0
    v_exp_f32 v180, v180
    v_exp_f32 v181, v181
    v_exp_f32 v182, v182
    v_exp_f32 v183, v183
    v_cvt_pk_bf16_f32 v204, v180, v181
    v_cvt_pk_bf16_f32 v205, v182, v183
    v_mfma_f32_32x32x16_bf16 v[164:179], a[28:31], v[132:135], v[164:179]
    buffer_load_dwordx4 v[104:107], v23, s[4:7], s54 offen
    v_exp_f32 v184, v184
    v_exp_f32 v185, v185
    v_exp_f32 v186, v186
    v_exp_f32 v187, v187
    v_cvt_pk_bf16_f32 v206, v184, v185
    v_cvt_pk_bf16_f32 v207, v186, v187
    v_mfma_f32_32x32x16_bf16 v[212:227], a[144:147], v[196:199], v[212:227]
    buffer_store_dwordx4 v[100:103], v22, s[12:15], s48 offen offset:1024 sc1
    v_exp_f32 v188, v188
    v_exp_f32 v189, v189
    v_exp_f32 v190, v190
    v_exp_f32 v191, v191
    v_cvt_pk_bf16_f32 v208, v188, v189
    v_cvt_pk_bf16_f32 v209, v190, v191
    v_mfma_f32_32x32x16_bf16 v[212:227], a[148:151], v[200:203], v[212:227]
    v_exp_f32 v192, v192
    v_exp_f32 v193, v193
    v_exp_f32 v194, v194
    v_exp_f32 v195, v195
    v_cvt_pk_bf16_f32 v210, v192, v193
    v_cvt_pk_bf16_f32 v211, v194, v195
    v_mfma_f32_32x32x8_bf16 v[180:195], a[78:79], v[158:159], 0
    v_exp_f32 v164, v164
    v_exp_f32 v165, v165
    v_exp_f32 v166, v166
    v_exp_f32 v167, v167
    v_cvt_pk_bf16_f32 v196, v164, v165
    v_cvt_pk_bf16_f32 v197, v166, v167
    v_mfma_f32_32x32x16_bf16 v[180:195], a[28:31], v[136:139], v[180:195]
    v_exp_f32 v168, v168
    v_exp_f32 v169, v169
    v_exp_f32 v170, v170
    v_exp_f32 v171, v171
    v_cvt_pk_bf16_f32 v198, v168, v169
    v_cvt_pk_bf16_f32 v199, v170, v171
    v_mfma_f32_32x32x16_bf16 v[228:243], a[144:147], v[204:207], v[228:243]
    v_exp_f32 v172, v172
    v_exp_f32 v173, v173
    v_exp_f32 v174, v174
    v_exp_f32 v175, v175
    v_cvt_pk_bf16_f32 v200, v172, v173
    v_cvt_pk_bf16_f32 v201, v174, v175
    v_mfma_f32_32x32x16_bf16 v[228:243], a[148:151], v[208:211], v[228:243]
    v_exp_f32 v176, v176
    v_exp_f32 v177, v177
    v_exp_f32 v178, v178
    v_exp_f32 v179, v179
    v_cvt_pk_bf16_f32 v202, v176, v177
    v_cvt_pk_bf16_f32 v203, v178, v179
    v_mfma_f32_32x32x8_bf16 v[164:179], a[80:81], v[156:157], 0
    v_exp_f32 v180, v180
    v_exp_f32 v181, v181
    v_exp_f32 v182, v182
    v_exp_f32 v183, v183
    v_cvt_pk_bf16_f32 v204, v180, v181
    v_cvt_pk_bf16_f32 v205, v182, v183
    v_mfma_f32_32x32x16_bf16 v[164:179], a[32:35], v[132:135], v[164:179]
    buffer_load_dwordx4 v[108:111], v23, s[4:7], s54 offen offset:64
    v_exp_f32 v184, v184
    v_exp_f32 v185, v185
    v_exp_f32 v186, v186
    v_exp_f32 v187, v187
    v_cvt_pk_bf16_f32 v206, v184, v185
    v_cvt_pk_bf16_f32 v207, v186, v187
    v_mfma_f32_32x32x16_bf16 v[212:227], a[152:155], v[196:199], v[212:227]
    v_exp_f32 v188, v188
    v_exp_f32 v189, v189
    v_exp_f32 v190, v190
    v_exp_f32 v191, v191
    v_cvt_pk_bf16_f32 v208, v188, v189
    v_cvt_pk_bf16_f32 v209, v190, v191
    v_mfma_f32_32x32x16_bf16 v[212:227], a[156:159], v[200:203], v[212:227]
    v_exp_f32 v192, v192
    v_exp_f32 v193, v193
    v_exp_f32 v194, v194
    v_exp_f32 v195, v195
    v_cvt_pk_bf16_f32 v210, v192, v193
    v_cvt_pk_bf16_f32 v211, v194, v195
    v_mfma_f32_32x32x8_bf16 v[180:195], a[80:81], v[158:159], 0
    v_exp_f32 v164, v164
    v_exp_f32 v165, v165
    v_exp_f32 v166, v166
    v_exp_f32 v167, v167
    v_cvt_pk_bf16_f32 v196, v164, v165
    v_cvt_pk_bf16_f32 v197, v166, v167
    v_mfma_f32_32x32x16_bf16 v[180:195], a[32:35], v[136:139], v[180:195]
    v_exp_f32 v168, v168
    v_exp_f32 v169, v169
    v_exp_f32 v170, v170
    v_exp_f32 v171, v171
    v_cvt_pk_bf16_f32 v198, v168, v169
    v_cvt_pk_bf16_f32 v199, v170, v171
    v_mfma_f32_32x32x16_bf16 v[228:243], a[152:155], v[204:207], v[228:243]
    buffer_store_dwordx4 v[100:103], v22, s[12:15], s48 offen offset:2048 sc1
    v_exp_f32 v172, v172
    v_exp_f32 v173, v173
    v_exp_f32 v174, v174
    v_exp_f32 v175, v175
    v_cvt_pk_bf16_f32 v200, v172, v173
    v_cvt_pk_bf16_f32 v201, v174, v175
    v_mfma_f32_32x32x16_bf16 v[228:243], a[156:159], v[208:211], v[228:243]
    v_exp_f32 v176, v176
    v_exp_f32 v177, v177
    v_exp_f32 v178, v178
    v_exp_f32 v179, v179
    v_cvt_pk_bf16_f32 v202, v176, v177
    v_cvt_pk_bf16_f32 v203, v178, v179
    v_mfma_f32_32x32x8_bf16 v[164:179], a[82:83], v[156:157], 0
    v_exp_f32 v180, v180
    v_exp_f32 v181, v181
    v_exp_f32 v182, v182
    v_exp_f32 v183, v183
    v_cvt_pk_bf16_f32 v204, v180, v181
    v_cvt_pk_bf16_f32 v205, v182, v183
    v_mfma_f32_32x32x16_bf16 v[164:179], a[36:39], v[132:135], v[164:179]
    buffer_load_dwordx2 v[112:113], v24, s[4:7], s54 offen offset:128
    v_exp_f32 v184, v184
    v_exp_f32 v185, v185
    v_exp_f32 v186, v186
    v_exp_f32 v187, v187
    v_cvt_pk_bf16_f32 v206, v184, v185
    v_cvt_pk_bf16_f32 v207, v186, v187
    v_mfma_f32_32x32x16_bf16 v[212:227], a[160:163], v[196:199], v[212:227]
    v_exp_f32 v188, v188
    v_exp_f32 v189, v189
    v_exp_f32 v190, v190
    v_exp_f32 v191, v191
    v_cvt_pk_bf16_f32 v208, v188, v189
    v_cvt_pk_bf16_f32 v209, v190, v191
    v_mfma_f32_32x32x16_bf16 v[212:227], a[164:167], v[200:203], v[212:227]
    v_exp_f32 v192, v192
    v_exp_f32 v193, v193
    v_exp_f32 v194, v194
    v_exp_f32 v195, v195
    v_cvt_pk_bf16_f32 v210, v192, v193
    v_cvt_pk_bf16_f32 v211, v194, v195
    v_mfma_f32_32x32x8_bf16 v[180:195], a[82:83], v[158:159], 0
    v_exp_f32 v164, v164
    v_exp_f32 v165, v165
    v_exp_f32 v166, v166
    v_exp_f32 v167, v167
    v_cvt_pk_bf16_f32 v196, v164, v165
    v_cvt_pk_bf16_f32 v197, v166, v167
    v_mfma_f32_32x32x16_bf16 v[180:195], a[36:39], v[136:139], v[180:195]
    v_exp_f32 v168, v168
    v_exp_f32 v169, v169
    v_exp_f32 v170, v170
    v_exp_f32 v171, v171
    v_cvt_pk_bf16_f32 v198, v168, v169
    v_cvt_pk_bf16_f32 v199, v170, v171
    v_mfma_f32_32x32x16_bf16 v[228:243], a[160:163], v[204:207], v[228:243]
    v_exp_f32 v172, v172
    v_exp_f32 v173, v173
    v_exp_f32 v174, v174
    v_exp_f32 v175, v175
    v_cvt_pk_bf16_f32 v200, v172, v173
    v_cvt_pk_bf16_f32 v201, v174, v175
    v_mfma_f32_32x32x16_bf16 v[228:243], a[164:167], v[208:211], v[228:243]
    s_mov_b32 s49, 204800
    s_mov_b32 s67, 131072
    buffer_load_dwordx4 v[80:83], v22, s[12:15], s49 offen offset:0 sc1
    buffer_load_dwordx4 v[84:87], v22, s[12:15], s49 offen offset:1024 sc1
    buffer_load_dwordx4 v[88:91], v22, s[12:15], s49 offen offset:2048 sc1
    buffer_load_dwordx4 v[92:95], v22, s[12:15], s49 offen offset:3072 sc1
    v_exp_f32 v176, v176
    v_exp_f32 v177, v177
    v_exp_f32 v178, v178
    v_exp_f32 v179, v179
    v_cvt_pk_bf16_f32 v202, v176, v177
    v_cvt_pk_bf16_f32 v203, v178, v179
    v_mfma_f32_32x32x8_bf16 v[164:179], a[84:85], v[156:157], 0
    v_exp_f32 v180, v180
    v_exp_f32 v181, v181
    v_exp_f32 v182, v182
    v_exp_f32 v183, v183
    v_cvt_pk_bf16_f32 v204, v180, v181
    v_cvt_pk_bf16_f32 v205, v182, v183
    v_mfma_f32_32x32x16_bf16 v[164:179], a[40:43], v[132:135], v[164:179]
    v_exp_f32 v184, v184
    v_exp_f32 v185, v185
    v_exp_f32 v186, v186
    v_exp_f32 v187, v187
    v_cvt_pk_bf16_f32 v206, v184, v185
    v_cvt_pk_bf16_f32 v207, v186, v187
    v_mfma_f32_32x32x16_bf16 v[212:227], a[168:171], v[196:199], v[212:227]
    s_add_u32 s48, s56, 19401728
    buffer_store_dwordx4 v[100:103], v22, s[12:15], s48 offen offset:0 sc1
    v_exp_f32 v188, v188
    v_exp_f32 v189, v189
    v_exp_f32 v190, v190
    v_exp_f32 v191, v191
    v_cvt_pk_bf16_f32 v208, v188, v189
    v_cvt_pk_bf16_f32 v209, v190, v191
    v_mfma_f32_32x32x16_bf16 v[212:227], a[172:175], v[200:203], v[212:227]
    v_exp_f32 v192, v192
    v_exp_f32 v193, v193
    v_exp_f32 v194, v194
    v_exp_f32 v195, v195
    v_cvt_pk_bf16_f32 v210, v192, v193
    v_cvt_pk_bf16_f32 v211, v194, v195
    v_mfma_f32_32x32x8_bf16 v[180:195], a[84:85], v[158:159], 0
    v_exp_f32 v164, v164
    v_exp_f32 v165, v165
    v_exp_f32 v166, v166
    v_exp_f32 v167, v167
    v_cvt_pk_bf16_f32 v196, v164, v165
    v_cvt_pk_bf16_f32 v197, v166, v167
    v_mfma_f32_32x32x16_bf16 v[180:195], a[40:43], v[136:139], v[180:195]
    v_exp_f32 v168, v168
    v_exp_f32 v169, v169
    v_exp_f32 v170, v170
    v_exp_f32 v171, v171
    v_cvt_pk_bf16_f32 v198, v168, v169
    v_cvt_pk_bf16_f32 v199, v170, v171
    v_mfma_f32_32x32x16_bf16 v[228:243], a[168:171], v[204:207], v[228:243]
    v_exp_f32 v172, v172
    v_exp_f32 v173, v173
    v_exp_f32 v174, v174
    v_exp_f32 v175, v175
    v_cvt_pk_bf16_f32 v200, v172, v173
    v_cvt_pk_bf16_f32 v201, v174, v175
    v_mfma_f32_32x32x16_bf16 v[228:243], a[172:175], v[208:211], v[228:243]
    v_exp_f32 v176, v176
    v_exp_f32 v177, v177
    v_exp_f32 v178, v178
    v_exp_f32 v179, v179
    v_cvt_pk_bf16_f32 v202, v176, v177
    v_cvt_pk_bf16_f32 v203, v178, v179
    v_mfma_f32_32x32x8_bf16 v[164:179], a[86:87], v[156:157], 0
    v_exp_f32 v180, v180
    v_exp_f32 v181, v181
    v_exp_f32 v182, v182
    v_exp_f32 v183, v183
    v_cvt_pk_bf16_f32 v204, v180, v181
    v_cvt_pk_bf16_f32 v205, v182, v183
    v_mfma_f32_32x32x16_bf16 v[164:179], a[44:47], v[132:135], v[164:179]
    v_exp_f32 v184, v184
    v_exp_f32 v185, v185
    v_exp_f32 v186, v186
    v_exp_f32 v187, v187
    v_cvt_pk_bf16_f32 v206, v184, v185
    v_cvt_pk_bf16_f32 v207, v186, v187
    v_mfma_f32_32x32x16_bf16 v[212:227], a[176:179], v[196:199], v[212:227]
    v_exp_f32 v188, v188
    v_exp_f32 v189, v189
    v_exp_f32 v190, v190
    v_exp_f32 v191, v191
    v_cvt_pk_bf16_f32 v208, v188, v189
    v_cvt_pk_bf16_f32 v209, v190, v191
    v_mfma_f32_32x32x16_bf16 v[212:227], a[180:183], v[200:203], v[212:227]
    v_exp_f32 v192, v192
    v_exp_f32 v193, v193
    v_exp_f32 v194, v194
    v_exp_f32 v195, v195
    v_cvt_pk_bf16_f32 v210, v192, v193
    v_cvt_pk_bf16_f32 v211, v194, v195
    v_mfma_f32_32x32x8_bf16 v[180:195], a[86:87], v[158:159], 0
    v_exp_f32 v164, v164
    v_exp_f32 v165, v165
    v_exp_f32 v166, v166
    v_exp_f32 v167, v167
    v_cvt_pk_bf16_f32 v196, v164, v165
    v_cvt_pk_bf16_f32 v197, v166, v167
    v_mfma_f32_32x32x16_bf16 v[180:195], a[44:47], v[136:139], v[180:195]
    v_exp_f32 v168, v168
    v_exp_f32 v169, v169
    v_exp_f32 v170, v170
    v_exp_f32 v171, v171
    v_cvt_pk_bf16_f32 v198, v168, v169
    v_cvt_pk_bf16_f32 v199, v170, v171
    v_mfma_f32_32x32x16_bf16 v[228:243], a[176:179], v[204:207], v[228:243]
    buffer_store_dwordx4 v[100:103], v22, s[12:15], s48 offen offset:1024 sc1
    v_exp_f32 v172, v172
    v_exp_f32 v173, v173
    v_exp_f32 v174, v174
    v_exp_f32 v175, v175
    v_cvt_pk_bf16_f32 v200, v172, v173
    v_cvt_pk_bf16_f32 v201, v174, v175
    v_mfma_f32_32x32x16_bf16 v[228:243], a[180:183], v[208:211], v[228:243]
    v_exp_f32 v176, v176
    v_exp_f32 v177, v177
    v_exp_f32 v178, v178
    v_exp_f32 v179, v179
    v_cvt_pk_bf16_f32 v202, v176, v177
    v_cvt_pk_bf16_f32 v203, v178, v179
    v_mfma_f32_32x32x8_bf16 v[164:179], a[88:89], v[156:157], 0
    v_exp_f32 v180, v180
    v_exp_f32 v181, v181
    v_exp_f32 v182, v182
    v_exp_f32 v183, v183
    v_cvt_pk_bf16_f32 v204, v180, v181
    v_cvt_pk_bf16_f32 v205, v182, v183
    v_mfma_f32_32x32x16_bf16 v[164:179], a[48:51], v[132:135], v[164:179]
    v_exp_f32 v184, v184
    v_exp_f32 v185, v185
    v_exp_f32 v186, v186
    v_exp_f32 v187, v187
    v_cvt_pk_bf16_f32 v206, v184, v185
    v_cvt_pk_bf16_f32 v207, v186, v187
    v_mfma_f32_32x32x16_bf16 v[212:227], a[184:187], v[196:199], v[212:227]
    v_exp_f32 v188, v188
    v_exp_f32 v189, v189
    v_exp_f32 v190, v190
    v_exp_f32 v191, v191
    v_cvt_pk_bf16_f32 v208, v188, v189
    v_cvt_pk_bf16_f32 v209, v190, v191
    v_mfma_f32_32x32x16_bf16 v[212:227], a[188:191], v[200:203], v[212:227]
    v_exp_f32 v192, v192
    v_exp_f32 v193, v193
    v_exp_f32 v194, v194
    v_exp_f32 v195, v195
    v_cvt_pk_bf16_f32 v210, v192, v193
    v_cvt_pk_bf16_f32 v211, v194, v195
    v_mfma_f32_32x32x8_bf16 v[180:195], a[88:89], v[158:159], 0
    v_exp_f32 v164, v164
    v_exp_f32 v165, v165
    v_exp_f32 v166, v166
    v_exp_f32 v167, v167
    v_cvt_pk_bf16_f32 v196, v164, v165
    v_cvt_pk_bf16_f32 v197, v166, v167
    v_mfma_f32_32x32x16_bf16 v[180:195], a[48:51], v[136:139], v[180:195]
    s_waitcnt vmcnt(2)
L_pchk_8:
    v_xor_b32 v80, s24, v80
    v_xor_b32 v81, s24, v81
    v_xor_b32 v82, s24, v82
    v_xor_b32 v83, s24, v83
    v_xor_b32 v84, s24, v84
    v_xor_b32 v85, s24, v85
    v_xor_b32 v86, s24, v86
    v_xor_b32 v87, s24, v87
    v_xor_b32 v88, s24, v88
    v_xor_b32 v89, s24, v89
    v_xor_b32 v90, s24, v90
    v_xor_b32 v91, s24, v91
    v_xor_b32 v92, s24, v92
    v_xor_b32 v93, s24, v93
    v_xor_b32 v94, s24, v94
    v_xor_b32 v95, s24, v95
    v_or_b32 v80, v80, v81
    v_or3_b32 v80, v80, v82, v83
    v_or3_b32 v80, v80, v84, v85
    v_or3_b32 v80, v80, v86, v87
    v_or3_b32 v80, v80, v88, v89
    v_or3_b32 v80, v80, v90, v91
    v_or3_b32 v80, v80, v92, v93
    v_or3_b32 v80, v80, v94, v95
    v_cmp_ne_u32 vcc, 0, v80
    s_sub_u32 s67, s67, 1
    s_cbranch_scc1 L_pchkd_9
    s_nop 2
    s_cbranch_vccz L_pchkd_9
    s_mov_b32 s49, 204800
    buffer_load_dwordx4 v[80:83], v22, s[12:15], s49 offen offset:0 sc1
    buffer_load_dwordx4 v[84:87], v22, s[12:15], s49 offen offset:1024 sc1
    buffer_load_dwordx4 v[88:91], v22, s[12:15], s49 offen offset:2048 sc1
    buffer_load_dwordx4 v[92:95], v22, s[12:15], s49 offen offset:3072 sc1
    s_waitcnt vmcnt(0)
    s_branch L_pchk_8
L_pchkd_9:
    v_exp_f32 v168, v168
    v_exp_f32 v169, v169
    v_exp_f32 v170, v170
    v_exp_f32 v171, v171
    v_cvt_pk_bf16_f32 v198, v168, v169
    v_cvt_pk_bf16_f32 v199, v170, v171
    v_mfma_f32_32x32x16_bf16 v[228:243], a[184:187], v[204:207], v[228:243]
    v_exp_f32 v172, v172
    v_exp_f32 v173, v173
    v_exp_f32 v174, v174
    v_exp_f32 v175, v175
    v_cvt_pk_bf16_f32 v200, v172, v173
    v_cvt_pk_bf16_f32 v201, v174, v175
    v_mfma_f32_32x32x16_bf16 v[228:243], a[188:191], v[208:211], v[228:243]
    v_exp_f32 v176, v176
    v_exp_f32 v177, v177
    v_exp_f32 v178, v178
    v_exp_f32 v179, v179
    v_cvt_pk_bf16_f32 v202, v176, v177
    v_cvt_pk_bf16_f32 v203, v178, v179
    v_mfma_f32_32x32x8_bf16 v[164:179], a[90:91], v[156:157], 0
    v_exp_f32 v180, v180
    v_exp_f32 v181, v181
    v_exp_f32 v182, v182
    v_exp_f32 v183, v183
    v_cvt_pk_bf16_f32 v204, v180, v181
    v_cvt_pk_bf16_f32 v205, v182, v183
    v_mfma_f32_32x32x16_bf16 v[164:179], a[52:55], v[132:135], v[164:179]
    s_add_u32 s49, s51, 0
    buffer_load_dwordx4 a[224:227], v22, s[12:15], s49 offen offset:0 sc1
    v_exp_f32 v184, v184
    v_exp_f32 v185, v185
    v_exp_f32 v186, v186
    v_exp_f32 v187, v187
    v_cvt_pk_bf16_f32 v206, v184, v185
    v_cvt_pk_bf16_f32 v207, v186, v187
    v_mfma_f32_32x32x16_bf16 v[212:227], a[192:195], v[196:199], v[212:227]
    buffer_store_dwordx4 v[100:103], v22, s[12:15], s48 offen offset:2048 sc1
    v_exp_f32 v188, v188
    v_exp_f32 v189, v189
    v_exp_f32 v190, v190
    v_exp_f32 v191, v191
    v_cvt_pk_bf16_f32 v208, v188, v189
    v_cvt_pk_bf16_f32 v209, v190, v191
    v_mfma_f32_32x32x16_bf16 v[212:227], a[196:199], v[200:203], v[212:227]
    buffer_load_dwordx4 a[228:231], v22, s[12:15], s49 offen offset:1024 sc1
    v_exp_f32 v192, v192
    v_exp_f32 v193, v193
    v_exp_f32 v194, v194
    v_exp_f32 v195, v195
    v_cvt_pk_bf16_f32 v210, v192, v193
    v_cvt_pk_bf16_f32 v211, v194, v195
    v_mfma_f32_32x32x8_bf16 v[180:195], a[90:91], v[158:159], 0
    v_exp_f32 v164, v164
    v_exp_f32 v165, v165
    v_exp_f32 v166, v166
    v_exp_f32 v167, v167
    v_cvt_pk_bf16_f32 v196, v164, v165
    v_cvt_pk_bf16_f32 v197, v166, v167
    v_mfma_f32_32x32x16_bf16 v[180:195], a[52:55], v[136:139], v[180:195]
    buffer_load_dwordx4 a[232:235], v22, s[12:15], s49 offen offset:2048 sc1
    v_exp_f32 v168, v168
    v_exp_f32 v169, v169
    v_exp_f32 v170, v170
    v_exp_f32 v171, v171
    v_cvt_pk_bf16_f32 v198, v168, v169
    v_cvt_pk_bf16_f32 v199, v170, v171
    v_mfma_f32_32x32x16_bf16 v[228:243], a[192:195], v[204:207], v[228:243]
    v_exp_f32 v172, v172
    v_exp_f32 v173, v173
    v_exp_f32 v174, v174
    v_exp_f32 v175, v175
    v_cvt_pk_bf16_f32 v200, v172, v173
    v_cvt_pk_bf16_f32 v201, v174, v175
    v_mfma_f32_32x32x16_bf16 v[228:243], a[196:199], v[208:211], v[228:243]
    buffer_load_dwordx4 a[236:239], v22, s[12:15], s49 offen offset:3072 sc1
    v_exp_f32 v176, v176
    v_exp_f32 v177, v177
    v_exp_f32 v178, v178
    v_exp_f32 v179, v179
    v_cvt_pk_bf16_f32 v202, v176, v177
    v_cvt_pk_bf16_f32 v203, v178, v179
    v_mfma_f32_32x32x8_bf16 v[164:179], a[92:93], v[156:157], 0
    v_exp_f32 v180, v180
    v_exp_f32 v181, v181
    v_exp_f32 v182, v182
    v_exp_f32 v183, v183
    v_cvt_pk_bf16_f32 v204, v180, v181
    v_cvt_pk_bf16_f32 v205, v182, v183
    v_mfma_f32_32x32x16_bf16 v[164:179], a[56:59], v[132:135], v[164:179]
    s_add_u32 s49, s51, 4096
    buffer_load_dwordx4 a[240:243], v22, s[12:15], s49 offen offset:0 sc1
    v_exp_f32 v184, v184
    v_exp_f32 v185, v185
    v_exp_f32 v186, v186
    v_exp_f32 v187, v187
    v_cvt_pk_bf16_f32 v206, v184, v185
    v_cvt_pk_bf16_f32 v207, v186, v187
    v_mfma_f32_32x32x16_bf16 v[212:227], a[200:203], v[196:199], v[212:227]
    v_exp_f32 v188, v188
    v_exp_f32 v189, v189
    v_exp_f32 v190, v190
    v_exp_f32 v191, v191
    v_cvt_pk_bf16_f32 v208, v188, v189
    v_cvt_pk_bf16_f32 v209, v190, v191
    v_mfma_f32_32x32x16_bf16 v[212:227], a[204:207], v[200:203], v[212:227]
    buffer_load_dwordx4 a[244:247], v22, s[12:15], s49 offen offset:1024 sc1
    v_exp_f32 v192, v192
    v_exp_f32 v193, v193
    v_exp_f32 v194, v194
    v_exp_f32 v195, v195
    v_cvt_pk_bf16_f32 v210, v192, v193
    v_cvt_pk_bf16_f32 v211, v194, v195
    v_mfma_f32_32x32x8_bf16 v[180:195], a[92:93], v[158:159], 0
    v_exp_f32 v164, v164
    v_exp_f32 v165, v165
    v_exp_f32 v166, v166
    v_exp_f32 v167, v167
    v_cvt_pk_bf16_f32 v196, v164, v165
    v_cvt_pk_bf16_f32 v197, v166, v167
    v_mfma_f32_32x32x16_bf16 v[180:195], a[56:59], v[136:139], v[180:195]
    buffer_load_dwordx4 a[248:251], v22, s[12:15], s49 offen offset:2048 sc1
    v_exp_f32 v168, v168
    v_exp_f32 v169, v169
    v_exp_f32 v170, v170
    v_exp_f32 v171, v171
    v_cvt_pk_bf16_f32 v198, v168, v169
    v_cvt_pk_bf16_f32 v199, v170, v171
    v_mfma_f32_32x32x16_bf16 v[228:243], a[200:203], v[204:207], v[228:243]
    v_exp_f32 v172, v172
    v_exp_f32 v173, v173
    v_exp_f32 v174, v174
    v_exp_f32 v175, v175
    v_cvt_pk_bf16_f32 v200, v172, v173
    v_cvt_pk_bf16_f32 v201, v174, v175
    v_mfma_f32_32x32x16_bf16 v[228:243], a[204:207], v[208:211], v[228:243]
    buffer_load_dwordx4 a[252:255], v22, s[12:15], s49 offen offset:3072 sc1
    v_exp_f32 v176, v176
    v_exp_f32 v177, v177
    v_exp_f32 v178, v178
    v_exp_f32 v179, v179
    v_cvt_pk_bf16_f32 v202, v176, v177
    v_cvt_pk_bf16_f32 v203, v178, v179
    v_mfma_f32_32x32x8_bf16 v[164:179], a[94:95], v[156:157], 0
    v_exp_f32 v180, v180
    v_exp_f32 v181, v181
    v_exp_f32 v182, v182
    v_exp_f32 v183, v183
    v_cvt_pk_bf16_f32 v204, v180, v181
    v_cvt_pk_bf16_f32 v205, v182, v183
    v_mfma_f32_32x32x16_bf16 v[164:179], a[60:63], v[132:135], v[164:179]
    s_add_u32 s49, s51, 8192
    buffer_load_dwordx4 v[32:35], v22, s[12:15], s49 offen offset:0 sc1
    v_exp_f32 v184, v184
    v_exp_f32 v185, v185
    v_exp_f32 v186, v186
    v_exp_f32 v187, v187
    v_cvt_pk_bf16_f32 v206, v184, v185
    v_cvt_pk_bf16_f32 v207, v186, v187
    v_mfma_f32_32x32x16_bf16 v[212:227], a[208:211], v[196:199], v[212:227]
    v_exp_f32 v188, v188
    v_exp_f32 v189, v189
    v_exp_f32 v190, v190
    v_exp_f32 v191, v191
    v_cvt_pk_bf16_f32 v208, v188, v189
    v_cvt_pk_bf16_f32 v209, v190, v191
    v_mfma_f32_32x32x16_bf16 v[212:227], a[212:215], v[200:203], v[212:227]
    buffer_load_dwordx4 v[36:39], v22, s[12:15], s49 offen offset:1024 sc1
    v_exp_f32 v192, v192
    v_exp_f32 v193, v193
    v_exp_f32 v194, v194
    v_exp_f32 v195, v195
    v_cvt_pk_bf16_f32 v210, v192, v193
    v_cvt_pk_bf16_f32 v211, v194, v195
    v_mfma_f32_32x32x8_bf16 v[180:195], a[94:95], v[158:159], 0
    v_exp_f32 v164, v164
    v_exp_f32 v165, v165
    v_exp_f32 v166, v166
    v_exp_f32 v167, v167
    v_cvt_pk_bf16_f32 v196, v164, v165
    v_cvt_pk_bf16_f32 v197, v166, v167
    v_mfma_f32_32x32x16_bf16 v[180:195], a[60:63], v[136:139], v[180:195]
    buffer_load_dwordx4 v[40:43], v22, s[12:15], s49 offen offset:2048 sc1
    v_exp_f32 v168, v168
    v_exp_f32 v169, v169
    v_exp_f32 v170, v170
    v_exp_f32 v171, v171
    v_cvt_pk_bf16_f32 v198, v168, v169
    v_cvt_pk_bf16_f32 v199, v170, v171
    v_mfma_f32_32x32x16_bf16 v[228:243], a[208:211], v[204:207], v[228:243]
    v_exp_f32 v172, v172
    v_exp_f32 v173, v173
    v_exp_f32 v174, v174
    v_exp_f32 v175, v175
    v_cvt_pk_bf16_f32 v200, v172, v173
    v_cvt_pk_bf16_f32 v201, v174, v175
    v_mfma_f32_32x32x16_bf16 v[228:243], a[212:215], v[208:211], v[228:243]
    buffer_load_dwordx4 v[44:47], v22, s[12:15], s49 offen offset:3072 sc1
    v_exp_f32 v176, v176
    v_exp_f32 v177, v177
    v_exp_f32 v178, v178
    v_exp_f32 v179, v179
    v_cvt_pk_bf16_f32 v202, v176, v177
    v_cvt_pk_bf16_f32 v203, v178, v179
    v_mfma_f32_32x32x8_bf16 v[164:179], a[64:65], v[160:161], 0
    v_exp_f32 v180, v180
    v_exp_f32 v181, v181
    v_exp_f32 v182, v182
    v_exp_f32 v183, v183
    v_cvt_pk_bf16_f32 v204, v180, v181
    v_cvt_pk_bf16_f32 v205, v182, v183
    v_mfma_f32_32x32x16_bf16 v[164:179], a[0:3], v[140:143], v[164:179]
    s_add_u32 s49, s51, 12288
    buffer_load_dwordx4 v[48:51], v22, s[12:15], s49 offen offset:0 sc1
    v_exp_f32 v184, v184
    v_exp_f32 v185, v185
    v_exp_f32 v186, v186
    v_exp_f32 v187, v187
    v_cvt_pk_bf16_f32 v206, v184, v185
    v_cvt_pk_bf16_f32 v207, v186, v187
    v_mfma_f32_32x32x16_bf16 v[212:227], a[216:219], v[196:199], v[212:227]
    v_exp_f32 v188, v188
    v_exp_f32 v189, v189
    v_exp_f32 v190, v190
    v_exp_f32 v191, v191
    v_cvt_pk_bf16_f32 v208, v188, v189
    v_cvt_pk_bf16_f32 v209, v190, v191
    v_mfma_f32_32x32x16_bf16 v[212:227], a[220:223], v[200:203], v[212:227]
    buffer_load_dwordx4 v[52:55], v22, s[12:15], s49 offen offset:1024 sc1
    v_exp_f32 v192, v192
    v_exp_f32 v193, v193
    v_exp_f32 v194, v194
    v_exp_f32 v195, v195
    v_cvt_pk_bf16_f32 v210, v192, v193
    v_cvt_pk_bf16_f32 v211, v194, v195
    v_mfma_f32_32x32x8_bf16 v[180:195], a[64:65], v[162:163], 0
    v_exp_f32 v164, v164
    v_exp_f32 v165, v165
    v_exp_f32 v166, v166
    v_exp_f32 v167, v167
    v_cvt_pk_bf16_f32 v196, v164, v165
    v_cvt_pk_bf16_f32 v197, v166, v167
    v_mfma_f32_32x32x16_bf16 v[180:195], a[0:3], v[144:147], v[180:195]
    buffer_load_dwordx4 v[56:59], v22, s[12:15], s49 offen offset:2048 sc1
    v_exp_f32 v168, v168
    v_exp_f32 v169, v169
    v_exp_f32 v170, v170
    v_exp_f32 v171, v171
    v_cvt_pk_bf16_f32 v198, v168, v169
    v_cvt_pk_bf16_f32 v199, v170, v171
    v_mfma_f32_32x32x16_bf16 v[228:243], a[216:219], v[204:207], v[228:243]
    v_mov_b32 v223, v248
    v_subrev_u32 v224, 0x2b800000, v222
    v_max_u32 v252, v252, v224
    ds_write_b128 v15, v[212:215] offset:0
    ds_write_b128 v15, v[216:219] offset:1024
    ds_write_b128 v15, v[220:223] offset:2048
    v_exp_f32 v172, v172
    v_exp_f32 v173, v173
    v_exp_f32 v174, v174
    v_exp_f32 v175, v175
    v_cvt_pk_bf16_f32 v200, v172, v173
    v_cvt_pk_bf16_f32 v201, v174, v175
    v_mfma_f32_32x32x16_bf16 v[228:243], a[220:223], v[208:211], v[228:243]
    buffer_load_dwordx4 v[60:63], v22, s[12:15], s49 offen offset:3072 sc1
    v_exp_f32 v176, v176
    v_exp_f32 v177, v177
    v_exp_f32 v178, v178
    v_exp_f32 v179, v179
    v_cvt_pk_bf16_f32 v202, v176, v177
    v_cvt_pk_bf16_f32 v203, v178, v179
    v_mfma_f32_32x32x8_bf16 v[164:179], a[66:67], v[160:161], 0
    v_exp_f32 v180, v180
    v_exp_f32 v181, v181
    v_exp_f32 v182, v182
    v_exp_f32 v183, v183
    v_cvt_pk_bf16_f32 v204, v180, v181
    v_cvt_pk_bf16_f32 v205, v182, v183
    v_mfma_f32_32x32x16_bf16 v[164:179], a[4:7], v[140:143], v[164:179]
    s_add_u32 s49, s51, 16384
    buffer_load_dwordx4 v[64:67], v22, s[12:15], s49 offen offset:0 sc1
    v_exp_f32 v184, v184
    v_exp_f32 v185, v185
    v_exp_f32 v186, v186
    v_exp_f32 v187, v187
    v_cvt_pk_bf16_f32 v206, v184, v185
    v_cvt_pk_bf16_f32 v207, v186, v187
    v_mfma_f32_32x32x16_bf16 v[212:227], a[96:99], v[196:199], 0
    v_mov_b32 v239, v249
    v_subrev_u32 v240, 0x2b800000, v238
    v_max_u32 v252, v252, v240
    ds_write_b128 v15, v[228:231] offset:12288
    ds_write_b128 v15, v[232:235] offset:13312
    ds_write_b128 v15, v[236:239] offset:14336
    v_exp_f32 v188, v188
    v_exp_f32 v189, v189
    v_exp_f32 v190, v190
    v_exp_f32 v191, v191
    v_cvt_pk_bf16_f32 v208, v188, v189
    v_cvt_pk_bf16_f32 v209, v190, v191
    v_mfma_f32_32x32x16_bf16 v[212:227], a[100:103], v[200:203], v[212:227]
    buffer_load_dwordx4 v[68:71], v22, s[12:15], s49 offen offset:1024 sc1
    v_exp_f32 v192, v192
    v_exp_f32 v193, v193
    v_exp_f32 v194, v194
    v_exp_f32 v195, v195
    v_cvt_pk_bf16_f32 v210, v192, v193
    v_cvt_pk_bf16_f32 v211, v194, v195
    v_mfma_f32_32x32x8_bf16 v[180:195], a[66:67], v[162:163], 0
    v_exp_f32 v164, v164
    v_exp_f32 v165, v165
    v_exp_f32 v166, v166
    v_exp_f32 v167, v167
    v_cvt_pk_bf16_f32 v196, v164, v165
    v_cvt_pk_bf16_f32 v197, v166, v167
    v_mfma_f32_32x32x16_bf16 v[180:195], a[4:7], v[144:147], v[180:195]
    buffer_load_dwordx4 v[72:75], v22, s[12:15], s49 offen offset:2048 sc1
    v_exp_f32 v168, v168
    v_exp_f32 v169, v169
    v_exp_f32 v170, v170
    v_exp_f32 v171, v171
    v_cvt_pk_bf16_f32 v198, v168, v169
    v_cvt_pk_bf16_f32 v199, v170, v171
    v_mfma_f32_32x32x16_bf16 v[228:243], a[96:99], v[204:207], 0
    v_exp_f32 v172, v172
    v_exp_f32 v173, v173
    v_exp_f32 v174, v174
    v_exp_f32 v175, v175
    v_cvt_pk_bf16_f32 v200, v172, v173
    v_cvt_pk_bf16_f32 v201, v174, v175
    v_mfma_f32_32x32x16_bf16 v[228:243], a[100:103], v[208:211], v[228:243]
    buffer_load_dwordx4 v[76:79], v22, s[12:15], s49 offen offset:3072 sc1
    v_exp_f32 v176, v176
    v_exp_f32 v177, v177
    v_exp_f32 v178, v178
    v_exp_f32 v179, v179
    v_cvt_pk_bf16_f32 v202, v176, v177
    v_cvt_pk_bf16_f32 v203, v178, v179
    v_mfma_f32_32x32x8_bf16 v[164:179], a[68:69], v[160:161], 0
    v_exp_f32 v180, v180
    v_exp_f32 v181, v181
    v_exp_f32 v182, v182
    v_exp_f32 v183, v183
    v_cvt_pk_bf16_f32 v204, v180, v181
    v_cvt_pk_bf16_f32 v205, v182, v183
    v_mfma_f32_32x32x16_bf16 v[164:179], a[8:11], v[140:143], v[164:179]
    s_add_u32 s49, s51, 20480
    buffer_load_dwordx4 v[80:83], v22, s[12:15], s49 offen offset:0 sc1
    v_exp_f32 v184, v184
    v_exp_f32 v185, v185
    v_exp_f32 v186, v186
    v_exp_f32 v187, v187
    v_cvt_pk_bf16_f32 v206, v184, v185
    v_cvt_pk_bf16_f32 v207, v186, v187
    v_mfma_f32_32x32x16_bf16 v[212:227], a[104:107], v[196:199], v[212:227]
    v_exp_f32 v188, v188
    v_exp_f32 v189, v189
    v_exp_f32 v190, v190
    v_exp_f32 v191, v191
    v_cvt_pk_bf16_f32 v208, v188, v189
    v_cvt_pk_bf16_f32 v209, v190, v191
    v_mfma_f32_32x32x16_bf16 v[212:227], a[108:111], v[200:203], v[212:227]
    buffer_load_dwordx4 v[84:87], v22, s[12:15], s49 offen offset:1024 sc1
    v_exp_f32 v192, v192
    v_exp_f32 v193, v193
    v_exp_f32 v194, v194
    v_exp_f32 v195, v195
    v_cvt_pk_bf16_f32 v210, v192, v193
    v_cvt_pk_bf16_f32 v211, v194, v195
    v_mfma_f32_32x32x8_bf16 v[180:195], a[68:69], v[162:163], 0
    v_exp_f32 v164, v164
    v_exp_f32 v165, v165
    v_exp_f32 v166, v166
    v_exp_f32 v167, v167
    v_cvt_pk_bf16_f32 v196, v164, v165
    v_cvt_pk_bf16_f32 v197, v166, v167
    v_mfma_f32_32x32x16_bf16 v[180:195], a[8:11], v[144:147], v[180:195]
    buffer_load_dwordx4 v[88:91], v22, s[12:15], s49 offen offset:2048 sc1
    v_exp_f32 v168, v168
    v_exp_f32 v169, v169
    v_exp_f32 v170, v170
    v_exp_f32 v171, v171
    v_cvt_pk_bf16_f32 v198, v168, v169
    v_cvt_pk_bf16_f32 v199, v170, v171
    v_mfma_f32_32x32x16_bf16 v[228:243], a[104:107], v[204:207], v[228:243]
    v_exp_f32 v172, v172
    v_exp_f32 v173, v173
    v_exp_f32 v174, v174
    v_exp_f32 v175, v175
    v_cvt_pk_bf16_f32 v200, v172, v173
    v_cvt_pk_bf16_f32 v201, v174, v175
    v_mfma_f32_32x32x16_bf16 v[228:243], a[108:111], v[208:211], v[228:243]
    buffer_load_dwordx4 v[92:95], v22, s[12:15], s49 offen offset:3072 sc1
    v_exp_f32 v176, v176
    v_exp_f32 v177, v177
    v_exp_f32 v178, v178
    v_exp_f32 v179, v179
    v_cvt_pk_bf16_f32 v202, v176, v177
    v_cvt_pk_bf16_f32 v203, v178, v179
    v_mfma_f32_32x32x8_bf16 v[164:179], a[70:71], v[160:161], 0
    v_exp_f32 v180, v180
    v_exp_f32 v181, v181
    v_exp_f32 v182, v182
    v_exp_f32 v183, v183
    v_cvt_pk_bf16_f32 v204, v180, v181
    v_cvt_pk_bf16_f32 v205, v182, v183
    v_mfma_f32_32x32x16_bf16 v[164:179], a[12:15], v[140:143], v[164:179]
    s_add_u32 s49, s51, 24576
    buffer_load_dwordx4 v[96:99], v22, s[12:15], s49 offen offset:0 sc1
    v_exp_f32 v184, v184
    v_exp_f32 v185, v185
    v_exp_f32 v186, v186
    v_exp_f32 v187, v187
    v_cvt_pk_bf16_f32 v206, v184, v185
    v_cvt_pk_bf16_f32 v207, v186, v187
    v_mfma_f32_32x32x16_bf16 v[212:227], a[112:115], v[196:199], v[212:227]
    v_exp_f32 v188, v188
    v_exp_f32 v189, v189
    v_exp_f32 v190, v190
    v_exp_f32 v191, v191
    v_cvt_pk_bf16_f32 v208, v188, v189
    v_cvt_pk_bf16_f32 v209, v190, v191
    v_mfma_f32_32x32x16_bf16 v[212:227], a[116:119], v[200:203], v[212:227]
    v_exp_f32 v192, v192
    v_exp_f32 v193, v193
    v_exp_f32 v194, v194
    v_exp_f32 v195, v195
    v_cvt_pk_bf16_f32 v210, v192, v193
    v_cvt_pk_bf16_f32 v211, v194, v195
    s_add_u32 s51, s50, 26099712
    v_mfma_f32_32x32x8_bf16 v[180:195], a[70:71], v[162:163], 0
    v_exp_f32 v164, v164
    v_exp_f32 v165, v165
    v_exp_f32 v166, v166
    v_exp_f32 v167, v167
    v_cvt_pk_bf16_f32 v196, v164, v165
    v_cvt_pk_bf16_f32 v197, v166, v167
    v_mfma_f32_32x32x16_bf16 v[180:195], a[12:15], v[144:147], v[180:195]
    s_add_u32 s49, s51, 0
    buffer_load_dwordx4 a[0:3], v22, s[12:15], s49 offen offset:0 sc1
    v_exp_f32 v168, v168
    v_exp_f32 v169, v169
    v_exp_f32 v170, v170
    v_exp_f32 v171, v171
    v_cvt_pk_bf16_f32 v198, v168, v169
    v_cvt_pk_bf16_f32 v199, v170, v171
    v_mfma_f32_32x32x16_bf16 v[228:243], a[112:115], v[204:207], v[228:243]
    v_exp_f32 v172, v172
    v_exp_f32 v173, v173
    v_exp_f32 v174, v174
    v_exp_f32 v175, v175
    v_cvt_pk_bf16_f32 v200, v172, v173
    v_cvt_pk_bf16_f32 v201, v174, v175
    v_mfma_f32_32x32x16_bf16 v[228:243], a[116:119], v[208:211], v[228:243]
    s_mov_b64 exec, s[44:45]
    buffer_load_dword v0, v114, s[12:15], s62 offen sc1
    s_mov_b64 exec, -1
    v_exp_f32 v176, v176
    v_exp_f32 v177, v177
    v_exp_f32 v178, v178
    v_exp_f32 v179, v179
    v_cvt_pk_bf16_f32 v202, v176, v177
    v_cvt_pk_bf16_f32 v203, v178, v179
    v_mfma_f32_32x32x8_bf16 v[164:179], a[72:73], v[160:161], 0
    v_exp_f32 v180, v180
    v_exp_f32 v181, v181
    v_exp_f32 v182, v182
    v_exp_f32 v183, v183
    v_cvt_pk_bf16_f32 v204, v180, v181
    v_cvt_pk_bf16_f32 v205, v182, v183
    v_mfma_f32_32x32x16_bf16 v[164:179], a[16:19], v[140:143], v[164:179]
    buffer_load_dwordx4 a[96:99], v22, s[12:15], s49 offen offset:1024 sc1
    v_exp_f32 v184, v184
    v_exp_f32 v185, v185
    v_exp_f32 v186, v186
    v_exp_f32 v187, v187
    v_cvt_pk_bf16_f32 v206, v184, v185
    v_cvt_pk_bf16_f32 v207, v186, v187
    v_mfma_f32_32x32x16_bf16 v[212:227], a[120:123], v[196:199], v[212:227]
    v_exp_f32 v188, v188
    v_exp_f32 v189, v189
    v_exp_f32 v190, v190
    v_exp_f32 v191, v191
    v_cvt_pk_bf16_f32 v208, v188, v189
    v_cvt_pk_bf16_f32 v209, v190, v191
    v_mfma_f32_32x32x16_bf16 v[212:227], a[124:127], v[200:203], v[212:227]
    v_exp_f32 v192, v192
    v_exp_f32 v193, v193
    v_exp_f32 v194, v194
    v_exp_f32 v195, v195
    v_cvt_pk_bf16_f32 v210, v192, v193
    v_cvt_pk_bf16_f32 v211, v194, v195
    v_mfma_f32_32x32x8_bf16 v[180:195], a[72:73], v[162:163], 0
    v_exp_f32 v164, v164
    v_exp_f32 v165, v165
    v_exp_f32 v166, v166
    v_exp_f32 v167, v167
    v_cvt_pk_bf16_f32 v196, v164, v165
    v_cvt_pk_bf16_f32 v197, v166, v167
    v_mfma_f32_32x32x16_bf16 v[180:195], a[16:19], v[144:147], v[180:195]
    buffer_load_dwordx4 a[100:103], v22, s[12:15], s49 offen offset:2048 sc1
    v_exp_f32 v168, v168
    v_exp_f32 v169, v169
    v_exp_f32 v170, v170
    v_exp_f32 v171, v171
    v_cvt_pk_bf16_f32 v198, v168, v169
    v_cvt_pk_bf16_f32 v199, v170, v171
    v_mfma_f32_32x32x16_bf16 v[228:243], a[120:123], v[204:207], v[228:243]
    v_exp_f32 v172, v172
    v_exp_f32 v173, v173
    v_exp_f32 v174, v174
    v_exp_f32 v175, v175
    v_cvt_pk_bf16_f32 v200, v172, v173
    v_cvt_pk_bf16_f32 v201, v174, v175
    v_mfma_f32_32x32x16_bf16 v[228:243], a[124:127], v[208:211], v[228:243]
    v_exp_f32 v176, v176
    v_exp_f32 v177, v177
    v_exp_f32 v178, v178
    v_exp_f32 v179, v179
    v_cvt_pk_bf16_f32 v202, v176, v177
    v_cvt_pk_bf16_f32 v203, v178, v179
    v_mfma_f32_32x32x8_bf16 v[164:179], a[74:75], v[160:161], 0
    v_exp_f32 v180, v180
    v_exp_f32 v181, v181
    v_exp_f32 v182, v182
    v_exp_f32 v183, v183
    v_cvt_pk_bf16_f32 v204, v180, v181
    v_cvt_pk_bf16_f32 v205, v182, v183
    v_mfma_f32_32x32x16_bf16 v[164:179], a[20:23], v[140:143], v[164:179]
    buffer_load_dwordx4 a[4:7], v22, s[12:15], s49 offen offset:3072 sc1
    v_exp_f32 v184, v184
    v_exp_f32 v185, v185
    v_exp_f32 v186, v186
    v_exp_f32 v187, v187
    v_cvt_pk_bf16_f32 v206, v184, v185
    v_cvt_pk_bf16_f32 v207, v186, v187
    v_mfma_f32_32x32x16_bf16 v[212:227], a[128:131], v[196:199], v[212:227]
    v_exp_f32 v188, v188
    v_exp_f32 v189, v189
    v_exp_f32 v190, v190
    v_exp_f32 v191, v191
    v_cvt_pk_bf16_f32 v208, v188, v189
    v_cvt_pk_bf16_f32 v209, v190, v191
    v_mfma_f32_32x32x16_bf16 v[212:227], a[132:135], v[200:203], v[212:227]
    v_exp_f32 v192, v192
    v_exp_f32 v193, v193
    v_exp_f32 v194, v194
    v_exp_f32 v195, v195
    v_cvt_pk_bf16_f32 v210, v192, v193
    v_cvt_pk_bf16_f32 v211, v194, v195
    v_mfma_f32_32x32x8_bf16 v[180:195], a[74:75], v[162:163], 0
    v_exp_f32 v164, v164
    v_exp_f32 v165, v165
    v_exp_f32 v166, v166
    v_exp_f32 v167, v167
    v_cvt_pk_bf16_f32 v196, v164, v165
    v_cvt_pk_bf16_f32 v197, v166, v167
    v_mfma_f32_32x32x16_bf16 v[180:195], a[20:23], v[144:147], v[180:195]
    s_add_u32 s49, s51, 4096
    buffer_load_dwordx4 a[104:107], v22, s[12:15], s49 offen offset:0 sc1
    v_exp_f32 v168, v168
    v_exp_f32 v169, v169
    v_exp_f32 v170, v170
    v_exp_f32 v171, v171
    v_cvt_pk_bf16_f32 v198, v168, v169
    v_cvt_pk_bf16_f32 v199, v170, v171
    v_mfma_f32_32x32x16_bf16 v[228:243], a[128:131], v[204:207], v[228:243]
    v_exp_f32 v172, v172
    v_exp_f32 v173, v173
    v_exp_f32 v174, v174
    v_exp_f32 v175, v175
    v_cvt_pk_bf16_f32 v200, v172, v173
    v_cvt_pk_bf16_f32 v201, v174, v175
    v_mfma_f32_32x32x16_bf16 v[228:243], a[132:135], v[208:211], v[228:243]
    v_exp_f32 v176, v176
    v_exp_f32 v177, v177
    v_exp_f32 v178, v178
    v_exp_f32 v179, v179
    v_cvt_pk_bf16_f32 v202, v176, v177
    v_cvt_pk_bf16_f32 v203, v178, v179
    v_mfma_f32_32x32x8_bf16 v[164:179], a[76:77], v[160:161], 0
    v_exp_f32 v180, v180
    v_exp_f32 v181, v181
    v_exp_f32 v182, v182
    v_exp_f32 v183, v183
    v_cvt_pk_bf16_f32 v204, v180, v181
    v_cvt_pk_bf16_f32 v205, v182, v183
    v_mfma_f32_32x32x16_bf16 v[164:179], a[24:27], v[140:143], v[164:179]
    buffer_load_dwordx4 a[108:111], v22, s[12:15], s49 offen offset:1024 sc1
    v_exp_f32 v184, v184
    v_exp_f32 v185, v185
    v_exp_f32 v186, v186
    v_exp_f32 v187, v187
    v_cvt_pk_bf16_f32 v206, v184, v185
    v_cvt_pk_bf16_f32 v207, v186, v187
    v_mfma_f32_32x32x16_bf16 v[212:227], a[136:139], v[196:199], v[212:227]
    v_exp_f32 v188, v188
    v_exp_f32 v189, v189
    v_exp_f32 v190, v190
    v_exp_f32 v191, v191
    v_cvt_pk_bf16_f32 v208, v188, v189
    v_cvt_pk_bf16_f32 v209, v190, v191
    v_mfma_f32_32x32x16_bf16 v[212:227], a[140:143], v[200:203], v[212:227]
    v_exp_f32 v192, v192
    v_exp_f32 v193, v193
    v_exp_f32 v194, v194
    v_exp_f32 v195, v195
    v_cvt_pk_bf16_f32 v210, v192, v193
    v_cvt_pk_bf16_f32 v211, v194, v195
    v_mfma_f32_32x32x8_bf16 v[180:195], a[76:77], v[162:163], 0
    v_exp_f32 v164, v164
    v_exp_f32 v165, v165
    v_exp_f32 v166, v166
    v_exp_f32 v167, v167
    v_cvt_pk_bf16_f32 v196, v164, v165
    v_cvt_pk_bf16_f32 v197, v166, v167
    v_mfma_f32_32x32x16_bf16 v[180:195], a[24:27], v[144:147], v[180:195]
    buffer_load_dwordx4 a[8:11], v22, s[12:15], s49 offen offset:2048 sc1
    v_exp_f32 v168, v168
    v_exp_f32 v169, v169
    v_exp_f32 v170, v170
    v_exp_f32 v171, v171
    v_cvt_pk_bf16_f32 v198, v168, v169
    v_cvt_pk_bf16_f32 v199, v170, v171
    v_mfma_f32_32x32x16_bf16 v[228:243], a[136:139], v[204:207], v[228:243]
    v_exp_f32 v172, v172
    v_exp_f32 v173, v173
    v_exp_f32 v174, v174
    v_exp_f32 v175, v175
    v_cvt_pk_bf16_f32 v200, v172, v173
    v_cvt_pk_bf16_f32 v201, v174, v175
    v_mfma_f32_32x32x16_bf16 v[228:243], a[140:143], v[208:211], v[228:243]
    s_mov_b64 exec, s[30:31]
    buffer_load_dword v0, v114, s[12:15], s62 offen sc1
    s_mov_b64 exec, -1
    v_exp_f32 v176, v176
    v_exp_f32 v177, v177
    v_exp_f32 v178, v178
    v_exp_f32 v179, v179
    v_cvt_pk_bf16_f32 v202, v176, v177
    v_cvt_pk_bf16_f32 v203, v178, v179
    v_mfma_f32_32x32x8_bf16 v[164:179], a[78:79], v[160:161], 0
    v_exp_f32 v180, v180
    v_exp_f32 v181, v181
    v_exp_f32 v182, v182
    v_exp_f32 v183, v183
    v_cvt_pk_bf16_f32 v204, v180, v181
    v_cvt_pk_bf16_f32 v205, v182, v183
    v_mfma_f32_32x32x16_bf16 v[164:179], a[28:31], v[140:143], v[164:179]
    buffer_load_dwordx4 a[112:115], v22, s[12:15], s49 offen offset:3072 sc1
    v_exp_f32 v184, v184
    v_exp_f32 v185, v185
    v_exp_f32 v186, v186
    v_exp_f32 v187, v187
    v_cvt_pk_bf16_f32 v206, v184, v185
    v_cvt_pk_bf16_f32 v207, v186, v187
    v_mfma_f32_32x32x16_bf16 v[212:227], a[144:147], v[196:199], v[212:227]
    v_exp_f32 v188, v188
    v_exp_f32 v189, v189
    v_exp_f32 v190, v190
    v_exp_f32 v191, v191
    v_cvt_pk_bf16_f32 v208, v188, v189
    v_cvt_pk_bf16_f32 v209, v190, v191
    v_mfma_f32_32x32x16_bf16 v[212:227], a[148:151], v[200:203], v[212:227]
    v_exp_f32 v192, v192
    v_exp_f32 v193, v193
    v_exp_f32 v194, v194
    v_exp_f32 v195, v195
    v_cvt_pk_bf16_f32 v210, v192, v193
    v_cvt_pk_bf16_f32 v211, v194, v195
    v_mfma_f32_32x32x8_bf16 v[180:195], a[78:79], v[162:163], 0
    v_exp_f32 v164, v164
    v_exp_f32 v165, v165
    v_exp_f32 v166, v166
    v_exp_f32 v167, v167
    v_cvt_pk_bf16_f32 v196, v164, v165
    v_cvt_pk_bf16_f32 v197, v166, v167
    v_mfma_f32_32x32x16_bf16 v[180:195], a[28:31], v[144:147], v[180:195]
    s_add_u32 s49, s51, 8192
    buffer_load_dwordx4 a[116:119], v22, s[12:15], s49 offen offset:0 sc1
    v_exp_f32 v168, v168
    v_exp_f32 v169, v169
    v_exp_f32 v170, v170
    v_exp_f32 v171, v171
    v_cvt_pk_bf16_f32 v198, v168, v169
    v_cvt_pk_bf16_f32 v199, v170, v171
    v_mfma_f32_32x32x16_bf16 v[228:243], a[144:147], v[204:207], v[228:243]
    v_exp_f32 v172, v172
    v_exp_f32 v173, v173
    v_exp_f32 v174, v174
    v_exp_f32 v175, v175
    v_cvt_pk_bf16_f32 v200, v172, v173
    v_cvt_pk_bf16_f32 v201, v174, v175
    v_mfma_f32_32x32x16_bf16 v[228:243], a[148:151], v[208:211], v[228:243]
    v_exp_f32 v176, v176
    v_exp_f32 v177, v177
    v_exp_f32 v178, v178
    v_exp_f32 v179, v179
    v_cvt_pk_bf16_f32 v202, v176, v177
    v_cvt_pk_bf16_f32 v203, v178, v179
    v_mfma_f32_32x32x8_bf16 v[164:179], a[80:81], v[160:161], 0
    v_exp_f32 v180, v180
    v_exp_f32 v181, v181
    v_exp_f32 v182, v182
    v_exp_f32 v183, v183
    v_cvt_pk_bf16_f32 v204, v180, v181
    v_cvt_pk_bf16_f32 v205, v182, v183
    v_mfma_f32_32x32x16_bf16 v[164:179], a[32:35], v[140:143], v[164:179]
    buffer_load_dwordx4 a[12:15], v22, s[12:15], s49 offen offset:1024 sc1
    v_exp_f32 v184, v184
    v_exp_f32 v185, v185
    v_exp_f32 v186, v186
    v_exp_f32 v187, v187
    v_cvt_pk_bf16_f32 v206, v184, v185
    v_cvt_pk_bf16_f32 v207, v186, v187
    v_mfma_f32_32x32x16_bf16 v[212:227], a[152:155], v[196:199], v[212:227]
    v_exp_f32 v188, v188
    v_exp_f32 v189, v189
    v_exp_f32 v190, v190
    v_exp_f32 v191, v191
    v_cvt_pk_bf16_f32 v208, v188, v189
    v_cvt_pk_bf16_f32 v209, v190, v191
    v_mfma_f32_32x32x16_bf16 v[212:227], a[156:159], v[200:203], v[212:227]
    v_exp_f32 v192, v192
    v_exp_f32 v193, v193
    v_exp_f32 v194, v194
    v_exp_f32 v195, v195
    v_cvt_pk_bf16_f32 v210, v192, v193
    v_cvt_pk_bf16_f32 v211, v194, v195
    v_mfma_f32_32x32x8_bf16 v[180:195], a[80:81], v[162:163], 0
    v_exp_f32 v164, v164
    v_exp_f32 v165, v165
    v_exp_f32 v166, v166
    v_exp_f32 v167, v167
    v_cvt_pk_bf16_f32 v196, v164, v165
    v_cvt_pk_bf16_f32 v197, v166, v167
    v_mfma_f32_32x32x16_bf16 v[180:195], a[32:35], v[144:147], v[180:195]
    buffer_load_dwordx4 a[120:123], v22, s[12:15], s49 offen offset:2048 sc1
    v_exp_f32 v168, v168
    v_exp_f32 v169, v169
    v_exp_f32 v170, v170
    v_exp_f32 v171, v171
    v_cvt_pk_bf16_f32 v198, v168, v169
    v_cvt_pk_bf16_f32 v199, v170, v171
    v_mfma_f32_32x32x16_bf16 v[228:243], a[152:155], v[204:207], v[228:243]
    v_exp_f32 v172, v172
    v_exp_f32 v173, v173
    v_exp_f32 v174, v174
    v_exp_f32 v175, v175
    v_cvt_pk_bf16_f32 v200, v172, v173
    v_cvt_pk_bf16_f32 v201, v174, v175
    v_mfma_f32_32x32x16_bf16 v[228:243], a[156:159], v[208:211], v[228:243]
    v_exp_f32 v176, v176
    v_exp_f32 v177, v177
    v_exp_f32 v178, v178
    v_exp_f32 v179, v179
    v_cvt_pk_bf16_f32 v202, v176, v177
    v_cvt_pk_bf16_f32 v203, v178, v179
    v_mfma_f32_32x32x8_bf16 v[164:179], a[82:83], v[160:161], 0
    v_exp_f32 v180, v180
    v_exp_f32 v181, v181
    v_exp_f32 v182, v182
    v_exp_f32 v183, v183
    v_cvt_pk_bf16_f32 v204, v180, v181
    v_cvt_pk_bf16_f32 v205, v182, v183
    v_mfma_f32_32x32x16_bf16 v[164:179], a[36:39], v[140:143], v[164:179]
    buffer_load_dwordx4 a[124:127], v22, s[12:15], s49 offen offset:3072 sc1
    v_exp_f32 v184, v184
    v_exp_f32 v185, v185
    v_exp_f32 v186, v186
    v_exp_f32 v187, v187
    v_cvt_pk_bf16_f32 v206, v184, v185
    v_cvt_pk_bf16_f32 v207, v186, v187
    v_mfma_f32_32x32x16_bf16 v[212:227], a[160:163], v[196:199], v[212:227]
    v_exp_f32 v188, v188
    v_exp_f32 v189, v189
    v_exp_f32 v190, v190
    v_exp_f32 v191, v191
    v_cvt_pk_bf16_f32 v208, v188, v189
    v_cvt_pk_bf16_f32 v209, v190, v191
    v_mfma_f32_32x32x16_bf16 v[212:227], a[164:167], v[200:203], v[212:227]
    v_exp_f32 v192, v192
    v_exp_f32 v193, v193
    v_exp_f32 v194, v194
    v_exp_f32 v195, v195
    v_cvt_pk_bf16_f32 v210, v192, v193
    v_cvt_pk_bf16_f32 v211, v194, v195
    v_mfma_f32_32x32x8_bf16 v[180:195], a[82:83], v[162:163], 0
    v_exp_f32 v164, v164
    v_exp_f32 v165, v165
    v_exp_f32 v166, v166
    v_exp_f32 v167, v167
    v_cvt_pk_bf16_f32 v196, v164, v165
    v_cvt_pk_bf16_f32 v197, v166, v167
    v_mfma_f32_32x32x16_bf16 v[180:195], a[36:39], v[144:147], v[180:195]
    s_add_u32 s49, s51, 12288
    buffer_load_dwordx4 a[16:19], v22, s[12:15], s49 offen offset:0 sc1
    v_exp_f32 v168, v168
    v_exp_f32 v169, v169
    v_exp_f32 v170, v170
    v_exp_f32 v171, v171
    v_cvt_pk_bf16_f32 v198, v168, v169
    v_cvt_pk_bf16_f32 v199, v170, v171
    v_mfma_f32_32x32x16_bf16 v[228:243], a[160:163], v[204:207], v[228:243]
    v_exp_f32 v172, v172
    v_exp_f32 v173, v173
    v_exp_f32 v174, v174
    v_exp_f32 v175, v175
    v_cvt_pk_bf16_f32 v200, v172, v173
    v_cvt_pk_bf16_f32 v201, v174, v175
    v_mfma_f32_32x32x16_bf16 v[228:243], a[164:167], v[208:211], v[228:243]
    s_mov_b64 exec, s[44:45]
    buffer_load_dword v0, v115, s[12:15], s23 offen sc1
    s_mov_b64 exec, -1
    v_exp_f32 v176, v176
    v_exp_f32 v177, v177
    v_exp_f32 v178, v178
    v_exp_f32 v179, v179
    v_cvt_pk_bf16_f32 v202, v176, v177
    v_cvt_pk_bf16_f32 v203, v178, v179
    v_mfma_f32_32x32x8_bf16 v[164:179], a[84:85], v[160:161], 0
    v_exp_f32 v180, v180
    v_exp_f32 v181, v181
    v_exp_f32 v182, v182
    v_exp_f32 v183, v183
    v_cvt_pk_bf16_f32 v204, v180, v181
    v_cvt_pk_bf16_f32 v205, v182, v183
    v_mfma_f32_32x32x16_bf16 v[164:179], a[40:43], v[140:143], v[164:179]
    buffer_load_dwordx4 a[128:131], v22, s[12:15], s49 offen offset:1024 sc1
    v_exp_f32 v184, v184
    v_exp_f32 v185, v185
    v_exp_f32 v186, v186
    v_exp_f32 v187, v187
    v_cvt_pk_bf16_f32 v206, v184, v185
    v_cvt_pk_bf16_f32 v207, v186, v187
    v_mfma_f32_32x32x16_bf16 v[212:227], a[168:171], v[196:199], v[212:227]
    v_exp_f32 v188, v188
    v_exp_f32 v189, v189
    v_exp_f32 v190, v190
    v_exp_f32 v191, v191
    v_cvt_pk_bf16_f32 v208, v188, v189
    v_cvt_pk_bf16_f32 v209, v190, v191
    v_mfma_f32_32x32x16_bf16 v[212:227], a[172:175], v[200:203], v[212:227]
    v_exp_f32 v192, v192
    v_exp_f32 v193, v193
    v_exp_f32 v194, v194
    v_exp_f32 v195, v195
    v_cvt_pk_bf16_f32 v210, v192, v193
    v_cvt_pk_bf16_f32 v211, v194, v195
    v_mfma_f32_32x32x8_bf16 v[180:195], a[84:85], v[162:163], 0
    v_exp_f32 v164, v164
    v_exp_f32 v165, v165
    v_exp_f32 v166, v166
    v_exp_f32 v167, v167
    v_cvt_pk_bf16_f32 v196, v164, v165
    v_cvt_pk_bf16_f32 v197, v166, v167
    v_mfma_f32_32x32x16_bf16 v[180:195], a[40:43], v[144:147], v[180:195]
    buffer_load_dwordx4 a[132:135], v22, s[12:15], s49 offen offset:2048 sc1
    v_exp_f32 v168, v168
    v_exp_f32 v169, v169
    v_exp_f32 v170, v170
    v_exp_f32 v171, v171
    v_cvt_pk_bf16_f32 v198, v168, v169
    v_cvt_pk_bf16_f32 v199, v170, v171
    v_mfma_f32_32x32x16_bf16 v[228:243], a[168:171], v[204:207], v[228:243]
    v_exp_f32 v172, v172
    v_exp_f32 v173, v173
    v_exp_f32 v174, v174
    v_exp_f32 v175, v175
    v_cvt_pk_bf16_f32 v200, v172, v173
    v_cvt_pk_bf16_f32 v201, v174, v175
    v_mfma_f32_32x32x16_bf16 v[228:243], a[172:175], v[208:211], v[228:243]
    v_exp_f32 v176, v176
    v_exp_f32 v177, v177
    v_exp_f32 v178, v178
    v_exp_f32 v179, v179
    v_cvt_pk_bf16_f32 v202, v176, v177
    v_cvt_pk_bf16_f32 v203, v178, v179
    v_mfma_f32_32x32x8_bf16 v[164:179], a[86:87], v[160:161], 0
    v_exp_f32 v180, v180
    v_exp_f32 v181, v181
    v_exp_f32 v182, v182
    v_exp_f32 v183, v183
    v_cvt_pk_bf16_f32 v204, v180, v181
    v_cvt_pk_bf16_f32 v205, v182, v183
    v_mfma_f32_32x32x16_bf16 v[164:179], a[44:47], v[140:143], v[164:179]
    buffer_load_dwordx4 a[20:23], v22, s[12:15], s49 offen offset:3072 sc1
    v_exp_f32 v184, v184
    v_exp_f32 v185, v185
    v_exp_f32 v186, v186
    v_exp_f32 v187, v187
    v_cvt_pk_bf16_f32 v206, v184, v185
    v_cvt_pk_bf16_f32 v207, v186, v187
    v_mfma_f32_32x32x16_bf16 v[212:227], a[176:179], v[196:199], v[212:227]
    v_exp_f32 v188, v188
    v_exp_f32 v189, v189
    v_exp_f32 v190, v190
    v_exp_f32 v191, v191
    v_cvt_pk_bf16_f32 v208, v188, v189
    v_cvt_pk_bf16_f32 v209, v190, v191
    v_mfma_f32_32x32x16_bf16 v[212:227], a[180:183], v[200:203], v[212:227]
    v_exp_f32 v192, v192
    v_exp_f32 v193, v193
    v_exp_f32 v194, v194
    v_exp_f32 v195, v195
    v_cvt_pk_bf16_f32 v210, v192, v193
    v_cvt_pk_bf16_f32 v211, v194, v195
    v_mfma_f32_32x32x8_bf16 v[180:195], a[86:87], v[162:163], 0
    v_exp_f32 v164, v164
    v_exp_f32 v165, v165
    v_exp_f32 v166, v166
    v_exp_f32 v167, v167
    v_cvt_pk_bf16_f32 v196, v164, v165
    v_cvt_pk_bf16_f32 v197, v166, v167
    v_mfma_f32_32x32x16_bf16 v[180:195], a[44:47], v[144:147], v[180:195]
    s_add_u32 s49, s51, 16384
    buffer_load_dwordx4 a[136:139], v22, s[12:15], s49 offen offset:0 sc1
    v_exp_f32 v168, v168
    v_exp_f32 v169, v169
    v_exp_f32 v170, v170
    v_exp_f32 v171, v171
    v_cvt_pk_bf16_f32 v198, v168, v169
    v_cvt_pk_bf16_f32 v199, v170, v171
    v_mfma_f32_32x32x16_bf16 v[228:243], a[176:179], v[204:207], v[228:243]
    v_exp_f32 v172, v172
    v_exp_f32 v173, v173
    v_exp_f32 v174, v174
    v_exp_f32 v175, v175
    v_cvt_pk_bf16_f32 v200, v172, v173
    v_cvt_pk_bf16_f32 v201, v174, v175
    v_mfma_f32_32x32x16_bf16 v[228:243], a[180:183], v[208:211], v[228:243]
    v_exp_f32 v176, v176
    v_exp_f32 v177, v177
    v_exp_f32 v178, v178
    v_exp_f32 v179, v179
    v_cvt_pk_bf16_f32 v202, v176, v177
    v_cvt_pk_bf16_f32 v203, v178, v179
    v_mfma_f32_32x32x8_bf16 v[164:179], a[88:89], v[160:161], 0
    v_exp_f32 v180, v180
    v_exp_f32 v181, v181
    v_exp_f32 v182, v182
    v_exp_f32 v183, v183
    v_cvt_pk_bf16_f32 v204, v180, v181
    v_cvt_pk_bf16_f32 v205, v182, v183
    v_mfma_f32_32x32x16_bf16 v[164:179], a[48:51], v[140:143], v[164:179]
    buffer_load_dwordx4 a[140:143], v22, s[12:15], s49 offen offset:1024 sc1
    v_exp_f32 v184, v184
    v_exp_f32 v185, v185
    v_exp_f32 v186, v186
    v_exp_f32 v187, v187
    v_cvt_pk_bf16_f32 v206, v184, v185
    v_cvt_pk_bf16_f32 v207, v186, v187
    v_mfma_f32_32x32x16_bf16 v[212:227], a[184:187], v[196:199], v[212:227]
    v_exp_f32 v188, v188
    v_exp_f32 v189, v189
    v_exp_f32 v190, v190
    v_exp_f32 v191, v191
    v_cvt_pk_bf16_f32 v208, v188, v189
    v_cvt_pk_bf16_f32 v209, v190, v191
    v_mfma_f32_32x32x16_bf16 v[212:227], a[188:191], v[200:203], v[212:227]
    v_exp_f32 v192, v192
    v_exp_f32 v193, v193
    v_exp_f32 v194, v194
    v_exp_f32 v195, v195
    v_cvt_pk_bf16_f32 v210, v192, v193
    v_cvt_pk_bf16_f32 v211, v194, v195
    v_mfma_f32_32x32x8_bf16 v[180:195], a[88:89], v[162:163], 0
    v_exp_f32 v164, v164
    v_exp_f32 v165, v165
    v_exp_f32 v166, v166
    v_exp_f32 v167, v167
    v_cvt_pk_bf16_f32 v196, v164, v165
    v_cvt_pk_bf16_f32 v197, v166, v167
    v_mfma_f32_32x32x16_bf16 v[180:195], a[48:51], v[144:147], v[180:195]
    buffer_load_dwordx4 a[24:27], v22, s[12:15], s49 offen offset:2048 sc1
    v_exp_f32 v168, v168
    v_exp_f32 v169, v169
    v_exp_f32 v170, v170
    v_exp_f32 v171, v171
    v_cvt_pk_bf16_f32 v198, v168, v169
    v_cvt_pk_bf16_f32 v199, v170, v171
    v_mfma_f32_32x32x16_bf16 v[228:243], a[184:187], v[204:207], v[228:243]
    v_exp_f32 v172, v172
    v_exp_f32 v173, v173
    v_exp_f32 v174, v174
    v_exp_f32 v175, v175
    v_cvt_pk_bf16_f32 v200, v172, v173
    v_cvt_pk_bf16_f32 v201, v174, v175
    v_mfma_f32_32x32x16_bf16 v[228:243], a[188:191], v[208:211], v[228:243]
    s_mov_b64 exec, s[30:31]
    buffer_load_dword v0, v115, s[12:15], s23 offen sc1
    s_mov_b64 exec, -1
    v_exp_f32 v176, v176
    v_exp_f32 v177, v177
    v_exp_f32 v178, v178
    v_exp_f32 v179, v179
    v_cvt_pk_bf16_f32 v202, v176, v177
    v_cvt_pk_bf16_f32 v203, v178, v179
    v_mfma_f32_32x32x8_bf16 v[164:179], a[90:91], v[160:161], 0
    v_exp_f32 v180, v180
    v_exp_f32 v181, v181
    v_exp_f32 v182, v182
    v_exp_f32 v183, v183
    v_cvt_pk_bf16_f32 v204, v180, v181
    v_cvt_pk_bf16_f32 v205, v182, v183
    v_mfma_f32_32x32x16_bf16 v[164:179], a[52:55], v[140:143], v[164:179]
    buffer_load_dwordx4 a[144:147], v22, s[12:15], s49 offen offset:3072 sc1
    v_exp_f32 v184, v184
    v_exp_f32 v185, v185
    v_exp_f32 v186, v186
    v_exp_f32 v187, v187
    v_cvt_pk_bf16_f32 v206, v184, v185
    v_cvt_pk_bf16_f32 v207, v186, v187
    v_mfma_f32_32x32x16_bf16 v[212:227], a[192:195], v[196:199], v[212:227]
    v_exp_f32 v188, v188
    v_exp_f32 v189, v189
    v_exp_f32 v190, v190
    v_exp_f32 v191, v191
    v_cvt_pk_bf16_f32 v208, v188, v189
    v_cvt_pk_bf16_f32 v209, v190, v191
    v_mfma_f32_32x32x16_bf16 v[212:227], a[196:199], v[200:203], v[212:227]
    v_exp_f32 v192, v192
    v_exp_f32 v193, v193
    v_exp_f32 v194, v194
    v_exp_f32 v195, v195
    v_cvt_pk_bf16_f32 v210, v192, v193
    v_cvt_pk_bf16_f32 v211, v194, v195
    v_mfma_f32_32x32x8_bf16 v[180:195], a[90:91], v[162:163], 0
    v_exp_f32 v164, v164
    v_exp_f32 v165, v165
    v_exp_f32 v166, v166
    v_exp_f32 v167, v167
    v_cvt_pk_bf16_f32 v196, v164, v165
    v_cvt_pk_bf16_f32 v197, v166, v167
    v_mfma_f32_32x32x16_bf16 v[180:195], a[52:55], v[144:147], v[180:195]
    s_add_u32 s49, s51, 20480
    buffer_load_dwordx4 a[148:151], v22, s[12:15], s49 offen offset:0 sc1
    v_exp_f32 v168, v168
    v_exp_f32 v169, v169
    v_exp_f32 v170, v170
    v_exp_f32 v171, v171
    v_cvt_pk_bf16_f32 v198, v168, v169
    v_cvt_pk_bf16_f32 v199, v170, v171
    v_mfma_f32_32x32x16_bf16 v[228:243], a[192:195], v[204:207], v[228:243]
    v_exp_f32 v172, v172
    v_exp_f32 v173, v173
    v_exp_f32 v174, v174
    v_exp_f32 v175, v175
    v_cvt_pk_bf16_f32 v200, v172, v173
    v_cvt_pk_bf16_f32 v201, v174, v175
    v_mfma_f32_32x32x16_bf16 v[228:243], a[196:199], v[208:211], v[228:243]
    s_getpc_b64 s[58:59]
L_pc_11:
    v_min_u32 v31, L_end-L_pc_11-4, v30
    s_mov_b64 exec, 3
    global_load_dword v0, v31, s[58:59]
    s_mov_b64 exec, -1
    v_exp_f32 v176, v176
    v_exp_f32 v177, v177
    v_exp_f32 v178, v178
    v_exp_f32 v179, v179
    v_cvt_pk_bf16_f32 v202, v176, v177
    v_cvt_pk_bf16_f32 v203, v178, v179
    v_mfma_f32_32x32x8_bf16 v[164:179], a[92:93], v[160:161], 0
    v_exp_f32 v180, v180
    v_exp_f32 v181, v181
    v_exp_f32 v182, v182
    v_exp_f32 v183, v183
    v_cvt_pk_bf16_f32 v204, v180, v181
    v_cvt_pk_bf16_f32 v205, v182, v183
    v_mfma_f32_32x32x16_bf16 v[164:179], a[56:59], v[140:143], v[164:179]
    buffer_load_dwordx4 a[28:31], v22, s[12:15], s49 offen offset:1024 sc1
    v_exp_f32 v184, v184
    v_exp_f32 v185, v185
    v_exp_f32 v186, v186
    v_exp_f32 v187, v187
    v_cvt_pk_bf16_f32 v206, v184, v185
    v_cvt_pk_bf16_f32 v207, v186, v187
    v_mfma_f32_32x32x16_bf16 v[212:227], a[200:203], v[196:199], v[212:227]
    v_exp_f32 v188, v188
    v_exp_f32 v189, v189
    v_exp_f32 v190, v190
    v_exp_f32 v191, v191
    v_cvt_pk_bf16_f32 v208, v188, v189
    v_cvt_pk_bf16_f32 v209, v190, v191
    v_mfma_f32_32x32x16_bf16 v[212:227], a[204:207], v[200:203], v[212:227]
    v_exp_f32 v192, v192
    v_exp_f32 v193, v193
    v_exp_f32 v194, v194
    v_exp_f32 v195, v195
    v_cvt_pk_bf16_f32 v210, v192, v193
    v_cvt_pk_bf16_f32 v211, v194, v195
    v_mfma_f32_32x32x8_bf16 v[180:195], a[92:93], v[162:163], 0
    v_exp_f32 v164, v164
    v_exp_f32 v165, v165
    v_exp_f32 v166, v166
    v_exp_f32 v167, v167
    v_cvt_pk_bf16_f32 v196, v164, v165
    v_cvt_pk_bf16_f32 v197, v166, v167
    v_mfma_f32_32x32x16_bf16 v[180:195], a[56:59], v[144:147], v[180:195]
    buffer_load_dwordx4 a[152:155], v22, s[12:15], s49 offen offset:2048 sc1
    v_exp_f32 v168, v168
    v_exp_f32 v169, v169
    v_exp_f32 v170, v170
    v_exp_f32 v171, v171
    v_cvt_pk_bf16_f32 v198, v168, v169
    v_cvt_pk_bf16_f32 v199, v170, v171
    v_mfma_f32_32x32x16_bf16 v[228:243], a[200:203], v[204:207], v[228:243]
    v_exp_f32 v172, v172
    v_exp_f32 v173, v173
    v_exp_f32 v174, v174
    v_exp_f32 v175, v175
    v_cvt_pk_bf16_f32 v200, v172, v173
    v_cvt_pk_bf16_f32 v201, v174, v175
    v_mfma_f32_32x32x16_bf16 v[228:243], a[204:207], v[208:211], v[228:243]
    v_exp_f32 v176, v176
    v_exp_f32 v177, v177
    v_exp_f32 v178, v178
    v_exp_f32 v179, v179
    v_cvt_pk_bf16_f32 v202, v176, v177
    v_cvt_pk_bf16_f32 v203, v178, v179
    v_mfma_f32_32x32x8_bf16 v[164:179], a[94:95], v[160:161], 0
    v_exp_f32 v180, v180
    v_exp_f32 v181, v181
    v_exp_f32 v182, v182
    v_exp_f32 v183, v183
    v_cvt_pk_bf16_f32 v204, v180, v181
    v_cvt_pk_bf16_f32 v205, v182, v183
    v_mfma_f32_32x32x16_bf16 v[164:179], a[60:63], v[140:143], v[164:179]
    buffer_load_dwordx4 a[156:159], v22, s[12:15], s49 offen offset:3072 sc1
    v_exp_f32 v184, v184
    v_exp_f32 v185, v185
    v_exp_f32 v186, v186
    v_exp_f32 v187, v187
    v_cvt_pk_bf16_f32 v206, v184, v185
    v_cvt_pk_bf16_f32 v207, v186, v187
    v_mfma_f32_32x32x16_bf16 v[212:227], a[208:211], v[196:199], v[212:227]
    v_exp_f32 v188, v188
    v_exp_f32 v189, v189
    v_exp_f32 v190, v190
    v_exp_f32 v191, v191
    v_cvt_pk_bf16_f32 v208, v188, v189
    v_cvt_pk_bf16_f32 v209, v190, v191
    v_mfma_f32_32x32x16_bf16 v[212:227], a[212:215], v[200:203], v[212:227]
    v_exp_f32 v192, v192
    v_exp_f32 v193, v193
    v_exp_f32 v194, v194
    v_exp_f32 v195, v195
    v_cvt_pk_bf16_f32 v210, v192, v193
    v_cvt_pk_bf16_f32 v211, v194, v195
    v_mfma_f32_32x32x8_bf16 v[180:195], a[94:95], v[162:163], 0
    v_exp_f32 v164, v164
    v_exp_f32 v165, v165
    v_exp_f32 v166, v166
    v_exp_f32 v167, v167
    v_cvt_pk_bf16_f32 v196, v164, v165
    v_cvt_pk_bf16_f32 v197, v166, v167
    v_mfma_f32_32x32x16_bf16 v[180:195], a[60:63], v[144:147], v[180:195]
    s_add_u32 s49, s51, 24576
    buffer_load_dwordx4 a[32:35], v22, s[12:15], s49 offen offset:0 sc1
    v_exp_f32 v168, v168
    v_exp_f32 v169, v169
    v_exp_f32 v170, v170
    v_exp_f32 v171, v171
    v_cvt_pk_bf16_f32 v198, v168, v169
    v_cvt_pk_bf16_f32 v199, v170, v171
    v_mfma_f32_32x32x16_bf16 v[228:243], a[208:211], v[204:207], v[228:243]
    v_exp_f32 v172, v172
    v_exp_f32 v173, v173
    v_exp_f32 v174, v174
    v_exp_f32 v175, v175
    v_cvt_pk_bf16_f32 v200, v172, v173
    v_cvt_pk_bf16_f32 v201, v174, v175
    v_mfma_f32_32x32x16_bf16 v[228:243], a[212:215], v[208:211], v[228:243]
    v_exp_f32 v176, v176
    v_exp_f32 v177, v177
    v_exp_f32 v178, v178
    v_exp_f32 v179, v179
    v_cvt_pk_bf16_f32 v202, v176, v177
    v_cvt_pk_bf16_f32 v203, v178, v179
    v_exp_f32 v180, v180
    v_exp_f32 v181, v181
    v_exp_f32 v182, v182
    v_exp_f32 v183, v183
    v_cvt_pk_bf16_f32 v204, v180, v181
    v_cvt_pk_bf16_f32 v205, v182, v183
    v_exp_f32 v184, v184
    v_exp_f32 v185, v185
    v_exp_f32 v186, v186
    v_exp_f32 v187, v187
    v_cvt_pk_bf16_f32 v206, v184, v185
    v_cvt_pk_bf16_f32 v207, v186, v187
    v_mfma_f32_32x32x16_bf16 v[212:227], a[216:219], v[196:199], v[212:227]
    v_exp_f32 v188, v188
    v_exp_f32 v189, v189
    v_exp_f32 v190, v190
    v_exp_f32 v191, v191
    v_cvt_pk_bf16_f32 v208, v188, v189
    v_cvt_pk_bf16_f32 v209, v190, v191
    v_mfma_f32_32x32x16_bf16 v[212:227], a[220:223], v[200:203], v[212:227]
    v_exp_f32 v192, v192
    v_exp_f32 v193, v193
    v_exp_f32 v194, v194
    v_exp_f32 v195, v195
    v_cvt_pk_bf16_f32 v210, v192, v193
    v_cvt_pk_bf16_f32 v211, v194, v195
    v_mfma_f32_32x32x16_bf16 v[228:243], a[216:219], v[204:207], v[228:243]
    s_nop 0
    v_mfma_f32_32x32x16_bf16 v[228:243], a[220:223], v[208:211], v[228:243]
    s_nop 2
    v_mov_b32 v223, v250
    v_subrev_u32 v224, 0x2b800000, v222
    v_max_u32 v252, v252, v224
    ds_write_b128 v15, v[212:215] offset:24576
    ds_write_b128 v15, v[216:219] offset:25600
    ds_write_b128 v15, v[220:223] offset:26624
    s_nop 2
    v_mov_b32 v239, v251
    v_subrev_u32 v240, 0x2b800000, v238
    v_max_u32 v252, v252, v240
    ds_write_b128 v15, v[228:231] offset:36864
    ds_write_b128 v15, v[232:235] offset:37888
    ds_write_b128 v15, v[236:239] offset:38912
    v_cmp_le_u32 vcc, 0x28000000, v252
    s_nop 4
    s_cbranch_vccnz L_fallback
L_fb_ret:
    s_waitcnt vmcnt(54) lgkmcnt(0)
    s_barrier
    s_mul_i32 s49, s3, 24576
    v_add_u32 v14, s49, v22
    v_or_b32 v15, 512, v14
    ds_read_b32 v212, v15 offset:2060
    ds_read_b32 v213, v15 offset:5132
    ds_read_b32 v214, v15 offset:8204
    ds_read_b32 v215, v15 offset:11276
    ds_read_b32 v216, v15 offset:14348
    ds_read_b32 v217, v15 offset:17420
    ds_read_b32 v218, v15 offset:20492
    ds_read_b32 v219, v15 offset:23564
    ds_read_b128 v[116:119], v14 offset:0
    ds_read_b128 v[120:123], v14 offset:1024
    ds_read_b128 v[124:127], v14 offset:2048
    ds_read_b128 v[128:131], v14 offset:3072
    ds_read_b128 v[132:135], v14 offset:4096
    ds_read_b128 v[136:139], v14 offset:5120
    s_waitcnt lgkmcnt(10)
    v_min3_f32 v12, v212, v213, v214
    v_min_f32 v12, v12, v215
    v_sub_f32 v212, v12, v212
    ds_read_b128 v[140:143], v14 offset:6144
    v_sub_f32 v213, v12, v213
    v_sub_f32 v214, v12, v214
    v_sub_f32 v215, v12, v215
    v_exp_f32 v220, v212
    ds_read_b128 v[144:147], v14 offset:7168
    v_exp_f32 v222, v213
    v_exp_f32 v224, v214
    v_exp_f32 v226, v215
    ds_read_b128 v[148:151], v14 offset:8192
    s_waitcnt lgkmcnt(9)
    v_min3_f32 v12, v216, v217, v218
    v_min_f32 v12, v12, v219
    v_sub_f32 v216, v12, v216
    ds_read_b128 v[152:155], v14 offset:9216
    v_sub_f32 v217, v12, v217
    v_sub_f32 v218, v12, v218
    v_sub_f32 v219, v12, v219
    v_exp_f32 v228, v216
    ds_read_b128 v[156:159], v14 offset:10240
    v_exp_f32 v230, v217
    v_exp_f32 v232, v218
    v_exp_f32 v234, v219
    ds_read_b128 v[160:163], v14 offset:11264
    s_waitcnt lgkmcnt(9)
    v_pk_mul_f32 v[116:117], v[116:117], v[220:221] op_sel_hi:[1,0]
    ds_read_b128 v[164:167], v14 offset:12288
    v_pk_mul_f32 v[118:119], v[118:119], v[220:221] op_sel_hi:[1,0]
    v_pk_mul_f32 v[120:121], v[120:121], v[220:221] op_sel_hi:[1,0]
    v_pk_mul_f32 v[122:123], v[122:123], v[220:221] op_sel_hi:[1,0]
    ds_read_b128 v[168:171], v14 offset:13312
    v_pk_mul_f32 v[124:125], v[124:125], v[220:221] op_sel_hi:[1,0]
    v_pk_mul_f32 v[126:127], v[126:127], v[220:221] op_sel_hi:[1,0]
    ds_read_b128 v[172:175], v14 offset:14336
    s_waitcnt lgkmcnt(9)
    v_pk_fma_f32 v[116:117], v[128:129], v[222:223], v[116:117] op_sel_hi:[1,0,1]
    v_pk_fma_f32 v[118:119], v[130:131], v[222:223], v[118:119] op_sel_hi:[1,0,1]
    v_pk_fma_f32 v[120:121], v[132:133], v[222:223], v[120:121] op_sel_hi:[1,0,1]
    ds_read_b128 v[176:179], v14 offset:15360
    v_pk_fma_f32 v[122:123], v[134:135], v[222:223], v[122:123] op_sel_hi:[1,0,1]
    v_pk_fma_f32 v[124:125], v[136:137], v[222:223], v[124:125] op_sel_hi:[1,0,1]
    v_pk_fma_f32 v[126:127], v[138:139], v[222:223], v[126:127] op_sel_hi:[1,0,1]
    ds_read_b128 v[180:183], v14 offset:16384
    s_waitcnt lgkmcnt(8)
    v_pk_fma_f32 v[116:117], v[140:141], v[224:225], v[116:117] op_sel_hi:[1,0,1]
    v_pk_fma_f32 v[118:119], v[142:143], v[224:225], v[118:119] op_sel_hi:[1,0,1]
    ds_read_b128 v[184:187], v14 offset:17408
    v_pk_fma_f32 v[120:121], v[144:145], v[224:225], v[120:121] op_sel_hi:[1,0,1]
    v_pk_fma_f32 v[122:123], v[146:147], v[224:225], v[122:123] op_sel_hi:[1,0,1]
    v_pk_fma_f32 v[124:125], v[148:149], v[224:225], v[124:125] op_sel_hi:[1,0,1]
    ds_read_b128 v[188:191], v14 offset:18432
    v_pk_fma_f32 v[126:127], v[150:151], v[224:225], v[126:127] op_sel_hi:[1,0,1]
    s_waitcnt lgkmcnt(7)
    v_pk_fma_f32 v[116:117], v[152:153], v[226:227], v[116:117] op_sel_hi:[1,0,1]
    v_pk_fma_f32 v[118:119], v[154:155], v[226:227], v[118:119] op_sel_hi:[1,0,1]
    ds_read_b128 v[192:195], v14 offset:19456
    v_pk_fma_f32 v[120:121], v[156:157], v[226:227], v[120:121] op_sel_hi:[1,0,1]
    v_pk_fma_f32 v[122:123], v[158:159], v[226:227], v[122:123] op_sel_hi:[1,0,1]
    ds_read_b128 v[196:199], v14 offset:20480
    v_pk_fma_f32 v[124:125], v[160:161], v[226:227], v[124:125] op_sel_hi:[1,0,1]
    v_pk_fma_f32 v[126:127], v[162:163], v[226:227], v[126:127] op_sel_hi:[1,0,1]
    v_rcp_f32 v126, v126
    ds_read_b128 v[200:203], v14 offset:21504
    v_pk_mul_f32 v[116:117], v[116:117], v[126:127] op_sel_hi:[1,0]
    v_pk_mul_f32 v[118:119], v[118:119], v[126:127] op_sel_hi:[1,0]
    v_pk_mul_f32 v[120:121], v[120:121], v[126:127] op_sel_hi:[1,0]
    ds_read_b128 v[204:207], v14 offset:22528
    v_pk_mul_f32 v[122:123], v[122:123], v[126:127] op_sel_hi:[1,0]
    v_pk_mul_f32 v[124:125], v[124:125], v[126:127] op_sel_hi:[1,0]
    v_cvt_pk_bf16_f32 v128, v116, v117
    ds_read_b128 v[208:211], v14 offset:23552
    v_cvt_pk_bf16_f32 v129, v118, v119
    v_cvt_pk_bf16_f32 v130, v120, v121
    v_cvt_pk_bf16_f32 v131, v122, v123
    v_cvt_pk_bf16_f32 v132, v124, v125
    v_mov_b32 v133, v132
    buffer_store_dwordx4 v[128:131], v17, s[12:15], s46 offen sc1
    s_nop 0
    v_permlane32_swap_b32 v132, v133
    buffer_store_dwordx2 v[132:133], v18, s[12:15], s47 offen sc1
    s_waitcnt lgkmcnt(9)
    v_pk_mul_f32 v[164:165], v[164:165], v[228:229] op_sel_hi:[1,0]
    v_pk_mul_f32 v[166:167], v[166:167], v[228:229] op_sel_hi:[1,0]
    v_pk_mul_f32 v[168:169], v[168:169], v[228:229] op_sel_hi:[1,0]
    v_pk_mul_f32 v[170:171], v[170:171], v[228:229] op_sel_hi:[1,0]
    v_pk_mul_f32 v[172:173], v[172:173], v[228:229] op_sel_hi:[1,0]
    v_pk_mul_f32 v[174:175], v[174:175], v[228:229] op_sel_hi:[1,0]
    s_waitcnt lgkmcnt(6)
    v_pk_fma_f32 v[164:165], v[176:177], v[230:231], v[164:165] op_sel_hi:[1,0,1]
    v_pk_fma_f32 v[166:167], v[178:179], v[230:231], v[166:167] op_sel_hi:[1,0,1]
    v_pk_fma_f32 v[168:169], v[180:181], v[230:231], v[168:169] op_sel_hi:[1,0,1]
    v_pk_fma_f32 v[170:171], v[182:183], v[230:231], v[170:171] op_sel_hi:[1,0,1]
    v_pk_fma_f32 v[172:173], v[184:185], v[230:231], v[172:173] op_sel_hi:[1,0,1]
    v_pk_fma_f32 v[174:175], v[186:187], v[230:231], v[174:175] op_sel_hi:[1,0,1]
    s_waitcnt lgkmcnt(3)
    v_pk_fma_f32 v[164:165], v[188:189], v[232:233], v[164:165] op_sel_hi:[1,0,1]
    v_pk_fma_f32 v[166:167], v[190:191], v[232:233], v[166:167] op_sel_hi:[1,0,1]
    v_pk_fma_f32 v[168:169], v[192:193], v[232:233], v[168:169] op_sel_hi:[1,0,1]
    v_pk_fma_f32 v[170:171], v[194:195], v[232:233], v[170:171] op_sel_hi:[1,0,1]
    v_pk_fma_f32 v[172:173], v[196:197], v[232:233], v[172:173] op_sel_hi:[1,0,1]
    v_pk_fma_f32 v[174:175], v[198:199], v[232:233], v[174:175] op_sel_hi:[1,0,1]
    s_waitcnt lgkmcnt(0)
    v_pk_fma_f32 v[164:165], v[200:201], v[234:235], v[164:165] op_sel_hi:[1,0,1]
    v_pk_fma_f32 v[166:167], v[202:203], v[234:235], v[166:167] op_sel_hi:[1,0,1]
    v_pk_fma_f32 v[168:169], v[204:205], v[234:235], v[168:169] op_sel_hi:[1,0,1]
    v_pk_fma_f32 v[170:171], v[206:207], v[234:235], v[170:171] op_sel_hi:[1,0,1]
    v_pk_fma_f32 v[172:173], v[208:209], v[234:235], v[172:173] op_sel_hi:[1,0,1]
    v_pk_fma_f32 v[174:175], v[210:211], v[234:235], v[174:175] op_sel_hi:[1,0,1]
    v_rcp_f32 v174, v174
    s_nop 0
    v_pk_mul_f32 v[164:165], v[164:165], v[174:175] op_sel_hi:[1,0]
    v_pk_mul_f32 v[166:167], v[166:167], v[174:175] op_sel_hi:[1,0]
    v_pk_mul_f32 v[168:169], v[168:169], v[174:175] op_sel_hi:[1,0]
    v_pk_mul_f32 v[170:171], v[170:171], v[174:175] op_sel_hi:[1,0]
    v_pk_mul_f32 v[172:173], v[172:173], v[174:175] op_sel_hi:[1,0]
    v_cvt_pk_bf16_f32 v176, v164, v165
    v_cvt_pk_bf16_f32 v177, v166, v167
    v_cvt_pk_bf16_f32 v178, v168, v169
    v_cvt_pk_bf16_f32 v179, v170, v171
    v_cvt_pk_bf16_f32 v180, v172, v173
    v_mov_b32 v181, v180
    s_add_u32 s46, s46, 40960
    s_add_u32 s47, s47, 40960
    buffer_store_dwordx4 v[176:179], v17, s[12:15], s46 offen sc1
    v_permlane32_swap_b32 v180, v181
    buffer_store_dwordx2 v[180:181], v18, s[12:15], s47 offen sc1
    s_lshl_b32 s59, s28, 5
    s_add_u32 s59, s59, s27
    s_lshl_b32 s32, s59, 7
    s_add_u32 s32, s32, 36864
    v_lshl_add_u32 v2, v1, 2, s32
    v_mov_b32 v3, s24
    s_cmp_lg_u32 s3, 0
    s_mov_b32 exec_hi, 0
    s_barrier
    s_cbranch_scc1 L_post_12
    buffer_store_dword v3, v2, s[12:15], 0 offen sc1
L_post_12:
    s_mov_b64 exec, -1
    s_add_u32 s62, s50, 26509312
    v_and_b32 v13, 15, v1
    v_and_b32 v16, 0x300, v22
    s_add_u32 s49, s62, 0
    buffer_load_dwordx4 a[36:39], v22, s[12:15], s49 offen offset:0 sc1
    v_lshl_add_u32 v16, v13, 3, v16
    v_add_u32 v16, 4096, v16
    s_lshr_b32 s32, s27, 2
    s_lshl_b32 s32, s32, 5
    buffer_load_dwordx4 a[40:43], v22, s[12:15], s49 offen offset:1024 sc1
    s_lshl_b32 s33, s3, 3
    s_add_u32 s32, s32, s33
    v_add_u32 v9, s32, v1
    s_and_b32 s34, s3, 1
    s_lshl_b32 s34, s34, 1
    s_waitcnt vmcnt(30)
    buffer_load_dwordx4 a[44:47], v22, s[12:15], s49 offen offset:2048 sc1
    s_add_u32 s34, s34, s27
    s_add_u32 s34, s34, 31
    s_and_b32 s34, s34, 31
    v_mov_b32 v10, s27
    buffer_load_dwordx4 a[48:51], v22, s[12:15], s49 offen offset:3072 sc1
    v_mov_b32 v11, s34
    v_cmp_gt_u32 vcc, 10, v1
    s_nop 1
    v_cndmask_b32 v10, v11, v10, vcc
    s_lshl_b32 s33, s3, 6
    s_add_u32 s49, s62, 4096
    buffer_load_dwordx4 a[52:55], v22, s[12:15], s49 offen offset:0 sc1
    v_add_u32 v10, s33, v10
    v_and_b32 v11, 1, v1
    v_lshl_add_u32 v10, v11, 5, v10
    v_cmp_gt_u32 vcc, 8, v1
    buffer_load_dwordx4 a[56:59], v22, s[12:15], s49 offen offset:1024 sc1
    s_nop 1
    v_cndmask_b32 v9, v10, v9, vcc
    v_lshlrev_b32 v9, 7, v9
    v_add_u32 v9, 36864, v9
    buffer_load_dwordx4 a[60:63], v22, s[12:15], s49 offen offset:2048 sc1
    s_mul_i32 s34, s27, 81920
    s_mul_i32 s35, s3, 5120
    s_add_u32 s34, s34, s35
    s_add_u32 s34, s34, 8912896
    s_xor_b32 s35, s20, 2
    buffer_load_dwordx4 a[64:67], v22, s[12:15], s49 offen offset:3072 sc1
    s_mul_i32 s35, s35, 20480
    s_add_u32 s36, s34, s35
    s_xor_b32 s35, s20, 3
    s_mul_i32 s35, s35, 20480
    s_add_u32 s49, s62, 8192
    buffer_load_dwordx4 a[68:71], v22, s[12:15], s49 offen offset:0 sc1
    s_add_u32 s37, s34, s35
    s_xor_b32 s35, s20, 1
    s_mul_i32 s35, s35, 20480
    s_add_u32 s38, s34, s35
    s_xor_b32 s35, s20, 0
    buffer_load_dwordx4 a[72:75], v22, s[12:15], s49 offen offset:1024 sc1
    s_mul_i32 s35, s35, 20480
    s_add_u32 s39, s34, s35
    v_mov_b32 v248, 0x3f803f80
    v_mov_b32 v249, 0x3f803f80
    buffer_load_dwordx4 a[76:79], v22, s[12:15], s49 offen offset:2048 sc1
    v_mov_b32 v250, 0x3f803f80
    v_mov_b32 v251, 0x3f803f80
    s_nop 0
    s_mov_b64 exec, 0
    s_cmp_eq_u32 s3, 0
    s_cbranch_scc1 L_pad_0
    s_cmp_eq_u32 s3, 1
    s_cbranch_scc1 L_pad_1
    s_cmp_eq_u32 s3, 2
    s_cbranch_scc1 L_pad_2
    s_branch L_pad_3
L_hret_0:
    s_mov_b64 exec, -1
    s_mov_b32 s67, 131072
    s_mov_b32 exec_lo, 0xfff
    s_mov_b32 exec_hi, 0x0
L_poll_13:
    buffer_load_dword v10, v9, s[12:15], 0 offen sc1
    s_waitcnt vmcnt(0)
    v_cmp_ne_u32 vcc, s24, v10
    s_sub_u32 s67, s67, 1
    s_cbranch_scc1 L_polld_14
    s_nop 2
    s_cbranch_vccz L_polld_14
    s_mov_b64 exec, vcc
    s_sleep 1
    s_branch L_poll_13
L_polld_14:
    s_mov_b64 exec, -1
    s_mov_b32 s67, 131072
    buffer_load_dwordx4 v[176:179], v22, s[12:15], s36 offen offset:0 sc1
    buffer_load_dwordx4 v[180:183], v22, s[12:15], s36 offen offset:1024 sc1
    buffer_load_dwordx4 v[184:187], v22, s[12:15], s36 offen offset:2048 sc1
    v_mfma_f32_16x16x32_bf16 a[200:203], a[0:3], v[248:251], 0
    s_mul_i32 s56, s28, 2560
    s_add_u32 s57, s56, s53
    v_mfma_f32_16x16x32_bf16 a[204:207], a[96:99], v[248:251], 0
    s_add_u32 s60, s22, 26918912
    s_add_u32 s61, s22, 27901952
    v_mfma_f32_16x16x32_bf16 a[208:211], a[100:103], v[248:251], 0
    s_xor_b32 s35, s20, 2
    v_mfma_f32_16x16x32_bf16 a[212:215], a[4:7], v[248:251], 0
    buffer_load_dwordx4 v[188:191], v22, s[12:15], s36 offen offset:3072 sc1
    s_mul_i32 s35, s35, 15360
    s_add_u32 s35, s35, 0
    v_mfma_f32_16x16x32_bf16 a[216:219], a[104:107], v[248:251], 0
    v_add_u32 v25, s35, v22
    v_mfma_f32_16x16x32_bf16 a[200:203], a[108:111], v[248:251], a[200:203]
    s_xor_b32 s35, s20, 3
    s_mul_i32 s35, s35, 15360
    v_mfma_f32_16x16x32_bf16 a[204:207], a[8:11], v[248:251], a[204:207]
    s_add_u32 s35, s35, 5120
    buffer_load_dwordx2 v[192:193], v16, s[12:15], s36 offen offset:0 sc1
    buffer_load_dwordx2 v[194:195], v16, s[12:15], s36 offen offset:128 sc1
    v_add_u32 v26, s35, v22
    v_mfma_f32_16x16x32_bf16 a[208:211], a[112:115], v[248:251], a[208:211]
    s_xor_b32 s35, s20, 1
    v_mfma_f32_16x16x32_bf16 a[212:215], a[116:119], v[248:251], a[212:215]
    s_mul_i32 s35, s35, 15360
    s_add_u32 s35, s35, 10240
    v_mfma_f32_16x16x32_bf16 a[216:219], a[12:15], v[248:251], a[216:219]
    v_add_u32 v27, s35, v22
    v_mfma_f32_16x16x32_bf16 a[200:203], a[120:123], v[248:251], a[200:203]
    s_mul_i32 s35, s20, 15360
    buffer_load_dwordx4 v[196:199], v22, s[12:15], s37 offen offset:0 sc1
    v_add_u32 v28, s35, v22
    v_mfma_f32_16x16x32_bf16 a[204:207], a[124:127], v[248:251], a[204:207]
    v_and_b32 v13, 15, v1
    v_lshrrev_b32 v11, 5, v1
    v_mfma_f32_16x16x32_bf16 a[208:211], a[16:19], v[248:251], a[208:211]
    v_lshlrev_b32 v11, 8, v11
    v_mfma_f32_16x16x32_bf16 a[212:215], a[128:131], v[248:251], a[212:215]
    v_lshl_add_u32 v29, v13, 4, v11
    v_mov_b32 v12, 0x80000000
    buffer_load_dwordx4 v[200:203], v22, s[12:15], s37 offen offset:1024 sc1
    v_mfma_f32_16x16x32_bf16 a[216:219], a[132:135], v[248:251], a[216:219]
    v_and_b32 v11, 16, v1
    v_mfma_f32_16x16x32_bf16 a[200:203], a[20:23], v[248:251], a[200:203]
    v_cmp_eq_u32 vcc, 0, v11
    s_nop 1
    v_cndmask_b32 v29, v12, v29, vcc
    v_mfma_f32_16x16x32_bf16 a[204:207], a[136:139], v[248:251], a[204:207]
    v_lshlrev_b32 v19, 2, v1
    v_cndmask_b32 v19, v19, v12, s[30:31]
    v_mfma_f32_16x16x32_bf16 a[208:211], a[140:143], v[248:251], a[208:211]
    buffer_load_dwordx4 v[204:207], v22, s[12:15], s37 offen offset:2048 sc1
    s_lshl_b32 s35, s20, 7
    v_mfma_f32_16x16x32_bf16 a[212:215], a[24:27], v[248:251], a[212:215]
    v_lshl_add_u32 v18, v13, 3, s35
    v_lshlrev_b32 v116, 16, v104
    v_mfma_f32_16x16x32_bf16 a[216:219], a[144:147], v[248:251], a[216:219]
    v_and_b32 v117, s29, v104
    v_mfma_f32_16x16x32_bf16 a[200:203], a[148:151], v[248:251], a[200:203]
    v_lshlrev_b32 v118, 16, v105
    v_and_b32 v119, s29, v105
    buffer_load_dwordx4 v[208:211], v22, s[12:15], s37 offen offset:3072 sc1
    v_mfma_f32_16x16x32_bf16 a[204:207], a[28:31], v[248:251], a[204:207]
    v_lshlrev_b32 v120, 16, v106
    v_and_b32 v121, s29, v106
    v_mfma_f32_16x16x32_bf16 a[208:211], a[152:155], v[248:251], a[208:211]
    v_lshlrev_b32 v122, 16, v107
    v_mfma_f32_16x16x32_bf16 a[212:215], a[156:159], v[248:251], a[212:215]
    v_and_b32 v123, s29, v107
    v_lshlrev_b32 v124, 16, v108
    v_mfma_f32_16x16x32_bf16 a[216:219], a[32:35], v[248:251], a[216:219]
    v_and_b32 v125, s29, v108
    buffer_load_dwordx2 v[212:213], v16, s[12:15], s37 offen offset:0 sc1
    buffer_load_dwordx2 v[214:215], v16, s[12:15], s37 offen offset:128 sc1
    v_lshlrev_b32 v126, 16, v109
    v_and_b32 v127, s29, v109
    v_lshlrev_b32 v128, 16, v110
    v_and_b32 v129, s29, v110
    v_lshlrev_b32 v130, 16, v111
    v_and_b32 v131, s29, v111
    v_lshlrev_b32 v132, 16, v112
    v_and_b32 v133, s29, v112
    v_lshlrev_b32 v134, 16, v113
    buffer_load_dwordx4 v[216:219], v22, s[12:15], s38 offen offset:0 sc1
    v_and_b32 v135, s29, v113
    s_mul_i32 s34, s3, 5120
    s_add_u32 s34, s34, 81920
    v_add_u32 v9, s34, v22
    ds_write_b128 v9, a[200:203] offset:0
    ds_write_b128 v9, a[204:207] offset:1024
    ds_write_b128 v9, a[208:211] offset:2048
    ds_write_b128 v9, a[212:215] offset:3072
    ds_write_b128 v9, a[216:219] offset:4096
    buffer_load_dwordx4 v[220:223], v22, s[12:15], s38 offen offset:1024 sc1
L_k3t_15:
    s_waitcnt vmcnt(13)
    v_mfma_f32_16x16x32_bf16 v[136:139], a[224:227], v[176:179], 0
    buffer_load_dwordx4 v[224:227], v22, s[12:15], s38 offen offset:2048 sc1
    v_mfma_f32_16x16x32_bf16 v[140:143], a[228:231], v[176:179], 0
    v_max_i32 v8, v176, v178
    v_mfma_f32_16x16x32_bf16 v[144:147], a[232:235], v[176:179], 0
    v_mfma_f32_16x16x32_bf16 v[148:151], a[236:239], v[176:179], 0
    v_mfma_f32_16x16x32_bf16 v[152:155], a[240:243], v[176:179], 0
    s_waitcnt vmcnt(13)
    v_mfma_f32_16x16x32_bf16 v[136:139], a[244:247], v[180:183], v[136:139]
    buffer_load_dwordx4 v[228:231], v22, s[12:15], s38 offen offset:3072 sc1
    v_mfma_f32_16x16x32_bf16 v[140:143], a[248:251], v[180:183], v[140:143]
    v_max3_i32 v8, v8, v180, v182
    v_mfma_f32_16x16x32_bf16 v[144:147], a[252:255], v[180:183], v[144:147]
    v_mfma_f32_16x16x32_bf16 v[148:151], v[32:35], v[180:183], v[148:151]
    v_mfma_f32_16x16x32_bf16 v[152:155], v[36:39], v[180:183], v[152:155]
    s_waitcnt vmcnt(13)
    v_mfma_f32_16x16x32_bf16 v[136:139], v[40:43], v[184:187], v[136:139]
    buffer_load_dwordx2 v[232:233], v16, s[12:15], s38 offen offset:0 sc1
    buffer_load_dwordx2 v[234:235], v16, s[12:15], s38 offen offset:128 sc1
    v_mfma_f32_16x16x32_bf16 v[140:143], v[44:47], v[184:187], v[140:143]
    v_max3_i32 v8, v8, v184, v186
    v_mfma_f32_16x16x32_bf16 v[144:147], v[48:51], v[184:187], v[144:147]
    v_mfma_f32_16x16x32_bf16 v[148:151], v[52:55], v[184:187], v[148:151]
    v_mfma_f32_16x16x32_bf16 v[152:155], v[56:59], v[184:187], v[152:155]
    s_waitcnt vmcnt(14)
    v_mfma_f32_16x16x32_bf16 v[136:139], v[60:63], v[188:191], v[136:139]
    buffer_load_dwordx4 v[236:239], v22, s[12:15], s39 offen offset:0 sc1
    v_mfma_f32_16x16x32_bf16 v[140:143], v[64:67], v[188:191], v[140:143]
    v_max3_i32 v8, v8, v188, v190
    v_mfma_f32_16x16x32_bf16 v[144:147], v[68:71], v[188:191], v[144:147]
    v_mfma_f32_16x16x32_bf16 v[148:151], v[72:75], v[188:191], v[148:151]
    v_mfma_f32_16x16x32_bf16 v[152:155], v[76:79], v[188:191], v[152:155]
    s_waitcnt vmcnt(13)
    v_mfma_f32_16x16x32_bf16 v[136:139], v[80:83], v[192:195], v[136:139]
    buffer_load_dwordx4 v[240:243], v22, s[12:15], s39 offen offset:1024 sc1
    v_mfma_f32_16x16x32_bf16 v[140:143], v[84:87], v[192:195], v[140:143]
    v_max3_i32 v8, v8, v192, v194
    v_mfma_f32_16x16x32_bf16 v[144:147], v[88:91], v[192:195], v[144:147]
    v_mfma_f32_16x16x32_bf16 v[148:151], v[92:95], v[192:195], v[148:151]
    v_cmp_eq_u32 vcc, s21, v8
    v_mfma_f32_16x16x32_bf16 v[152:155], v[96:99], v[192:195], v[152:155]
    s_nop 0
    s_cbranch_vccnz L_k3r_16
L_k3t_17:
    s_waitcnt vmcnt(13)
    v_mfma_f32_16x16x32_bf16 v[156:159], a[224:227], v[196:199], 0
    buffer_load_dwordx4 v[244:247], v22, s[12:15], s39 offen offset:2048 sc1
    v_mfma_f32_16x16x32_bf16 v[160:163], a[228:231], v[196:199], 0
    v_max_i32 v8, v196, v198
    v_mfma_f32_16x16x32_bf16 v[164:167], a[232:235], v[196:199], 0
    v_mfma_f32_16x16x32_bf16 v[168:171], a[236:239], v[196:199], 0
    ds_write_b128 v25, v[136:139] offset:0
    v_mfma_f32_16x16x32_bf16 v[172:175], a[240:243], v[196:199], 0
    s_waitcnt vmcnt(13)
    v_mfma_f32_16x16x32_bf16 v[156:159], a[244:247], v[200:203], v[156:159]
    buffer_load_dwordx4 v[248:251], v22, s[12:15], s39 offen offset:3072 sc1
    v_mfma_f32_16x16x32_bf16 v[160:163], a[248:251], v[200:203], v[160:163]
    v_max3_i32 v8, v8, v200, v202
    v_mfma_f32_16x16x32_bf16 v[164:167], a[252:255], v[200:203], v[164:167]
    ds_write_b128 v25, v[140:143] offset:1024
    v_mfma_f32_16x16x32_bf16 v[168:171], v[32:35], v[200:203], v[168:171]
    v_mfma_f32_16x16x32_bf16 v[172:175], v[36:39], v[200:203], v[172:175]
    s_waitcnt vmcnt(13)
    v_mfma_f32_16x16x32_bf16 v[156:159], v[40:43], v[204:207], v[156:159]
    buffer_load_dwordx2 v[252:253], v16, s[12:15], s39 offen offset:0 sc1
    buffer_load_dwordx2 v[254:255], v16, s[12:15], s39 offen offset:128 sc1
    v_mfma_f32_16x16x32_bf16 v[160:163], v[44:47], v[204:207], v[160:163]
    v_max3_i32 v8, v8, v204, v206
    ds_write_b128 v25, v[144:147] offset:2048
    v_mfma_f32_16x16x32_bf16 v[164:167], v[48:51], v[204:207], v[164:167]
    v_mfma_f32_16x16x32_bf16 v[168:171], v[52:55], v[204:207], v[168:171]
    v_mfma_f32_16x16x32_bf16 v[172:175], v[56:59], v[204:207], v[172:175]
    s_add_u32 s49, s62, 8192
    buffer_load_dwordx4 a[80:83], v22, s[12:15], s49 offen offset:3072 sc1
    s_waitcnt vmcnt(15)
    v_mfma_f32_16x16x32_bf16 v[156:159], v[60:63], v[208:211], v[156:159]
    ds_write_b128 v25, v[148:151] offset:3072
    v_mfma_f32_16x16x32_bf16 v[160:163], v[64:67], v[208:211], v[160:163]
    v_max3_i32 v8, v8, v208, v210
    v_mfma_f32_16x16x32_bf16 v[164:167], v[68:71], v[208:211], v[164:167]
    s_add_u32 s49, s62, 12288
    buffer_load_dwordx4 a[84:87], v22, s[12:15], s49 offen offset:0 sc1
    v_mfma_f32_16x16x32_bf16 v[168:171], v[72:75], v[208:211], v[168:171]
    v_mfma_f32_16x16x32_bf16 v[172:175], v[76:79], v[208:211], v[172:175]
    ds_write_b128 v25, v[152:155] offset:4096
    s_waitcnt vmcnt(14)
    v_mfma_f32_16x16x32_bf16 v[156:159], v[80:83], v[212:215], v[156:159]
    v_mfma_f32_16x16x32_bf16 v[160:163], v[84:87], v[212:215], v[160:163]
    v_max3_i32 v8, v8, v212, v214
    v_mfma_f32_16x16x32_bf16 v[164:167], v[88:91], v[212:215], v[164:167]
    v_mfma_f32_16x16x32_bf16 v[168:171], v[92:95], v[212:215], v[168:171]
    v_cmp_eq_u32 vcc, s21, v8
    v_mfma_f32_16x16x32_bf16 v[172:175], v[96:99], v[212:215], v[172:175]
    s_nop 0
    s_cbranch_vccnz L_k3r_18
L_k3t_19:
    s_waitcnt vmcnt(13)
    v_mfma_f32_16x16x32_bf16 v[136:139], a[224:227], v[216:219], 0
    s_add_u32 s49, s62, 12288
    buffer_load_dwordx4 a[88:91], v22, s[12:15], s49 offen offset:1024 sc1
    v_mfma_f32_16x16x32_bf16 v[140:143], a[228:231], v[216:219], 0
    v_max_i32 v8, v216, v218
    v_mfma_f32_16x16x32_bf16 v[144:147], a[232:235], v[216:219], 0
    v_mfma_f32_16x16x32_bf16 v[148:151], a[236:239], v[216:219], 0
    ds_write_b128 v26, v[156:159] offset:0
    v_mfma_f32_16x16x32_bf16 v[152:155], a[240:243], v[216:219], 0
    buffer_load_dwordx4 a[92:95], v22, s[12:15], s49 offen offset:2048 sc1
    s_waitcnt vmcnt(14)
    v_mfma_f32_16x16x32_bf16 v[136:139], a[244:247], v[220:223], v[136:139]
    v_mfma_f32_16x16x32_bf16 v[140:143], a[248:251], v[220:223], v[140:143]
    v_max3_i32 v8, v8, v220, v222
    v_mfma_f32_16x16x32_bf16 v[144:147], a[252:255], v[220:223], v[144:147]
    ds_write_b128 v26, v[160:163] offset:1024
    buffer_load_dwordx4 a[160:163], v22, s[12:15], s49 offen offset:3072 sc1
    v_mfma_f32_16x16x32_bf16 v[148:151], v[32:35], v[220:223], v[148:151]
    v_mfma_f32_16x16x32_bf16 v[152:155], v[36:39], v[220:223], v[152:155]
    s_waitcnt vmcnt(14)
    v_mfma_f32_16x16x32_bf16 v[136:139], v[40:43], v[224:227], v[136:139]
    v_mfma_f32_16x16x32_bf16 v[140:143], v[44:47], v[224:227], v[140:143]
    v_max3_i32 v8, v8, v224, v226
    ds_write_b128 v26, v[164:167] offset:2048
    s_add_u32 s49, s62, 16384
    buffer_load_dwordx4 a[164:167], v22, s[12:15], s49 offen offset:0 sc1
    v_mfma_f32_16x16x32_bf16 v[144:147], v[48:51], v[224:227], v[144:147]
    v_mfma_f32_16x16x32_bf16 v[148:151], v[52:55], v[224:227], v[148:151]
    v_mfma_f32_16x16x32_bf16 v[152:155], v[56:59], v[224:227], v[152:155]
    buffer_load_dwordx4 a[168:171], v22, s[12:15], s49 offen offset:1024 sc1
    s_waitcnt vmcnt(15)
    v_mfma_f32_16x16x32_bf16 v[136:139], v[60:63], v[228:231], v[136:139]
    ds_write_b128 v26, v[168:171] offset:3072
    v_mfma_f32_16x16x32_bf16 v[140:143], v[64:67], v[228:231], v[140:143]
    v_max3_i32 v8, v8, v228, v230
    v_mfma_f32_16x16x32_bf16 v[144:147], v[68:71], v[228:231], v[144:147]
    buffer_load_dwordx4 a[172:175], v22, s[12:15], s49 offen offset:2048 sc1
    v_mfma_f32_16x16x32_bf16 v[148:151], v[72:75], v[228:231], v[148:151]
    v_mfma_f32_16x16x32_bf16 v[152:155], v[76:79], v[228:231], v[152:155]
    ds_write_b128 v26, v[172:175] offset:4096
    s_waitcnt vmcnt(14)
    v_mfma_f32_16x16x32_bf16 v[136:139], v[80:83], v[232:235], v[136:139]
    v_mfma_f32_16x16x32_bf16 v[140:143], v[84:87], v[232:235], v[140:143]
    v_max3_i32 v8, v8, v232, v234
    v_mfma_f32_16x16x32_bf16 v[144:147], v[88:91], v[232:235], v[144:147]
    v_mfma_f32_16x16x32_bf16 v[148:151], v[92:95], v[232:235], v[148:151]
    v_cmp_eq_u32 vcc, s21, v8
    v_mfma_f32_16x16x32_bf16 v[152:155], v[96:99], v[232:235], v[152:155]
    s_waitcnt lgkmcnt(0)
    s_cbranch_vccnz L_k3r_20
    s_barrier
L_k3t_21:
    s_waitcnt vmcnt(13)
    v_mfma_f32_16x16x32_bf16 v[156:159], a[224:227], v[236:239], v[116:119]
    s_add_u32 s49, s62, 16384
    buffer_load_dwordx4 a[176:179], v22, s[12:15], s49 offen offset:3072 sc1
    ds_read_b128 v[176:179], v28 offset:0
    v_mfma_f32_16x16x32_bf16 v[160:163], a[228:231], v[236:239], v[120:123]
    v_max_i32 v8, v236, v238
    v_mfma_f32_16x16x32_bf16 v[164:167], a[232:235], v[236:239], v[124:127]
    ds_read_b128 v[180:183], v28 offset:1024
    v_mfma_f32_16x16x32_bf16 v[168:171], a[236:239], v[236:239], v[128:131]
    ds_write_b128 v27, v[136:139] offset:0
    v_mfma_f32_16x16x32_bf16 v[172:175], a[240:243], v[236:239], v[132:135]
    s_add_u32 s49, s62, 20480
    buffer_load_dwordx4 a[180:183], v22, s[12:15], s49 offen offset:0 sc1
    ds_read_b128 v[184:187], v28 offset:2048
    s_waitcnt vmcnt(14)
    v_mfma_f32_16x16x32_bf16 v[156:159], a[244:247], v[240:243], v[156:159]
    v_mfma_f32_16x16x32_bf16 v[160:163], a[248:251], v[240:243], v[160:163]
    v_max3_i32 v8, v8, v240, v242
    ds_read_b128 v[188:191], v28 offset:3072
    v_mfma_f32_16x16x32_bf16 v[164:167], a[252:255], v[240:243], v[164:167]
    ds_write_b128 v27, v[140:143] offset:1024
    buffer_load_dwordx4 a[184:187], v22, s[12:15], s49 offen offset:1024 sc1
    v_mfma_f32_16x16x32_bf16 v[168:171], v[32:35], v[240:243], v[168:171]
    ds_read_b128 v[192:195], v28 offset:4096
    v_mfma_f32_16x16x32_bf16 v[172:175], v[36:39], v[240:243], v[172:175]
    s_waitcnt vmcnt(14)
    v_mfma_f32_16x16x32_bf16 v[156:159], v[40:43], v[244:247], v[156:159]
    ds_read_b128 v[196:199], v28 offset:5120
    v_mfma_f32_16x16x32_bf16 v[160:163], v[44:47], v[244:247], v[160:163]
    v_max3_i32 v8, v8, v244, v246
    ds_write_b128 v27, v[144:147] offset:2048
    buffer_load_dwordx4 a[188:191], v22, s[12:15], s49 offen offset:2048 sc1
    v_mfma_f32_16x16x32_bf16 v[164:167], v[48:51], v[244:247], v[164:167]
    ds_read_b128 v[200:203], v28 offset:6144
    v_mfma_f32_16x16x32_bf16 v[168:171], v[52:55], v[244:247], v[168:171]
    v_mfma_f32_16x16x32_bf16 v[172:175], v[56:59], v[244:247], v[172:175]
    buffer_load_dwordx4 a[192:195], v22, s[12:15], s49 offen offset:3072 sc1
    ds_read_b128 v[204:207], v28 offset:7168
    s_waitcnt vmcnt(15)
    v_mfma_f32_16x16x32_bf16 v[156:159], v[60:63], v[248:251], v[156:159]
    ds_write_b128 v27, v[148:151] offset:3072
    v_mfma_f32_16x16x32_bf16 v[160:163], v[64:67], v[248:251], v[160:163]
    v_max3_i32 v8, v8, v248, v250
    ds_read_b128 v[208:211], v28 offset:8192
    v_mfma_f32_16x16x32_bf16 v[164:167], v[68:71], v[248:251], v[164:167]
    s_add_u32 s49, s62, 24576
    buffer_load_dwordx4 a[196:199], v22, s[12:15], s49 offen offset:0 sc1
    v_mfma_f32_16x16x32_bf16 v[168:171], v[72:75], v[248:251], v[168:171]
    ds_read_b128 v[212:215], v28 offset:9216
    v_mfma_f32_16x16x32_bf16 v[172:175], v[76:79], v[248:251], v[172:175]
    ds_write_b128 v27, v[152:155] offset:4096
    s_waitcnt vmcnt(14)
    v_mfma_f32_16x16x32_bf16 v[156:159], v[80:83], v[252:255], v[156:159]
    v_mfma_f32_16x16x32_bf16 v[160:163], v[84:87], v[252:255], v[160:163]
    v_max3_i32 v8, v8, v252, v254
    v_mfma_f32_16x16x32_bf16 v[164:167], v[88:91], v[252:255], v[164:167]
    v_mfma_f32_16x16x32_bf16 v[168:171], v[92:95], v[252:255], v[168:171]
    v_cmp_eq_u32 vcc, s21, v8
    v_mfma_f32_16x16x32_bf16 v[172:175], v[96:99], v[252:255], v[172:175]
    s_waitcnt lgkmcnt(0)
    s_cbranch_vccnz L_k3r_22
    s_barrier
    ds_read_b128 v[216:219], v28 offset:10240
    ds_read_b128 v[220:223], v28 offset:11264
    ds_read_b128 v[224:227], v28 offset:12288
    ds_read_b128 v[228:231], v28 offset:13312
    ds_read_b128 v[232:235], v28 offset:14336
    v_pk_add_f32 v[176:177], v[176:177], v[196:197]
    v_pk_add_f32 v[178:179], v[178:179], v[198:199]
    v_pk_add_f32 v[180:181], v[180:181], v[200:201]
    v_pk_add_f32 v[182:183], v[182:183], v[202:203]
    v_pk_add_f32 v[184:185], v[184:185], v[204:205]
    v_pk_add_f32 v[186:187], v[186:187], v[206:207]
    v_pk_add_f32 v[188:189], v[188:189], v[208:209]
    v_pk_add_f32 v[190:191], v[190:191], v[210:211]
    v_pk_add_f32 v[192:193], v[192:193], v[212:213]
    v_pk_add_f32 v[194:195], v[194:195], v[214:215]
    v_pk_add_f32 v[156:157], v[156:157], v[176:177]
    v_pk_add_f32 v[158:159], v[158:159], v[178:179]
    v_pk_add_f32 v[160:161], v[160:161], v[180:181]
    v_pk_add_f32 v[162:163], v[162:163], v[182:183]
    v_pk_add_f32 v[164:165], v[164:165], v[184:185]
    v_pk_add_f32 v[166:167], v[166:167], v[186:187]
    v_pk_add_f32 v[168:169], v[168:169], v[188:189]
    v_pk_add_f32 v[170:171], v[170:171], v[190:191]
    v_pk_add_f32 v[172:173], v[172:173], v[192:193]
    v_pk_add_f32 v[174:175], v[174:175], v[194:195]
    s_waitcnt lgkmcnt(0)
    v_pk_add_f32 v[156:157], v[156:157], v[216:217]
    v_pk_add_f32 v[158:159], v[158:159], v[218:219]
    v_pk_add_f32 v[160:161], v[160:161], v[220:221]
    v_pk_add_f32 v[162:163], v[162:163], v[222:223]
    v_pk_add_f32 v[164:165], v[164:165], v[224:225]
    v_pk_add_f32 v[166:167], v[166:167], v[226:227]
    v_pk_add_f32 v[168:169], v[168:169], v[228:229]
    v_pk_add_f32 v[170:171], v[170:171], v[230:231]
    v_pk_add_f32 v[172:173], v[172:173], v[232:233]
    v_pk_add_f32 v[174:175], v[174:175], v[234:235]
    v_cvt_pk_bf16_f32 v104, v156, v157
    v_cvt_pk_bf16_f32 v105, v158, v159
    v_cvt_pk_bf16_f32 v106, v160, v161
    v_cvt_pk_bf16_f32 v107, v162, v163
    v_cvt_pk_bf16_f32 v108, v164, v165
    v_cvt_pk_bf16_f32 v109, v166, v167
    v_cvt_pk_bf16_f32 v110, v168, v169
    v_cvt_pk_bf16_f32 v111, v170, v171
    v_cvt_pk_bf16_f32 v112, v172, v173
    v_cvt_pk_bf16_f32 v113, v174, v175
    s_add_u32 s42, s57, 11534336
    buffer_store_dwordx4 v[104:107], v22, s[12:15], s42 offen sc1
    v_mov_b32 v252, v112
    v_mov_b32 v253, v113
    v_mov_b32 v254, v112
    v_mov_b32 v255, v113
    buffer_store_dwordx4 v[108:111], v22, s[12:15], s42 offen offset:1024 sc1
    v_permlane16_swap_b32 v252, v254
    v_permlane16_swap_b32 v253, v255
    buffer_store_dwordx4 v[252:255], v29, s[12:15], s42 offen offset:2048 sc1
    v_pk_add_f32 v[236:237], v[156:157], v[158:159]
    v_pk_add_f32 v[238:239], v[160:161], v[162:163]
    v_pk_mul_f32 v[240:241], v[156:157], v[156:157]
    v_pk_mul_f32 v[242:243], v[158:159], v[158:159]
    v_pk_add_f32 v[236:237], v[236:237], v[164:165]
    s_add_u32 s49, s60, 49152
    buffer_load_dwordx4 v[32:35], v22, s[12:15], s49 offen offset:1024 sc1
    v_pk_add_f32 v[238:239], v[238:239], v[166:167]
    v_pk_add_f32 v[236:237], v[236:237], v[168:169]
    v_pk_add_f32 v[238:239], v[238:239], v[170:171]
    v_pk_add_f32 v[236:237], v[236:237], v[172:173]
    v_pk_add_f32 v[238:239], v[238:239], v[174:175]
    v_pk_fma_f32 v[240:241], v[160:161], v[160:161], v[240:241]
    v_pk_fma_f32 v[242:243], v[162:163], v[162:163], v[242:243]
    v_pk_fma_f32 v[240:241], v[164:165], v[164:165], v[240:241]
    v_pk_fma_f32 v[242:243], v[166:167], v[166:167], v[242:243]
    v_pk_fma_f32 v[240:241], v[168:169], v[168:169], v[240:241]
    buffer_load_dwordx4 v[36:39], v22, s[12:15], s49 offen offset:2048 sc1
    v_pk_fma_f32 v[242:243], v[170:171], v[170:171], v[242:243]
    v_pk_fma_f32 v[240:241], v[172:173], v[172:173], v[240:241]
    v_pk_fma_f32 v[242:243], v[174:175], v[174:175], v[242:243]
    v_pk_add_f32 v[236:237], v[236:237], v[238:239]
    v_pk_add_f32 v[240:241], v[240:241], v[242:243]
    v_add_f32 v236, v236, v237
    v_add_f32 v240, v240, v241
    s_nop 1
    v_permlane16_swap_b32 v236, v240
    v_add_f32 v236, v236, v240
    v_mov_b32 v240, v236
    buffer_load_dwordx4 v[40:43], v22, s[12:15], s49 offen offset:3072 sc1
    s_nop 0
    v_permlane32_swap_b32 v236, v240
    v_add_f32 v236, v236, v240
    s_lshl_b32 s40, s27, 2
    s_add_u32 s40, s40, s20
    s_lshl_b32 s40, s40, 10
    s_lshl_b32 s41, s28, 7
    s_add_u32 s40, s40, s41
    s_add_u32 s40, s40, 393216
    buffer_store_dword v236, v19, s[12:15], s40 offen sc1
    v_add_u32 v9, 81920, v22
    s_add_u32 s49, s60, 53248
    buffer_load_dwordx4 v[44:47], v22, s[12:15], s49 offen offset:0 sc1
    ds_read_b128 v[116:119], v9 offset:0
    ds_read_b128 v[120:123], v9 offset:1024
    ds_read_b128 v[124:127], v9 offset:2048
    ds_read_b128 v[128:131], v9 offset:3072
    ds_read_b128 v[132:135], v9 offset:4096
    ds_read_b128 v[176:179], v9 offset:5120
    ds_read_b128 v[180:183], v9 offset:6144
    ds_read_b128 v[184:187], v9 offset:7168
    ds_read_b128 v[188:191], v9 offset:8192
    ds_read_b128 v[192:195], v9 offset:9216
    ds_read_b128 v[196:199], v9 offset:10240
    buffer_load_dwordx4 v[48:51], v22, s[12:15], s49 offen offset:1024 sc1
    ds_read_b128 v[200:203], v9 offset:11264
    ds_read_b128 v[204:207], v9 offset:12288
    ds_read_b128 v[208:211], v9 offset:13312
    ds_read_b128 v[212:215], v9 offset:14336
    ds_read_b128 v[216:219], v9 offset:15360
    ds_read_b128 v[220:223], v9 offset:16384
    ds_read_b128 v[224:227], v9 offset:17408
    ds_read_b128 v[228:231], v9 offset:18432
    ds_read_b128 v[232:235], v9 offset:19456
    s_mul_i32 s34, s27, 81920
    buffer_load_dwordx4 v[52:55], v22, s[12:15], s49 offen offset:2048 sc1
    s_mul_i32 s35, s3, 5120
    s_add_u32 s34, s34, s35
    s_add_u32 s34, s34, 11534336
    s_xor_b32 s35, s20, 2
    s_mul_i32 s35, s35, 20480
    s_add_u32 s36, s34, s35
    s_xor_b32 s35, s20, 3
    s_mul_i32 s35, s35, 20480
    s_add_u32 s37, s34, s35
    s_xor_b32 s35, s20, 1
    buffer_load_dwordx4 v[56:59], v22, s[12:15], s49 offen offset:3072 sc1
    s_mul_i32 s35, s35, 20480
    s_add_u32 s38, s34, s35
    s_xor_b32 s35, s20, 0
    s_mul_i32 s35, s35, 20480
    s_add_u32 s39, s34, s35
    s_lshl_b32 s40, s27, 12
    s_lshl_b32 s41, s3, 8
    s_add_u32 s40, s40, s41
    s_add_u32 s40, s40, 393216
    v_lshrrev_b32 v14, 4, v1
    v_lshlrev_b32 v14, 10, v14
    s_add_u32 s49, s60, 57344
    buffer_load_dwordx4 v[60:63], v22, s[12:15], s49 offen offset:0 sc1
    v_and_b32 v15, 15, v1
    v_lshl_add_u32 v14, v15, 2, v14
    s_waitcnt lgkmcnt(10)
L_pad_0:
    s_cbranch_execz L_pad_4
    v_pk_add_f32 v[116:117], v[116:117], v[176:177]
    v_pk_add_f32 v[118:119], v[118:119], v[178:179]
    v_pk_add_f32 v[120:121], v[120:121], v[180:181]
    v_pk_add_f32 v[122:123], v[122:123], v[182:183]
    v_pk_add_f32 v[124:125], v[124:125], v[184:185]
    v_pk_add_f32 v[126:127], v[126:127], v[186:187]
    v_pk_add_f32 v[128:129], v[128:129], v[188:189]
    buffer_load_dwordx4 v[64:67], v22, s[12:15], s49 offen offset:1024 sc1
    v_pk_add_f32 v[130:131], v[130:131], v[190:191]
    v_pk_add_f32 v[132:133], v[132:133], v[192:193]
    v_pk_add_f32 v[134:135], v[134:135], v[194:195]
    s_waitcnt lgkmcnt(5)
    v_pk_add_f32 v[116:117], v[116:117], v[196:197]
    v_pk_add_f32 v[118:119], v[118:119], v[198:199]
    v_pk_add_f32 v[120:121], v[120:121], v[200:201]
    v_pk_add_f32 v[122:123], v[122:123], v[202:203]
    v_pk_add_f32 v[124:125], v[124:125], v[204:205]
    v_pk_add_f32 v[126:127], v[126:127], v[206:207]
    buffer_load_dwordx4 v[68:71], v22, s[12:15], s49 offen offset:2048 sc1
    v_pk_add_f32 v[128:129], v[128:129], v[208:209]
    v_pk_add_f32 v[130:131], v[130:131], v[210:211]
    v_pk_add_f32 v[132:133], v[132:133], v[212:213]
    v_pk_add_f32 v[134:135], v[134:135], v[214:215]
    s_waitcnt lgkmcnt(0)
    v_pk_add_f32 v[116:117], v[116:117], v[216:217]
    v_pk_add_f32 v[118:119], v[118:119], v[218:219]
    v_pk_add_f32 v[120:121], v[120:121], v[220:221]
    v_pk_add_f32 v[122:123], v[122:123], v[222:223]
    v_pk_add_f32 v[124:125], v[124:125], v[224:225]
    buffer_load_dwordx4 v[72:75], v22, s[12:15], s49 offen offset:3072 sc1
    v_pk_add_f32 v[126:127], v[126:127], v[226:227]
    v_pk_add_f32 v[128:129], v[128:129], v[228:229]
    v_pk_add_f32 v[130:131], v[130:131], v[230:231]
    v_pk_add_f32 v[132:133], v[132:133], v[232:233]
    v_pk_add_f32 v[134:135], v[134:135], v[234:235]
    s_nop 0
    s_waitcnt vmcnt(12)
    s_barrier
    buffer_load_dwordx4 v[176:179], v22, s[12:15], s36 offen offset:0 sc1
    buffer_load_dwordx4 v[180:183], v22, s[12:15], s36 offen offset:1024 sc1
    buffer_load_dwordx4 v[184:187], v22, s[12:15], s36 offen offset:2048 sc1
    buffer_load_dwordx4 v[188:191], v22, s[12:15], s36 offen offset:3072 sc1
    s_add_u32 s35, s36, 4096
    buffer_load_dwordx4 v[192:195], v22, s[12:15], s35 offen offset:0 sc1
    buffer_load_dwordx4 v[196:199], v22, s[12:15], s37 offen offset:0 sc1
    buffer_load_dwordx4 v[200:203], v22, s[12:15], s37 offen offset:1024 sc1
    buffer_load_dwordx4 v[204:207], v22, s[12:15], s37 offen offset:2048 sc1
    buffer_load_dwordx4 v[208:211], v22, s[12:15], s37 offen offset:3072 sc1
    s_add_u32 s35, s37, 4096
    buffer_load_dwordx4 v[212:215], v22, s[12:15], s35 offen offset:0 sc1
    buffer_load_dword v10, v14, s[12:15], s40 offen offset:0 sc1
    buffer_load_dword v11, v14, s[12:15], s40 offen offset:64 sc1
    buffer_load_dword v12, v14, s[12:15], s40 offen offset:128 sc1
    buffer_load_dword v13, v14, s[12:15], s40 offen offset:192 sc1
L_k4t_25:
    s_waitcnt vmcnt(13)
    v_mfma_f32_16x16x32_bf16 v[136:139], a[0:3], v[176:179], 0
    buffer_load_dwordx4 v[216:219], v22, s[12:15], s38 offen offset:0 sc1
    v_mfma_f32_16x16x32_bf16 v[140:143], a[96:99], v[176:179], 0
    v_max_i32 v8, v176, v178
    v_mfma_f32_16x16x32_bf16 v[144:147], a[100:103], v[176:179], 0
    v_mfma_f32_16x16x32_bf16 v[148:151], a[4:7], v[176:179], 0
    v_mfma_f32_16x16x32_bf16 v[152:155], a[104:107], v[176:179], 0
    s_waitcnt vmcnt(13)
    v_mfma_f32_16x16x32_bf16 v[136:139], a[108:111], v[180:183], v[136:139]
    buffer_load_dwordx4 v[220:223], v22, s[12:15], s38 offen offset:1024 sc1
    v_mfma_f32_16x16x32_bf16 v[140:143], a[8:11], v[180:183], v[140:143]
    v_max3_i32 v8, v8, v180, v182
    v_mfma_f32_16x16x32_bf16 v[144:147], a[112:115], v[180:183], v[144:147]
    v_mfma_f32_16x16x32_bf16 v[148:151], a[116:119], v[180:183], v[148:151]
    v_mfma_f32_16x16x32_bf16 v[152:155], a[12:15], v[180:183], v[152:155]
    s_waitcnt vmcnt(13)
    v_mfma_f32_16x16x32_bf16 v[136:139], a[120:123], v[184:187], v[136:139]
    buffer_load_dwordx4 v[224:227], v22, s[12:15], s38 offen offset:2048 sc1
    v_mfma_f32_16x16x32_bf16 v[140:143], a[124:127], v[184:187], v[140:143]
    v_max3_i32 v8, v8, v184, v186
    v_mfma_f32_16x16x32_bf16 v[144:147], a[16:19], v[184:187], v[144:147]
    v_mfma_f32_16x16x32_bf16 v[148:151], a[128:131], v[184:187], v[148:151]
    v_mfma_f32_16x16x32_bf16 v[152:155], a[132:135], v[184:187], v[152:155]
    s_waitcnt vmcnt(13)
    v_mfma_f32_16x16x32_bf16 v[136:139], a[20:23], v[188:191], v[136:139]
    buffer_load_dwordx4 v[228:231], v22, s[12:15], s38 offen offset:3072 sc1
    v_mfma_f32_16x16x32_bf16 v[140:143], a[136:139], v[188:191], v[140:143]
    v_max3_i32 v8, v8, v188, v190
    v_mfma_f32_16x16x32_bf16 v[144:147], a[140:143], v[188:191], v[144:147]
    v_mfma_f32_16x16x32_bf16 v[148:151], a[24:27], v[188:191], v[148:151]
    v_mfma_f32_16x16x32_bf16 v[152:155], a[144:147], v[188:191], v[152:155]
    s_waitcnt vmcnt(13)
    v_mfma_f32_16x16x32_bf16 v[136:139], a[148:151], v[192:195], v[136:139]
    s_add_u32 s35, s38, 4096
    buffer_load_dwordx4 v[232:235], v22, s[12:15], s35 offen offset:0 sc1
    v_mfma_f32_16x16x32_bf16 v[140:143], a[28:31], v[192:195], v[140:143]
    v_max3_i32 v8, v8, v192, v194
    v_mfma_f32_16x16x32_bf16 v[144:147], a[152:155], v[192:195], v[144:147]
    v_mfma_f32_16x16x32_bf16 v[148:151], a[156:159], v[192:195], v[148:151]
    v_cmp_eq_u32 vcc, s21, v8
    v_mfma_f32_16x16x32_bf16 v[152:155], a[32:35], v[192:195], v[152:155]
    s_nop 0
    s_cbranch_vccnz L_k4r_26
L_k4t_27:
    s_waitcnt vmcnt(13)
    v_mfma_f32_16x16x32_bf16 v[156:159], a[0:3], v[196:199], 0
    buffer_load_dwordx4 v[236:239], v22, s[12:15], s39 offen offset:0 sc1
    v_mfma_f32_16x16x32_bf16 v[160:163], a[96:99], v[196:199], 0
    v_max_i32 v8, v196, v198
    v_mfma_f32_16x16x32_bf16 v[164:167], a[100:103], v[196:199], 0
    v_mfma_f32_16x16x32_bf16 v[168:171], a[4:7], v[196:199], 0
    ds_write_b128 v25, v[136:139] offset:0
    v_mfma_f32_16x16x32_bf16 v[172:175], a[104:107], v[196:199], 0
    s_waitcnt vmcnt(13)
    v_mfma_f32_16x16x32_bf16 v[156:159], a[108:111], v[200:203], v[156:159]
    buffer_load_dwordx4 v[240:243], v22, s[12:15], s39 offen offset:1024 sc1
    v_mfma_f32_16x16x32_bf16 v[160:163], a[8:11], v[200:203], v[160:163]
    v_max3_i32 v8, v8, v200, v202
    v_mfma_f32_16x16x32_bf16 v[164:167], a[112:115], v[200:203], v[164:167]
    ds_write_b128 v25, v[140:143] offset:1024
    v_mfma_f32_16x16x32_bf16 v[168:171], a[116:119], v[200:203], v[168:171]
    v_mfma_f32_16x16x32_bf16 v[172:175], a[12:15], v[200:203], v[172:175]
    s_waitcnt vmcnt(13)
    v_mfma_f32_16x16x32_bf16 v[156:159], a[120:123], v[204:207], v[156:159]
    buffer_load_dwordx4 v[244:247], v22, s[12:15], s39 offen offset:2048 sc1
    v_mfma_f32_16x16x32_bf16 v[160:163], a[124:127], v[204:207], v[160:163]
    v_max3_i32 v8, v8, v204, v206
    ds_write_b128 v25, v[144:147] offset:2048
    v_mfma_f32_16x16x32_bf16 v[164:167], a[16:19], v[204:207], v[164:167]
    v_mfma_f32_16x16x32_bf16 v[168:171], a[128:131], v[204:207], v[168:171]
    v_mfma_f32_16x16x32_bf16 v[172:175], a[132:135], v[204:207], v[172:175]
    s_add_u32 s49, s60, 0
    buffer_load_dwordx4 a[224:227], v22, s[12:15], s49 offen offset:0 sc1
    s_waitcnt vmcnt(14)
    v_mfma_f32_16x16x32_bf16 v[156:159], a[20:23], v[208:211], v[156:159]
    buffer_load_dwordx4 v[248:251], v22, s[12:15], s39 offen offset:3072 sc1
    ds_write_b128 v25, v[148:151] offset:3072
    v_mfma_f32_16x16x32_bf16 v[160:163], a[136:139], v[208:211], v[160:163]
    v_max3_i32 v8, v8, v208, v210
    v_mfma_f32_16x16x32_bf16 v[164:167], a[140:143], v[208:211], v[164:167]
    buffer_load_dwordx4 a[228:231], v22, s[12:15], s49 offen offset:1024 sc1
    v_mfma_f32_16x16x32_bf16 v[168:171], a[24:27], v[208:211], v[168:171]
    v_mfma_f32_16x16x32_bf16 v[172:175], a[144:147], v[208:211], v[172:175]
    ds_write_b128 v25, v[152:155] offset:4096
    s_waitcnt vmcnt(15)
    v_mfma_f32_16x16x32_bf16 v[156:159], a[148:151], v[212:215], v[156:159]
    s_add_u32 s35, s39, 4096
    buffer_load_dwordx4 v[252:255], v22, s[12:15], s35 offen offset:0 sc1
    v_mfma_f32_16x16x32_bf16 v[160:163], a[28:31], v[212:215], v[160:163]
    v_max3_i32 v8, v8, v212, v214
    v_mfma_f32_16x16x32_bf16 v[164:167], a[152:155], v[212:215], v[164:167]
    v_mfma_f32_16x16x32_bf16 v[168:171], a[156:159], v[212:215], v[168:171]
    v_cmp_eq_u32 vcc, s21, v8
    v_mfma_f32_16x16x32_bf16 v[172:175], a[32:35], v[212:215], v[172:175]
    s_nop 0
    s_cbranch_vccnz L_k4r_28
L_k4t_29:
    s_waitcnt vmcnt(11)
    v_mfma_f32_16x16x32_bf16 v[136:139], a[0:3], v[216:219], 0
    s_add_u32 s49, s60, 0
    buffer_load_dwordx4 a[232:235], v22, s[12:15], s49 offen offset:2048 sc1
    v_mfma_f32_16x16x32_bf16 v[140:143], a[96:99], v[216:219], 0
    v_max_i32 v8, v216, v218
    v_mfma_f32_16x16x32_bf16 v[144:147], a[100:103], v[216:219], 0
L_ss_23:
    v_max3_i32 v6, v10, v11, v12
    v_max_i32 v6, v6, v13
    v_cmp_eq_u32 vcc, s21, v6
    v_add_f32 v6, v10, v12
    v_add_f32 v7, v11, v13
    s_lshl_b32 s41, s3, 9
    v_lshl_add_u32 v15, v1, 3, s41
    s_cbranch_vccnz L_ssr_24
    ds_write_b64 v15, v[6:7] offset:61440
    v_mfma_f32_16x16x32_bf16 v[148:151], a[4:7], v[216:219], 0
    ds_write_b128 v26, v[156:159] offset:0
    v_mfma_f32_16x16x32_bf16 v[152:155], a[104:107], v[216:219], 0
    buffer_load_dwordx4 a[236:239], v22, s[12:15], s49 offen offset:3072 sc1
    s_waitcnt vmcnt(12)
    v_mfma_f32_16x16x32_bf16 v[136:139], a[108:111], v[220:223], v[136:139]
    v_mfma_f32_16x16x32_bf16 v[140:143], a[8:11], v[220:223], v[140:143]
    v_max3_i32 v8, v8, v220, v222
    v_mfma_f32_16x16x32_bf16 v[144:147], a[112:115], v[220:223], v[144:147]
    ds_write_b128 v26, v[160:163] offset:1024
    s_add_u32 s49, s60, 4096
    buffer_load_dwordx4 a[240:243], v22, s[12:15], s49 offen offset:0 sc1
    v_mfma_f32_16x16x32_bf16 v[148:151], a[116:119], v[220:223], v[148:151]
    v_mfma_f32_16x16x32_bf16 v[152:155], a[12:15], v[220:223], v[152:155]
    s_waitcnt vmcnt(12)
    v_mfma_f32_16x16x32_bf16 v[136:139], a[120:123], v[224:227], v[136:139]
    v_mfma_f32_16x16x32_bf16 v[140:143], a[124:127], v[224:227], v[140:143]
    v_max3_i32 v8, v8, v224, v226
    ds_write_b128 v26, v[164:167] offset:2048
    buffer_load_dwordx4 a[244:247], v22, s[12:15], s49 offen offset:1024 sc1
    v_mfma_f32_16x16x32_bf16 v[144:147], a[16:19], v[224:227], v[144:147]
    v_mfma_f32_16x16x32_bf16 v[148:151], a[128:131], v[224:227], v[148:151]
    v_mfma_f32_16x16x32_bf16 v[152:155], a[132:135], v[224:227], v[152:155]
    buffer_load_dwordx4 a[248:251], v22, s[12:15], s49 offen offset:2048 sc1
    s_waitcnt vmcnt(13)
    v_mfma_f32_16x16x32_bf16 v[136:139], a[20:23], v[228:231], v[136:139]
    ds_write_b128 v26, v[168:171] offset:3072
    v_mfma_f32_16x16x32_bf16 v[140:143], a[136:139], v[228:231], v[140:143]
    v_max3_i32 v8, v8, v228, v230
    v_mfma_f32_16x16x32_bf16 v[144:147], a[140:143], v[228:231], v[144:147]
    buffer_load_dwordx4 a[252:255], v22, s[12:15], s49 offen offset:3072 sc1
    v_mfma_f32_16x16x32_bf16 v[148:151], a[24:27], v[228:231], v[148:151]
    v_mfma_f32_16x16x32_bf16 v[152:155], a[144:147], v[228:231], v[152:155]
    ds_write_b128 v26, v[172:175] offset:4096
    s_waitcnt vmcnt(13)
    v_mfma_f32_16x16x32_bf16 v[136:139], a[148:151], v[232:235], v[136:139]
    v_mfma_f32_16x16x32_bf16 v[140:143], a[28:31], v[232:235], v[140:143]
    v_max3_i32 v8, v8, v232, v234
    v_mfma_f32_16x16x32_bf16 v[144:147], a[152:155], v[232:235], v[144:147]
    v_mfma_f32_16x16x32_bf16 v[148:151], a[156:159], v[232:235], v[148:151]
    v_cmp_eq_u32 vcc, s21, v8
    v_mfma_f32_16x16x32_bf16 v[152:155], a[32:35], v[232:235], v[152:155]
    s_waitcnt lgkmcnt(0)
    s_cbranch_vccnz L_k4r_30
    s_barrier
L_k4t_31:
    ds_read_b64 v[216:217], v18 offset:61440
    ds_read_b64 v[218:219], v18 offset:61952
    ds_read_b64 v[220:221], v18 offset:62464
    ds_read_b64 v[222:223], v18 offset:62976
    s_waitcnt vmcnt(12)
    v_mfma_f32_16x16x32_bf16 v[156:159], a[0:3], v[236:239], 0
    s_add_u32 s49, s60, 8192
    buffer_load_dwordx4 a[200:203], v22, s[12:15], s49 offen offset:0 sc1
    ds_read_b128 v[176:179], v28 offset:0
    v_mfma_f32_16x16x32_bf16 v[160:163], a[96:99], v[236:239], 0
    v_max_i32 v8, v236, v238
    ds_read_b128 v[180:183], v28 offset:1024
    v_mfma_f32_16x16x32_bf16 v[164:167], a[100:103], v[236:239], 0
    ds_read_b128 v[184:187], v28 offset:2048
    v_mfma_f32_16x16x32_bf16 v[168:171], a[4:7], v[236:239], 0
    ds_write_b128 v27, v[136:139] offset:0
    ds_read_b128 v[188:191], v28 offset:3072
    v_mfma_f32_16x16x32_bf16 v[172:175], a[104:107], v[236:239], 0
    buffer_load_dwordx4 a[204:207], v22, s[12:15], s49 offen offset:1024 sc1
    ds_read_b128 v[192:195], v28 offset:4096
    s_waitcnt vmcnt(13)
    v_mfma_f32_16x16x32_bf16 v[156:159], a[108:111], v[240:243], v[156:159]
    ds_read_b128 v[196:199], v28 offset:5120
    v_mfma_f32_16x16x32_bf16 v[160:163], a[8:11], v[240:243], v[160:163]
    v_max3_i32 v8, v8, v240, v242
    ds_read_b128 v[200:203], v28 offset:6144
    s_waitcnt lgkmcnt(8)
    v_add_f32 v216, v216, v218
    v_add_f32 v217, v217, v219
    v_mfma_f32_16x16x32_bf16 v[164:167], a[112:115], v[240:243], v[164:167]
    ds_write_b128 v27, v[140:143] offset:1024
    buffer_load_dwordx4 a[208:211], v22, s[12:15], s49 offen offset:2048 sc1
    ds_read_b128 v[204:207], v28 offset:7168
    v_add_f32 v220, v220, v222
    v_mfma_f32_16x16x32_bf16 v[168:171], a[116:119], v[240:243], v[168:171]
    ds_read_b128 v[208:211], v28 offset:8192
    v_add_f32 v221, v221, v223
    v_add_f32 v216, v216, v220
    v_mfma_f32_16x16x32_bf16 v[172:175], a[12:15], v[240:243], v[172:175]
    ds_read_b128 v[212:215], v28 offset:9216
    v_add_f32 v217, v217, v221
    s_waitcnt vmcnt(13)
    v_mfma_f32_16x16x32_bf16 v[156:159], a[120:123], v[244:247], v[156:159]
    v_mul_f32 v216, 0x3acccccd, v216
    v_mul_f32 v217, 0x3acccccd, v217
    v_mfma_f32_16x16x32_bf16 v[160:163], a[124:127], v[244:247], v[160:163]
    v_max3_i32 v8, v8, v244, v246
    ds_write_b128 v27, v[144:147] offset:2048
    buffer_load_dwordx4 a[212:215], v22, s[12:15], s49 offen offset:3072 sc1
    v_fma_f32 v217, -v216, v216, v217
    v_mfma_f32_16x16x32_bf16 v[164:167], a[16:19], v[244:247], v[164:167]
    v_max_f32 v217, 0, v217
    v_add_f32 v3, 0x3727c5ac, v217
    v_mfma_f32_16x16x32_bf16 v[168:171], a[128:131], v[244:247], v[168:171]
    v_rsq_f32 v20, v3
    v_mfma_f32_16x16x32_bf16 v[172:175], a[132:135], v[244:247], v[172:175]
    s_add_u32 s49, s60, 12288
    buffer_load_dwordx4 a[216:219], v22, s[12:15], s49 offen offset:0 sc1
    v_sub_f32 v4, 0, v216
    v_mul_f32 v3, v217, v20
    s_waitcnt vmcnt(13)
    v_mfma_f32_16x16x32_bf16 v[156:159], a[20:23], v[248:251], v[156:159]
    ds_write_b128 v27, v[148:151] offset:3072
    v_mul_f32 v3, v3, v20
    v_mfma_f32_16x16x32_bf16 v[160:163], a[136:139], v[248:251], v[160:163]
    v_max3_i32 v8, v8, v248, v250
    v_add_f32 v3, 0x3727c5ac, v3
    v_rsq_f32 v3, v3
    v_mfma_f32_16x16x32_bf16 v[164:167], a[140:143], v[248:251], v[164:167]
    buffer_load_dwordx4 a[220:223], v22, s[12:15], s49 offen offset:1024 sc1
    v_mul_f32 v21, v4, v20
    v_mfma_f32_16x16x32_bf16 v[168:171], a[24:27], v[248:251], v[168:171]
    v_mul_f32 v3, v3, v20
    v_rcp_f32 v5, v3
    v_mfma_f32_16x16x32_bf16 v[172:175], a[144:147], v[248:251], v[172:175]
    ds_write_b128 v27, v[152:155] offset:4096
    v_mul_f32 v7, 0xc0135761, v3
    s_waitcnt vmcnt(12)
    v_mfma_f32_16x16x32_bf16 v[156:159], a[148:151], v[252:255], v[156:159]
    v_mul_f32 v6, v3, v3
    v_mul_f32 v6, v6, v7
    v_mfma_f32_16x16x32_bf16 v[160:163], a[28:31], v[252:255], v[160:163]
    v_max3_i32 v8, v8, v252, v254
    v_mul_f32 v6, 0x3d372713, v6
    v_mfma_f32_16x16x32_bf16 v[164:167], a[152:155], v[252:255], v[164:167]
    v_mfma_f32_16x16x32_bf16 v[168:171], a[156:159], v[252:255], v[168:171]
    v_cmp_eq_u32 vcc, s21, v8
    v_mfma_f32_16x16x32_bf16 v[172:175], a[32:35], v[252:255], v[172:175]
    s_waitcnt lgkmcnt(0)
    s_cbranch_vccnz L_k4r_32
    s_barrier
    ds_read_b128 v[216:219], v28 offset:10240
    ds_read_b128 v[220:223], v28 offset:11264
    ds_read_b128 v[224:227], v28 offset:12288
    ds_read_b128 v[228:231], v28 offset:13312
    ds_read_b128 v[232:235], v28 offset:14336
    v_pk_add_f32 v[176:177], v[176:177], v[196:197]
    v_pk_add_f32 v[178:179], v[178:179], v[198:199]
    v_pk_add_f32 v[180:181], v[180:181], v[200:201]
    v_pk_add_f32 v[182:183], v[182:183], v[202:203]
    v_pk_add_f32 v[184:185], v[184:185], v[204:205]
    v_pk_add_f32 v[186:187], v[186:187], v[206:207]
    v_pk_add_f32 v[188:189], v[188:189], v[208:209]
    v_pk_add_f32 v[190:191], v[190:191], v[210:211]
    v_pk_add_f32 v[192:193], v[192:193], v[212:213]
    v_pk_add_f32 v[194:195], v[194:195], v[214:215]
    v_pk_fma_f32 v[176:177], v[116:117], v[4:5], v[176:177] op_sel_hi:[1,0,1]
    v_pk_fma_f32 v[178:179], v[118:119], v[4:5], v[178:179] op_sel_hi:[1,0,1]
    v_pk_fma_f32 v[180:181], v[120:121], v[4:5], v[180:181] op_sel_hi:[1,0,1]
    v_pk_fma_f32 v[182:183], v[122:123], v[4:5], v[182:183] op_sel_hi:[1,0,1]
    v_pk_fma_f32 v[184:185], v[124:125], v[4:5], v[184:185] op_sel_hi:[1,0,1]
    v_pk_fma_f32 v[186:187], v[126:127], v[4:5], v[186:187] op_sel_hi:[1,0,1]
    v_pk_fma_f32 v[188:189], v[128:129], v[4:5], v[188:189] op_sel_hi:[1,0,1]
    v_pk_fma_f32 v[190:191], v[130:131], v[4:5], v[190:191] op_sel_hi:[1,0,1]
    v_pk_fma_f32 v[192:193], v[132:133], v[4:5], v[192:193] op_sel_hi:[1,0,1]
    v_pk_fma_f32 v[194:195], v[134:135], v[4:5], v[194:195] op_sel_hi:[1,0,1]
    v_pk_add_f32 v[156:157], v[156:157], v[176:177]
    v_pk_add_f32 v[158:159], v[158:159], v[178:179]
    v_pk_add_f32 v[160:161], v[160:161], v[180:181]
    v_pk_add_f32 v[162:163], v[162:163], v[182:183]
    v_pk_add_f32 v[164:165], v[164:165], v[184:185]
    v_pk_add_f32 v[166:167], v[166:167], v[186:187]
    v_pk_add_f32 v[168:169], v[168:169], v[188:189]
    v_pk_add_f32 v[170:171], v[170:171], v[190:191]
    v_pk_add_f32 v[172:173], v[172:173], v[192:193]
    v_pk_add_f32 v[174:175], v[174:175], v[194:195]
    s_waitcnt lgkmcnt(0)
    v_pk_add_f32 v[156:157], v[156:157], v[216:217]
    v_pk_add_f32 v[158:159], v[158:159], v[218:219]
    v_pk_add_f32 v[160:161], v[160:161], v[220:221]
    v_pk_add_f32 v[162:163], v[162:163], v[222:223]
    v_pk_mul_f32 v[136:137], v[156:157], v[156:157]
    v_pk_mul_f32 v[138:139], v[158:159], v[158:159]
    v_pk_mul_f32 v[140:141], v[160:161], v[160:161]
    v_pk_mul_f32 v[142:143], v[162:163], v[162:163]
    v_pk_fma_f32 v[136:137], v[136:137], v[6:7], v[6:7] op_sel:[0,0,1] op_sel_hi:[1,0,1]
    v_pk_fma_f32 v[138:139], v[138:139], v[6:7], v[6:7] op_sel:[0,0,1] op_sel_hi:[1,0,1]
    v_pk_fma_f32 v[140:141], v[140:141], v[6:7], v[6:7] op_sel:[0,0,1] op_sel_hi:[1,0,1]
    v_pk_fma_f32 v[142:143], v[142:143], v[6:7], v[6:7] op_sel:[0,0,1] op_sel_hi:[1,0,1]
    v_pk_mul_f32 v[136:137], v[136:137], v[156:157]
    v_pk_mul_f32 v[138:139], v[138:139], v[158:159]
    v_pk_mul_f32 v[140:141], v[140:141], v[160:161]
    v_pk_mul_f32 v[142:143], v[142:143], v[162:163]
    v_exp_f32 v136, v136
    v_exp_f32 v137, v137
    v_exp_f32 v138, v138
    v_exp_f32 v139, v139
    v_exp_f32 v140, v140
    v_exp_f32 v141, v141
    v_exp_f32 v142, v142
    v_exp_f32 v143, v143
    v_pk_fma_f32 v[136:137], v[136:137], v[4:5], v[4:5] op_sel:[0,1,1] op_sel_hi:[1,1,1]
    v_pk_fma_f32 v[138:139], v[138:139], v[4:5], v[4:5] op_sel:[0,1,1] op_sel_hi:[1,1,1]
    v_pk_fma_f32 v[140:141], v[140:141], v[4:5], v[4:5] op_sel:[0,1,1] op_sel_hi:[1,1,1]
    v_pk_fma_f32 v[142:143], v[142:143], v[4:5], v[4:5] op_sel:[0,1,1] op_sel_hi:[1,1,1]
    v_rcp_f32 v136, v136
    v_rcp_f32 v137, v137
    v_rcp_f32 v138, v138
    v_rcp_f32 v139, v139
    v_rcp_f32 v140, v140
    v_rcp_f32 v141, v141
    v_rcp_f32 v142, v142
    v_rcp_f32 v143, v143
    v_pk_mul_f32 v[136:137], v[136:137], v[156:157]
    v_pk_mul_f32 v[138:139], v[138:139], v[158:159]
    v_pk_mul_f32 v[140:141], v[140:141], v[160:161]
    v_pk_mul_f32 v[142:143], v[142:143], v[162:163]
    v_cvt_pk_bf16_f32 v176, v136, v137
    v_cvt_pk_bf16_f32 v177, v138, v139
    v_cvt_pk_bf16_f32 v178, v140, v141
    v_cvt_pk_bf16_f32 v179, v142, v143
    v_pk_add_f32 v[164:165], v[164:165], v[224:225]
    v_pk_add_f32 v[166:167], v[166:167], v[226:227]
    v_pk_add_f32 v[168:169], v[168:169], v[228:229]
    v_pk_add_f32 v[170:171], v[170:171], v[230:231]
    v_pk_mul_f32 v[144:145], v[164:165], v[164:165]
    v_pk_mul_f32 v[146:147], v[166:167], v[166:167]
    v_pk_mul_f32 v[148:149], v[168:169], v[168:169]
    v_pk_mul_f32 v[150:151], v[170:171], v[170:171]
    v_pk_fma_f32 v[144:145], v[144:145], v[6:7], v[6:7] op_sel:[0,0,1] op_sel_hi:[1,0,1]
    v_pk_fma_f32 v[146:147], v[146:147], v[6:7], v[6:7] op_sel:[0,0,1] op_sel_hi:[1,0,1]
    v_pk_fma_f32 v[148:149], v[148:149], v[6:7], v[6:7] op_sel:[0,0,1] op_sel_hi:[1,0,1]
    v_pk_fma_f32 v[150:151], v[150:151], v[6:7], v[6:7] op_sel:[0,0,1] op_sel_hi:[1,0,1]
    v_pk_mul_f32 v[144:145], v[144:145], v[164:165]
    v_pk_mul_f32 v[146:147], v[146:147], v[166:167]
    v_pk_mul_f32 v[148:149], v[148:149], v[168:169]
    v_pk_mul_f32 v[150:151], v[150:151], v[170:171]
    v_exp_f32 v144, v144
    v_exp_f32 v145, v145
    v_exp_f32 v146, v146
    v_exp_f32 v147, v147
    v_exp_f32 v148, v148
    v_exp_f32 v149, v149
    v_exp_f32 v150, v150
    v_exp_f32 v151, v151
    v_pk_fma_f32 v[144:145], v[144:145], v[4:5], v[4:5] op_sel:[0,1,1] op_sel_hi:[1,1,1]
    v_pk_fma_f32 v[146:147], v[146:147], v[4:5], v[4:5] op_sel:[0,1,1] op_sel_hi:[1,1,1]
    v_pk_fma_f32 v[148:149], v[148:149], v[4:5], v[4:5] op_sel:[0,1,1] op_sel_hi:[1,1,1]
    v_pk_fma_f32 v[150:151], v[150:151], v[4:5], v[4:5] op_sel:[0,1,1] op_sel_hi:[1,1,1]
    v_rcp_f32 v144, v144
    v_rcp_f32 v145, v145
    v_rcp_f32 v146, v146
    v_rcp_f32 v147, v147
    v_rcp_f32 v148, v148
    v_rcp_f32 v149, v149
    v_rcp_f32 v150, v150
    v_rcp_f32 v151, v151
    v_pk_mul_f32 v[144:145], v[144:145], v[164:165]
    v_pk_mul_f32 v[146:147], v[146:147], v[166:167]
    v_pk_mul_f32 v[148:149], v[148:149], v[168:169]
    v_pk_mul_f32 v[150:151], v[150:151], v[170:171]
    v_cvt_pk_bf16_f32 v180, v144, v145
    v_cvt_pk_bf16_f32 v181, v146, v147
    v_cvt_pk_bf16_f32 v182, v148, v149
    v_cvt_pk_bf16_f32 v183, v150, v151
    v_pk_add_f32 v[172:173], v[172:173], v[232:233]
    v_pk_add_f32 v[174:175], v[174:175], v[234:235]
    v_pk_mul_f32 v[152:153], v[172:173], v[172:173]
    v_pk_mul_f32 v[154:155], v[174:175], v[174:175]
    v_pk_fma_f32 v[152:153], v[152:153], v[6:7], v[6:7] op_sel:[0,0,1] op_sel_hi:[1,0,1]
    v_pk_fma_f32 v[154:155], v[154:155], v[6:7], v[6:7] op_sel:[0,0,1] op_sel_hi:[1,0,1]
    v_pk_mul_f32 v[152:153], v[152:153], v[172:173]
    v_pk_mul_f32 v[154:155], v[154:155], v[174:175]
    v_exp_f32 v152, v152
    v_exp_f32 v153, v153
    v_exp_f32 v154, v154
    v_exp_f32 v155, v155
    v_pk_fma_f32 v[152:153], v[152:153], v[4:5], v[4:5] op_sel:[0,1,1] op_sel_hi:[1,1,1]
    v_pk_fma_f32 v[154:155], v[154:155], v[4:5], v[4:5] op_sel:[0,1,1] op_sel_hi:[1,1,1]
    v_rcp_f32 v152, v152
    v_rcp_f32 v153, v153
    v_rcp_f32 v154, v154
    v_rcp_f32 v155, v155
    v_pk_mul_f32 v[152:153], v[152:153], v[172:173]
    v_pk_mul_f32 v[154:155], v[154:155], v[174:175]
    v_cvt_pk_bf16_f32 v184, v152, v153
    v_cvt_pk_bf16_f32 v185, v154, v155
    s_add_u32 s42, s57, 14155776
    buffer_store_dwordx4 v[176:179], v22, s[12:15], s42 offen sc1
    v_mov_b32 v252, v184
    v_mov_b32 v253, v185
    v_mov_b32 v254, v184
    v_mov_b32 v255, v185
    buffer_store_dwordx4 v[180:183], v22, s[12:15], s42 offen offset:1024 sc1
    v_permlane16_swap_b32 v252, v254
    v_permlane16_swap_b32 v253, v255
    buffer_store_dwordx4 v[252:255], v29, s[12:15], s42 offen offset:2048 sc1
    s_lshr_b32 s42, s3, 1
    s_add_u32 s42, s42, 1
    s_bitcmp1_b32 s3, 0
    s_cselect_b32 s43, 1, -1
    s_mul_i32 s42, s42, s43
    s_mul_i32 s36, s3, 5120
    s_add_u32 s36, s36, 14155776
    s_mov_b32 s37, s36
    s_mov_b32 s38, s36
    s_add_u32 s49, s60, 36864
    buffer_load_dwordx4 a[28:31], v22, s[12:15], s49 offen offset:2048 sc1
    s_mov_b32 s39, s36
    s_lshl_b32 s43, s27, 6
    s_add_u32 s42, s42, s43
    v_and_b32 v16, 15, v1
    v_and_b32 v17, 0x300, v22
    v_mov_b32 v6, 0x80000000
    s_xor_b32 s35, s20, 2
    s_lshl_b32 s35, s35, 4
    buffer_load_dwordx4 a[152:155], v22, s[12:15], s49 offen offset:3072 sc1
    s_add_u32 s35, s35, s42
    v_add_u32 v5, s35, v16
    v_cmp_gt_u32 vcc, 2048, v5
    v_lshrrev_b32 v4, 4, v5
    v_mul_u32_u24 v4, 20480, v4
    v_and_b32 v5, 15, v5
    v_lshl_add_u32 v5, v5, 4, v17
    v_add_u32 v5, v5, v4
    s_add_u32 s49, s60, 40960
    buffer_load_dwordx4 a[156:159], v22, s[12:15], s49 offen offset:0 sc1
    v_cndmask_b32 v12, v6, v5, vcc
    s_xor_b32 s35, s20, 3
    s_lshl_b32 s35, s35, 4
    s_add_u32 s35, s35, s42
    v_add_u32 v5, s35, v16
    v_cmp_gt_u32 vcc, 2048, v5
    v_lshrrev_b32 v4, 4, v5
    v_mul_u32_u24 v4, 20480, v4
    buffer_load_dwordx4 a[32:35], v22, s[12:15], s49 offen offset:1024 sc1
    v_and_b32 v5, 15, v5
    v_lshl_add_u32 v5, v5, 4, v17
    v_add_u32 v5, v5, v4
    v_cndmask_b32 v13, v6, v5, vcc
    s_xor_b32 s35, s20, 1
    s_lshl_b32 s35, s35, 4
    s_add_u32 s35, s35, s42
    v_add_u32 v5, s35, v16
    buffer_load_dwordx4 v[76:79], v22, s[12:15], s49 offen offset:2048 sc1
    v_cmp_gt_u32 vcc, 2048, v5
    v_lshrrev_b32 v4, 4, v5
    v_mul_u32_u24 v4, 20480, v4
    v_and_b32 v5, 15, v5
    v_lshl_add_u32 v5, v5, 4, v17
    v_add_u32 v5, v5, v4
    v_cndmask_b32 v14, v6, v5, vcc
    s_xor_b32 s35, s20, 0
    buffer_load_dwordx4 v[80:83], v22, s[12:15], s49 offen offset:3072 sc1
    s_lshl_b32 s35, s35, 4
    s_add_u32 s35, s35, s42
    v_add_u32 v5, s35, v16
    v_cmp_gt_u32 vcc, 2048, v5
    v_lshrrev_b32 v4, 4, v5
    v_mul_u32_u24 v4, 20480, v4
    v_and_b32 v5, 15, v5
    v_lshl_add_u32 v5, v5, 4, v17
    s_add_u32 s49, s60, 45056
    buffer_load_dwordx4 v[84:87], v22, s[12:15], s49 offen offset:0 sc1
    v_add_u32 v5, v5, v4
    v_cndmask_b32 v15, v6, v5, vcc
    v_mov_b32 v248, 0x3f803f80
    v_mov_b32 v249, 0x3f803f80
    v_mov_b32 v250, 0x3f803f80
    v_mov_b32 v251, 0x3f803f80
    v_lshlrev_b32 v116, 16, v104
    v_and_b32 v117, s29, v104
    buffer_load_dwordx4 v[88:91], v22, s[12:15], s49 offen offset:1024 sc1
    v_lshlrev_b32 v118, 16, v105
    v_and_b32 v119, s29, v105
    v_lshlrev_b32 v120, 16, v106
    v_and_b32 v121, s29, v106
    v_lshlrev_b32 v122, 16, v107
    v_and_b32 v123, s29, v107
    v_lshlrev_b32 v124, 16, v108
    v_and_b32 v125, s29, v108
    buffer_load_dwordx4 v[92:95], v22, s[12:15], s49 offen offset:2048 sc1
    v_lshlrev_b32 v126, 16, v109
    v_and_b32 v127, s29, v109
    v_lshlrev_b32 v128, 16, v110
    v_and_b32 v129, s29, v110
    v_lshlrev_b32 v130, 16, v111
    v_and_b32 v131, s29, v111
    v_lshlrev_b32 v132, 16, v112
    v_and_b32 v133, s29, v112
    buffer_load_dwordx4 v[96:99], v22, s[12:15], s49 offen offset:3072 sc1
    v_lshlrev_b32 v134, 16, v113
    v_and_b32 v135, s29, v113
    v_pk_fma_f32 v[116:117], v[116:117], v[20:21], v[20:21] op_sel:[0,0,1] op_sel_hi:[1,0,1]
    v_pk_fma_f32 v[118:119], v[118:119], v[20:21], v[20:21] op_sel:[0,0,1] op_sel_hi:[1,0,1]
    v_pk_fma_f32 v[120:121], v[120:121], v[20:21], v[20:21] op_sel:[0,0,1] op_sel_hi:[1,0,1]
    v_pk_fma_f32 v[122:123], v[122:123], v[20:21], v[20:21] op_sel:[0,0,1] op_sel_hi:[1,0,1]
    v_pk_fma_f32 v[124:125], v[124:125], v[20:21], v[20:21] op_sel:[0,0,1] op_sel_hi:[1,0,1]
    v_pk_fma_f32 v[126:127], v[126:127], v[20:21], v[20:21] op_sel:[0,0,1] op_sel_hi:[1,0,1]
    s_add_u32 s49, s60, 49152
    buffer_load_dwordx4 v[100:103], v22, s[12:15], s49 offen offset:0 sc1
    v_pk_fma_f32 v[128:129], v[128:129], v[20:21], v[20:21] op_sel:[0,0,1] op_sel_hi:[1,0,1]
    v_pk_fma_f32 v[130:131], v[130:131], v[20:21], v[20:21] op_sel:[0,0,1] op_sel_hi:[1,0,1]
    v_pk_fma_f32 v[132:133], v[132:133], v[20:21], v[20:21] op_sel:[0,0,1] op_sel_hi:[1,0,1]
    v_pk_fma_f32 v[134:135], v[134:135], v[20:21], v[20:21] op_sel:[0,0,1] op_sel_hi:[1,0,1]
    s_nop 0
    s_waitcnt vmcnt(11)
    s_barrier
    buffer_load_dwordx4 v[176:179], v12, s[12:15], s36 offen offset:0 sc1
    buffer_load_dwordx4 v[180:183], v12, s[12:15], s36 offen offset:1024 sc1
    buffer_load_dwordx4 v[184:187], v12, s[12:15], s36 offen offset:2048 sc1
    v_mfma_f32_16x16x32_bf16 a[144:147], v[32:35], v[248:251], 0
    v_mfma_f32_16x16x32_bf16 a[148:151], v[36:39], v[248:251], 0
    v_mfma_f32_16x16x32_bf16 a[24:27], v[40:43], v[248:251], 0
    v_mfma_f32_16x16x32_bf16 a[144:147], v[44:47], v[248:251], a[144:147]
    buffer_load_dwordx4 v[188:191], v12, s[12:15], s36 offen offset:3072 sc1
    v_mfma_f32_16x16x32_bf16 a[148:151], v[48:51], v[248:251], a[148:151]
    v_mfma_f32_16x16x32_bf16 a[24:27], v[52:55], v[248:251], a[24:27]
    v_mfma_f32_16x16x32_bf16 a[144:147], v[56:59], v[248:251], a[144:147]
    v_mfma_f32_16x16x32_bf16 a[148:151], v[60:63], v[248:251], a[148:151]
    s_add_u32 s35, s36, 4096
    buffer_load_dwordx4 v[192:195], v12, s[12:15], s35 offen offset:0 sc1
    v_mfma_f32_16x16x32_bf16 a[24:27], v[64:67], v[248:251], a[24:27]
    v_mfma_f32_16x16x32_bf16 a[144:147], v[68:71], v[248:251], a[144:147]
    v_mfma_f32_16x16x32_bf16 a[148:151], v[72:75], v[248:251], a[148:151]
    v_mfma_f32_16x16x32_bf16 a[24:27], a[224:227], v[248:251], a[24:27]
    buffer_load_dwordx4 v[196:199], v13, s[12:15], s37 offen offset:0 sc1
    v_mfma_f32_16x16x32_bf16 a[144:147], a[228:231], v[248:251], a[144:147]
    v_mfma_f32_16x16x32_bf16 a[148:151], a[232:235], v[248:251], a[148:151]
    v_mfma_f32_16x16x32_bf16 a[24:27], a[236:239], v[248:251], a[24:27]
    v_mfma_f32_16x16x32_bf16 a[144:147], a[240:243], v[248:251], a[144:147]
    buffer_load_dwordx4 v[200:203], v13, s[12:15], s37 offen offset:1024 sc1
    v_mfma_f32_16x16x32_bf16 a[148:151], a[244:247], v[248:251], a[148:151]
    v_mfma_f32_16x16x32_bf16 a[24:27], a[248:251], v[248:251], a[24:27]
    v_mfma_f32_16x16x32_bf16 a[144:147], a[252:255], v[248:251], a[144:147]
    v_mfma_f32_16x16x32_bf16 a[148:151], a[200:203], v[248:251], a[148:151]
    buffer_load_dwordx4 v[204:207], v13, s[12:15], s37 offen offset:2048 sc1
    v_mfma_f32_16x16x32_bf16 a[24:27], a[204:207], v[248:251], a[24:27]
    v_mfma_f32_16x16x32_bf16 a[144:147], a[208:211], v[248:251], a[144:147]
    v_mfma_f32_16x16x32_bf16 a[148:151], a[212:215], v[248:251], a[148:151]
    v_mfma_f32_16x16x32_bf16 a[24:27], a[216:219], v[248:251], a[24:27]
    buffer_load_dwordx4 v[208:211], v13, s[12:15], s37 offen offset:3072 sc1
L_pad_1:
    s_cbranch_execz L_hret_0
    v_mfma_f32_16x16x32_bf16 a[144:147], a[220:223], v[248:251], a[144:147]
    s_waitcnt vmcnt(19)
    v_mfma_f32_16x16x32_bf16 a[148:151], a[28:31], v[248:251], a[148:151]
    s_waitcnt vmcnt(18)
    v_mfma_f32_16x16x32_bf16 a[24:27], a[152:155], v[248:251], a[24:27]
    s_waitcnt vmcnt(17)
    v_mfma_f32_16x16x32_bf16 a[144:147], a[156:159], v[248:251], a[144:147]
    s_add_u32 s35, s37, 4096
    buffer_load_dwordx4 v[212:215], v13, s[12:15], s35 offen offset:0 sc1
    s_waitcnt vmcnt(17)
    v_mfma_f32_16x16x32_bf16 a[148:151], a[32:35], v[248:251], a[148:151]
    s_waitcnt vmcnt(16)
    v_mfma_f32_16x16x32_bf16 a[24:27], v[76:79], v[248:251], a[24:27]
    s_waitcnt vmcnt(15)
    v_mfma_f32_16x16x32_bf16 a[144:147], v[80:83], v[248:251], a[144:147]
    s_waitcnt vmcnt(14)
    v_mfma_f32_16x16x32_bf16 a[148:151], v[84:87], v[248:251], a[148:151]
    buffer_load_dwordx4 v[216:219], v14, s[12:15], s38 offen offset:0 sc1
    s_waitcnt vmcnt(14)
    v_mfma_f32_16x16x32_bf16 a[24:27], v[88:91], v[248:251], a[24:27]
    s_waitcnt vmcnt(13)
    v_mfma_f32_16x16x32_bf16 a[144:147], v[92:95], v[248:251], a[144:147]
    s_waitcnt vmcnt(12)
    v_mfma_f32_16x16x32_bf16 a[148:151], v[96:99], v[248:251], a[148:151]
    s_waitcnt vmcnt(11)
    v_mfma_f32_16x16x32_bf16 a[24:27], v[100:103], v[248:251], a[24:27]
    buffer_load_dwordx4 v[220:223], v14, s[12:15], s38 offen offset:1024 sc1
L_k5t_33:
    s_waitcnt vmcnt(11)
    v_mfma_f32_16x16x32_bf16 v[136:139], a[36:39], v[176:179], 0
    buffer_load_dwordx4 v[224:227], v14, s[12:15], s38 offen offset:2048 sc1
    v_mfma_f32_16x16x32_bf16 v[140:143], a[40:43], v[176:179], 0
    v_max_i32 v8, v176, v178
    v_mfma_f32_16x16x32_bf16 v[144:147], a[44:47], v[176:179], 0
    v_mfma_f32_16x16x32_bf16 v[148:151], a[48:51], v[176:179], 0
    v_mfma_f32_16x16x32_bf16 v[152:155], a[52:55], v[176:179], 0
    s_waitcnt vmcnt(11)
    v_mfma_f32_16x16x32_bf16 v[136:139], a[56:59], v[180:183], v[136:139]
    buffer_load_dwordx4 v[228:231], v14, s[12:15], s38 offen offset:3072 sc1
    v_mfma_f32_16x16x32_bf16 v[140:143], a[60:63], v[180:183], v[140:143]
    v_max3_i32 v8, v8, v180, v182
    v_mfma_f32_16x16x32_bf16 v[144:147], a[64:67], v[180:183], v[144:147]
    v_mfma_f32_16x16x32_bf16 v[148:151], a[68:71], v[180:183], v[148:151]
    v_mfma_f32_16x16x32_bf16 v[152:155], a[72:75], v[180:183], v[152:155]
    s_waitcnt vmcnt(11)
    v_mfma_f32_16x16x32_bf16 v[136:139], a[76:79], v[184:187], v[136:139]
    s_add_u32 s35, s38, 4096
    buffer_load_dwordx4 v[232:235], v14, s[12:15], s35 offen offset:0 sc1
    v_mfma_f32_16x16x32_bf16 v[140:143], a[80:83], v[184:187], v[140:143]
    v_max3_i32 v8, v8, v184, v186
    v_mfma_f32_16x16x32_bf16 v[144:147], a[84:87], v[184:187], v[144:147]
    v_mfma_f32_16x16x32_bf16 v[148:151], a[88:91], v[184:187], v[148:151]
    v_mfma_f32_16x16x32_bf16 v[152:155], a[92:95], v[184:187], v[152:155]
    s_waitcnt vmcnt(11)
    v_mfma_f32_16x16x32_bf16 v[136:139], a[160:163], v[188:191], v[136:139]
    buffer_load_dwordx4 v[236:239], v15, s[12:15], s39 offen offset:0 sc1
    v_mfma_f32_16x16x32_bf16 v[140:143], a[164:167], v[188:191], v[140:143]
    v_max3_i32 v8, v8, v188, v190
    v_mfma_f32_16x16x32_bf16 v[144:147], a[168:171], v[188:191], v[144:147]
    v_mfma_f32_16x16x32_bf16 v[148:151], a[172:175], v[188:191], v[148:151]
    v_mfma_f32_16x16x32_bf16 v[152:155], a[176:179], v[188:191], v[152:155]
    s_waitcnt vmcnt(11)
    v_mfma_f32_16x16x32_bf16 v[136:139], a[180:183], v[192:195], v[136:139]
    buffer_load_dwordx4 v[240:243], v15, s[12:15], s39 offen offset:1024 sc1
    v_mfma_f32_16x16x32_bf16 v[140:143], a[184:187], v[192:195], v[140:143]
    v_max3_i32 v8, v8, v192, v194
    v_mfma_f32_16x16x32_bf16 v[144:147], a[188:191], v[192:195], v[144:147]
    v_mfma_f32_16x16x32_bf16 v[148:151], a[192:195], v[192:195], v[148:151]
    v_cmp_eq_u32 vcc, s21, v8
    v_mfma_f32_16x16x32_bf16 v[152:155], a[196:199], v[192:195], v[152:155]
    s_nop 0
    s_cbranch_vccnz L_k5r_34
L_k5t_35:
    s_waitcnt vmcnt(11)
    v_mfma_f32_16x16x32_bf16 v[156:159], a[36:39], v[196:199], 0
    buffer_load_dwordx4 v[244:247], v15, s[12:15], s39 offen offset:2048 sc1
    v_mfma_f32_16x16x32_bf16 v[160:163], a[40:43], v[196:199], 0
    v_max_i32 v8, v196, v198
    v_mfma_f32_16x16x32_bf16 v[164:167], a[44:47], v[196:199], 0
    v_mfma_f32_16x16x32_bf16 v[168:171], a[48:51], v[196:199], 0
    ds_write_b128 v25, v[136:139] offset:0
    v_mfma_f32_16x16x32_bf16 v[172:175], a[52:55], v[196:199], 0
    s_waitcnt vmcnt(11)
    v_mfma_f32_16x16x32_bf16 v[156:159], a[56:59], v[200:203], v[156:159]
    buffer_load_dwordx4 v[248:251], v15, s[12:15], s39 offen offset:3072 sc1
    v_mfma_f32_16x16x32_bf16 v[160:163], a[60:63], v[200:203], v[160:163]
    v_max3_i32 v8, v8, v200, v202
    v_mfma_f32_16x16x32_bf16 v[164:167], a[64:67], v[200:203], v[164:167]
    ds_write_b128 v25, v[140:143] offset:1024
    v_mfma_f32_16x16x32_bf16 v[168:171], a[68:71], v[200:203], v[168:171]
    v_mfma_f32_16x16x32_bf16 v[172:175], a[72:75], v[200:203], v[172:175]
    s_waitcnt vmcnt(11)
    v_mfma_f32_16x16x32_bf16 v[156:159], a[76:79], v[204:207], v[156:159]
    s_add_u32 s35, s39, 4096
    buffer_load_dwordx4 v[252:255], v15, s[12:15], s35 offen offset:0 sc1
    v_mfma_f32_16x16x32_bf16 v[160:163], a[80:83], v[204:207], v[160:163]
    v_max3_i32 v8, v8, v204, v206
    ds_write_b128 v25, v[144:147] offset:2048
    v_mfma_f32_16x16x32_bf16 v[164:167], a[84:87], v[204:207], v[164:167]
    v_mfma_f32_16x16x32_bf16 v[168:171], a[88:91], v[204:207], v[168:171]
    v_mfma_f32_16x16x32_bf16 v[172:175], a[92:95], v[204:207], v[172:175]
    s_add_u32 s49, s60, 12288
    buffer_load_dwordx4 a[0:3], v22, s[12:15], s49 offen offset:2048 sc1
    s_waitcnt vmcnt(12)
    v_mfma_f32_16x16x32_bf16 v[156:159], a[160:163], v[208:211], v[156:159]
    ds_write_b128 v25, v[148:151] offset:3072
    v_mfma_f32_16x16x32_bf16 v[160:163], a[164:167], v[208:211], v[160:163]
    v_max3_i32 v8, v8, v208, v210
    v_mfma_f32_16x16x32_bf16 v[164:167], a[168:171], v[208:211], v[164:167]
    buffer_load_dwordx4 a[96:99], v22, s[12:15], s49 offen offset:3072 sc1
    v_mfma_f32_16x16x32_bf16 v[168:171], a[172:175], v[208:211], v[168:171]
    v_mfma_f32_16x16x32_bf16 v[172:175], a[176:179], v[208:211], v[172:175]
    ds_write_b128 v25, v[152:155] offset:4096
    s_waitcnt vmcnt(12)
    v_mfma_f32_16x16x32_bf16 v[156:159], a[180:183], v[212:215], v[156:159]
    v_mfma_f32_16x16x32_bf16 v[160:163], a[184:187], v[212:215], v[160:163]
    v_max3_i32 v8, v8, v212, v214
    v_mfma_f32_16x16x32_bf16 v[164:167], a[188:191], v[212:215], v[164:167]
    v_mfma_f32_16x16x32_bf16 v[168:171], a[192:195], v[212:215], v[168:171]
    v_cmp_eq_u32 vcc, s21, v8
    v_mfma_f32_16x16x32_bf16 v[172:175], a[196:199], v[212:215], v[172:175]
    s_nop 0
    s_cbranch_vccnz L_k5r_36
L_k5t_37:
    s_waitcnt vmcnt(11)
    v_mfma_f32_16x16x32_bf16 v[136:139], a[36:39], v[216:219], 0
    s_add_u32 s49, s60, 16384
    buffer_load_dwordx4 a[100:103], v22, s[12:15], s49 offen offset:0 sc1
    v_mfma_f32_16x16x32_bf16 v[140:143], a[40:43], v[216:219], 0
    v_max_i32 v8, v216, v218
    v_mfma_f32_16x16x32_bf16 v[144:147], a[44:47], v[216:219], 0
    v_mfma_f32_16x16x32_bf16 v[148:151], a[48:51], v[216:219], 0
    ds_write_b128 v26, v[156:159] offset:0
    v_mfma_f32_16x16x32_bf16 v[152:155], a[52:55], v[216:219], 0
    buffer_load_dwordx4 a[4:7], v22, s[12:15], s49 offen offset:1024 sc1
    s_waitcnt vmcnt(12)
    v_mfma_f32_16x16x32_bf16 v[136:139], a[56:59], v[220:223], v[136:139]
    v_mfma_f32_16x16x32_bf16 v[140:143], a[60:63], v[220:223], v[140:143]
    v_max3_i32 v8, v8, v220, v222
    v_mfma_f32_16x16x32_bf16 v[144:147], a[64:67], v[220:223], v[144:147]
    ds_write_b128 v26, v[160:163] offset:1024
    buffer_load_dwordx4 a[104:107], v22, s[12:15], s49 offen offset:2048 sc1
    v_mfma_f32_16x16x32_bf16 v[148:151], a[68:71], v[220:223], v[148:151]
    v_mfma_f32_16x16x32_bf16 v[152:155], a[72:75], v[220:223], v[152:155]
    s_waitcnt vmcnt(12)
    v_mfma_f32_16x16x32_bf16 v[136:139], a[76:79], v[224:227], v[136:139]
    v_mfma_f32_16x16x32_bf16 v[140:143], a[80:83], v[224:227], v[140:143]
    v_max3_i32 v8, v8, v224, v226
    ds_write_b128 v26, v[164:167] offset:2048
    buffer_load_dwordx4 a[108:111], v22, s[12:15], s49 offen offset:3072 sc1
    v_mfma_f32_16x16x32_bf16 v[144:147], a[84:87], v[224:227], v[144:147]
    v_mfma_f32_16x16x32_bf16 v[148:151], a[88:91], v[224:227], v[148:151]
    v_mfma_f32_16x16x32_bf16 v[152:155], a[92:95], v[224:227], v[152:155]
    s_add_u32 s49, s60, 20480
    buffer_load_dwordx4 a[8:11], v22, s[12:15], s49 offen offset:0 sc1
    s_waitcnt vmcnt(13)
    v_mfma_f32_16x16x32_bf16 v[136:139], a[160:163], v[228:231], v[136:139]
    ds_write_b128 v26, v[168:171] offset:3072
    v_mfma_f32_16x16x32_bf16 v[140:143], a[164:167], v[228:231], v[140:143]
    v_max3_i32 v8, v8, v228, v230
    v_mfma_f32_16x16x32_bf16 v[144:147], a[168:171], v[228:231], v[144:147]
    buffer_load_dwordx4 a[112:115], v22, s[12:15], s49 offen offset:1024 sc1
    v_mfma_f32_16x16x32_bf16 v[148:151], a[172:175], v[228:231], v[148:151]
    v_mfma_f32_16x16x32_bf16 v[152:155], a[176:179], v[228:231], v[152:155]
    ds_write_b128 v26, v[172:175] offset:4096
    s_waitcnt vmcnt(13)
    v_mfma_f32_16x16x32_bf16 v[136:139], a[180:183], v[232:235], v[136:139]
    v_mfma_f32_16x16x32_bf16 v[140:143], a[184:187], v[232:235], v[140:143]
    v_max3_i32 v8, v8, v232, v234
    v_mfma_f32_16x16x32_bf16 v[144:147], a[188:191], v[232:235], v[144:147]
    v_mfma_f32_16x16x32_bf16 v[148:151], a[192:195], v[232:235], v[148:151]
    v_cmp_eq_u32 vcc, s21, v8
    v_mfma_f32_16x16x32_bf16 v[152:155], a[196:199], v[232:235], v[152:155]
    s_waitcnt lgkmcnt(0)
    s_cbranch_vccnz L_k5r_38
    s_barrier
L_k5t_39:
    s_waitcnt vmcnt(12)
    v_mfma_f32_16x16x32_bf16 v[156:159], a[36:39], v[236:239], v[116:119]
    s_add_u32 s49, s60, 20480
    buffer_load_dwordx4 a[116:119], v22, s[12:15], s49 offen offset:2048 sc1
    ds_read_b128 v[176:179], v28 offset:0
    v_mfma_f32_16x16x32_bf16 v[160:163], a[40:43], v[236:239], v[120:123]
    v_max_i32 v8, v236, v238
    v_mfma_f32_16x16x32_bf16 v[164:167], a[44:47], v[236:239], v[124:127]
    ds_read_b128 v[180:183], v28 offset:1024
    v_mfma_f32_16x16x32_bf16 v[168:171], a[48:51], v[236:239], v[128:131]
    ds_write_b128 v27, v[136:139] offset:0
    v_mfma_f32_16x16x32_bf16 v[172:175], a[52:55], v[236:239], v[132:135]
    buffer_load_dwordx4 a[12:15], v22, s[12:15], s49 offen offset:3072 sc1
    ds_read_b128 v[184:187], v28 offset:2048
    s_waitcnt vmcnt(13)
    v_mfma_f32_16x16x32_bf16 v[156:159], a[56:59], v[240:243], v[156:159]
    v_mfma_f32_16x16x32_bf16 v[160:163], a[60:63], v[240:243], v[160:163]
    v_max3_i32 v8, v8, v240, v242
    ds_read_b128 v[188:191], v28 offset:3072
    v_mfma_f32_16x16x32_bf16 v[164:167], a[64:67], v[240:243], v[164:167]
    ds_write_b128 v27, v[140:143] offset:1024
    s_add_u32 s49, s60, 24576
    buffer_load_dwordx4 a[120:123], v22, s[12:15], s49 offen offset:0 sc1
    v_mfma_f32_16x16x32_bf16 v[168:171], a[68:71], v[240:243], v[168:171]
    ds_read_b128 v[192:195], v28 offset:4096
    v_mfma_f32_16x16x32_bf16 v[172:175], a[72:75], v[240:243], v[172:175]
    s_waitcnt vmcnt(13)
    v_mfma_f32_16x16x32_bf16 v[156:159], a[76:79], v[244:247], v[156:159]
    ds_read_b128 v[196:199], v28 offset:5120
    v_mfma_f32_16x16x32_bf16 v[160:163], a[80:83], v[244:247], v[160:163]
    v_max3_i32 v8, v8, v244, v246
    ds_write_b128 v27, v[144:147] offset:2048
    buffer_load_dwordx4 a[124:127], v22, s[12:15], s49 offen offset:1024 sc1
    v_mfma_f32_16x16x32_bf16 v[164:167], a[84:87], v[244:247], v[164:167]
    ds_read_b128 v[200:203], v28 offset:6144
    v_mfma_f32_16x16x32_bf16 v[168:171], a[88:91], v[244:247], v[168:171]
    v_mfma_f32_16x16x32_bf16 v[172:175], a[92:95], v[244:247], v[172:175]
    buffer_load_dwordx4 a[16:19], v22, s[12:15], s49 offen offset:2048 sc1
    ds_read_b128 v[204:207], v28 offset:7168
    s_waitcnt vmcnt(14)
    v_mfma_f32_16x16x32_bf16 v[156:159], a[160:163], v[248:251], v[156:159]
    ds_write_b128 v27, v[148:151] offset:3072
    v_mfma_f32_16x16x32_bf16 v[160:163], a[164:167], v[248:251], v[160:163]
    v_max3_i32 v8, v8, v248, v250
    ds_read_b128 v[208:211], v28 offset:8192
    v_mfma_f32_16x16x32_bf16 v[164:167], a[168:171], v[248:251], v[164:167]
    buffer_load_dwordx4 a[128:131], v22, s[12:15], s49 offen offset:3072 sc1
    v_mfma_f32_16x16x32_bf16 v[168:171], a[172:175], v[248:251], v[168:171]
    ds_read_b128 v[212:215], v28 offset:9216
    v_mfma_f32_16x16x32_bf16 v[172:175], a[176:179], v[248:251], v[172:175]
    ds_write_b128 v27, v[152:155] offset:4096
    s_waitcnt vmcnt(14)
    v_mfma_f32_16x16x32_bf16 v[156:159], a[180:183], v[252:255], v[156:159]
    v_mfma_f32_16x16x32_bf16 v[160:163], a[184:187], v[252:255], v[160:163]
    v_max3_i32 v8, v8, v252, v254
    v_mfma_f32_16x16x32_bf16 v[164:167], a[188:191], v[252:255], v[164:167]
    v_mfma_f32_16x16x32_bf16 v[168:171], a[192:195], v[252:255], v[168:171]
    v_cmp_eq_u32 vcc, s21, v8
    v_mfma_f32_16x16x32_bf16 v[172:175], a[196:199], v[252:255], v[172:175]
    s_waitcnt lgkmcnt(0)
    s_cbranch_vccnz L_k5r_40
    s_barrier
    ds_read_b128 v[216:219], v28 offset:10240
    ds_read_b128 v[220:223], v28 offset:11264
    ds_read_b128 v[224:227], v28 offset:12288
    ds_read_b128 v[228:231], v28 offset:13312
    ds_read_b128 v[232:235], v28 offset:14336
    v_pk_add_f32 v[176:177], v[176:177], v[196:197]
    v_pk_add_f32 v[178:179], v[178:179], v[198:199]
    v_pk_add_f32 v[180:181], v[180:181], v[200:201]
    v_pk_add_f32 v[182:183], v[182:183], v[202:203]
    v_pk_add_f32 v[184:185], v[184:185], v[204:205]
    v_pk_add_f32 v[186:187], v[186:187], v[206:207]
    v_pk_add_f32 v[188:189], v[188:189], v[208:209]
    v_pk_add_f32 v[190:191], v[190:191], v[210:211]
    v_pk_add_f32 v[192:193], v[192:193], v[212:213]
    v_pk_add_f32 v[194:195], v[194:195], v[214:215]
    v_pk_add_f32 v[156:157], v[156:157], v[176:177]
    v_pk_add_f32 v[158:159], v[158:159], v[178:179]
    v_pk_add_f32 v[160:161], v[160:161], v[180:181]
    v_pk_add_f32 v[162:163], v[162:163], v[182:183]
    v_pk_add_f32 v[164:165], v[164:165], v[184:185]
    v_pk_add_f32 v[166:167], v[166:167], v[186:187]
    v_pk_add_f32 v[168:169], v[168:169], v[188:189]
    v_pk_add_f32 v[170:171], v[170:171], v[190:191]
    v_pk_add_f32 v[172:173], v[172:173], v[192:193]
    v_pk_add_f32 v[174:175], v[174:175], v[194:195]
    s_waitcnt lgkmcnt(0)
    v_pk_add_f32 v[156:157], v[156:157], v[216:217]
    v_pk_add_f32 v[158:159], v[158:159], v[218:219]
    v_pk_add_f32 v[160:161], v[160:161], v[220:221]
    v_pk_add_f32 v[162:163], v[162:163], v[222:223]
    v_pk_add_f32 v[164:165], v[164:165], v[224:225]
    v_pk_add_f32 v[166:167], v[166:167], v[226:227]
    v_pk_add_f32 v[168:169], v[168:169], v[228:229]
    v_pk_add_f32 v[170:171], v[170:171], v[230:231]
    v_pk_add_f32 v[172:173], v[172:173], v[232:233]
    v_pk_add_f32 v[174:175], v[174:175], v[234:235]
    v_cvt_pk_bf16_f32 v176, v156, v157
    v_cvt_pk_bf16_f32 v177, v158, v159
    v_cvt_pk_bf16_f32 v178, v160, v161
    v_cvt_pk_bf16_f32 v179, v162, v163
    v_cvt_pk_bf16_f32 v180, v164, v165
    v_cvt_pk_bf16_f32 v181, v166, v167
    v_cvt_pk_bf16_f32 v182, v168, v169
    v_cvt_pk_bf16_f32 v183, v170, v171
    v_cvt_pk_bf16_f32 v184, v172, v173
    v_cvt_pk_bf16_f32 v185, v174, v175
    s_add_u32 s42, s57, 16777216
    buffer_store_dwordx4 v[176:179], v22, s[12:15], s42 offen sc1
    v_mov_b32 v252, v184
    v_mov_b32 v253, v185
    v_mov_b32 v254, v184
    v_mov_b32 v255, v185
    buffer_store_dwordx4 v[180:183], v22, s[12:15], s42 offen offset:1024 sc1
    v_permlane16_swap_b32 v252, v254
    v_permlane16_swap_b32 v253, v255
    buffer_store_dwordx4 v[252:255], v29, s[12:15], s42 offen offset:2048 sc1
    v_pk_add_f32 v[236:237], v[156:157], v[158:159]
    v_pk_add_f32 v[238:239], v[160:161], v[162:163]
    v_pk_mul_f32 v[240:241], v[156:157], v[156:157]
    v_pk_mul_f32 v[242:243], v[158:159], v[158:159]
    v_pk_add_f32 v[236:237], v[236:237], v[164:165]
    v_pk_add_f32 v[238:239], v[238:239], v[166:167]
    v_pk_add_f32 v[236:237], v[236:237], v[168:169]
    v_pk_add_f32 v[238:239], v[238:239], v[170:171]
    v_pk_add_f32 v[236:237], v[236:237], v[172:173]
    v_pk_add_f32 v[238:239], v[238:239], v[174:175]
    v_pk_fma_f32 v[240:241], v[160:161], v[160:161], v[240:241]
    v_pk_fma_f32 v[242:243], v[162:163], v[162:163], v[242:243]
    v_pk_fma_f32 v[240:241], v[164:165], v[164:165], v[240:241]
    v_pk_fma_f32 v[242:243], v[166:167], v[166:167], v[242:243]
    v_pk_fma_f32 v[240:241], v[168:169], v[168:169], v[240:241]
    v_pk_fma_f32 v[242:243], v[170:171], v[170:171], v[242:243]
    v_pk_fma_f32 v[240:241], v[172:173], v[172:173], v[240:241]
    v_pk_fma_f32 v[242:243], v[174:175], v[174:175], v[242:243]
    v_pk_add_f32 v[236:237], v[236:237], v[238:239]
    v_pk_add_f32 v[240:241], v[240:241], v[242:243]
    v_add_f32 v236, v236, v237
    v_add_f32 v240, v240, v241
    s_nop 1
    v_permlane16_swap_b32 v236, v240
    v_add_f32 v236, v236, v240
    v_mov_b32 v240, v236
    s_nop 1
    v_permlane32_swap_b32 v236, v240
    v_add_f32 v236, v236, v240
    s_lshl_b32 s40, s27, 2
    s_add_u32 s40, s40, s20
    s_lshl_b32 s40, s40, 10
    s_lshl_b32 s41, s28, 7
    s_add_u32 s40, s40, s41
    s_add_u32 s40, s40, 524288
    buffer_store_dword v236, v19, s[12:15], s40 offen sc1
    v_accvgpr_read_b32 v184, a24
    v_accvgpr_read_b32 v185, a25
    v_accvgpr_read_b32 v186, a26
    v_accvgpr_read_b32 v187, a27
    v_accvgpr_read_b32 v188, a144
    v_accvgpr_read_b32 v189, a145
    v_accvgpr_read_b32 v190, a146
    v_accvgpr_read_b32 v191, a147
    v_accvgpr_read_b32 v192, a148
    v_accvgpr_read_b32 v193, a149
    v_accvgpr_read_b32 v194, a150
    v_accvgpr_read_b32 v195, a151
    v_lshlrev_b32 v116, 16, v104
    v_and_b32 v117, s29, v104
    v_lshlrev_b32 v118, 16, v105
    v_and_b32 v119, s29, v105
    s_add_u32 s49, s60, 28672
    buffer_load_dwordx4 a[132:135], v22, s[12:15], s49 offen offset:0 sc1
    v_lshlrev_b32 v120, 16, v106
    v_and_b32 v121, s29, v106
    v_lshlrev_b32 v122, 16, v107
    v_and_b32 v123, s29, v107
    v_lshlrev_b32 v124, 16, v108
    v_and_b32 v125, s29, v108
    v_lshlrev_b32 v126, 16, v109
    v_and_b32 v127, s29, v109
    v_lshlrev_b32 v128, 16, v110
    buffer_load_dwordx4 a[20:23], v22, s[12:15], s49 offen offset:1024 sc1
    v_and_b32 v129, s29, v110
    v_lshlrev_b32 v130, 16, v111
    v_and_b32 v131, s29, v111
    v_lshlrev_b32 v132, 16, v112
    v_and_b32 v133, s29, v112
    v_lshlrev_b32 v134, 16, v113
    v_and_b32 v135, s29, v113
    v_pk_add_f32 v[116:117], v[156:157], v[116:117]
    v_pk_add_f32 v[118:119], v[158:159], v[118:119]
    v_pk_add_f32 v[120:121], v[160:161], v[120:121]
    buffer_load_dwordx4 a[136:139], v22, s[12:15], s49 offen offset:2048 sc1
    v_pk_add_f32 v[122:123], v[162:163], v[122:123]
    v_pk_add_f32 v[124:125], v[164:165], v[124:125]
    v_pk_add_f32 v[126:127], v[166:167], v[126:127]
    v_pk_add_f32 v[128:129], v[168:169], v[128:129]
    v_pk_add_f32 v[130:131], v[170:171], v[130:131]
    v_pk_add_f32 v[132:133], v[172:173], v[132:133]
    v_pk_add_f32 v[134:135], v[174:175], v[134:135]
    v_mov_b32 v248, 0x3f803f80
    v_mov_b32 v249, 0x3f803f80
    buffer_load_dwordx4 a[140:143], v22, s[12:15], s49 offen offset:3072 sc1
    v_mov_b32 v250, 0x3f803f80
    v_mov_b32 v251, 0x3f803f80
    s_lshl_b32 s40, s27, 12
    s_lshl_b32 s41, s3, 8
    s_add_u32 s40, s40, s41
    s_add_u32 s40, s40, 524288
    v_lshrrev_b32 v14, 4, v1
    v_lshlrev_b32 v14, 10, v14
    v_and_b32 v15, 15, v1
    s_add_u32 s49, s60, 32768
    buffer_load_dwordx4 a[24:27], v22, s[12:15], s49 offen offset:0 sc1
    v_lshl_add_u32 v14, v15, 2, v14
    s_mul_i32 s36, s27, 81920
    s_mul_i32 s37, s3, 5120
    s_add_u32 s36, s36, s37
    s_add_u32 s36, s36, 16777216
    s_add_u32 s37, s37, 81920
    s_xor_b32 s35, s3, 0
    s_mul_i32 s35, s35, 20480
    s_add_u32 s35, s35, 81920
    buffer_load_dwordx4 a[144:147], v22, s[12:15], s49 offen offset:1024 sc1
    v_add_u32 v104, s35, v22
    s_xor_b32 s35, s3, 1
    s_mul_i32 s35, s35, 20480
    s_add_u32 s35, s35, 81920
    v_add_u32 v105, s35, v22
    s_xor_b32 s35, s3, 2
    s_mul_i32 s35, s35, 20480
    s_add_u32 s35, s35, 81920
    v_add_u32 v106, s35, v22
    buffer_load_dwordx4 a[148:151], v22, s[12:15], s49 offen offset:2048 sc1
    s_xor_b32 s35, s3, 3
    s_mul_i32 s35, s35, 20480
    s_add_u32 s35, s35, 81920
    v_add_u32 v107, s35, v22
    s_waitcnt vmcnt(24)
    v_mfma_f32_16x16x32_bf16 v[192:195], a[0:3], v[248:251], v[192:195]
    s_waitcnt vmcnt(23)
    v_mfma_f32_16x16x32_bf16 v[184:187], a[96:99], v[248:251], v[184:187]
    s_waitcnt vmcnt(22)
    v_mfma_f32_16x16x32_bf16 v[188:191], a[100:103], v[248:251], v[188:191]
    buffer_load_dwordx4 a[188:191], v22, s[12:15], s49 offen offset:3072 sc1
    s_waitcnt vmcnt(22)
    v_mfma_f32_16x16x32_bf16 v[192:195], a[4:7], v[248:251], v[192:195]
    s_waitcnt vmcnt(21)
    v_mfma_f32_16x16x32_bf16 v[184:187], a[104:107], v[248:251], v[184:187]
    s_waitcnt vmcnt(20)
    v_mfma_f32_16x16x32_bf16 v[188:191], a[108:111], v[248:251], v[188:191]
    s_waitcnt vmcnt(19)
    v_mfma_f32_16x16x32_bf16 v[192:195], a[8:11], v[248:251], v[192:195]
    s_waitcnt vmcnt(18)
    s_add_u32 s49, s60, 36864
    buffer_load_dwordx4 a[192:195], v22, s[12:15], s49 offen offset:0 sc1
    v_mfma_f32_16x16x32_bf16 v[184:187], a[112:115], v[248:251], v[184:187]
    s_waitcnt vmcnt(18)
    v_mfma_f32_16x16x32_bf16 v[188:191], a[116:119], v[248:251], v[188:191]
    s_waitcnt vmcnt(17)
    v_mfma_f32_16x16x32_bf16 v[192:195], a[12:15], v[248:251], v[192:195]
    s_waitcnt vmcnt(16)
    v_mfma_f32_16x16x32_bf16 v[184:187], a[120:123], v[248:251], v[184:187]
    s_waitcnt vmcnt(15)
    v_mfma_f32_16x16x32_bf16 v[188:191], a[124:127], v[248:251], v[188:191]
    buffer_load_dwordx4 a[196:199], v22, s[12:15], s49 offen offset:1024 sc1
    s_waitcnt vmcnt(15)
    v_mfma_f32_16x16x32_bf16 v[192:195], a[16:19], v[248:251], v[192:195]
    s_waitcnt vmcnt(14)
    v_mfma_f32_16x16x32_bf16 v[184:187], a[128:131], v[248:251], v[184:187]
    s_nop 0
    s_waitcnt vmcnt(10)
    s_barrier
    buffer_load_dword v10, v14, s[12:15], s40 offen offset:0 sc1
    buffer_load_dword v11, v14, s[12:15], s40 offen offset:64 sc1
    buffer_load_dword v12, v14, s[12:15], s40 offen offset:128 sc1
    buffer_load_dword v13, v14, s[12:15], s40 offen offset:192 sc1
    s_add_u32 m0, s37, 0
    s_add_u32 s35, s36, 0
    buffer_load_dwordx4 v22, s[12:15], s35 offen sc1 lds
    s_add_u32 m0, s37, 20480
    s_add_u32 s35, s36, 20480
    buffer_load_dwordx4 v22, s[12:15], s35 offen sc1 lds
    s_waitcnt vmcnt(15)
    v_mfma_f32_16x16x32_bf16 v[188:191], a[132:135], v[248:251], v[188:191]
    s_add_u32 m0, s37, 40960
    s_add_u32 s35, s36, 40960
    buffer_load_dwordx4 v22, s[12:15], s35 offen sc1 lds
    s_waitcnt vmcnt(15)
    v_mfma_f32_16x16x32_bf16 v[192:195], a[20:23], v[248:251], v[192:195]
    s_waitcnt vmcnt(14)
    v_mfma_f32_16x16x32_bf16 v[184:187], a[136:139], v[248:251], v[184:187]
    s_add_u32 m0, s37, 61440
    s_add_u32 s35, s36, 61440
    buffer_load_dwordx4 v22, s[12:15], s35 offen sc1 lds
    s_waitcnt vmcnt(14)
    v_mfma_f32_16x16x32_bf16 v[188:191], a[140:143], v[248:251], v[188:191]
    s_waitcnt vmcnt(13)
    v_mfma_f32_16x16x32_bf16 v[192:195], a[24:27], v[248:251], v[192:195]
    s_add_u32 m0, s37, 1024
    s_add_u32 s35, s36, 1024
    buffer_load_dwordx4 v22, s[12:15], s35 offen sc1 lds
    s_waitcnt vmcnt(13)
    v_mfma_f32_16x16x32_bf16 v[184:187], a[144:147], v[248:251], v[184:187]
    s_add_u32 m0, s37, 21504
    s_add_u32 s35, s36, 21504
    buffer_load_dwordx4 v22, s[12:15], s35 offen sc1 lds
    s_waitcnt vmcnt(13)
    v_mfma_f32_16x16x32_bf16 v[188:191], a[148:151], v[248:251], v[188:191]
    s_waitcnt vmcnt(12)
    v_mfma_f32_16x16x32_bf16 v[192:195], a[188:191], v[248:251], v[192:195]
    s_add_u32 m0, s37, 41984
    s_add_u32 s35, s36, 41984
    buffer_load_dwordx4 v22, s[12:15], s35 offen sc1 lds
    s_waitcnt vmcnt(12)
    v_mfma_f32_16x16x32_bf16 v[184:187], a[192:195], v[248:251], v[184:187]
    s_waitcnt vmcnt(11)
    v_mfma_f32_16x16x32_bf16 v[188:191], a[196:199], v[248:251], v[188:191]
    s_add_u32 m0, s37, 62464
    s_add_u32 s35, s36, 62464
    buffer_load_dwordx4 v22, s[12:15], s35 offen sc1 lds
L_k6_41:
    s_waitcnt vmcnt(8)
L_ss_43:
    v_max3_i32 v6, v10, v11, v12
    v_max_i32 v6, v6, v13
    v_cmp_eq_u32 vcc, s21, v6
    v_add_f32 v6, v10, v12
    v_add_f32 v7, v11, v13
    s_lshl_b32 s41, s3, 9
    v_lshl_add_u32 v15, v1, 3, s41
    s_cbranch_vccnz L_ssr_44
    ds_write_b64 v15, v[6:7] offset:61440
    s_waitcnt vmcnt(4)
    s_barrier
    ds_read_b128 v[196:199], v104 offset:0
    ds_read_b128 v[200:203], v105 offset:0
    ds_read_b128 v[204:207], v106 offset:0
    ds_read_b128 v[208:211], v107 offset:0
    s_waitcnt lgkmcnt(3)
    v_mfma_f32_16x16x32_bf16 v[136:139], a[224:227], v[196:199], 0
    ds_read_b128 v[212:215], v104 offset:5120
    v_mfma_f32_16x16x32_bf16 v[140:143], a[228:231], v[196:199], 0
    s_add_u32 m0, s37, 2048
    s_add_u32 s35, s36, 2048
    buffer_load_dwordx4 v22, s[12:15], s35 offen offset:0 sc1 lds
    v_mfma_f32_16x16x32_bf16 v[144:147], a[232:235], v[196:199], 0
    s_waitcnt lgkmcnt(3)
    v_mfma_f32_16x16x32_bf16 v[148:151], a[224:227], v[200:203], 0
    ds_read_b128 v[216:219], v105 offset:5120
    v_mfma_f32_16x16x32_bf16 v[152:155], a[228:231], v[200:203], 0
    buffer_load_dwordx4 v22, s[12:15], s35 offen offset:1024 sc1 lds
    v_mfma_f32_16x16x32_bf16 v[156:159], a[232:235], v[200:203], 0
    s_waitcnt lgkmcnt(3)
    v_mfma_f32_16x16x32_bf16 v[160:163], a[224:227], v[204:207], 0
    ds_read_b128 v[220:223], v106 offset:5120
    v_mfma_f32_16x16x32_bf16 v[164:167], a[228:231], v[204:207], 0
    buffer_load_dwordx4 v22, s[12:15], s35 offen offset:2048 sc1 lds
    v_mfma_f32_16x16x32_bf16 v[168:171], a[232:235], v[204:207], 0
    s_waitcnt lgkmcnt(3)
    v_mfma_f32_16x16x32_bf16 v[172:175], a[224:227], v[208:211], 0
    ds_read_b128 v[224:227], v107 offset:5120
    v_mfma_f32_16x16x32_bf16 v[176:179], a[228:231], v[208:211], 0
    v_max_i32 v8, v196, v198
    v_mfma_f32_16x16x32_bf16 v[180:183], a[232:235], v[208:211], 0
    s_waitcnt lgkmcnt(2)
    v_mfma_f32_16x16x32_bf16 v[136:139], a[236:239], v[212:215], v[136:139]
    ds_read_b128 v[196:199], v104 offset:10240
    v_mfma_f32_16x16x32_bf16 v[140:143], a[240:243], v[212:215], v[140:143]
    s_add_u32 m0, s37, 22528
    s_add_u32 s35, s36, 22528
    buffer_load_dwordx4 v22, s[12:15], s35 offen offset:0 sc1 lds
    v_mfma_f32_16x16x32_bf16 v[144:147], a[244:247], v[212:215], v[144:147]
    v_mfma_f32_16x16x32_bf16 v[148:151], a[236:239], v[216:219], v[148:151]
    ds_read_b128 v[200:203], v105 offset:10240
    v_mfma_f32_16x16x32_bf16 v[152:155], a[240:243], v[216:219], v[152:155]
    buffer_load_dwordx4 v22, s[12:15], s35 offen offset:1024 sc1 lds
    v_mfma_f32_16x16x32_bf16 v[156:159], a[244:247], v[216:219], v[156:159]
    s_waitcnt lgkmcnt(2)
    v_mfma_f32_16x16x32_bf16 v[160:163], a[236:239], v[220:223], v[160:163]
    ds_read_b128 v[204:207], v106 offset:10240
    v_mfma_f32_16x16x32_bf16 v[164:167], a[240:243], v[220:223], v[164:167]
    buffer_load_dwordx4 v22, s[12:15], s35 offen offset:2048 sc1 lds
    v_mfma_f32_16x16x32_bf16 v[168:171], a[244:247], v[220:223], v[168:171]
    v_mfma_f32_16x16x32_bf16 v[172:175], a[236:239], v[224:227], v[172:175]
    ds_read_b128 v[208:211], v107 offset:10240
    v_mfma_f32_16x16x32_bf16 v[176:179], a[240:243], v[224:227], v[176:179]
    v_max3_i32 v8, v8, v212, v214
    v_mfma_f32_16x16x32_bf16 v[180:183], a[244:247], v[224:227], v[180:183]
    s_waitcnt lgkmcnt(2)
    v_mfma_f32_16x16x32_bf16 v[136:139], a[248:251], v[196:199], v[136:139]
    ds_read_b128 v[212:215], v104 offset:15360
    v_mfma_f32_16x16x32_bf16 v[140:143], a[252:255], v[196:199], v[140:143]
    s_add_u32 m0, s37, 43008
    s_add_u32 s35, s36, 43008
    buffer_load_dwordx4 v22, s[12:15], s35 offen offset:0 sc1 lds
    v_mfma_f32_16x16x32_bf16 v[144:147], a[200:203], v[196:199], v[144:147]
    v_mfma_f32_16x16x32_bf16 v[148:151], a[248:251], v[200:203], v[148:151]
    ds_read_b128 v[216:219], v105 offset:15360
    v_mfma_f32_16x16x32_bf16 v[152:155], a[252:255], v[200:203], v[152:155]
    buffer_load_dwordx4 v22, s[12:15], s35 offen offset:1024 sc1 lds
    v_mfma_f32_16x16x32_bf16 v[156:159], a[200:203], v[200:203], v[156:159]
    s_waitcnt lgkmcnt(2)
    v_mfma_f32_16x16x32_bf16 v[160:163], a[248:251], v[204:207], v[160:163]
    ds_read_b128 v[220:223], v106 offset:15360
    v_mfma_f32_16x16x32_bf16 v[164:167], a[252:255], v[204:207], v[164:167]
    buffer_load_dwordx4 v22, s[12:15], s35 offen offset:2048 sc1 lds
    v_mfma_f32_16x16x32_bf16 v[168:171], a[200:203], v[204:207], v[168:171]
    v_mfma_f32_16x16x32_bf16 v[172:175], a[248:251], v[208:211], v[172:175]
    ds_read_b128 v[224:227], v107 offset:15360
    v_mfma_f32_16x16x32_bf16 v[176:179], a[252:255], v[208:211], v[176:179]
    v_max3_i32 v8, v8, v196, v198
    v_mfma_f32_16x16x32_bf16 v[180:183], a[200:203], v[208:211], v[180:183]
    s_waitcnt vmcnt(9)
    s_barrier
    s_waitcnt lgkmcnt(2)
    v_mfma_f32_16x16x32_bf16 v[136:139], a[204:207], v[212:215], v[136:139]
    ds_read_b128 v[196:199], v104 offset:1024
L_pad_2:
    s_cbranch_execz L_hret_0
    v_mfma_f32_16x16x32_bf16 v[140:143], a[208:211], v[212:215], v[140:143]
    s_add_u32 m0, s37, 63488
    s_add_u32 s35, s36, 63488
    buffer_load_dwordx4 v22, s[12:15], s35 offen offset:0 sc1 lds
    v_mfma_f32_16x16x32_bf16 v[144:147], a[212:215], v[212:215], v[144:147]
    v_mfma_f32_16x16x32_bf16 v[148:151], a[204:207], v[216:219], v[148:151]
    ds_read_b128 v[200:203], v105 offset:1024
    v_mfma_f32_16x16x32_bf16 v[152:155], a[208:211], v[216:219], v[152:155]
    buffer_load_dwordx4 v22, s[12:15], s35 offen offset:1024 sc1 lds
    v_mfma_f32_16x16x32_bf16 v[156:159], a[212:215], v[216:219], v[156:159]
    s_waitcnt lgkmcnt(2)
    v_mfma_f32_16x16x32_bf16 v[160:163], a[204:207], v[220:223], v[160:163]
    ds_read_b128 v[204:207], v106 offset:1024
    v_mfma_f32_16x16x32_bf16 v[164:167], a[208:211], v[220:223], v[164:167]
    buffer_load_dwordx4 v22, s[12:15], s35 offen offset:2048 sc1 lds
    v_mfma_f32_16x16x32_bf16 v[168:171], a[212:215], v[220:223], v[168:171]
    v_mfma_f32_16x16x32_bf16 v[172:175], a[204:207], v[224:227], v[172:175]
    ds_read_b128 v[208:211], v107 offset:1024
    v_mfma_f32_16x16x32_bf16 v[176:179], a[208:211], v[224:227], v[176:179]
    v_max3_i32 v8, v8, v212, v214
    v_mfma_f32_16x16x32_bf16 v[180:183], a[212:215], v[224:227], v[180:183]
    s_waitcnt lgkmcnt(2)
    v_mfma_f32_16x16x32_bf16 v[136:139], a[216:219], v[196:199], v[136:139]
    ds_read_b128 v[212:215], v104 offset:6144
    v_mfma_f32_16x16x32_bf16 v[140:143], a[220:223], v[196:199], v[140:143]
    s_add_u32 s49, s61, 0
    buffer_load_dwordx4 a[36:39], v22, s[12:15], s49 offen offset:0 sc1
    v_mfma_f32_16x16x32_bf16 v[144:147], a[0:3], v[196:199], v[144:147]
    v_mfma_f32_16x16x32_bf16 v[148:151], a[216:219], v[200:203], v[148:151]
    ds_read_b128 v[216:219], v105 offset:6144
    v_mfma_f32_16x16x32_bf16 v[152:155], a[220:223], v[200:203], v[152:155]
    buffer_load_dwordx4 a[40:43], v22, s[12:15], s49 offen offset:1024 sc1
    v_mfma_f32_16x16x32_bf16 v[156:159], a[0:3], v[200:203], v[156:159]
    s_waitcnt lgkmcnt(2)
    v_mfma_f32_16x16x32_bf16 v[160:163], a[216:219], v[204:207], v[160:163]
    ds_read_b128 v[220:223], v106 offset:6144
    v_mfma_f32_16x16x32_bf16 v[164:167], a[220:223], v[204:207], v[164:167]
    buffer_load_dwordx4 a[44:47], v22, s[12:15], s49 offen offset:2048 sc1
    v_mfma_f32_16x16x32_bf16 v[168:171], a[0:3], v[204:207], v[168:171]
    v_mfma_f32_16x16x32_bf16 v[172:175], a[216:219], v[208:211], v[172:175]
    ds_read_b128 v[224:227], v107 offset:6144
    v_mfma_f32_16x16x32_bf16 v[176:179], a[220:223], v[208:211], v[176:179]
    v_max3_i32 v8, v8, v196, v198
    v_mfma_f32_16x16x32_bf16 v[180:183], a[0:3], v[208:211], v[180:183]
    s_waitcnt lgkmcnt(2)
    v_mfma_f32_16x16x32_bf16 v[136:139], a[96:99], v[212:215], v[136:139]
    ds_read_b128 v[196:199], v104 offset:11264
    v_mfma_f32_16x16x32_bf16 v[140:143], a[100:103], v[212:215], v[140:143]
    buffer_load_dwordx4 a[48:51], v22, s[12:15], s49 offen offset:3072 sc1
    v_mfma_f32_16x16x32_bf16 v[144:147], a[4:7], v[212:215], v[144:147]
    v_mfma_f32_16x16x32_bf16 v[148:151], a[96:99], v[216:219], v[148:151]
    ds_read_b128 v[200:203], v105 offset:11264
    v_mfma_f32_16x16x32_bf16 v[152:155], a[100:103], v[216:219], v[152:155]
    s_add_u32 s49, s61, 4096
    buffer_load_dwordx4 a[52:55], v22, s[12:15], s49 offen offset:0 sc1
    v_mfma_f32_16x16x32_bf16 v[156:159], a[4:7], v[216:219], v[156:159]
    s_waitcnt lgkmcnt(2)
    v_mfma_f32_16x16x32_bf16 v[160:163], a[96:99], v[220:223], v[160:163]
    ds_read_b128 v[204:207], v106 offset:11264
    v_mfma_f32_16x16x32_bf16 v[164:167], a[100:103], v[220:223], v[164:167]
    buffer_load_dwordx4 a[56:59], v22, s[12:15], s49 offen offset:1024 sc1
    v_mfma_f32_16x16x32_bf16 v[168:171], a[4:7], v[220:223], v[168:171]
    v_mfma_f32_16x16x32_bf16 v[172:175], a[96:99], v[224:227], v[172:175]
    ds_read_b128 v[208:211], v107 offset:11264
    v_mfma_f32_16x16x32_bf16 v[176:179], a[100:103], v[224:227], v[176:179]
    v_max3_i32 v8, v8, v212, v214
    v_mfma_f32_16x16x32_bf16 v[180:183], a[4:7], v[224:227], v[180:183]
    s_waitcnt lgkmcnt(2)
    v_mfma_f32_16x16x32_bf16 v[136:139], a[104:107], v[196:199], v[136:139]
    ds_read_b128 v[212:215], v104 offset:16384
    v_mfma_f32_16x16x32_bf16 v[140:143], a[108:111], v[196:199], v[140:143]
    buffer_load_dwordx4 a[60:63], v22, s[12:15], s49 offen offset:2048 sc1
    v_mfma_f32_16x16x32_bf16 v[144:147], a[8:11], v[196:199], v[144:147]
    v_mfma_f32_16x16x32_bf16 v[148:151], a[104:107], v[200:203], v[148:151]
    ds_read_b128 v[216:219], v105 offset:16384
    v_mfma_f32_16x16x32_bf16 v[152:155], a[108:111], v[200:203], v[152:155]
    buffer_load_dwordx4 a[64:67], v22, s[12:15], s49 offen offset:3072 sc1
    v_mfma_f32_16x16x32_bf16 v[156:159], a[8:11], v[200:203], v[156:159]
    s_waitcnt lgkmcnt(2)
    v_mfma_f32_16x16x32_bf16 v[160:163], a[104:107], v[204:207], v[160:163]
    ds_read_b128 v[220:223], v106 offset:16384
    v_mfma_f32_16x16x32_bf16 v[164:167], a[108:111], v[204:207], v[164:167]
    s_add_u32 s49, s61, 8192
    buffer_load_dwordx4 a[68:71], v22, s[12:15], s49 offen offset:0 sc1
    v_mfma_f32_16x16x32_bf16 v[168:171], a[8:11], v[204:207], v[168:171]
    v_mfma_f32_16x16x32_bf16 v[172:175], a[104:107], v[208:211], v[172:175]
    ds_read_b128 v[224:227], v107 offset:16384
    v_mfma_f32_16x16x32_bf16 v[176:179], a[108:111], v[208:211], v[176:179]
    v_max3_i32 v8, v8, v196, v198
    v_mfma_f32_16x16x32_bf16 v[180:183], a[8:11], v[208:211], v[180:183]
    s_waitcnt vmcnt(9) lgkmcnt(0)
    s_barrier
    v_mfma_f32_16x16x32_bf16 v[136:139], a[112:115], v[212:215], v[136:139]
    ds_read_b128 v[196:199], v104 offset:2048
    v_mfma_f32_16x16x32_bf16 v[140:143], a[116:119], v[212:215], v[140:143]
    buffer_load_dwordx4 a[72:75], v22, s[12:15], s49 offen offset:1024 sc1
    v_mfma_f32_16x16x32_bf16 v[144:147], a[12:15], v[212:215], v[144:147]
    v_mfma_f32_16x16x32_bf16 v[148:151], a[112:115], v[216:219], v[148:151]
    ds_read_b128 v[200:203], v105 offset:2048
    v_mfma_f32_16x16x32_bf16 v[152:155], a[116:119], v[216:219], v[152:155]
    buffer_load_dwordx4 a[76:79], v22, s[12:15], s49 offen offset:2048 sc1
    v_mfma_f32_16x16x32_bf16 v[156:159], a[12:15], v[216:219], v[156:159]
    v_mfma_f32_16x16x32_bf16 v[160:163], a[112:115], v[220:223], v[160:163]
    ds_read_b128 v[204:207], v106 offset:2048
    v_mfma_f32_16x16x32_bf16 v[164:167], a[116:119], v[220:223], v[164:167]
    buffer_load_dwordx4 a[80:83], v22, s[12:15], s49 offen offset:3072 sc1
    v_mfma_f32_16x16x32_bf16 v[168:171], a[12:15], v[220:223], v[168:171]
    v_mfma_f32_16x16x32_bf16 v[172:175], a[112:115], v[224:227], v[172:175]
    ds_read_b128 v[208:211], v107 offset:2048
    v_mfma_f32_16x16x32_bf16 v[176:179], a[116:119], v[224:227], v[176:179]
    v_max3_i32 v8, v8, v212, v214
    v_mfma_f32_16x16x32_bf16 v[180:183], a[12:15], v[224:227], v[180:183]
    s_waitcnt lgkmcnt(2)
    v_mfma_f32_16x16x32_bf16 v[136:139], a[120:123], v[196:199], v[136:139]
    ds_read_b128 v[212:215], v104 offset:7168
    v_mfma_f32_16x16x32_bf16 v[140:143], a[124:127], v[196:199], v[140:143]
    s_add_u32 s49, s61, 12288
    buffer_load_dwordx4 a[84:87], v22, s[12:15], s49 offen offset:0 sc1
    v_mfma_f32_16x16x32_bf16 v[144:147], a[16:19], v[196:199], v[144:147]
    v_lshlrev_b32 v15, 3, v1
    ds_read_b64 v[108:109], v15 offset:61440
    v_mfma_f32_16x16x32_bf16 v[148:151], a[120:123], v[200:203], v[148:151]
    ds_read_b128 v[216:219], v105 offset:7168
    v_mfma_f32_16x16x32_bf16 v[152:155], a[124:127], v[200:203], v[152:155]
    buffer_load_dwordx4 a[88:91], v22, s[12:15], s49 offen offset:1024 sc1
    v_mfma_f32_16x16x32_bf16 v[156:159], a[16:19], v[200:203], v[156:159]
    ds_read_b64 v[110:111], v15 offset:61952
    ds_read_b64 v[112:113], v15 offset:62464
    s_waitcnt lgkmcnt(5)
    v_mfma_f32_16x16x32_bf16 v[160:163], a[120:123], v[204:207], v[160:163]
    ds_read_b128 v[220:223], v106 offset:7168
    v_mfma_f32_16x16x32_bf16 v[164:167], a[124:127], v[204:207], v[164:167]
    buffer_load_dwordx4 a[92:95], v22, s[12:15], s49 offen offset:2048 sc1
    v_mfma_f32_16x16x32_bf16 v[168:171], a[16:19], v[204:207], v[168:171]
    ds_read_b64 v[114:115], v15 offset:62976
    s_nop 0
    v_mfma_f32_16x16x32_bf16 v[172:175], a[120:123], v[208:211], v[172:175]
    ds_read_b128 v[224:227], v107 offset:7168
    v_mfma_f32_16x16x32_bf16 v[176:179], a[124:127], v[208:211], v[176:179]
    v_max3_i32 v8, v8, v196, v198
    v_mfma_f32_16x16x32_bf16 v[180:183], a[16:19], v[208:211], v[180:183]
    s_nop 0
    s_waitcnt lgkmcnt(1)
    v_add_f32 v108, v108, v110
    v_mfma_f32_16x16x32_bf16 v[136:139], a[128:131], v[212:215], v[136:139]
    ds_read_b128 v[196:199], v104 offset:12288
    v_mfma_f32_16x16x32_bf16 v[140:143], a[132:135], v[212:215], v[140:143]
    buffer_load_dwordx4 a[160:163], v22, s[12:15], s49 offen offset:3072 sc1
    v_mfma_f32_16x16x32_bf16 v[144:147], a[20:23], v[212:215], v[144:147]
    v_add_f32 v109, v109, v111
    v_add_f32 v112, v112, v114
    v_mfma_f32_16x16x32_bf16 v[148:151], a[128:131], v[216:219], v[148:151]
    ds_read_b128 v[200:203], v105 offset:12288
    v_mfma_f32_16x16x32_bf16 v[152:155], a[132:135], v[216:219], v[152:155]
    s_add_u32 s49, s61, 16384
    buffer_load_dwordx4 a[164:167], v22, s[12:15], s49 offen offset:0 sc1
    v_mfma_f32_16x16x32_bf16 v[156:159], a[20:23], v[216:219], v[156:159]
    v_add_f32 v113, v113, v115
    v_add_f32 v108, v108, v112
    s_waitcnt lgkmcnt(2)
    v_mfma_f32_16x16x32_bf16 v[160:163], a[128:131], v[220:223], v[160:163]
    ds_read_b128 v[204:207], v106 offset:12288
    v_mfma_f32_16x16x32_bf16 v[164:167], a[132:135], v[220:223], v[164:167]
    buffer_load_dwordx4 a[168:171], v22, s[12:15], s49 offen offset:1024 sc1
    v_mfma_f32_16x16x32_bf16 v[168:171], a[20:23], v[220:223], v[168:171]
    v_add_f32 v109, v109, v113
    v_mul_f32 v108, 0x3acccccd, v108
    v_mfma_f32_16x16x32_bf16 v[172:175], a[128:131], v[224:227], v[172:175]
    ds_read_b128 v[208:211], v107 offset:12288
    v_mfma_f32_16x16x32_bf16 v[176:179], a[132:135], v[224:227], v[176:179]
    v_max3_i32 v8, v8, v212, v214
    v_mfma_f32_16x16x32_bf16 v[180:183], a[20:23], v[224:227], v[180:183]
    v_mul_f32 v109, 0x3acccccd, v109
    v_fma_f32 v109, -v108, v108, v109
    s_waitcnt lgkmcnt(2)
    v_mfma_f32_16x16x32_bf16 v[136:139], a[136:139], v[196:199], v[136:139]
    ds_read_b128 v[212:215], v104 offset:17408
    v_mfma_f32_16x16x32_bf16 v[140:143], a[140:143], v[196:199], v[140:143]
    buffer_load_dwordx4 a[172:175], v22, s[12:15], s49 offen offset:2048 sc1
    v_mfma_f32_16x16x32_bf16 v[144:147], a[24:27], v[196:199], v[144:147]
    v_max_f32 v109, 0, v109
    v_add_f32 v3, 0x3727c5ac, v109
    v_mfma_f32_16x16x32_bf16 v[148:151], a[136:139], v[200:203], v[148:151]
    ds_read_b128 v[216:219], v105 offset:17408
    v_mfma_f32_16x16x32_bf16 v[152:155], a[140:143], v[200:203], v[152:155]
    buffer_load_dwordx4 a[176:179], v22, s[12:15], s49 offen offset:3072 sc1
    v_mfma_f32_16x16x32_bf16 v[156:159], a[24:27], v[200:203], v[156:159]
    v_rsq_f32 v3, v3
    v_sub_f32 v4, 0, v108
    s_waitcnt lgkmcnt(2)
    v_mfma_f32_16x16x32_bf16 v[160:163], a[136:139], v[204:207], v[160:163]
    ds_read_b128 v[220:223], v106 offset:17408
    v_mfma_f32_16x16x32_bf16 v[164:167], a[140:143], v[204:207], v[164:167]
    s_add_u32 s49, s61, 20480
    buffer_load_dwordx4 a[180:183], v22, s[12:15], s49 offen offset:0 sc1
    v_mfma_f32_16x16x32_bf16 v[168:171], a[24:27], v[204:207], v[168:171]
    v_rcp_f32 v5, v3
    v_mul_f32 v7, 0xc0135761, v3
    v_mfma_f32_16x16x32_bf16 v[172:175], a[136:139], v[208:211], v[172:175]
    ds_read_b128 v[224:227], v107 offset:17408
    v_mfma_f32_16x16x32_bf16 v[176:179], a[140:143], v[208:211], v[176:179]
    v_max3_i32 v8, v8, v196, v198
    v_mfma_f32_16x16x32_bf16 v[180:183], a[24:27], v[208:211], v[180:183]
    v_mul_f32 v6, v3, v3
    v_mul_f32 v6, v6, v7
    s_waitcnt lgkmcnt(2)
    v_mfma_f32_16x16x32_bf16 v[136:139], a[144:147], v[212:215], v[136:139]
    ds_read_b128 v[196:199], v104 offset:3072
    v_mfma_f32_16x16x32_bf16 v[140:143], a[148:151], v[212:215], v[140:143]
    buffer_load_dwordx4 a[184:187], v22, s[12:15], s49 offen offset:1024 sc1
    v_mfma_f32_16x16x32_bf16 v[144:147], a[188:191], v[212:215], v[144:147]
    v_mul_f32 v6, 0x3d372713, v6
    s_lshl_b32 s41, s3, 10
    v_mfma_f32_16x16x32_bf16 v[148:151], a[144:147], v[216:219], v[148:151]
    ds_read_b128 v[200:203], v105 offset:3072
    v_mfma_f32_16x16x32_bf16 v[152:155], a[148:151], v[216:219], v[152:155]
    buffer_load_dwordx4 a[224:227], v22, s[12:15], s49 offen offset:2048 sc1
    v_mfma_f32_16x16x32_bf16 v[156:159], a[188:191], v[216:219], v[156:159]
    v_add_u32 v15, s41, v22
    ds_write_b128 v15, v[4:7] offset:25600
    s_waitcnt lgkmcnt(3)
    v_mfma_f32_16x16x32_bf16 v[160:163], a[144:147], v[220:223], v[160:163]
    ds_read_b128 v[204:207], v106 offset:3072
    v_mfma_f32_16x16x32_bf16 v[164:167], a[148:151], v[220:223], v[164:167]
    buffer_load_dwordx4 a[228:231], v22, s[12:15], s49 offen offset:3072 sc1
    v_mfma_f32_16x16x32_bf16 v[168:171], a[188:191], v[220:223], v[168:171]
    v_and_b32 v15, 0xcff, v15
    s_lshl_b32 s41, s3, 8
    v_mfma_f32_16x16x32_bf16 v[172:175], a[144:147], v[224:227], v[172:175]
    ds_read_b128 v[208:211], v107 offset:3072
    v_mfma_f32_16x16x32_bf16 v[176:179], a[148:151], v[224:227], v[176:179]
    v_max3_i32 v8, v8, v212, v214
    v_mfma_f32_16x16x32_bf16 v[180:183], a[188:191], v[224:227], v[180:183]
    v_or_b32 v15, s41, v15
    v_xor_b32 v3, 0, v15
    s_waitcnt lgkmcnt(3)
    v_mfma_f32_16x16x32_bf16 v[136:139], a[192:195], v[196:199], v[136:139]
    ds_read_b128 v[212:215], v104 offset:8192
    v_mfma_f32_16x16x32_bf16 v[140:143], a[196:199], v[196:199], v[140:143]
    s_add_u32 s49, s61, 24576
    buffer_load_dwordx4 a[232:235], v22, s[12:15], s49 offen offset:0 sc1
    v_mfma_f32_16x16x32_bf16 v[144:147], a[28:31], v[196:199], v[144:147]
    ds_read_b128 v[108:111], v3 offset:25600
    v_xor_b32 v3, 256, v15
    v_mfma_f32_16x16x32_bf16 v[148:151], a[192:195], v[200:203], v[148:151]
    ds_read_b128 v[216:219], v105 offset:8192
    v_mfma_f32_16x16x32_bf16 v[152:155], a[196:199], v[200:203], v[152:155]
    buffer_load_dwordx4 a[236:239], v22, s[12:15], s49 offen offset:1024 sc1
    v_mfma_f32_16x16x32_bf16 v[156:159], a[28:31], v[200:203], v[156:159]
    ds_read_b128 v[112:115], v3 offset:25600
    v_xor_b32 v3, 512, v15
    s_waitcnt lgkmcnt(4)
    v_mfma_f32_16x16x32_bf16 v[160:163], a[192:195], v[204:207], v[160:163]
    ds_read_b128 v[220:223], v106 offset:8192
    v_mfma_f32_16x16x32_bf16 v[164:167], a[196:199], v[204:207], v[164:167]
    buffer_load_dwordx4 a[240:243], v22, s[12:15], s49 offen offset:2048 sc1
    v_mfma_f32_16x16x32_bf16 v[168:171], a[28:31], v[204:207], v[168:171]
    ds_read_b128 v[252:255], v3 offset:25600
    v_xor_b32 v3, 768, v15
    v_mfma_f32_16x16x32_bf16 v[172:175], a[192:195], v[208:211], v[172:175]
    ds_read_b128 v[224:227], v107 offset:8192
    v_mfma_f32_16x16x32_bf16 v[176:179], a[196:199], v[208:211], v[176:179]
    v_max3_i32 v8, v8, v196, v198
    v_mfma_f32_16x16x32_bf16 v[180:183], a[28:31], v[208:211], v[180:183]
    ds_read_b128 v[16:19], v3 offset:25600
    s_mul_i32 s42, s27, 196608
    s_waitcnt lgkmcnt(5)
    v_mfma_f32_16x16x32_bf16 v[136:139], a[152:155], v[212:215], v[136:139]
    ds_read_b128 v[196:199], v104 offset:13312
    v_mfma_f32_16x16x32_bf16 v[140:143], a[156:159], v[212:215], v[140:143]
    buffer_load_dwordx4 a[244:247], v22, s[12:15], s49 offen offset:3072 sc1
    v_mfma_f32_16x16x32_bf16 v[144:147], a[32:35], v[212:215], v[144:147]
    s_mul_i32 s43, s28, 6144
    s_add_u32 s42, s42, s43
    v_mfma_f32_16x16x32_bf16 v[148:151], a[152:155], v[216:219], v[148:151]
    ds_read_b128 v[200:203], v105 offset:13312
    v_mfma_f32_16x16x32_bf16 v[152:155], a[156:159], v[216:219], v[152:155]
    s_add_u32 s49, s61, 28672
    buffer_load_dwordx4 a[248:251], v22, s[12:15], s49 offen offset:0 sc1
    v_mfma_f32_16x16x32_bf16 v[156:159], a[32:35], v[216:219], v[156:159]
    s_mul_i32 s43, s3, 1536
    s_add_u32 s42, s42, s43
    s_waitcnt lgkmcnt(3)
    v_mfma_f32_16x16x32_bf16 v[160:163], a[152:155], v[220:223], v[160:163]
    ds_read_b128 v[204:207], v106 offset:13312
    v_mfma_f32_16x16x32_bf16 v[164:167], a[156:159], v[220:223], v[164:167]
    buffer_load_dwordx4 a[252:255], v22, s[12:15], s49 offen offset:1024 sc1
    v_mfma_f32_16x16x32_bf16 v[168:171], a[32:35], v[220:223], v[168:171]
    s_add_u32 s42, s42, 19398656
    v_bfe_u32 v10, v1, 4, 1
    v_mfma_f32_16x16x32_bf16 v[172:175], a[152:155], v[224:227], v[172:175]
    ds_read_b128 v[208:211], v107 offset:13312
    v_mfma_f32_16x16x32_bf16 v[176:179], a[156:159], v[224:227], v[176:179]
    v_max3_i32 v8, v8, v212, v214
    v_mfma_f32_16x16x32_bf16 v[180:183], a[32:35], v[224:227], v[180:183]
    s_and_b32 s43, s3, 1
    v_xor_b32 v10, s43, v10
    s_waitcnt lgkmcnt(2)
    v_mfma_f32_16x16x32_bf16 v[136:139], v[76:79], v[196:199], v[136:139]
    ds_read_b128 v[212:215], v104 offset:18432
    v_mfma_f32_16x16x32_bf16 v[140:143], v[80:83], v[196:199], v[140:143]
    buffer_load_dwordx4 a[200:203], v22, s[12:15], s49 offen offset:2048 sc1
    v_mfma_f32_16x16x32_bf16 v[144:147], v[84:87], v[196:199], v[144:147]
    v_mul_u32_u24 v10, 49152, v10
    v_lshrrev_b32 v11, 5, v1
    v_mfma_f32_16x16x32_bf16 v[148:151], v[76:79], v[200:203], v[148:151]
    ds_read_b128 v[216:219], v105 offset:18432
    v_mfma_f32_16x16x32_bf16 v[152:155], v[80:83], v[200:203], v[152:155]
    buffer_load_dwordx4 a[204:207], v22, s[12:15], s49 offen offset:3072 sc1
    v_mfma_f32_16x16x32_bf16 v[156:159], v[84:87], v[200:203], v[156:159]
    v_lshl_add_u32 v10, v11, 8, v10
    v_and_b32 v11, 15, v1
    s_waitcnt lgkmcnt(2)
    v_mfma_f32_16x16x32_bf16 v[160:163], v[76:79], v[204:207], v[160:163]
    ds_read_b128 v[220:223], v106 offset:18432
    v_mfma_f32_16x16x32_bf16 v[164:167], v[80:83], v[204:207], v[164:167]
    s_add_u32 s49, s61, 32768
    buffer_load_dwordx4 a[208:211], v22, s[12:15], s49 offen offset:0 sc1
    v_mfma_f32_16x16x32_bf16 v[168:171], v[84:87], v[204:207], v[168:171]
    v_lshl_add_u32 v10, v11, 4, v10
    s_lshl_b32 s41, s3, 8
    v_mfma_f32_16x16x32_bf16 v[172:175], v[76:79], v[208:211], v[172:175]
    ds_read_b128 v[224:227], v107 offset:18432
    v_mfma_f32_16x16x32_bf16 v[176:179], v[80:83], v[208:211], v[176:179]
    v_max3_i32 v8, v8, v196, v198
    v_mfma_f32_16x16x32_bf16 v[180:183], v[84:87], v[208:211], v[180:183]
    v_lshl_add_u32 v11, v1, 2, s41
    s_xor_b32 s43, s3, 0
    s_waitcnt lgkmcnt(2)
    v_mfma_f32_16x16x32_bf16 v[136:139], v[88:91], v[212:215], v[136:139]
    ds_read_b128 v[196:199], v104 offset:4096
    v_mfma_f32_16x16x32_bf16 v[140:143], v[92:95], v[212:215], v[140:143]
    buffer_load_dwordx4 a[212:215], v22, s[12:15], s49 offen offset:1024 sc1
    v_mfma_f32_16x16x32_bf16 v[144:147], v[96:99], v[212:215], v[144:147]
    s_mul_i32 s43, s43, 49152
    s_add_u32 s44, s43, s42
    v_mfma_f32_16x16x32_bf16 v[148:151], v[88:91], v[216:219], v[148:151]
    ds_read_b128 v[200:203], v105 offset:4096
    v_mfma_f32_16x16x32_bf16 v[152:155], v[92:95], v[216:219], v[152:155]
    buffer_load_dwordx4 a[216:219], v22, s[12:15], s49 offen offset:2048 sc1
    v_mfma_f32_16x16x32_bf16 v[156:159], v[96:99], v[216:219], v[156:159]
    s_xor_b32 s43, s3, 1
    s_mul_i32 s43, s43, 49152
    s_waitcnt lgkmcnt(2)
    v_mfma_f32_16x16x32_bf16 v[160:163], v[88:91], v[220:223], v[160:163]
    ds_read_b128 v[204:207], v106 offset:4096
    v_mfma_f32_16x16x32_bf16 v[164:167], v[92:95], v[220:223], v[164:167]
    buffer_load_dwordx4 a[220:223], v22, s[12:15], s49 offen offset:3072 sc1
    v_mfma_f32_16x16x32_bf16 v[168:171], v[96:99], v[220:223], v[168:171]
    s_add_u32 s45, s43, s42
    s_xor_b32 s43, s3, 2
    v_mfma_f32_16x16x32_bf16 v[172:175], v[88:91], v[224:227], v[172:175]
    ds_read_b128 v[208:211], v107 offset:4096
    v_mfma_f32_16x16x32_bf16 v[176:179], v[92:95], v[224:227], v[176:179]
    v_max3_i32 v8, v8, v212, v214
    v_mfma_f32_16x16x32_bf16 v[180:183], v[96:99], v[224:227], v[180:183]
    s_mul_i32 s43, s43, 49152
    s_add_u32 s46, s43, s42
    s_waitcnt lgkmcnt(2)
    v_mfma_f32_16x16x32_bf16 v[136:139], v[100:103], v[196:199], v[136:139]
    ds_read_b128 v[212:215], v104 offset:9216
    v_mfma_f32_16x16x32_bf16 v[140:143], v[32:35], v[196:199], v[140:143]
    s_add_u32 s49, s61, 36864
    buffer_load_dwordx4 a[0:3], v22, s[12:15], s49 offen offset:0 sc1
    v_mfma_f32_16x16x32_bf16 v[144:147], v[36:39], v[196:199], v[144:147]
    s_xor_b32 s43, s3, 3
    s_mul_i32 s43, s43, 49152
    v_mfma_f32_16x16x32_bf16 v[148:151], v[100:103], v[200:203], v[148:151]
    ds_read_b128 v[216:219], v105 offset:9216
    v_mfma_f32_16x16x32_bf16 v[152:155], v[32:35], v[200:203], v[152:155]
    buffer_load_dwordx4 a[96:99], v22, s[12:15], s49 offen offset:1024 sc1
    v_mfma_f32_16x16x32_bf16 v[156:159], v[36:39], v[200:203], v[156:159]
    s_add_u32 s47, s43, s42
    s_min_u32 s42, s44, s45
    s_waitcnt lgkmcnt(2)
    v_mfma_f32_16x16x32_bf16 v[160:163], v[100:103], v[204:207], v[160:163]
    ds_read_b128 v[220:223], v106 offset:9216
    v_mfma_f32_16x16x32_bf16 v[164:167], v[32:35], v[204:207], v[164:167]
    buffer_load_dwordx4 a[100:103], v22, s[12:15], s49 offen offset:2048 sc1
    v_mfma_f32_16x16x32_bf16 v[168:171], v[36:39], v[204:207], v[168:171]
    s_min_u32 s43, s46, s47
    v_mfma_f32_16x16x32_bf16 v[172:175], v[100:103], v[208:211], v[172:175]
    ds_read_b128 v[224:227], v107 offset:9216
    v_mfma_f32_16x16x32_bf16 v[176:179], v[32:35], v[208:211], v[176:179]
    v_max3_i32 v8, v8, v196, v198
    v_mfma_f32_16x16x32_bf16 v[180:183], v[36:39], v[208:211], v[180:183]
    s_waitcnt lgkmcnt(2)
    v_mfma_f32_16x16x32_bf16 v[136:139], v[40:43], v[212:215], v[136:139]
    ds_read_b128 v[196:199], v104 offset:14336
    v_mfma_f32_16x16x32_bf16 v[140:143], v[44:47], v[212:215], v[140:143]
    buffer_load_dwordx4 a[4:7], v22, s[12:15], s49 offen offset:3072 sc1
    v_mfma_f32_16x16x32_bf16 v[144:147], v[48:51], v[212:215], v[144:147]
    v_mfma_f32_16x16x32_bf16 v[148:151], v[40:43], v[216:219], v[148:151]
    ds_read_b128 v[200:203], v105 offset:14336
    v_mfma_f32_16x16x32_bf16 v[152:155], v[44:47], v[216:219], v[152:155]
    s_add_u32 s49, s61, 40960
    buffer_load_dwordx4 a[104:107], v22, s[12:15], s49 offen offset:0 sc1
    v_mfma_f32_16x16x32_bf16 v[156:159], v[48:51], v[216:219], v[156:159]
    s_waitcnt lgkmcnt(2)
    v_mfma_f32_16x16x32_bf16 v[160:163], v[40:43], v[220:223], v[160:163]
    ds_read_b128 v[204:207], v106 offset:14336
    v_mfma_f32_16x16x32_bf16 v[164:167], v[44:47], v[220:223], v[164:167]
    buffer_load_dwordx4 a[108:111], v22, s[12:15], s49 offen offset:1024 sc1
    v_mfma_f32_16x16x32_bf16 v[168:171], v[48:51], v[220:223], v[168:171]
    v_mfma_f32_16x16x32_bf16 v[172:175], v[40:43], v[224:227], v[172:175]
    ds_read_b128 v[208:211], v107 offset:14336
    v_mfma_f32_16x16x32_bf16 v[176:179], v[44:47], v[224:227], v[176:179]
    v_max3_i32 v8, v8, v212, v214
    v_mfma_f32_16x16x32_bf16 v[180:183], v[48:51], v[224:227], v[180:183]
    s_waitcnt lgkmcnt(2)
    v_mfma_f32_16x16x32_bf16 v[136:139], v[52:55], v[196:199], v[136:139]
    ds_read_b128 v[212:215], v104 offset:19456
    v_mfma_f32_16x16x32_bf16 v[140:143], v[56:59], v[196:199], v[140:143]
    buffer_load_dwordx4 a[8:11], v22, s[12:15], s49 offen offset:2048 sc1
    v_mfma_f32_16x16x32_bf16 v[144:147], v[60:63], v[196:199], v[144:147]
    v_mfma_f32_16x16x32_bf16 v[148:151], v[52:55], v[200:203], v[148:151]
    ds_read_b128 v[216:219], v105 offset:19456
    v_mfma_f32_16x16x32_bf16 v[152:155], v[56:59], v[200:203], v[152:155]
    buffer_load_dwordx4 a[112:115], v22, s[12:15], s49 offen offset:3072 sc1
    v_mfma_f32_16x16x32_bf16 v[156:159], v[60:63], v[200:203], v[156:159]
    s_waitcnt lgkmcnt(2)
    v_mfma_f32_16x16x32_bf16 v[160:163], v[52:55], v[204:207], v[160:163]
    ds_read_b128 v[220:223], v106 offset:19456
    v_mfma_f32_16x16x32_bf16 v[164:167], v[56:59], v[204:207], v[164:167]
    s_add_u32 s49, s61, 45056
    buffer_load_dwordx4 a[116:119], v22, s[12:15], s49 offen offset:0 sc1
    v_mfma_f32_16x16x32_bf16 v[168:171], v[60:63], v[204:207], v[168:171]
    v_mfma_f32_16x16x32_bf16 v[172:175], v[52:55], v[208:211], v[172:175]
    ds_read_b128 v[224:227], v107 offset:19456
    v_mfma_f32_16x16x32_bf16 v[176:179], v[56:59], v[208:211], v[176:179]
    v_max3_i32 v8, v8, v196, v198
    v_mfma_f32_16x16x32_bf16 v[180:183], v[60:63], v[208:211], v[180:183]
    s_waitcnt lgkmcnt(2)
    v_mfma_f32_16x16x32_bf16 v[136:139], v[64:67], v[212:215], v[136:139]
    v_mfma_f32_16x16x32_bf16 v[140:143], v[68:71], v[212:215], v[140:143]
    buffer_load_dwordx4 a[12:15], v22, s[12:15], s49 offen offset:1024 sc1
    v_mfma_f32_16x16x32_bf16 v[144:147], v[72:75], v[212:215], v[144:147]
    v_mfma_f32_16x16x32_bf16 v[148:151], v[64:67], v[216:219], v[148:151]
    v_mfma_f32_16x16x32_bf16 v[152:155], v[68:71], v[216:219], v[152:155]
    buffer_load_dwordx4 a[120:123], v22, s[12:15], s49 offen offset:2048 sc1
    v_mfma_f32_16x16x32_bf16 v[156:159], v[72:75], v[216:219], v[156:159]
    s_waitcnt lgkmcnt(0)
    v_mfma_f32_16x16x32_bf16 v[160:163], v[64:67], v[220:223], v[160:163]
    v_mfma_f32_16x16x32_bf16 v[164:167], v[68:71], v[220:223], v[164:167]
    buffer_load_dwordx4 a[124:127], v22, s[12:15], s49 offen offset:3072 sc1
    v_mfma_f32_16x16x32_bf16 v[168:171], v[72:75], v[220:223], v[168:171]
    v_mfma_f32_16x16x32_bf16 v[172:175], v[64:67], v[224:227], v[172:175]
    v_mfma_f32_16x16x32_bf16 v[176:179], v[68:71], v[224:227], v[176:179]
    v_max3_i32 v8, v8, v212, v214
    v_mfma_f32_16x16x32_bf16 v[180:183], v[72:75], v[224:227], v[180:183]
    ds_write_b32 v11, v8 offset:10240
    s_waitcnt vmcnt(27)
    v_pk_fma_f32 v[136:137], v[184:185], v[108:109], v[136:137] op_sel_hi:[1,0,1]
    v_pk_fma_f32 v[138:139], v[186:187], v[108:109], v[138:139] op_sel_hi:[1,0,1]
    v_pk_fma_f32 v[140:141], v[188:189], v[108:109], v[140:141] op_sel_hi:[1,0,1]
    v_pk_fma_f32 v[142:143], v[190:191], v[108:109], v[142:143] op_sel_hi:[1,0,1]
    v_pk_mul_f32 v[228:229], v[136:137], v[136:137]
    s_add_u32 s49, s61, 49152
    buffer_load_dwordx4 a[16:19], v22, s[12:15], s49 offen offset:0 sc1
    v_pk_mul_f32 v[230:231], v[138:139], v[138:139]
    v_pk_mul_f32 v[232:233], v[140:141], v[140:141]
    v_pk_mul_f32 v[234:235], v[142:143], v[142:143]
    v_pk_fma_f32 v[228:229], v[228:229], v[110:111], v[110:111] op_sel:[0,0,1] op_sel_hi:[1,0,1]
    v_pk_fma_f32 v[230:231], v[230:231], v[110:111], v[110:111] op_sel:[0,0,1] op_sel_hi:[1,0,1]
    v_pk_fma_f32 v[232:233], v[232:233], v[110:111], v[110:111] op_sel:[0,0,1] op_sel_hi:[1,0,1]
    v_pk_fma_f32 v[234:235], v[234:235], v[110:111], v[110:111] op_sel:[0,0,1] op_sel_hi:[1,0,1]
    v_pk_mul_f32 v[228:229], v[228:229], v[136:137]
    v_pk_mul_f32 v[230:231], v[230:231], v[138:139]
    v_pk_mul_f32 v[232:233], v[232:233], v[140:141]
    buffer_load_dwordx4 a[128:131], v22, s[12:15], s49 offen offset:1024 sc1
    v_pk_mul_f32 v[234:235], v[234:235], v[142:143]
    v_exp_f32 v228, v228
    v_exp_f32 v229, v229
    v_exp_f32 v230, v230
    v_exp_f32 v231, v231
    v_exp_f32 v232, v232
    v_exp_f32 v233, v233
    v_exp_f32 v234, v234
    v_exp_f32 v235, v235
    v_pk_fma_f32 v[228:229], v[228:229], v[108:109], v[108:109] op_sel:[0,1,1] op_sel_hi:[1,1,1]
    buffer_load_dwordx4 a[132:135], v22, s[12:15], s49 offen offset:2048 sc1
    v_pk_fma_f32 v[230:231], v[230:231], v[108:109], v[108:109] op_sel:[0,1,1] op_sel_hi:[1,1,1]
    v_pk_fma_f32 v[232:233], v[232:233], v[108:109], v[108:109] op_sel:[0,1,1] op_sel_hi:[1,1,1]
    v_pk_fma_f32 v[234:235], v[234:235], v[108:109], v[108:109] op_sel:[0,1,1] op_sel_hi:[1,1,1]
    v_rcp_f32 v228, v228
    v_rcp_f32 v229, v229
    v_rcp_f32 v230, v230
    v_rcp_f32 v231, v231
    v_rcp_f32 v232, v232
    v_rcp_f32 v233, v233
    v_rcp_f32 v234, v234
    buffer_load_dwordx4 a[20:23], v22, s[12:15], s49 offen offset:3072 sc1
    v_rcp_f32 v235, v235
    v_pk_mul_f32 v[228:229], v[228:229], v[136:137]
    v_pk_mul_f32 v[230:231], v[230:231], v[138:139]
    v_pk_mul_f32 v[232:233], v[232:233], v[140:141]
    v_pk_mul_f32 v[234:235], v[234:235], v[142:143]
    v_cvt_pk_bf16_f32 v196, v228, v229
    v_cvt_pk_bf16_f32 v197, v230, v231
    v_cvt_pk_bf16_f32 v198, v232, v233
    v_cvt_pk_bf16_f32 v199, v234, v235
    v_pk_fma_f32 v[144:145], v[192:193], v[108:109], v[144:145] op_sel_hi:[1,0,1]
    s_add_u32 s49, s61, 53248
    buffer_load_dwordx4 a[136:139], v22, s[12:15], s49 offen offset:0 sc1
    v_pk_fma_f32 v[146:147], v[194:195], v[108:109], v[146:147] op_sel_hi:[1,0,1]
    v_pk_fma_f32 v[148:149], v[184:185], v[112:113], v[148:149] op_sel_hi:[1,0,1]
    v_pk_fma_f32 v[150:151], v[186:187], v[112:113], v[150:151] op_sel_hi:[1,0,1]
    v_pk_mul_f32 v[236:237], v[144:145], v[144:145]
    v_pk_mul_f32 v[238:239], v[146:147], v[146:147]
    v_pk_mul_f32 v[240:241], v[148:149], v[148:149]
    v_pk_mul_f32 v[242:243], v[150:151], v[150:151]
    v_pk_fma_f32 v[236:237], v[236:237], v[110:111], v[110:111] op_sel:[0,0,1] op_sel_hi:[1,0,1]
    v_pk_fma_f32 v[238:239], v[238:239], v[110:111], v[110:111] op_sel:[0,0,1] op_sel_hi:[1,0,1]
    v_pk_fma_f32 v[240:241], v[240:241], v[114:115], v[114:115] op_sel:[0,0,1] op_sel_hi:[1,0,1]
    buffer_load_dwordx4 a[140:143], v22, s[12:15], s49 offen offset:1024 sc1
    v_pk_fma_f32 v[242:243], v[242:243], v[114:115], v[114:115] op_sel:[0,0,1] op_sel_hi:[1,0,1]
    v_pk_mul_f32 v[236:237], v[236:237], v[144:145]
    v_pk_mul_f32 v[238:239], v[238:239], v[146:147]
    v_pk_mul_f32 v[240:241], v[240:241], v[148:149]
    v_pk_mul_f32 v[242:243], v[242:243], v[150:151]
    s_waitcnt lgkmcnt(0)
    s_barrier
    ds_read_b128 v[4:7], v22 offset:10240
    v_exp_f32 v236, v236
    v_exp_f32 v237, v237
    v_exp_f32 v238, v238
    v_exp_f32 v239, v239
    buffer_load_dwordx4 a[24:27], v22, s[12:15], s49 offen offset:2048 sc1
    v_exp_f32 v240, v240
    v_exp_f32 v241, v241
    v_exp_f32 v242, v242
    v_exp_f32 v243, v243
    v_pk_fma_f32 v[236:237], v[236:237], v[108:109], v[108:109] op_sel:[0,1,1] op_sel_hi:[1,1,1]
    v_pk_fma_f32 v[238:239], v[238:239], v[108:109], v[108:109] op_sel:[0,1,1] op_sel_hi:[1,1,1]
    v_pk_fma_f32 v[240:241], v[240:241], v[112:113], v[112:113] op_sel:[0,1,1] op_sel_hi:[1,1,1]
    v_pk_fma_f32 v[242:243], v[242:243], v[112:113], v[112:113] op_sel:[0,1,1] op_sel_hi:[1,1,1]
    buffer_load_dwordx4 a[144:147], v22, s[12:15], s49 offen offset:3072 sc1
    v_rcp_f32 v236, v236
    v_rcp_f32 v237, v237
    v_rcp_f32 v238, v238
    v_rcp_f32 v239, v239
    v_rcp_f32 v240, v240
    v_rcp_f32 v241, v241
    v_rcp_f32 v242, v242
    v_rcp_f32 v243, v243
    s_add_u32 s49, s61, 57344
    buffer_load_dwordx4 a[148:151], v22, s[12:15], s49 offen offset:0 sc1
    v_pk_mul_f32 v[236:237], v[236:237], v[144:145]
    v_pk_mul_f32 v[238:239], v[238:239], v[146:147]
    v_pk_mul_f32 v[240:241], v[240:241], v[148:149]
    v_pk_mul_f32 v[242:243], v[242:243], v[150:151]
    v_cvt_pk_bf16_f32 v212, v236, v237
    v_cvt_pk_bf16_f32 v213, v238, v239
    v_cvt_pk_bf16_f32 v200, v240, v241
    v_cvt_pk_bf16_f32 v201, v242, v243
    v_pk_fma_f32 v[152:153], v[188:189], v[112:113], v[152:153] op_sel_hi:[1,0,1]
    buffer_load_dwordx4 a[188:191], v22, s[12:15], s49 offen offset:1024 sc1
    v_pk_fma_f32 v[154:155], v[190:191], v[112:113], v[154:155] op_sel_hi:[1,0,1]
    v_pk_fma_f32 v[156:157], v[192:193], v[112:113], v[156:157] op_sel_hi:[1,0,1]
    v_pk_fma_f32 v[158:159], v[194:195], v[112:113], v[158:159] op_sel_hi:[1,0,1]
    v_pk_mul_f32 v[244:245], v[152:153], v[152:153]
    v_pk_mul_f32 v[246:247], v[154:155], v[154:155]
    v_pk_mul_f32 v[248:249], v[156:157], v[156:157]
    v_pk_mul_f32 v[250:251], v[158:159], v[158:159]
L_pad_3:
    s_cbranch_execz L_hret_0
    v_pk_fma_f32 v[244:245], v[244:245], v[114:115], v[114:115] op_sel:[0,0,1] op_sel_hi:[1,0,1]
    buffer_load_dwordx4 a[192:195], v22, s[12:15], s49 offen offset:2048 sc1
    v_pk_fma_f32 v[246:247], v[246:247], v[114:115], v[114:115] op_sel:[0,0,1] op_sel_hi:[1,0,1]
    v_pk_fma_f32 v[248:249], v[248:249], v[114:115], v[114:115] op_sel:[0,0,1] op_sel_hi:[1,0,1]
    v_pk_fma_f32 v[250:251], v[250:251], v[114:115], v[114:115] op_sel:[0,0,1] op_sel_hi:[1,0,1]
    v_pk_mul_f32 v[244:245], v[244:245], v[152:153]
    v_pk_mul_f32 v[246:247], v[246:247], v[154:155]
    v_pk_mul_f32 v[248:249], v[248:249], v[156:157]
    v_pk_mul_f32 v[250:251], v[250:251], v[158:159]
    v_exp_f32 v244, v244
    buffer_load_dwordx4 a[196:199], v22, s[12:15], s49 offen offset:3072 sc1
    v_exp_f32 v245, v245
    v_exp_f32 v246, v246
    v_exp_f32 v247, v247
    v_exp_f32 v248, v248
    v_exp_f32 v249, v249
    s_waitcnt lgkmcnt(0)
    v_max3_i32 v4, v4, v5, v6
    v_max_i32 v4, v4, v7
    v_cmp_eq_u32 vcc, s21, v4
    v_exp_f32 v250, v250
    v_exp_f32 v251, v251
    v_pk_fma_f32 v[244:245], v[244:245], v[112:113], v[112:113] op_sel:[0,1,1] op_sel_hi:[1,1,1]
    v_pk_fma_f32 v[246:247], v[246:247], v[112:113], v[112:113] op_sel:[0,1,1] op_sel_hi:[1,1,1]
    v_pk_fma_f32 v[248:249], v[248:249], v[112:113], v[112:113] op_sel:[0,1,1] op_sel_hi:[1,1,1]
    v_pk_fma_f32 v[250:251], v[250:251], v[112:113], v[112:113] op_sel:[0,1,1] op_sel_hi:[1,1,1]
    v_rcp_f32 v244, v244
    v_rcp_f32 v245, v245
    v_rcp_f32 v246, v246
    v_rcp_f32 v247, v247
    v_rcp_f32 v248, v248
    v_rcp_f32 v249, v249
    v_rcp_f32 v250, v250
    v_rcp_f32 v251, v251
    v_pk_mul_f32 v[244:245], v[244:245], v[152:153]
    v_pk_mul_f32 v[246:247], v[246:247], v[154:155]
    v_pk_mul_f32 v[248:249], v[248:249], v[156:157]
    v_pk_mul_f32 v[250:251], v[250:251], v[158:159]
    v_cvt_pk_bf16_f32 v202, v244, v245
    v_cvt_pk_bf16_f32 v203, v246, v247
    v_cvt_pk_bf16_f32 v214, v248, v249
    v_cvt_pk_bf16_f32 v215, v250, v251
    s_cbranch_vccnz L_k6r_42
    buffer_store_dwordx4 v[196:199], v22, s[12:15], s44 offen sc1
    v_permlane16_swap_b32 v212, v214
    v_permlane16_swap_b32 v213, v215
    buffer_store_dwordx4 v[200:203], v22, s[12:15], s45 offen sc1
    buffer_store_dwordx4 v[212:215], v10, s[12:15], s42 offen offset:1024 sc1
    v_pk_fma_f32 v[160:161], v[184:185], v[252:253], v[160:161] op_sel_hi:[1,0,1]
    v_pk_fma_f32 v[162:163], v[186:187], v[252:253], v[162:163] op_sel_hi:[1,0,1]
    v_pk_fma_f32 v[164:165], v[188:189], v[252:253], v[164:165] op_sel_hi:[1,0,1]
    v_pk_fma_f32 v[166:167], v[190:191], v[252:253], v[166:167] op_sel_hi:[1,0,1]
    v_pk_mul_f32 v[228:229], v[160:161], v[160:161]
    v_pk_mul_f32 v[230:231], v[162:163], v[162:163]
    v_pk_mul_f32 v[232:233], v[164:165], v[164:165]
    v_pk_mul_f32 v[234:235], v[166:167], v[166:167]
    v_pk_fma_f32 v[228:229], v[228:229], v[254:255], v[254:255] op_sel:[0,0,1] op_sel_hi:[1,0,1]
    v_pk_fma_f32 v[230:231], v[230:231], v[254:255], v[254:255] op_sel:[0,0,1] op_sel_hi:[1,0,1]
    v_pk_fma_f32 v[232:233], v[232:233], v[254:255], v[254:255] op_sel:[0,0,1] op_sel_hi:[1,0,1]
    v_pk_fma_f32 v[234:235], v[234:235], v[254:255], v[254:255] op_sel:[0,0,1] op_sel_hi:[1,0,1]
    v_pk_mul_f32 v[228:229], v[228:229], v[160:161]
    v_pk_mul_f32 v[230:231], v[230:231], v[162:163]
    v_pk_mul_f32 v[232:233], v[232:233], v[164:165]
    v_pk_mul_f32 v[234:235], v[234:235], v[166:167]
    v_exp_f32 v228, v228
    v_exp_f32 v229, v229
    v_exp_f32 v230, v230
    v_exp_f32 v231, v231
    v_exp_f32 v232, v232
    v_exp_f32 v233, v233
    v_exp_f32 v234, v234
    v_exp_f32 v235, v235
    v_pk_fma_f32 v[228:229], v[228:229], v[252:253], v[252:253] op_sel:[0,1,1] op_sel_hi:[1,1,1]
    v_pk_fma_f32 v[230:231], v[230:231], v[252:253], v[252:253] op_sel:[0,1,1] op_sel_hi:[1,1,1]
    v_pk_fma_f32 v[232:233], v[232:233], v[252:253], v[252:253] op_sel:[0,1,1] op_sel_hi:[1,1,1]
    v_pk_fma_f32 v[234:235], v[234:235], v[252:253], v[252:253] op_sel:[0,1,1] op_sel_hi:[1,1,1]
    v_rcp_f32 v228, v228
    v_rcp_f32 v229, v229
    v_rcp_f32 v230, v230
    v_rcp_f32 v231, v231
    v_rcp_f32 v232, v232
    v_rcp_f32 v233, v233
    v_rcp_f32 v234, v234
    v_rcp_f32 v235, v235
    v_pk_mul_f32 v[228:229], v[228:229], v[160:161]
    v_pk_mul_f32 v[230:231], v[230:231], v[162:163]
    v_pk_mul_f32 v[232:233], v[232:233], v[164:165]
    v_pk_mul_f32 v[234:235], v[234:235], v[166:167]
    v_cvt_pk_bf16_f32 v204, v228, v229
    v_cvt_pk_bf16_f32 v205, v230, v231
    v_cvt_pk_bf16_f32 v206, v232, v233
    v_cvt_pk_bf16_f32 v207, v234, v235
    v_pk_fma_f32 v[168:169], v[192:193], v[252:253], v[168:169] op_sel_hi:[1,0,1]
    v_pk_fma_f32 v[170:171], v[194:195], v[252:253], v[170:171] op_sel_hi:[1,0,1]
    v_pk_fma_f32 v[172:173], v[184:185], v[16:17], v[172:173] op_sel_hi:[1,0,1]
    v_pk_fma_f32 v[174:175], v[186:187], v[16:17], v[174:175] op_sel_hi:[1,0,1]
    v_pk_mul_f32 v[236:237], v[168:169], v[168:169]
    v_pk_mul_f32 v[238:239], v[170:171], v[170:171]
    v_pk_mul_f32 v[240:241], v[172:173], v[172:173]
    v_pk_mul_f32 v[242:243], v[174:175], v[174:175]
    v_pk_fma_f32 v[236:237], v[236:237], v[254:255], v[254:255] op_sel:[0,0,1] op_sel_hi:[1,0,1]
    v_pk_fma_f32 v[238:239], v[238:239], v[254:255], v[254:255] op_sel:[0,0,1] op_sel_hi:[1,0,1]
    v_pk_fma_f32 v[240:241], v[240:241], v[18:19], v[18:19] op_sel:[0,0,1] op_sel_hi:[1,0,1]
    v_pk_fma_f32 v[242:243], v[242:243], v[18:19], v[18:19] op_sel:[0,0,1] op_sel_hi:[1,0,1]
    v_pk_mul_f32 v[236:237], v[236:237], v[168:169]
    v_pk_mul_f32 v[238:239], v[238:239], v[170:171]
    v_pk_mul_f32 v[240:241], v[240:241], v[172:173]
    v_pk_mul_f32 v[242:243], v[242:243], v[174:175]
    v_exp_f32 v236, v236
    v_exp_f32 v237, v237
    v_exp_f32 v238, v238
    v_exp_f32 v239, v239
    v_exp_f32 v240, v240
    v_exp_f32 v241, v241
    v_exp_f32 v242, v242
    v_exp_f32 v243, v243
    v_pk_fma_f32 v[236:237], v[236:237], v[252:253], v[252:253] op_sel:[0,1,1] op_sel_hi:[1,1,1]
    v_pk_fma_f32 v[238:239], v[238:239], v[252:253], v[252:253] op_sel:[0,1,1] op_sel_hi:[1,1,1]
    v_pk_fma_f32 v[240:241], v[240:241], v[16:17], v[16:17] op_sel:[0,1,1] op_sel_hi:[1,1,1]
    v_pk_fma_f32 v[242:243], v[242:243], v[16:17], v[16:17] op_sel:[0,1,1] op_sel_hi:[1,1,1]
    v_rcp_f32 v236, v236
    v_rcp_f32 v237, v237
    v_rcp_f32 v238, v238
    v_rcp_f32 v239, v239
    v_rcp_f32 v240, v240
    v_rcp_f32 v241, v241
    v_rcp_f32 v242, v242
    v_rcp_f32 v243, v243
    v_pk_mul_f32 v[236:237], v[236:237], v[168:169]
    v_pk_mul_f32 v[238:239], v[238:239], v[170:171]
    v_pk_mul_f32 v[240:241], v[240:241], v[172:173]
    v_pk_mul_f32 v[242:243], v[242:243], v[174:175]
    v_cvt_pk_bf16_f32 v216, v236, v237
    v_cvt_pk_bf16_f32 v217, v238, v239
    v_cvt_pk_bf16_f32 v208, v240, v241
    v_cvt_pk_bf16_f32 v209, v242, v243
    v_pk_fma_f32 v[176:177], v[188:189], v[16:17], v[176:177] op_sel_hi:[1,0,1]
    v_pk_fma_f32 v[178:179], v[190:191], v[16:17], v[178:179] op_sel_hi:[1,0,1]
    v_pk_fma_f32 v[180:181], v[192:193], v[16:17], v[180:181] op_sel_hi:[1,0,1]
    v_pk_fma_f32 v[182:183], v[194:195], v[16:17], v[182:183] op_sel_hi:[1,0,1]
    v_pk_mul_f32 v[244:245], v[176:177], v[176:177]
    v_pk_mul_f32 v[246:247], v[178:179], v[178:179]
    v_pk_mul_f32 v[248:249], v[180:181], v[180:181]
    v_pk_mul_f32 v[250:251], v[182:183], v[182:183]
    v_pk_fma_f32 v[244:245], v[244:245], v[18:19], v[18:19] op_sel:[0,0,1] op_sel_hi:[1,0,1]
    v_pk_fma_f32 v[246:247], v[246:247], v[18:19], v[18:19] op_sel:[0,0,1] op_sel_hi:[1,0,1]
    v_pk_fma_f32 v[248:249], v[248:249], v[18:19], v[18:19] op_sel:[0,0,1] op_sel_hi:[1,0,1]
    v_pk_fma_f32 v[250:251], v[250:251], v[18:19], v[18:19] op_sel:[0,0,1] op_sel_hi:[1,0,1]
    v_pk_mul_f32 v[244:245], v[244:245], v[176:177]
    v_pk_mul_f32 v[246:247], v[246:247], v[178:179]
    v_pk_mul_f32 v[248:249], v[248:249], v[180:181]
    v_pk_mul_f32 v[250:251], v[250:251], v[182:183]
    v_exp_f32 v244, v244
    v_exp_f32 v245, v245
    v_exp_f32 v246, v246
    v_exp_f32 v247, v247
    v_exp_f32 v248, v248
    v_exp_f32 v249, v249
    v_exp_f32 v250, v250
    v_exp_f32 v251, v251
    v_pk_fma_f32 v[244:245], v[244:245], v[16:17], v[16:17] op_sel:[0,1,1] op_sel_hi:[1,1,1]
    v_pk_fma_f32 v[246:247], v[246:247], v[16:17], v[16:17] op_sel:[0,1,1] op_sel_hi:[1,1,1]
    v_pk_fma_f32 v[248:249], v[248:249], v[16:17], v[16:17] op_sel:[0,1,1] op_sel_hi:[1,1,1]
    v_pk_fma_f32 v[250:251], v[250:251], v[16:17], v[16:17] op_sel:[0,1,1] op_sel_hi:[1,1,1]
    v_rcp_f32 v244, v244
    v_rcp_f32 v245, v245
    v_rcp_f32 v246, v246
    v_rcp_f32 v247, v247
    v_rcp_f32 v248, v248
    v_rcp_f32 v249, v249
    v_rcp_f32 v250, v250
    v_rcp_f32 v251, v251
    v_pk_mul_f32 v[244:245], v[244:245], v[176:177]
    v_pk_mul_f32 v[246:247], v[246:247], v[178:179]
    v_pk_mul_f32 v[248:249], v[248:249], v[180:181]
    v_pk_mul_f32 v[250:251], v[250:251], v[182:183]
    v_cvt_pk_bf16_f32 v210, v244, v245
    v_cvt_pk_bf16_f32 v211, v246, v247
    v_cvt_pk_bf16_f32 v218, v248, v249
    v_cvt_pk_bf16_f32 v219, v250, v251
    buffer_store_dwordx4 v[204:207], v22, s[12:15], s46 offen sc1
    v_permlane16_swap_b32 v216, v218
    v_permlane16_swap_b32 v217, v219
    buffer_store_dwordx4 v[208:211], v22, s[12:15], s47 offen sc1
    buffer_store_dwordx4 v[216:219], v10, s[12:15], s43 offen offset:1024 sc1
    s_mul_i32 s34, s27, 196608
    s_mul_i32 s35, s3, 12288
    s_add_u32 s34, s34, s35
    s_add_u32 s34, s34, 19398656
    s_xor_b32 s35, s20, 2
    s_mul_i32 s35, s35, 49152
    s_add_u32 s36, s34, s35
    s_xor_b32 s35, s20, 3
    s_mul_i32 s35, s35, 49152
    s_add_u32 s37, s34, s35
    s_xor_b32 s35, s20, 1
    s_mul_i32 s35, s35, 49152
    s_add_u32 s38, s34, s35
    s_xor_b32 s35, s20, 0
    s_mul_i32 s35, s35, 49152
    s_add_u32 s39, s34, s35
    s_nop 0
    s_waitcnt vmcnt(0)
    s_barrier
    buffer_load_dwordx4 v[32:35], v22, s[12:15], s36 offen offset:0 sc1
    buffer_load_dwordx4 v[36:39], v22, s[12:15], s36 offen offset:1024 sc1
    buffer_load_dwordx4 v[40:43], v22, s[12:15], s36 offen offset:2048 sc1
    buffer_load_dwordx4 v[44:47], v22, s[12:15], s36 offen offset:3072 sc1
    s_add_u32 s35, s36, 4096
    buffer_load_dwordx4 v[48:51], v22, s[12:15], s35 offen offset:0 sc1
    buffer_load_dwordx4 v[52:55], v22, s[12:15], s35 offen offset:1024 sc1
    buffer_load_dwordx4 v[56:59], v22, s[12:15], s35 offen offset:2048 sc1
    buffer_load_dwordx4 v[60:63], v22, s[12:15], s35 offen offset:3072 sc1
    s_add_u32 s35, s36, 8192
    buffer_load_dwordx4 v[64:67], v22, s[12:15], s35 offen offset:0 sc1
    buffer_load_dwordx4 v[68:71], v22, s[12:15], s35 offen offset:1024 sc1
    buffer_load_dwordx4 v[72:75], v22, s[12:15], s35 offen offset:2048 sc1
    buffer_load_dwordx4 v[76:79], v22, s[12:15], s35 offen offset:3072 sc1
L_k7t_45:
    s_waitcnt vmcnt(11)
    v_mfma_f32_16x16x32_bf16 v[136:139], a[36:39], v[32:35], 0
    buffer_load_dwordx4 v[80:83], v22, s[12:15], s37 offen offset:0 sc1
    v_mfma_f32_16x16x32_bf16 v[140:143], a[40:43], v[32:35], 0
    v_max_i32 v8, v32, v34
    v_mfma_f32_16x16x32_bf16 v[144:147], a[44:47], v[32:35], 0
    v_mfma_f32_16x16x32_bf16 v[148:151], a[48:51], v[32:35], 0
    v_mfma_f32_16x16x32_bf16 v[152:155], a[52:55], v[32:35], 0
    s_waitcnt vmcnt(11)
    v_mfma_f32_16x16x32_bf16 v[136:139], a[56:59], v[36:39], v[136:139]
    buffer_load_dwordx4 v[84:87], v22, s[12:15], s37 offen offset:1024 sc1
    v_mfma_f32_16x16x32_bf16 v[140:143], a[60:63], v[36:39], v[140:143]
    v_max3_i32 v8, v8, v36, v38
    v_mfma_f32_16x16x32_bf16 v[144:147], a[64:67], v[36:39], v[144:147]
    v_mfma_f32_16x16x32_bf16 v[148:151], a[68:71], v[36:39], v[148:151]
    v_mfma_f32_16x16x32_bf16 v[152:155], a[72:75], v[36:39], v[152:155]
    s_waitcnt vmcnt(11)
    v_mfma_f32_16x16x32_bf16 v[136:139], a[76:79], v[40:43], v[136:139]
    buffer_load_dwordx4 v[88:91], v22, s[12:15], s37 offen offset:2048 sc1
    v_mfma_f32_16x16x32_bf16 v[140:143], a[80:83], v[40:43], v[140:143]
    v_max3_i32 v8, v8, v40, v42
    v_mfma_f32_16x16x32_bf16 v[144:147], a[84:87], v[40:43], v[144:147]
    v_mfma_f32_16x16x32_bf16 v[148:151], a[88:91], v[40:43], v[148:151]
    v_mfma_f32_16x16x32_bf16 v[152:155], a[92:95], v[40:43], v[152:155]
    s_waitcnt vmcnt(11)
    v_mfma_f32_16x16x32_bf16 v[136:139], a[160:163], v[44:47], v[136:139]
    buffer_load_dwordx4 v[92:95], v22, s[12:15], s37 offen offset:3072 sc1
    v_mfma_f32_16x16x32_bf16 v[140:143], a[164:167], v[44:47], v[140:143]
    v_max3_i32 v8, v8, v44, v46
    v_mfma_f32_16x16x32_bf16 v[144:147], a[168:171], v[44:47], v[144:147]
    v_mfma_f32_16x16x32_bf16 v[148:151], a[172:175], v[44:47], v[148:151]
    v_mfma_f32_16x16x32_bf16 v[152:155], a[176:179], v[44:47], v[152:155]
    s_waitcnt vmcnt(11)
    v_mfma_f32_16x16x32_bf16 v[136:139], a[180:183], v[48:51], v[136:139]
    s_add_u32 s35, s37, 4096
    buffer_load_dwordx4 v[96:99], v22, s[12:15], s35 offen offset:0 sc1
    v_mfma_f32_16x16x32_bf16 v[140:143], a[184:187], v[48:51], v[140:143]
    v_max3_i32 v8, v8, v48, v50
    v_mfma_f32_16x16x32_bf16 v[144:147], a[224:227], v[48:51], v[144:147]
    v_mfma_f32_16x16x32_bf16 v[148:151], a[228:231], v[48:51], v[148:151]
    v_mfma_f32_16x16x32_bf16 v[152:155], a[232:235], v[48:51], v[152:155]
    s_waitcnt vmcnt(11)
    v_mfma_f32_16x16x32_bf16 v[136:139], a[236:239], v[52:55], v[136:139]
    buffer_load_dwordx4 v[100:103], v22, s[12:15], s35 offen offset:1024 sc1
    v_mfma_f32_16x16x32_bf16 v[140:143], a[240:243], v[52:55], v[140:143]
    v_max3_i32 v8, v8, v52, v54
    v_mfma_f32_16x16x32_bf16 v[144:147], a[244:247], v[52:55], v[144:147]
    v_mfma_f32_16x16x32_bf16 v[148:151], a[248:251], v[52:55], v[148:151]
    v_mfma_f32_16x16x32_bf16 v[152:155], a[252:255], v[52:55], v[152:155]
    s_waitcnt vmcnt(11)
    v_mfma_f32_16x16x32_bf16 v[136:139], a[200:203], v[56:59], v[136:139]
    buffer_load_dwordx4 v[216:219], v22, s[12:15], s35 offen offset:2048 sc1
    v_mfma_f32_16x16x32_bf16 v[140:143], a[204:207], v[56:59], v[140:143]
    v_max3_i32 v8, v8, v56, v58
    v_mfma_f32_16x16x32_bf16 v[144:147], a[208:211], v[56:59], v[144:147]
    v_mfma_f32_16x16x32_bf16 v[148:151], a[212:215], v[56:59], v[148:151]
    v_mfma_f32_16x16x32_bf16 v[152:155], a[216:219], v[56:59], v[152:155]
    s_waitcnt vmcnt(11)
    v_mfma_f32_16x16x32_bf16 v[136:139], a[220:223], v[60:63], v[136:139]
    buffer_load_dwordx4 v[220:223], v22, s[12:15], s35 offen offset:3072 sc1
    v_mfma_f32_16x16x32_bf16 v[140:143], a[0:3], v[60:63], v[140:143]
    v_max3_i32 v8, v8, v60, v62
    v_mfma_f32_16x16x32_bf16 v[144:147], a[96:99], v[60:63], v[144:147]
    v_mfma_f32_16x16x32_bf16 v[148:151], a[100:103], v[60:63], v[148:151]
    v_mfma_f32_16x16x32_bf16 v[152:155], a[4:7], v[60:63], v[152:155]
    s_waitcnt vmcnt(11)
    v_mfma_f32_16x16x32_bf16 v[136:139], a[104:107], v[64:67], v[136:139]
    s_add_u32 s35, s37, 8192
    buffer_load_dwordx4 v[224:227], v22, s[12:15], s35 offen offset:0 sc1
    v_mfma_f32_16x16x32_bf16 v[140:143], a[108:111], v[64:67], v[140:143]
    v_max3_i32 v8, v8, v64, v66
    v_mfma_f32_16x16x32_bf16 v[144:147], a[8:11], v[64:67], v[144:147]
    v_mfma_f32_16x16x32_bf16 v[148:151], a[112:115], v[64:67], v[148:151]
    v_mfma_f32_16x16x32_bf16 v[152:155], a[116:119], v[64:67], v[152:155]
    s_waitcnt vmcnt(11)
    v_mfma_f32_16x16x32_bf16 v[136:139], a[12:15], v[68:71], v[136:139]
    buffer_load_dwordx4 v[228:231], v22, s[12:15], s35 offen offset:1024 sc1
    v_mfma_f32_16x16x32_bf16 v[140:143], a[120:123], v[68:71], v[140:143]
    v_max3_i32 v8, v8, v68, v70
    v_mfma_f32_16x16x32_bf16 v[144:147], a[124:127], v[68:71], v[144:147]
    v_mfma_f32_16x16x32_bf16 v[148:151], a[16:19], v[68:71], v[148:151]
    v_mfma_f32_16x16x32_bf16 v[152:155], a[128:131], v[68:71], v[152:155]
    s_waitcnt vmcnt(11)
    v_mfma_f32_16x16x32_bf16 v[136:139], a[132:135], v[72:75], v[136:139]
    buffer_load_dwordx4 v[232:235], v22, s[12:15], s35 offen offset:2048 sc1
    v_mfma_f32_16x16x32_bf16 v[140:143], a[20:23], v[72:75], v[140:143]
    v_max3_i32 v8, v8, v72, v74
    v_mfma_f32_16x16x32_bf16 v[144:147], a[136:139], v[72:75], v[144:147]
    v_mfma_f32_16x16x32_bf16 v[148:151], a[140:143], v[72:75], v[148:151]
    v_mfma_f32_16x16x32_bf16 v[152:155], a[24:27], v[72:75], v[152:155]
    s_waitcnt vmcnt(11)
    v_mfma_f32_16x16x32_bf16 v[136:139], a[144:147], v[76:79], v[136:139]
    buffer_load_dwordx4 v[236:239], v22, s[12:15], s35 offen offset:3072 sc1
    v_mfma_f32_16x16x32_bf16 v[140:143], a[148:151], v[76:79], v[140:143]
    v_max3_i32 v8, v8, v76, v78
    v_mfma_f32_16x16x32_bf16 v[144:147], a[188:191], v[76:79], v[144:147]
    v_mfma_f32_16x16x32_bf16 v[148:151], a[192:195], v[76:79], v[148:151]
    v_cmp_eq_u32 vcc, s21, v8
    v_mfma_f32_16x16x32_bf16 v[152:155], a[196:199], v[76:79], v[152:155]
    s_nop 0
    s_cbranch_vccnz L_k7r_46
L_k7t_47:
    s_waitcnt vmcnt(11)
    v_mfma_f32_16x16x32_bf16 v[156:159], a[36:39], v[80:83], 0
    buffer_load_dwordx4 v[240:243], v22, s[12:15], s38 offen offset:0 sc1
    v_mfma_f32_16x16x32_bf16 v[160:163], a[40:43], v[80:83], 0
    v_max_i32 v8, v80, v82
    v_mfma_f32_16x16x32_bf16 v[164:167], a[44:47], v[80:83], 0
    v_mfma_f32_16x16x32_bf16 v[168:171], a[48:51], v[80:83], 0
    ds_write_b128 v25, v[136:139] offset:0
    v_mfma_f32_16x16x32_bf16 v[172:175], a[52:55], v[80:83], 0
    s_waitcnt vmcnt(11)
    v_mfma_f32_16x16x32_bf16 v[156:159], a[56:59], v[84:87], v[156:159]
    buffer_load_dwordx4 v[244:247], v22, s[12:15], s38 offen offset:1024 sc1
    v_mfma_f32_16x16x32_bf16 v[160:163], a[60:63], v[84:87], v[160:163]
    v_max3_i32 v8, v8, v84, v86
    v_mfma_f32_16x16x32_bf16 v[164:167], a[64:67], v[84:87], v[164:167]
    ds_write_b128 v25, v[140:143] offset:1024
    v_mfma_f32_16x16x32_bf16 v[168:171], a[68:71], v[84:87], v[168:171]
    v_mfma_f32_16x16x32_bf16 v[172:175], a[72:75], v[84:87], v[172:175]
    s_waitcnt vmcnt(11)
    v_mfma_f32_16x16x32_bf16 v[156:159], a[76:79], v[88:91], v[156:159]
    buffer_load_dwordx4 v[248:251], v22, s[12:15], s38 offen offset:2048 sc1
    v_mfma_f32_16x16x32_bf16 v[160:163], a[80:83], v[88:91], v[160:163]
    v_max3_i32 v8, v8, v88, v90
    ds_write_b128 v25, v[144:147] offset:2048
    v_mfma_f32_16x16x32_bf16 v[164:167], a[84:87], v[88:91], v[164:167]
    v_mfma_f32_16x16x32_bf16 v[168:171], a[88:91], v[88:91], v[168:171]
    v_mfma_f32_16x16x32_bf16 v[172:175], a[92:95], v[88:91], v[172:175]
    s_waitcnt vmcnt(11)
    v_mfma_f32_16x16x32_bf16 v[156:159], a[160:163], v[92:95], v[156:159]
    buffer_load_dwordx4 v[252:255], v22, s[12:15], s38 offen offset:3072 sc1
    ds_write_b128 v25, v[148:151] offset:3072
    v_mfma_f32_16x16x32_bf16 v[160:163], a[164:167], v[92:95], v[160:163]
    v_max3_i32 v8, v8, v92, v94
    v_mfma_f32_16x16x32_bf16 v[164:167], a[168:171], v[92:95], v[164:167]
    v_mfma_f32_16x16x32_bf16 v[168:171], a[172:175], v[92:95], v[168:171]
    v_mfma_f32_16x16x32_bf16 v[172:175], a[176:179], v[92:95], v[172:175]
    ds_write_b128 v25, v[152:155] offset:4096
    s_waitcnt vmcnt(11)
    v_mfma_f32_16x16x32_bf16 v[156:159], a[180:183], v[96:99], v[156:159]
    s_add_u32 s35, s38, 4096
    buffer_load_dwordx4 v[32:35], v22, s[12:15], s35 offen offset:0 sc1
    v_mfma_f32_16x16x32_bf16 v[160:163], a[184:187], v[96:99], v[160:163]
    v_max3_i32 v8, v8, v96, v98
    v_mfma_f32_16x16x32_bf16 v[164:167], a[224:227], v[96:99], v[164:167]
    v_mfma_f32_16x16x32_bf16 v[168:171], a[228:231], v[96:99], v[168:171]
    v_mfma_f32_16x16x32_bf16 v[172:175], a[232:235], v[96:99], v[172:175]
    s_waitcnt vmcnt(11)
    v_mfma_f32_16x16x32_bf16 v[156:159], a[236:239], v[100:103], v[156:159]
    buffer_load_dwordx4 v[36:39], v22, s[12:15], s35 offen offset:1024 sc1
    v_mfma_f32_16x16x32_bf16 v[160:163], a[240:243], v[100:103], v[160:163]
    v_max3_i32 v8, v8, v100, v102
    v_mfma_f32_16x16x32_bf16 v[164:167], a[244:247], v[100:103], v[164:167]
    v_mfma_f32_16x16x32_bf16 v[168:171], a[248:251], v[100:103], v[168:171]
    v_mfma_f32_16x16x32_bf16 v[172:175], a[252:255], v[100:103], v[172:175]
    s_waitcnt vmcnt(11)
    v_mfma_f32_16x16x32_bf16 v[156:159], a[200:203], v[216:219], v[156:159]
    buffer_load_dwordx4 v[40:43], v22, s[12:15], s35 offen offset:2048 sc1
    v_mfma_f32_16x16x32_bf16 v[160:163], a[204:207], v[216:219], v[160:163]
    v_max3_i32 v8, v8, v216, v218
    v_mfma_f32_16x16x32_bf16 v[164:167], a[208:211], v[216:219], v[164:167]
    v_mfma_f32_16x16x32_bf16 v[168:171], a[212:215], v[216:219], v[168:171]
    v_mfma_f32_16x16x32_bf16 v[172:175], a[216:219], v[216:219], v[172:175]
    s_waitcnt vmcnt(11)
    v_mfma_f32_16x16x32_bf16 v[156:159], a[220:223], v[220:223], v[156:159]
    buffer_load_dwordx4 v[44:47], v22, s[12:15], s35 offen offset:3072 sc1
    v_mfma_f32_16x16x32_bf16 v[160:163], a[0:3], v[220:223], v[160:163]
    v_max3_i32 v8, v8, v220, v222
    v_mfma_f32_16x16x32_bf16 v[164:167], a[96:99], v[220:223], v[164:167]
    v_mfma_f32_16x16x32_bf16 v[168:171], a[100:103], v[220:223], v[168:171]
    v_mfma_f32_16x16x32_bf16 v[172:175], a[4:7], v[220:223], v[172:175]
    s_waitcnt vmcnt(11)
    v_mfma_f32_16x16x32_bf16 v[156:159], a[104:107], v[224:227], v[156:159]
    s_add_u32 s35, s38, 8192
    buffer_load_dwordx4 v[48:51], v22, s[12:15], s35 offen offset:0 sc1
    v_mfma_f32_16x16x32_bf16 v[160:163], a[108:111], v[224:227], v[160:163]
    v_max3_i32 v8, v8, v224, v226
    v_mfma_f32_16x16x32_bf16 v[164:167], a[8:11], v[224:227], v[164:167]
    v_mfma_f32_16x16x32_bf16 v[168:171], a[112:115], v[224:227], v[168:171]
    v_mfma_f32_16x16x32_bf16 v[172:175], a[116:119], v[224:227], v[172:175]
    s_waitcnt vmcnt(11)
    v_mfma_f32_16x16x32_bf16 v[156:159], a[12:15], v[228:231], v[156:159]
    buffer_load_dwordx4 v[52:55], v22, s[12:15], s35 offen offset:1024 sc1
    v_mfma_f32_16x16x32_bf16 v[160:163], a[120:123], v[228:231], v[160:163]
    v_max3_i32 v8, v8, v228, v230
    v_mfma_f32_16x16x32_bf16 v[164:167], a[124:127], v[228:231], v[164:167]
    v_mfma_f32_16x16x32_bf16 v[168:171], a[16:19], v[228:231], v[168:171]
    v_mfma_f32_16x16x32_bf16 v[172:175], a[128:131], v[228:231], v[172:175]
    s_waitcnt vmcnt(11)
    v_mfma_f32_16x16x32_bf16 v[156:159], a[132:135], v[232:235], v[156:159]
    buffer_load_dwordx4 v[56:59], v22, s[12:15], s35 offen offset:2048 sc1
    v_mfma_f32_16x16x32_bf16 v[160:163], a[20:23], v[232:235], v[160:163]
    v_max3_i32 v8, v8, v232, v234
    v_mfma_f32_16x16x32_bf16 v[164:167], a[136:139], v[232:235], v[164:167]
    v_mfma_f32_16x16x32_bf16 v[168:171], a[140:143], v[232:235], v[168:171]
    v_mfma_f32_16x16x32_bf16 v[172:175], a[24:27], v[232:235], v[172:175]
    s_waitcnt vmcnt(11)
    v_mfma_f32_16x16x32_bf16 v[156:159], a[144:147], v[236:239], v[156:159]
    buffer_load_dwordx4 v[60:63], v22, s[12:15], s35 offen offset:3072 sc1
    v_mfma_f32_16x16x32_bf16 v[160:163], a[148:151], v[236:239], v[160:163]
    v_max3_i32 v8, v8, v236, v238
    v_mfma_f32_16x16x32_bf16 v[164:167], a[188:191], v[236:239], v[164:167]
    v_mfma_f32_16x16x32_bf16 v[168:171], a[192:195], v[236:239], v[168:171]
    v_cmp_eq_u32 vcc, s21, v8
    v_mfma_f32_16x16x32_bf16 v[172:175], a[196:199], v[236:239], v[172:175]
    s_nop 0
    s_cbranch_vccnz L_k7r_48
L_k7t_49:
    s_waitcnt vmcnt(11)
    v_mfma_f32_16x16x32_bf16 v[136:139], a[36:39], v[240:243], 0
    buffer_load_dwordx4 v[64:67], v22, s[12:15], s39 offen offset:0 sc1
    v_mfma_f32_16x16x32_bf16 v[140:143], a[40:43], v[240:243], 0
    v_max_i32 v8, v240, v242
    v_mfma_f32_16x16x32_bf16 v[144:147], a[44:47], v[240:243], 0
    v_mfma_f32_16x16x32_bf16 v[148:151], a[48:51], v[240:243], 0
    ds_write_b128 v26, v[156:159] offset:0
    v_mfma_f32_16x16x32_bf16 v[152:155], a[52:55], v[240:243], 0
    s_waitcnt vmcnt(11)
    v_mfma_f32_16x16x32_bf16 v[136:139], a[56:59], v[244:247], v[136:139]
    buffer_load_dwordx4 v[68:71], v22, s[12:15], s39 offen offset:1024 sc1
    v_mfma_f32_16x16x32_bf16 v[140:143], a[60:63], v[244:247], v[140:143]
    v_max3_i32 v8, v8, v244, v246
    v_mfma_f32_16x16x32_bf16 v[144:147], a[64:67], v[244:247], v[144:147]
    ds_write_b128 v26, v[160:163] offset:1024
    v_mfma_f32_16x16x32_bf16 v[148:151], a[68:71], v[244:247], v[148:151]
    v_mfma_f32_16x16x32_bf16 v[152:155], a[72:75], v[244:247], v[152:155]
    s_waitcnt vmcnt(11)
    v_mfma_f32_16x16x32_bf16 v[136:139], a[76:79], v[248:251], v[136:139]
    buffer_load_dwordx4 v[72:75], v22, s[12:15], s39 offen offset:2048 sc1
    v_mfma_f32_16x16x32_bf16 v[140:143], a[80:83], v[248:251], v[140:143]
    v_max3_i32 v8, v8, v248, v250
    ds_write_b128 v26, v[164:167] offset:2048
    v_mfma_f32_16x16x32_bf16 v[144:147], a[84:87], v[248:251], v[144:147]
    v_mfma_f32_16x16x32_bf16 v[148:151], a[88:91], v[248:251], v[148:151]
    v_mfma_f32_16x16x32_bf16 v[152:155], a[92:95], v[248:251], v[152:155]
    s_waitcnt vmcnt(11)
    v_mfma_f32_16x16x32_bf16 v[136:139], a[160:163], v[252:255], v[136:139]
    buffer_load_dwordx4 v[76:79], v22, s[12:15], s39 offen offset:3072 sc1
    ds_write_b128 v26, v[168:171] offset:3072
    v_mfma_f32_16x16x32_bf16 v[140:143], a[164:167], v[252:255], v[140:143]
    v_max3_i32 v8, v8, v252, v254
    v_mfma_f32_16x16x32_bf16 v[144:147], a[168:171], v[252:255], v[144:147]
    v_mfma_f32_16x16x32_bf16 v[148:151], a[172:175], v[252:255], v[148:151]
    v_mfma_f32_16x16x32_bf16 v[152:155], a[176:179], v[252:255], v[152:155]
    ds_write_b128 v26, v[172:175] offset:4096
    s_waitcnt vmcnt(11)
    v_mfma_f32_16x16x32_bf16 v[136:139], a[180:183], v[32:35], v[136:139]
    s_add_u32 s35, s39, 4096
    buffer_load_dwordx4 v[80:83], v22, s[12:15], s35 offen offset:0 sc1
    v_mfma_f32_16x16x32_bf16 v[140:143], a[184:187], v[32:35], v[140:143]
    v_max3_i32 v8, v8, v32, v34
    v_mfma_f32_16x16x32_bf16 v[144:147], a[224:227], v[32:35], v[144:147]
    v_mfma_f32_16x16x32_bf16 v[148:151], a[228:231], v[32:35], v[148:151]
    v_mfma_f32_16x16x32_bf16 v[152:155], a[232:235], v[32:35], v[152:155]
    s_waitcnt vmcnt(11)
    v_mfma_f32_16x16x32_bf16 v[136:139], a[236:239], v[36:39], v[136:139]
    buffer_load_dwordx4 v[84:87], v22, s[12:15], s35 offen offset:1024 sc1
    v_mfma_f32_16x16x32_bf16 v[140:143], a[240:243], v[36:39], v[140:143]
    v_max3_i32 v8, v8, v36, v38
    v_mfma_f32_16x16x32_bf16 v[144:147], a[244:247], v[36:39], v[144:147]
    v_mfma_f32_16x16x32_bf16 v[148:151], a[248:251], v[36:39], v[148:151]
    v_mfma_f32_16x16x32_bf16 v[152:155], a[252:255], v[36:39], v[152:155]
    s_waitcnt vmcnt(11)
    v_mfma_f32_16x16x32_bf16 v[136:139], a[200:203], v[40:43], v[136:139]
    buffer_load_dwordx4 v[88:91], v22, s[12:15], s35 offen offset:2048 sc1
    v_mfma_f32_16x16x32_bf16 v[140:143], a[204:207], v[40:43], v[140:143]
    v_max3_i32 v8, v8, v40, v42
    v_mfma_f32_16x16x32_bf16 v[144:147], a[208:211], v[40:43], v[144:147]
    v_mfma_f32_16x16x32_bf16 v[148:151], a[212:215], v[40:43], v[148:151]
    v_mfma_f32_16x16x32_bf16 v[152:155], a[216:219], v[40:43], v[152:155]
    s_waitcnt vmcnt(11)
    v_mfma_f32_16x16x32_bf16 v[136:139], a[220:223], v[44:47], v[136:139]
    buffer_load_dwordx4 v[92:95], v22, s[12:15], s35 offen offset:3072 sc1
    v_mfma_f32_16x16x32_bf16 v[140:143], a[0:3], v[44:47], v[140:143]
    v_max3_i32 v8, v8, v44, v46
    v_mfma_f32_16x16x32_bf16 v[144:147], a[96:99], v[44:47], v[144:147]
    v_mfma_f32_16x16x32_bf16 v[148:151], a[100:103], v[44:47], v[148:151]
    v_mfma_f32_16x16x32_bf16 v[152:155], a[4:7], v[44:47], v[152:155]
    s_waitcnt vmcnt(11)
    v_mfma_f32_16x16x32_bf16 v[136:139], a[104:107], v[48:51], v[136:139]
    s_add_u32 s35, s39, 8192
    buffer_load_dwordx4 v[96:99], v22, s[12:15], s35 offen offset:0 sc1
    v_mfma_f32_16x16x32_bf16 v[140:143], a[108:111], v[48:51], v[140:143]
    v_max3_i32 v8, v8, v48, v50
    v_mfma_f32_16x16x32_bf16 v[144:147], a[8:11], v[48:51], v[144:147]
    v_mfma_f32_16x16x32_bf16 v[148:151], a[112:115], v[48:51], v[148:151]
    v_mfma_f32_16x16x32_bf16 v[152:155], a[116:119], v[48:51], v[152:155]
    s_waitcnt vmcnt(11)
    v_mfma_f32_16x16x32_bf16 v[136:139], a[12:15], v[52:55], v[136:139]
    buffer_load_dwordx4 v[100:103], v22, s[12:15], s35 offen offset:1024 sc1
    v_mfma_f32_16x16x32_bf16 v[140:143], a[120:123], v[52:55], v[140:143]
    v_max3_i32 v8, v8, v52, v54
    v_mfma_f32_16x16x32_bf16 v[144:147], a[124:127], v[52:55], v[144:147]
    v_mfma_f32_16x16x32_bf16 v[148:151], a[16:19], v[52:55], v[148:151]
    v_mfma_f32_16x16x32_bf16 v[152:155], a[128:131], v[52:55], v[152:155]
    s_waitcnt vmcnt(11)
    v_mfma_f32_16x16x32_bf16 v[136:139], a[132:135], v[56:59], v[136:139]
    buffer_load_dwordx4 v[216:219], v22, s[12:15], s35 offen offset:2048 sc1
    v_mfma_f32_16x16x32_bf16 v[140:143], a[20:23], v[56:59], v[140:143]
    v_max3_i32 v8, v8, v56, v58
    v_mfma_f32_16x16x32_bf16 v[144:147], a[136:139], v[56:59], v[144:147]
    v_mfma_f32_16x16x32_bf16 v[148:151], a[140:143], v[56:59], v[148:151]
    v_mfma_f32_16x16x32_bf16 v[152:155], a[24:27], v[56:59], v[152:155]
    s_waitcnt vmcnt(11)
    v_mfma_f32_16x16x32_bf16 v[136:139], a[144:147], v[60:63], v[136:139]
    buffer_load_dwordx4 v[220:223], v22, s[12:15], s35 offen offset:3072 sc1
    v_mfma_f32_16x16x32_bf16 v[140:143], a[148:151], v[60:63], v[140:143]
    v_max3_i32 v8, v8, v60, v62
    v_mfma_f32_16x16x32_bf16 v[144:147], a[188:191], v[60:63], v[144:147]
    v_mfma_f32_16x16x32_bf16 v[148:151], a[192:195], v[60:63], v[148:151]
    v_cmp_eq_u32 vcc, s21, v8
    v_mfma_f32_16x16x32_bf16 v[152:155], a[196:199], v[60:63], v[152:155]
    s_waitcnt lgkmcnt(0)
    s_cbranch_vccnz L_k7r_50
    s_barrier
L_k7t_51:
    ds_read_b128 v[176:179], v28 offset:0
    s_waitcnt vmcnt(11)
    v_mfma_f32_16x16x32_bf16 v[156:159], a[36:39], v[64:67], v[116:119]
    ds_read_b128 v[180:183], v28 offset:1024
    v_mfma_f32_16x16x32_bf16 v[160:163], a[40:43], v[64:67], v[120:123]
    v_max_i32 v8, v64, v66
    ds_read_b128 v[184:187], v28 offset:2048
    ds_read_b128 v[188:191], v28 offset:3072
    v_mfma_f32_16x16x32_bf16 v[164:167], a[44:47], v[64:67], v[124:127]
    ds_read_b128 v[192:195], v28 offset:4096
    v_mfma_f32_16x16x32_bf16 v[168:171], a[48:51], v[64:67], v[128:131]
    ds_write_b128 v27, v[136:139] offset:0
    ds_read_b128 v[196:199], v28 offset:5120
    v_mfma_f32_16x16x32_bf16 v[172:175], a[52:55], v[64:67], v[132:135]
    ds_read_b128 v[200:203], v28 offset:6144
    s_waitcnt vmcnt(10)
    v_mfma_f32_16x16x32_bf16 v[156:159], a[56:59], v[68:71], v[156:159]
    ds_read_b128 v[204:207], v28 offset:7168
    v_mfma_f32_16x16x32_bf16 v[160:163], a[60:63], v[68:71], v[160:163]
    v_max3_i32 v8, v8, v68, v70
    ds_read_b128 v[208:211], v28 offset:8192
    ds_read_b128 v[212:215], v28 offset:9216
    v_mfma_f32_16x16x32_bf16 v[164:167], a[64:67], v[68:71], v[164:167]
    ds_write_b128 v27, v[140:143] offset:1024
    s_waitcnt lgkmcnt(1)
    v_add_f32 v176, v176, v196
    v_mfma_f32_16x16x32_bf16 v[168:171], a[68:71], v[68:71], v[168:171]
    v_add_f32 v177, v177, v197
    v_mfma_f32_16x16x32_bf16 v[172:175], a[72:75], v[68:71], v[172:175]
    v_add_f32 v178, v178, v198
    s_waitcnt vmcnt(9)
    v_mfma_f32_16x16x32_bf16 v[156:159], a[76:79], v[72:75], v[156:159]
    v_add_f32 v179, v179, v199
    v_mfma_f32_16x16x32_bf16 v[160:163], a[80:83], v[72:75], v[160:163]
    v_max3_i32 v8, v8, v72, v74
    ds_write_b128 v27, v[144:147] offset:2048
    v_add_f32 v180, v180, v200
    v_mfma_f32_16x16x32_bf16 v[164:167], a[84:87], v[72:75], v[164:167]
    v_add_f32 v181, v181, v201
    v_add_f32 v182, v182, v202
    v_mfma_f32_16x16x32_bf16 v[168:171], a[88:91], v[72:75], v[168:171]
    v_add_f32 v183, v183, v203
    v_mfma_f32_16x16x32_bf16 v[172:175], a[92:95], v[72:75], v[172:175]
    v_add_f32 v184, v184, v204
    s_waitcnt vmcnt(8)
    v_mfma_f32_16x16x32_bf16 v[156:159], a[160:163], v[76:79], v[156:159]
    ds_write_b128 v27, v[148:151] offset:3072
    v_add_f32 v185, v185, v205
    v_mfma_f32_16x16x32_bf16 v[160:163], a[164:167], v[76:79], v[160:163]
    v_max3_i32 v8, v8, v76, v78
    v_add_f32 v186, v186, v206
    v_mfma_f32_16x16x32_bf16 v[164:167], a[168:171], v[76:79], v[164:167]
    v_add_f32 v187, v187, v207
    v_add_f32 v188, v188, v208
    v_mfma_f32_16x16x32_bf16 v[168:171], a[172:175], v[76:79], v[168:171]
    v_add_f32 v189, v189, v209
L_pad_4:
    s_cbranch_execz L_hret_0
    v_mfma_f32_16x16x32_bf16 v[172:175], a[176:179], v[76:79], v[172:175]
    ds_write_b128 v27, v[152:155] offset:4096
    v_add_f32 v190, v190, v210
    s_waitcnt vmcnt(7)
    v_mfma_f32_16x16x32_bf16 v[156:159], a[180:183], v[80:83], v[156:159]
    v_add_f32 v191, v191, v211
    v_mfma_f32_16x16x32_bf16 v[160:163], a[184:187], v[80:83], v[160:163]
    v_max3_i32 v8, v8, v80, v82
    v_add_f32 v192, v192, v212
    v_mfma_f32_16x16x32_bf16 v[164:167], a[224:227], v[80:83], v[164:167]
    v_add_f32 v193, v193, v213
    v_add_f32 v194, v194, v214
    v_mfma_f32_16x16x32_bf16 v[168:171], a[228:231], v[80:83], v[168:171]
    v_add_f32 v195, v195, v215
    v_mfma_f32_16x16x32_bf16 v[172:175], a[232:235], v[80:83], v[172:175]
    s_waitcnt vmcnt(6)
    v_mfma_f32_16x16x32_bf16 v[156:159], a[236:239], v[84:87], v[156:159]
    v_mfma_f32_16x16x32_bf16 v[160:163], a[240:243], v[84:87], v[160:163]
    v_max3_i32 v8, v8, v84, v86
    v_mfma_f32_16x16x32_bf16 v[164:167], a[244:247], v[84:87], v[164:167]
    s_waitcnt vmcnt(0)
    v_max3_i32 v8, v8, v88, v90
    v_max3_i32 v8, v8, v92, v94
    v_max3_i32 v8, v8, v96, v98
    v_max3_i32 v8, v8, v100, v102
    v_max3_i32 v8, v8, v216, v218
    v_max3_i32 v8, v8, v220, v222
    v_mfma_f32_16x16x32_bf16 v[168:171], a[248:251], v[84:87], v[168:171]
    v_cmp_eq_u32 vcc, s21, v8
    v_mfma_f32_16x16x32_bf16 v[172:175], a[252:255], v[84:87], v[172:175]
    s_waitcnt lgkmcnt(0)
    s_cbranch_vccnz L_k7r_52
    s_barrier
    ds_read_b128 v[196:199], v28 offset:10240
    v_mfma_f32_16x16x32_bf16 v[156:159], a[200:203], v[88:91], v[156:159]
    ds_read_b128 v[200:203], v28 offset:11264
    v_mfma_f32_16x16x32_bf16 v[160:163], a[204:207], v[88:91], v[160:163]
    ds_read_b128 v[204:207], v28 offset:12288
    v_mfma_f32_16x16x32_bf16 v[164:167], a[208:211], v[88:91], v[164:167]
    ds_read_b128 v[208:211], v28 offset:13312
    v_mfma_f32_16x16x32_bf16 v[168:171], a[212:215], v[88:91], v[168:171]
    v_mfma_f32_16x16x32_bf16 v[172:175], a[216:219], v[88:91], v[172:175]
    ds_read_b128 v[212:215], v28 offset:14336
    v_mfma_f32_16x16x32_bf16 v[156:159], a[220:223], v[92:95], v[156:159]
    s_nop 0
    v_mfma_f32_16x16x32_bf16 v[160:163], a[0:3], v[92:95], v[160:163]
    s_nop 0
    v_mfma_f32_16x16x32_bf16 v[164:167], a[96:99], v[92:95], v[164:167]
    s_waitcnt lgkmcnt(0)
    v_add_f32 v176, v176, v196
    v_mfma_f32_16x16x32_bf16 v[168:171], a[100:103], v[92:95], v[168:171]
    v_add_f32 v177, v177, v197
    v_mfma_f32_16x16x32_bf16 v[172:175], a[4:7], v[92:95], v[172:175]
    v_add_f32 v178, v178, v198
    v_mfma_f32_16x16x32_bf16 v[156:159], a[104:107], v[96:99], v[156:159]
    v_add_f32 v179, v179, v199
    v_mfma_f32_16x16x32_bf16 v[160:163], a[108:111], v[96:99], v[160:163]
    v_add_f32 v180, v180, v200
    v_mfma_f32_16x16x32_bf16 v[164:167], a[8:11], v[96:99], v[164:167]
    v_add_f32 v181, v181, v201
    v_mfma_f32_16x16x32_bf16 v[168:171], a[112:115], v[96:99], v[168:171]
    v_mfma_f32_16x16x32_bf16 v[172:175], a[116:119], v[96:99], v[172:175]
    v_add_f32 v182, v182, v202
    v_mfma_f32_16x16x32_bf16 v[156:159], a[12:15], v[100:103], v[156:159]
    v_add_f32 v183, v183, v203
    v_mfma_f32_16x16x32_bf16 v[160:163], a[120:123], v[100:103], v[160:163]
    v_add_f32 v184, v184, v204
    v_mfma_f32_16x16x32_bf16 v[164:167], a[124:127], v[100:103], v[164:167]
    v_add_f32 v185, v185, v205
    v_mfma_f32_16x16x32_bf16 v[168:171], a[16:19], v[100:103], v[168:171]
    v_add_f32 v186, v186, v206
    v_mfma_f32_16x16x32_bf16 v[172:175], a[128:131], v[100:103], v[172:175]
    v_add_f32 v187, v187, v207
    v_mfma_f32_16x16x32_bf16 v[156:159], a[132:135], v[216:219], v[156:159]
    v_add_f32 v188, v188, v208
    v_mfma_f32_16x16x32_bf16 v[160:163], a[20:23], v[216:219], v[160:163]
    v_add_f32 v189, v189, v209
    v_mfma_f32_16x16x32_bf16 v[164:167], a[136:139], v[216:219], v[164:167]
    v_add_f32 v190, v190, v210
    v_mfma_f32_16x16x32_bf16 v[168:171], a[140:143], v[216:219], v[168:171]
    v_mfma_f32_16x16x32_bf16 v[172:175], a[24:27], v[216:219], v[172:175]
    v_add_f32 v191, v191, v211
    v_mfma_f32_16x16x32_bf16 v[156:159], a[144:147], v[220:223], v[156:159]
    v_add_f32 v192, v192, v212
    v_mfma_f32_16x16x32_bf16 v[160:163], a[148:151], v[220:223], v[160:163]
    v_add_f32 v193, v193, v213
    v_mfma_f32_16x16x32_bf16 v[164:167], a[188:191], v[220:223], v[164:167]
    v_add_f32 v194, v194, v214
    v_mfma_f32_16x16x32_bf16 v[168:171], a[192:195], v[220:223], v[168:171]
    v_add_f32 v195, v195, v215
    v_mfma_f32_16x16x32_bf16 v[172:175], a[196:199], v[220:223], v[172:175]
    v_pk_add_f32 v[156:157], v[156:157], v[176:177]
    v_pk_add_f32 v[158:159], v[158:159], v[178:179]
    v_pk_add_f32 v[160:161], v[160:161], v[180:181]
    v_pk_add_f32 v[162:163], v[162:163], v[182:183]
    v_pk_add_f32 v[164:165], v[164:165], v[184:185]
    v_pk_add_f32 v[166:167], v[166:167], v[186:187]
    v_pk_add_f32 v[168:169], v[168:169], v[188:189]
    v_pk_add_f32 v[170:171], v[170:171], v[190:191]
    v_pk_add_f32 v[172:173], v[172:173], v[192:193]
    v_pk_add_f32 v[174:175], v[174:175], v[194:195]
    v_cvt_pk_bf16_f32 v176, v156, v157
    v_cvt_pk_bf16_f32 v177, v158, v159
    v_cvt_pk_bf16_f32 v178, v160, v161
    v_cvt_pk_bf16_f32 v179, v162, v163
    v_cvt_pk_bf16_f32 v180, v164, v165
    v_cvt_pk_bf16_f32 v181, v166, v167
    v_cvt_pk_bf16_f32 v182, v168, v169
    v_cvt_pk_bf16_f32 v183, v170, v171
    v_cvt_pk_bf16_f32 v184, v172, v173
    v_cvt_pk_bf16_f32 v185, v174, v175
    buffer_store_dwordx4 v[176:179], v23, s[16:19], s54 offen
    buffer_store_dwordx4 v[180:183], v23, s[16:19], s54 offen offset:64
    buffer_store_dwordx2 v[184:185], v24, s[16:19], s54 offen offset:128
    s_or_b32 s32, s2, s3
    s_cmp_lg_u32 s32, 0
    s_cbranch_scc1 L_exit
    v_mov_b32 v2, 0
    v_mov_b32 v3, s24
    s_mov_b64 exec, 1
    buffer_store_dword v3, v2, s[12:15], 0 offen
L_exit:
    s_endpgm
L_fallback:
    s_waitcnt vmcnt(0) lgkmcnt(0)
    s_mov_b32 s58, 0
    s_mov_b32 s59, s40
    s_mov_b32 s55, s39
    v_mov_b32 v16, v14
    v_mov_b32 v2, 0x3f803f80
    v_and_b32 v13, 27, v1
    v_cmp_eq_u32 vcc, 18, v13
    s_nop 1
    v_cndmask_b32 v13, 0, v2, vcc
    v_accvgpr_write_b32 a96, v13
    v_accvgpr_write_b32 a97, v13
    v_accvgpr_write_b32 a98, v13
    v_accvgpr_write_b32 a99, v13
    v_accvgpr_write_b32 a100, v13
    v_accvgpr_write_b32 a101, v13
    v_accvgpr_write_b32 a102, v13
    v_accvgpr_write_b32 a103, v13
    v_accvgpr_write_b32 a104, v13
    v_accvgpr_write_b32 a105, v13
    v_accvgpr_write_b32 a106, v13
    v_accvgpr_write_b32 a107, v13
    v_accvgpr_write_b32 a108, v13
    v_accvgpr_write_b32 a109, v13
    v_accvgpr_write_b32 a110, v13
    v_accvgpr_write_b32 a111, v13
    v_accvgpr_write_b32 a112, v13
    v_accvgpr_write_b32 a113, v13
    v_accvgpr_write_b32 a114, v13
    v_accvgpr_write_b32 a115, v13
    v_accvgpr_write_b32 a116, v13
    v_accvgpr_write_b32 a117, v13
    v_accvgpr_write_b32 a118, v13
    v_accvgpr_write_b32 a119, v13
    v_accvgpr_write_b32 a120, v13
    v_accvgpr_write_b32 a121, v13
    v_accvgpr_write_b32 a122, v13
    v_accvgpr_write_b32 a123, v13
    v_accvgpr_write_b32 a124, v13
    v_accvgpr_write_b32 a125, v13
    v_accvgpr_write_b32 a126, v13
    v_accvgpr_write_b32 a127, v13
    v_accvgpr_write_b32 a128, v13
    v_accvgpr_write_b32 a129, v13
    v_accvgpr_write_b32 a130, v13
    v_accvgpr_write_b32 a131, v13
    v_accvgpr_write_b32 a132, v13
    v_accvgpr_write_b32 a133, v13
    v_accvgpr_write_b32 a134, v13
    v_accvgpr_write_b32 a135, v13
    v_accvgpr_write_b32 a136, v13
    v_accvgpr_write_b32 a137, v13
    v_accvgpr_write_b32 a138, v13
    v_accvgpr_write_b32 a139, v13
    v_accvgpr_write_b32 a140, v13
    v_accvgpr_write_b32 a141, v13
    v_accvgpr_write_b32 a142, v13
    v_accvgpr_write_b32 a143, v13
    v_accvgpr_write_b32 a144, v13
    v_accvgpr_write_b32 a145, v13
    v_accvgpr_write_b32 a146, v13
    v_accvgpr_write_b32 a147, v13
    v_accvgpr_write_b32 a148, v13
    v_accvgpr_write_b32 a149, v13
    v_accvgpr_write_b32 a150, v13
    v_accvgpr_write_b32 a151, v13
    v_accvgpr_write_b32 a152, v13
    v_accvgpr_write_b32 a153, v13
    v_accvgpr_write_b32 a154, v13
    v_accvgpr_write_b32 a155, v13
    v_accvgpr_write_b32 a156, v13
    v_accvgpr_write_b32 a157, v13
    v_accvgpr_write_b32 a158, v13
    v_accvgpr_write_b32 a159, v13
    buffer_load_dwordx4 a[0:3], v7, s[12:15], s34 offen offset:0 sc1
    s_mov_b64 exec, s[44:45]
    buffer_load_dwordx2 a[64:65], v7, s[12:15], s36 offen offset:0 sc1
    s_mov_b64 exec, s[42:43]
    s_add_u32 s38, s41, 0
    buffer_load_dwordx4 a[96:99], v8, s[12:15], s38 offen sc1
    buffer_load_dwordx4 a[100:103], v6, s[12:15], s38 offen sc1
    s_mov_b64 exec, -1
    buffer_load_dwordx4 a[4:7], v7, s[12:15], s34 offen offset:512 sc1
    s_mov_b64 exec, s[44:45]
    buffer_load_dwordx2 a[66:67], v7, s[12:15], s36 offen offset:512 sc1
    s_mov_b64 exec, s[42:43]
    s_add_u32 s38, s41, 40960
    buffer_load_dwordx4 a[104:107], v8, s[12:15], s38 offen sc1
    buffer_load_dwordx4 a[108:111], v6, s[12:15], s38 offen sc1
    s_mov_b64 exec, -1
    buffer_load_dwordx4 a[8:11], v7, s[12:15], s34 offen offset:1024 sc1
    s_mov_b64 exec, s[44:45]
    buffer_load_dwordx2 a[68:69], v7, s[12:15], s36 offen offset:1024 sc1
    s_mov_b64 exec, s[42:43]
    s_add_u32 s38, s41, 81920
    buffer_load_dwordx4 a[112:115], v8, s[12:15], s38 offen sc1
    buffer_load_dwordx4 a[116:119], v6, s[12:15], s38 offen sc1
    s_mov_b64 exec, -1
    buffer_load_dwordx4 a[12:15], v7, s[12:15], s34 offen offset:1536 sc1
    s_mov_b64 exec, s[44:45]
    buffer_load_dwordx2 a[70:71], v7, s[12:15], s36 offen offset:1536 sc1
    s_mov_b64 exec, s[42:43]
    s_add_u32 s38, s41, 122880
    buffer_load_dwordx4 a[120:123], v8, s[12:15], s38 offen sc1
    buffer_load_dwordx4 a[124:127], v6, s[12:15], s38 offen sc1
    s_mov_b64 exec, -1
    buffer_load_dwordx4 a[16:19], v7, s[12:15], s34 offen offset:2048 sc1
    s_mov_b64 exec, s[44:45]
    buffer_load_dwordx2 a[72:73], v7, s[12:15], s36 offen offset:2048 sc1
    s_mov_b64 exec, s[42:43]
    s_add_u32 s38, s41, 163840
    buffer_load_dwordx4 a[128:131], v8, s[12:15], s38 offen sc1
    buffer_load_dwordx4 a[132:135], v6, s[12:15], s38 offen sc1
    s_mov_b64 exec, -1
    buffer_load_dwordx4 a[20:23], v7, s[12:15], s34 offen offset:2560 sc1
    s_mov_b64 exec, s[44:45]
    buffer_load_dwordx2 a[74:75], v7, s[12:15], s36 offen offset:2560 sc1
    s_mov_b64 exec, s[42:43]
    s_add_u32 s38, s41, 204800
    buffer_load_dwordx4 a[136:139], v8, s[12:15], s38 offen sc1
    buffer_load_dwordx4 a[140:143], v6, s[12:15], s38 offen sc1
    s_mov_b64 exec, -1
    buffer_load_dwordx4 a[24:27], v7, s[12:15], s34 offen offset:3072 sc1
    s_mov_b64 exec, s[44:45]
    buffer_load_dwordx2 a[76:77], v7, s[12:15], s36 offen offset:3072 sc1
    s_mov_b64 exec, s[42:43]
    s_add_u32 s38, s41, 245760
    buffer_load_dwordx4 a[144:147], v8, s[12:15], s38 offen sc1
    buffer_load_dwordx4 a[148:151], v6, s[12:15], s38 offen sc1
    s_mov_b64 exec, -1
    buffer_load_dwordx4 a[28:31], v7, s[12:15], s34 offen offset:3584 sc1
    s_mov_b64 exec, s[44:45]
    buffer_load_dwordx2 a[78:79], v7, s[12:15], s36 offen offset:3584 sc1
    s_mov_b64 exec, s[42:43]
    s_add_u32 s38, s41, 286720
    buffer_load_dwordx4 a[152:155], v8, s[12:15], s38 offen sc1
    buffer_load_dwordx4 a[156:159], v6, s[12:15], s38 offen sc1
    s_mov_b64 exec, -1
    buffer_load_dwordx4 a[32:35], v7, s[12:15], s35 offen offset:0 sc1
    s_mov_b64 exec, s[44:45]
    buffer_load_dwordx2 a[80:81], v7, s[12:15], s37 offen offset:0 sc1
    s_mov_b64 exec, s[42:43]
    s_add_u32 s38, s41, 327680
    buffer_load_dwordx4 a[160:163], v8, s[12:15], s38 offen sc1
    buffer_load_dwordx4 a[164:167], v6, s[12:15], s38 offen sc1
    s_mov_b64 exec, -1
    s_waitcnt vmcnt(0)
L_fb_loop:
    v_mov_b32 v148, 0
    v_mov_b32 v149, 0
    buffer_load_dwordx4 v[116:119], v7, s[12:15], s55 offen sc1
    s_mov_b64 exec, s[44:45]
    buffer_load_dwordx2 v[148:149], v7, s[12:15], s59 offen sc1
    s_mov_b64 exec, -1
    s_waitcnt vmcnt(0)
    v_mfma_f32_32x32x8_bf16 v[164:179], a[64:65], v[148:149], 0
    v_mfma_f32_32x32x16_bf16 v[164:179], a[0:3], v[116:119], v[164:179]
    s_nop 11
    v_max3_f32 v164, v164, v165, v166
    v_max3_f32 v167, v167, v168, v169
    v_max3_f32 v170, v170, v171, v172
    v_max3_f32 v173, v173, v174, v175
    v_max3_f32 v176, v176, v177, v178
    v_max3_f32 v164, v164, v167, v170
    v_max3_f32 v173, v173, v176, v179
    v_max_f32 v244, v164, v173
    v_mfma_f32_32x32x8_bf16 v[164:179], a[66:67], v[148:149], 0
    v_mfma_f32_32x32x16_bf16 v[164:179], a[4:7], v[116:119], v[164:179]
    s_nop 11
    v_max3_f32 v164, v164, v165, v166
    v_max3_f32 v167, v167, v168, v169
    v_max3_f32 v170, v170, v171, v172
    v_max3_f32 v173, v173, v174, v175
    v_max3_f32 v176, v176, v177, v178
    v_max3_f32 v164, v164, v167, v170
    v_max3_f32 v173, v173, v176, v179
    v_max3_f32 v244, v164, v173, v244
    v_mfma_f32_32x32x8_bf16 v[164:179], a[68:69], v[148:149], 0
    v_mfma_f32_32x32x16_bf16 v[164:179], a[8:11], v[116:119], v[164:179]
    s_nop 11
    v_max3_f32 v164, v164, v165, v166
    v_max3_f32 v167, v167, v168, v169
    v_max3_f32 v170, v170, v171, v172
    v_max3_f32 v173, v173, v174, v175
    v_max3_f32 v176, v176, v177, v178
    v_max3_f32 v164, v164, v167, v170
    v_max3_f32 v173, v173, v176, v179
    v_max3_f32 v244, v164, v173, v244
    v_mfma_f32_32x32x8_bf16 v[164:179], a[70:71], v[148:149], 0
    v_mfma_f32_32x32x16_bf16 v[164:179], a[12:15], v[116:119], v[164:179]
    s_nop 11
    v_max3_f32 v164, v164, v165, v166
    v_max3_f32 v167, v167, v168, v169
    v_max3_f32 v170, v170, v171, v172
    v_max3_f32 v173, v173, v174, v175
    v_max3_f32 v176, v176, v177, v178
    v_max3_f32 v164, v164, v167, v170
    v_max3_f32 v173, v173, v176, v179
    v_max3_f32 v244, v164, v173, v244
    v_mfma_f32_32x32x8_bf16 v[164:179], a[72:73], v[148:149], 0
    v_mfma_f32_32x32x16_bf16 v[164:179], a[16:19], v[116:119], v[164:179]
    s_nop 11
    v_max3_f32 v164, v164, v165, v166
    v_max3_f32 v167, v167, v168, v169
    v_max3_f32 v170, v170, v171, v172
    v_max3_f32 v173, v173, v174, v175
    v_max3_f32 v176, v176, v177, v178
    v_max3_f32 v164, v164, v167, v170
    v_max3_f32 v173, v173, v176, v179
    v_max3_f32 v244, v164, v173, v244
    v_mfma_f32_32x32x8_bf16 v[164:179], a[74:75], v[148:149], 0
    v_mfma_f32_32x32x16_bf16 v[164:179], a[20:23], v[116:119], v[164:179]
    s_nop 11
    v_max3_f32 v164, v164, v165, v166
    v_max3_f32 v167, v167, v168, v169
    v_max3_f32 v170, v170, v171, v172
    v_max3_f32 v173, v173, v174, v175
    v_max3_f32 v176, v176, v177, v178
    v_max3_f32 v164, v164, v167, v170
    v_max3_f32 v173, v173, v176, v179
    v_max3_f32 v244, v164, v173, v244
    v_mfma_f32_32x32x8_bf16 v[164:179], a[76:77], v[148:149], 0
    v_mfma_f32_32x32x16_bf16 v[164:179], a[24:27], v[116:119], v[164:179]
    s_nop 11
    v_max3_f32 v164, v164, v165, v166
    v_max3_f32 v167, v167, v168, v169
    v_max3_f32 v170, v170, v171, v172
    v_max3_f32 v173, v173, v174, v175
    v_max3_f32 v176, v176, v177, v178
    v_max3_f32 v164, v164, v167, v170
    v_max3_f32 v173, v173, v176, v179
    v_max3_f32 v244, v164, v173, v244
    v_mfma_f32_32x32x8_bf16 v[164:179], a[78:79], v[148:149], 0
    v_mfma_f32_32x32x16_bf16 v[164:179], a[28:31], v[116:119], v[164:179]
    s_nop 11
    v_max3_f32 v164, v164, v165, v166
    v_max3_f32 v167, v167, v168, v169
    v_max3_f32 v170, v170, v171, v172
    v_max3_f32 v173, v173, v174, v175
    v_max3_f32 v176, v176, v177, v178
    v_max3_f32 v164, v164, v167, v170
    v_max3_f32 v173, v173, v176, v179
    v_max3_f32 v244, v164, v173, v244
    v_mfma_f32_32x32x8_bf16 v[164:179], a[80:81], v[148:149], 0
    v_mfma_f32_32x32x16_bf16 v[164:179], a[32:35], v[116:119], v[164:179]
    s_nop 11
    v_max3_f32 v164, v164, v165, v166
    v_max3_f32 v167, v167, v168, v169
    v_max3_f32 v170, v170, v171, v172
    v_max3_f32 v173, v173, v174, v175
    v_max3_f32 v176, v176, v177, v178
    v_max3_f32 v164, v164, v167, v170
    v_max3_f32 v173, v173, v176, v179
    v_max3_f32 v244, v164, v173, v244
    v_mfma_f32_32x32x8_bf16 v[164:179], a[82:83], v[148:149], 0
    v_mfma_f32_32x32x16_bf16 v[164:179], a[36:39], v[116:119], v[164:179]
    s_nop 11
    v_max3_f32 v164, v164, v165, v166
    v_max3_f32 v167, v167, v168, v169
    v_max3_f32 v170, v170, v171, v172
    v_max3_f32 v173, v173, v174, v175
    v_max3_f32 v176, v176, v177, v178
    v_max3_f32 v164, v164, v167, v170
    v_max3_f32 v173, v173, v176, v179
    v_max3_f32 v244, v164, v173, v244
    v_mfma_f32_32x32x8_bf16 v[164:179], a[84:85], v[148:149], 0
    v_mfma_f32_32x32x16_bf16 v[164:179], a[40:43], v[116:119], v[164:179]
    s_nop 11
    v_max3_f32 v164, v164, v165, v166
    v_max3_f32 v167, v167, v168, v169
    v_max3_f32 v170, v170, v171, v172
    v_max3_f32 v173, v173, v174, v175
    v_max3_f32 v176, v176, v177, v178
    v_max3_f32 v164, v164, v167, v170
    v_max3_f32 v173, v173, v176, v179
    v_max3_f32 v244, v164, v173, v244
    v_mfma_f32_32x32x8_bf16 v[164:179], a[86:87], v[148:149], 0
    v_mfma_f32_32x32x16_bf16 v[164:179], a[44:47], v[116:119], v[164:179]
    s_nop 11
    v_max3_f32 v164, v164, v165, v166
    v_max3_f32 v167, v167, v168, v169
    v_max3_f32 v170, v170, v171, v172
    v_max3_f32 v173, v173, v174, v175
    v_max3_f32 v176, v176, v177, v178
    v_max3_f32 v164, v164, v167, v170
    v_max3_f32 v173, v173, v176, v179
    v_max3_f32 v244, v164, v173, v244
    v_mfma_f32_32x32x8_bf16 v[164:179], a[88:89], v[148:149], 0
    v_mfma_f32_32x32x16_bf16 v[164:179], a[48:51], v[116:119], v[164:179]
    s_nop 11
    v_max3_f32 v164, v164, v165, v166
    v_max3_f32 v167, v167, v168, v169
    v_max3_f32 v170, v170, v171, v172
    v_max3_f32 v173, v173, v174, v175
    v_max3_f32 v176, v176, v177, v178
    v_max3_f32 v164, v164, v167, v170
    v_max3_f32 v173, v173, v176, v179
    v_max3_f32 v244, v164, v173, v244
    v_mfma_f32_32x32x8_bf16 v[164:179], a[90:91], v[148:149], 0
    v_mfma_f32_32x32x16_bf16 v[164:179], a[52:55], v[116:119], v[164:179]
    s_nop 11
    v_max3_f32 v164, v164, v165, v166
    v_max3_f32 v167, v167, v168, v169
    v_max3_f32 v170, v170, v171, v172
    v_max3_f32 v173, v173, v174, v175
    v_max3_f32 v176, v176, v177, v178
    v_max3_f32 v164, v164, v167, v170
    v_max3_f32 v173, v173, v176, v179
    v_max3_f32 v244, v164, v173, v244
    v_mfma_f32_32x32x8_bf16 v[164:179], a[92:93], v[148:149], 0
    v_mfma_f32_32x32x16_bf16 v[164:179], a[56:59], v[116:119], v[164:179]
    s_nop 11
    v_max3_f32 v164, v164, v165, v166
    v_max3_f32 v167, v167, v168, v169
    v_max3_f32 v170, v170, v171, v172
    v_max3_f32 v173, v173, v174, v175
    v_max3_f32 v176, v176, v177, v178
    v_max3_f32 v164, v164, v167, v170
    v_max3_f32 v173, v173, v176, v179
    v_max3_f32 v244, v164, v173, v244
    v_mfma_f32_32x32x8_bf16 v[164:179], a[94:95], v[148:149], 0
    v_mfma_f32_32x32x16_bf16 v[164:179], a[60:63], v[116:119], v[164:179]
    s_nop 11
    v_max3_f32 v164, v164, v165, v166
    v_max3_f32 v167, v167, v168, v169
    v_max3_f32 v170, v170, v171, v172
    v_max3_f32 v173, v173, v174, v175
    v_max3_f32 v176, v176, v177, v178
    v_max3_f32 v164, v164, v167, v170
    v_max3_f32 v173, v173, v176, v179
    v_max3_f32 v244, v164, v173, v244
    v_mov_b32 v245, v244
    s_nop 1
    v_permlane32_swap_b32 v244, v245
    v_max_f32 v244, v244, v245
    v_sub_f32 v244, 0, v244
    v_and_b32 v245, s29, v244
    v_sub_f32 v246, v244, v245
    v_and_b32 v247, s29, v246
    v_sub_f32 v248, v246, v247
    v_lshrrev_b32 v245, 16, v245
    v_or_b32 v245, v245, v247
    v_lshrrev_b32 v248, 16, v248
    v_cndmask_b32 v148, v148, v245, s[30:31]
    v_cndmask_b32 v149, v149, v248, s[30:31]
    s_nop 1
    v_mfma_f32_32x32x8_bf16 v[164:179], a[64:65], v[148:149], 0
    v_mfma_f32_32x32x16_bf16 v[164:179], a[0:3], v[116:119], v[164:179]
    s_nop 11
    v_exp_f32 v164, v164
    v_exp_f32 v165, v165
    v_exp_f32 v166, v166
    v_exp_f32 v167, v167
    v_exp_f32 v168, v168
    v_exp_f32 v169, v169
    v_exp_f32 v170, v170
    v_exp_f32 v171, v171
    v_exp_f32 v172, v172
    v_exp_f32 v173, v173
    v_exp_f32 v174, v174
    v_exp_f32 v175, v175
    v_exp_f32 v176, v176
    v_exp_f32 v177, v177
    v_exp_f32 v178, v178
    v_exp_f32 v179, v179
    v_cvt_pk_bf16_f32 v196, v164, v165
    v_cvt_pk_bf16_f32 v197, v166, v167
    v_cvt_pk_bf16_f32 v198, v168, v169
    v_cvt_pk_bf16_f32 v199, v170, v171
    v_cvt_pk_bf16_f32 v200, v172, v173
    v_cvt_pk_bf16_f32 v201, v174, v175
    v_cvt_pk_bf16_f32 v202, v176, v177
    v_cvt_pk_bf16_f32 v203, v178, v179
    v_mfma_f32_32x32x16_bf16 v[212:227], a[96:99], v[196:199], 0
    s_nop 0
    v_mfma_f32_32x32x16_bf16 v[212:227], a[100:103], v[200:203], v[212:227]
    v_mfma_f32_32x32x8_bf16 v[164:179], a[66:67], v[148:149], 0
    v_mfma_f32_32x32x16_bf16 v[164:179], a[4:7], v[116:119], v[164:179]
    s_nop 11
    v_exp_f32 v164, v164
    v_exp_f32 v165, v165
    v_exp_f32 v166, v166
    v_exp_f32 v167, v167
    v_exp_f32 v168, v168
    v_exp_f32 v169, v169
    v_exp_f32 v170, v170
    v_exp_f32 v171, v171
    v_exp_f32 v172, v172
    v_exp_f32 v173, v173
    v_exp_f32 v174, v174
    v_exp_f32 v175, v175
    v_exp_f32 v176, v176
    v_exp_f32 v177, v177
    v_exp_f32 v178, v178
    v_exp_f32 v179, v179
    v_cvt_pk_bf16_f32 v196, v164, v165
    v_cvt_pk_bf16_f32 v197, v166, v167
    v_cvt_pk_bf16_f32 v198, v168, v169
    v_cvt_pk_bf16_f32 v199, v170, v171
    v_cvt_pk_bf16_f32 v200, v172, v173
    v_cvt_pk_bf16_f32 v201, v174, v175
    v_cvt_pk_bf16_f32 v202, v176, v177
    v_cvt_pk_bf16_f32 v203, v178, v179
    v_mfma_f32_32x32x16_bf16 v[212:227], a[104:107], v[196:199], v[212:227]
    s_nop 0
    v_mfma_f32_32x32x16_bf16 v[212:227], a[108:111], v[200:203], v[212:227]
    v_mfma_f32_32x32x8_bf16 v[164:179], a[68:69], v[148:149], 0
    v_mfma_f32_32x32x16_bf16 v[164:179], a[8:11], v[116:119], v[164:179]
    s_nop 11
    v_exp_f32 v164, v164
    v_exp_f32 v165, v165
    v_exp_f32 v166, v166
    v_exp_f32 v167, v167
    v_exp_f32 v168, v168
    v_exp_f32 v169, v169
    v_exp_f32 v170, v170
    v_exp_f32 v171, v171
    v_exp_f32 v172, v172
    v_exp_f32 v173, v173
    v_exp_f32 v174, v174
    v_exp_f32 v175, v175
    v_exp_f32 v176, v176
    v_exp_f32 v177, v177
    v_exp_f32 v178, v178
    v_exp_f32 v179, v179
    v_cvt_pk_bf16_f32 v196, v164, v165
    v_cvt_pk_bf16_f32 v197, v166, v167
    v_cvt_pk_bf16_f32 v198, v168, v169
    v_cvt_pk_bf16_f32 v199, v170, v171
    v_cvt_pk_bf16_f32 v200, v172, v173
    v_cvt_pk_bf16_f32 v201, v174, v175
    v_cvt_pk_bf16_f32 v202, v176, v177
    v_cvt_pk_bf16_f32 v203, v178, v179
    v_mfma_f32_32x32x16_bf16 v[212:227], a[112:115], v[196:199], v[212:227]
    s_nop 0
    v_mfma_f32_32x32x16_bf16 v[212:227], a[116:119], v[200:203], v[212:227]
    v_mfma_f32_32x32x8_bf16 v[164:179], a[70:71], v[148:149], 0
    v_mfma_f32_32x32x16_bf16 v[164:179], a[12:15], v[116:119], v[164:179]
    s_nop 11
    v_exp_f32 v164, v164
    v_exp_f32 v165, v165
    v_exp_f32 v166, v166
    v_exp_f32 v167, v167
    v_exp_f32 v168, v168
    v_exp_f32 v169, v169
    v_exp_f32 v170, v170
    v_exp_f32 v171, v171
    v_exp_f32 v172, v172
    v_exp_f32 v173, v173
    v_exp_f32 v174, v174
    v_exp_f32 v175, v175
    v_exp_f32 v176, v176
    v_exp_f32 v177, v177
    v_exp_f32 v178, v178
    v_exp_f32 v179, v179
    v_cvt_pk_bf16_f32 v196, v164, v165
    v_cvt_pk_bf16_f32 v197, v166, v167
    v_cvt_pk_bf16_f32 v198, v168, v169
    v_cvt_pk_bf16_f32 v199, v170, v171
    v_cvt_pk_bf16_f32 v200, v172, v173
    v_cvt_pk_bf16_f32 v201, v174, v175
    v_cvt_pk_bf16_f32 v202, v176, v177
    v_cvt_pk_bf16_f32 v203, v178, v179
    v_mfma_f32_32x32x16_bf16 v[212:227], a[120:123], v[196:199], v[212:227]
    s_nop 0
    v_mfma_f32_32x32x16_bf16 v[212:227], a[124:127], v[200:203], v[212:227]
    v_mfma_f32_32x32x8_bf16 v[164:179], a[72:73], v[148:149], 0
    v_mfma_f32_32x32x16_bf16 v[164:179], a[16:19], v[116:119], v[164:179]
    s_nop 11
    v_exp_f32 v164, v164
    v_exp_f32 v165, v165
    v_exp_f32 v166, v166
    v_exp_f32 v167, v167
    v_exp_f32 v168, v168
    v_exp_f32 v169, v169
    v_exp_f32 v170, v170
    v_exp_f32 v171, v171
    v_exp_f32 v172, v172
    v_exp_f32 v173, v173
    v_exp_f32 v174, v174
    v_exp_f32 v175, v175
    v_exp_f32 v176, v176
    v_exp_f32 v177, v177
    v_exp_f32 v178, v178
    v_exp_f32 v179, v179
    v_cvt_pk_bf16_f32 v196, v164, v165
    v_cvt_pk_bf16_f32 v197, v166, v167
    v_cvt_pk_bf16_f32 v198, v168, v169
    v_cvt_pk_bf16_f32 v199, v170, v171
    v_cvt_pk_bf16_f32 v200, v172, v173
    v_cvt_pk_bf16_f32 v201, v174, v175
    v_cvt_pk_bf16_f32 v202, v176, v177
    v_cvt_pk_bf16_f32 v203, v178, v179
    v_mfma_f32_32x32x16_bf16 v[212:227], a[128:131], v[196:199], v[212:227]
    s_nop 0
    v_mfma_f32_32x32x16_bf16 v[212:227], a[132:135], v[200:203], v[212:227]
    v_mfma_f32_32x32x8_bf16 v[164:179], a[74:75], v[148:149], 0
    v_mfma_f32_32x32x16_bf16 v[164:179], a[20:23], v[116:119], v[164:179]
    s_nop 11
    v_exp_f32 v164, v164
    v_exp_f32 v165, v165
    v_exp_f32 v166, v166
    v_exp_f32 v167, v167
    v_exp_f32 v168, v168
    v_exp_f32 v169, v169
    v_exp_f32 v170, v170
    v_exp_f32 v171, v171
    v_exp_f32 v172, v172
    v_exp_f32 v173, v173
    v_exp_f32 v174, v174
    v_exp_f32 v175, v175
    v_exp_f32 v176, v176
    v_exp_f32 v177, v177
    v_exp_f32 v178, v178
    v_exp_f32 v179, v179
    v_cvt_pk_bf16_f32 v196, v164, v165
    v_cvt_pk_bf16_f32 v197, v166, v167
    v_cvt_pk_bf16_f32 v198, v168, v169
    v_cvt_pk_bf16_f32 v199, v170, v171
    v_cvt_pk_bf16_f32 v200, v172, v173
    v_cvt_pk_bf16_f32 v201, v174, v175
    v_cvt_pk_bf16_f32 v202, v176, v177
    v_cvt_pk_bf16_f32 v203, v178, v179
    v_mfma_f32_32x32x16_bf16 v[212:227], a[136:139], v[196:199], v[212:227]
    s_nop 0
    v_mfma_f32_32x32x16_bf16 v[212:227], a[140:143], v[200:203], v[212:227]
    v_mfma_f32_32x32x8_bf16 v[164:179], a[76:77], v[148:149], 0
    v_mfma_f32_32x32x16_bf16 v[164:179], a[24:27], v[116:119], v[164:179]
    s_nop 11
    v_exp_f32 v164, v164
    v_exp_f32 v165, v165
    v_exp_f32 v166, v166
    v_exp_f32 v167, v167
    v_exp_f32 v168, v168
    v_exp_f32 v169, v169
    v_exp_f32 v170, v170
    v_exp_f32 v171, v171
    v_exp_f32 v172, v172
    v_exp_f32 v173, v173
    v_exp_f32 v174, v174
    v_exp_f32 v175, v175
    v_exp_f32 v176, v176
    v_exp_f32 v177, v177
    v_exp_f32 v178, v178
    v_exp_f32 v179, v179
    v_cvt_pk_bf16_f32 v196, v164, v165
    v_cvt_pk_bf16_f32 v197, v166, v167
    v_cvt_pk_bf16_f32 v198, v168, v169
    v_cvt_pk_bf16_f32 v199, v170, v171
    v_cvt_pk_bf16_f32 v200, v172, v173
    v_cvt_pk_bf16_f32 v201, v174, v175
    v_cvt_pk_bf16_f32 v202, v176, v177
    v_cvt_pk_bf16_f32 v203, v178, v179
    v_mfma_f32_32x32x16_bf16 v[212:227], a[144:147], v[196:199], v[212:227]
    s_nop 0
    v_mfma_f32_32x32x16_bf16 v[212:227], a[148:151], v[200:203], v[212:227]
    v_mfma_f32_32x32x8_bf16 v[164:179], a[78:79], v[148:149], 0
    v_mfma_f32_32x32x16_bf16 v[164:179], a[28:31], v[116:119], v[164:179]
    s_nop 11
    v_exp_f32 v164, v164
    v_exp_f32 v165, v165
    v_exp_f32 v166, v166
    v_exp_f32 v167, v167
    v_exp_f32 v168, v168
    v_exp_f32 v169, v169
    v_exp_f32 v170, v170
    v_exp_f32 v171, v171
    v_exp_f32 v172, v172
    v_exp_f32 v173, v173
    v_exp_f32 v174, v174
    v_exp_f32 v175, v175
    v_exp_f32 v176, v176
    v_exp_f32 v177, v177
    v_exp_f32 v178, v178
    v_exp_f32 v179, v179
    v_cvt_pk_bf16_f32 v196, v164, v165
    v_cvt_pk_bf16_f32 v197, v166, v167
    v_cvt_pk_bf16_f32 v198, v168, v169
    v_cvt_pk_bf16_f32 v199, v170, v171
    v_cvt_pk_bf16_f32 v200, v172, v173
    v_cvt_pk_bf16_f32 v201, v174, v175
    v_cvt_pk_bf16_f32 v202, v176, v177
    v_cvt_pk_bf16_f32 v203, v178, v179
    v_mfma_f32_32x32x16_bf16 v[212:227], a[152:155], v[196:199], v[212:227]
    s_nop 0
    v_mfma_f32_32x32x16_bf16 v[212:227], a[156:159], v[200:203], v[212:227]
    v_mfma_f32_32x32x8_bf16 v[164:179], a[80:81], v[148:149], 0
    v_mfma_f32_32x32x16_bf16 v[164:179], a[32:35], v[116:119], v[164:179]
    s_nop 11
    v_exp_f32 v164, v164
    v_exp_f32 v165, v165
    v_exp_f32 v166, v166
    v_exp_f32 v167, v167
    v_exp_f32 v168, v168
    v_exp_f32 v169, v169
    v_exp_f32 v170, v170
    v_exp_f32 v171, v171
    v_exp_f32 v172, v172
    v_exp_f32 v173, v173
    v_exp_f32 v174, v174
    v_exp_f32 v175, v175
    v_exp_f32 v176, v176
    v_exp_f32 v177, v177
    v_exp_f32 v178, v178
    v_exp_f32 v179, v179
    v_cvt_pk_bf16_f32 v196, v164, v165
    v_cvt_pk_bf16_f32 v197, v166, v167
    v_cvt_pk_bf16_f32 v198, v168, v169
    v_cvt_pk_bf16_f32 v199, v170, v171
    v_cvt_pk_bf16_f32 v200, v172, v173
    v_cvt_pk_bf16_f32 v201, v174, v175
    v_cvt_pk_bf16_f32 v202, v176, v177
    v_cvt_pk_bf16_f32 v203, v178, v179
    v_mfma_f32_32x32x16_bf16 v[212:227], a[160:163], v[196:199], v[212:227]
    s_nop 0
    v_mfma_f32_32x32x16_bf16 v[212:227], a[164:167], v[200:203], v[212:227]
    v_mfma_f32_32x32x8_bf16 v[164:179], a[82:83], v[148:149], 0
    v_mfma_f32_32x32x16_bf16 v[164:179], a[36:39], v[116:119], v[164:179]
    s_nop 11
    v_exp_f32 v164, v164
    v_exp_f32 v165, v165
    v_exp_f32 v166, v166
    v_exp_f32 v167, v167
    v_exp_f32 v168, v168
    v_exp_f32 v169, v169
    v_exp_f32 v170, v170
    v_exp_f32 v171, v171
    v_exp_f32 v172, v172
    v_exp_f32 v173, v173
    v_exp_f32 v174, v174
    v_exp_f32 v175, v175
    v_exp_f32 v176, v176
    v_exp_f32 v177, v177
    v_exp_f32 v178, v178
    v_exp_f32 v179, v179
    v_cvt_pk_bf16_f32 v196, v164, v165
    v_cvt_pk_bf16_f32 v197, v166, v167
    v_cvt_pk_bf16_f32 v198, v168, v169
    v_cvt_pk_bf16_f32 v199, v170, v171
    v_cvt_pk_bf16_f32 v200, v172, v173
    v_cvt_pk_bf16_f32 v201, v174, v175
    v_cvt_pk_bf16_f32 v202, v176, v177
    v_cvt_pk_bf16_f32 v203, v178, v179
    v_mfma_f32_32x32x16_bf16 v[212:227], a[168:171], v[196:199], v[212:227]
    s_nop 0
    v_mfma_f32_32x32x16_bf16 v[212:227], a[172:175], v[200:203], v[212:227]
    v_mfma_f32_32x32x8_bf16 v[164:179], a[84:85], v[148:149], 0
    v_mfma_f32_32x32x16_bf16 v[164:179], a[40:43], v[116:119], v[164:179]
    s_nop 11
    v_exp_f32 v164, v164
    v_exp_f32 v165, v165
    v_exp_f32 v166, v166
    v_exp_f32 v167, v167
    v_exp_f32 v168, v168
    v_exp_f32 v169, v169
    v_exp_f32 v170, v170
    v_exp_f32 v171, v171
    v_exp_f32 v172, v172
    v_exp_f32 v173, v173
    v_exp_f32 v174, v174
    v_exp_f32 v175, v175
    v_exp_f32 v176, v176
    v_exp_f32 v177, v177
    v_exp_f32 v178, v178
    v_exp_f32 v179, v179
    v_cvt_pk_bf16_f32 v196, v164, v165
    v_cvt_pk_bf16_f32 v197, v166, v167
    v_cvt_pk_bf16_f32 v198, v168, v169
    v_cvt_pk_bf16_f32 v199, v170, v171
    v_cvt_pk_bf16_f32 v200, v172, v173
    v_cvt_pk_bf16_f32 v201, v174, v175
    v_cvt_pk_bf16_f32 v202, v176, v177
    v_cvt_pk_bf16_f32 v203, v178, v179
    v_mfma_f32_32x32x16_bf16 v[212:227], a[176:179], v[196:199], v[212:227]
    s_nop 0
    v_mfma_f32_32x32x16_bf16 v[212:227], a[180:183], v[200:203], v[212:227]
    v_mfma_f32_32x32x8_bf16 v[164:179], a[86:87], v[148:149], 0
    v_mfma_f32_32x32x16_bf16 v[164:179], a[44:47], v[116:119], v[164:179]
    s_nop 11
    v_exp_f32 v164, v164
    v_exp_f32 v165, v165
    v_exp_f32 v166, v166
    v_exp_f32 v167, v167
    v_exp_f32 v168, v168
    v_exp_f32 v169, v169
    v_exp_f32 v170, v170
    v_exp_f32 v171, v171
    v_exp_f32 v172, v172
    v_exp_f32 v173, v173
    v_exp_f32 v174, v174
    v_exp_f32 v175, v175
    v_exp_f32 v176, v176
    v_exp_f32 v177, v177
    v_exp_f32 v178, v178
    v_exp_f32 v179, v179
    v_cvt_pk_bf16_f32 v196, v164, v165
    v_cvt_pk_bf16_f32 v197, v166, v167
    v_cvt_pk_bf16_f32 v198, v168, v169
    v_cvt_pk_bf16_f32 v199, v170, v171
    v_cvt_pk_bf16_f32 v200, v172, v173
    v_cvt_pk_bf16_f32 v201, v174, v175
    v_cvt_pk_bf16_f32 v202, v176, v177
    v_cvt_pk_bf16_f32 v203, v178, v179
    v_mfma_f32_32x32x16_bf16 v[212:227], a[184:187], v[196:199], v[212:227]
    s_nop 0
    v_mfma_f32_32x32x16_bf16 v[212:227], a[188:191], v[200:203], v[212:227]
    v_mfma_f32_32x32x8_bf16 v[164:179], a[88:89], v[148:149], 0
    v_mfma_f32_32x32x16_bf16 v[164:179], a[48:51], v[116:119], v[164:179]
    s_nop 11
    v_exp_f32 v164, v164
    v_exp_f32 v165, v165
    v_exp_f32 v166, v166
    v_exp_f32 v167, v167
    v_exp_f32 v168, v168
    v_exp_f32 v169, v169
    v_exp_f32 v170, v170
    v_exp_f32 v171, v171
    v_exp_f32 v172, v172
    v_exp_f32 v173, v173
    v_exp_f32 v174, v174
    v_exp_f32 v175, v175
    v_exp_f32 v176, v176
    v_exp_f32 v177, v177
    v_exp_f32 v178, v178
    v_exp_f32 v179, v179
    v_cvt_pk_bf16_f32 v196, v164, v165
    v_cvt_pk_bf16_f32 v197, v166, v167
    v_cvt_pk_bf16_f32 v198, v168, v169
    v_cvt_pk_bf16_f32 v199, v170, v171
    v_cvt_pk_bf16_f32 v200, v172, v173
    v_cvt_pk_bf16_f32 v201, v174, v175
    v_cvt_pk_bf16_f32 v202, v176, v177
    v_cvt_pk_bf16_f32 v203, v178, v179
    v_mfma_f32_32x32x16_bf16 v[212:227], a[192:195], v[196:199], v[212:227]
    s_nop 0
    v_mfma_f32_32x32x16_bf16 v[212:227], a[196:199], v[200:203], v[212:227]
    v_mfma_f32_32x32x8_bf16 v[164:179], a[90:91], v[148:149], 0
    v_mfma_f32_32x32x16_bf16 v[164:179], a[52:55], v[116:119], v[164:179]
    s_nop 11
    v_exp_f32 v164, v164
    v_exp_f32 v165, v165
    v_exp_f32 v166, v166
    v_exp_f32 v167, v167
    v_exp_f32 v168, v168
    v_exp_f32 v169, v169
    v_exp_f32 v170, v170
    v_exp_f32 v171, v171
    v_exp_f32 v172, v172
    v_exp_f32 v173, v173
    v_exp_f32 v174, v174
    v_exp_f32 v175, v175
    v_exp_f32 v176, v176
    v_exp_f32 v177, v177
    v_exp_f32 v178, v178
    v_exp_f32 v179, v179
    v_cvt_pk_bf16_f32 v196, v164, v165
    v_cvt_pk_bf16_f32 v197, v166, v167
    v_cvt_pk_bf16_f32 v198, v168, v169
    v_cvt_pk_bf16_f32 v199, v170, v171
    v_cvt_pk_bf16_f32 v200, v172, v173
    v_cvt_pk_bf16_f32 v201, v174, v175
    v_cvt_pk_bf16_f32 v202, v176, v177
    v_cvt_pk_bf16_f32 v203, v178, v179
    v_mfma_f32_32x32x16_bf16 v[212:227], a[200:203], v[196:199], v[212:227]
    s_nop 0
    v_mfma_f32_32x32x16_bf16 v[212:227], a[204:207], v[200:203], v[212:227]
    v_mfma_f32_32x32x8_bf16 v[164:179], a[92:93], v[148:149], 0
    v_mfma_f32_32x32x16_bf16 v[164:179], a[56:59], v[116:119], v[164:179]
    s_nop 11
    v_exp_f32 v164, v164
    v_exp_f32 v165, v165
    v_exp_f32 v166, v166
    v_exp_f32 v167, v167
    v_exp_f32 v168, v168
    v_exp_f32 v169, v169
    v_exp_f32 v170, v170
    v_exp_f32 v171, v171
    v_exp_f32 v172, v172
    v_exp_f32 v173, v173
    v_exp_f32 v174, v174
    v_exp_f32 v175, v175
    v_exp_f32 v176, v176
    v_exp_f32 v177, v177
    v_exp_f32 v178, v178
    v_exp_f32 v179, v179
    v_cvt_pk_bf16_f32 v196, v164, v165
    v_cvt_pk_bf16_f32 v197, v166, v167
    v_cvt_pk_bf16_f32 v198, v168, v169
    v_cvt_pk_bf16_f32 v199, v170, v171
    v_cvt_pk_bf16_f32 v200, v172, v173
    v_cvt_pk_bf16_f32 v201, v174, v175
    v_cvt_pk_bf16_f32 v202, v176, v177
    v_cvt_pk_bf16_f32 v203, v178, v179
    v_mfma_f32_32x32x16_bf16 v[212:227], a[208:211], v[196:199], v[212:227]
    s_nop 0
    v_mfma_f32_32x32x16_bf16 v[212:227], a[212:215], v[200:203], v[212:227]
    v_mfma_f32_32x32x8_bf16 v[164:179], a[94:95], v[148:149], 0
    v_mfma_f32_32x32x16_bf16 v[164:179], a[60:63], v[116:119], v[164:179]
    s_nop 11
    v_exp_f32 v164, v164
    v_exp_f32 v165, v165
    v_exp_f32 v166, v166
    v_exp_f32 v167, v167
    v_exp_f32 v168, v168
    v_exp_f32 v169, v169
    v_exp_f32 v170, v170
    v_exp_f32 v171, v171
    v_exp_f32 v172, v172
    v_exp_f32 v173, v173
    v_exp_f32 v174, v174
    v_exp_f32 v175, v175
    v_exp_f32 v176, v176
    v_exp_f32 v177, v177
    v_exp_f32 v178, v178
    v_exp_f32 v179, v179
    v_cvt_pk_bf16_f32 v196, v164, v165
    v_cvt_pk_bf16_f32 v197, v166, v167
    v_cvt_pk_bf16_f32 v198, v168, v169
    v_cvt_pk_bf16_f32 v199, v170, v171
    v_cvt_pk_bf16_f32 v200, v172, v173
    v_cvt_pk_bf16_f32 v201, v174, v175
    v_cvt_pk_bf16_f32 v202, v176, v177
    v_cvt_pk_bf16_f32 v203, v178, v179
    v_mfma_f32_32x32x16_bf16 v[212:227], a[216:219], v[196:199], v[212:227]
    s_nop 0
    v_mfma_f32_32x32x16_bf16 v[212:227], a[220:223], v[200:203], v[212:227]
    s_nop 11
    v_mov_b32 v223, v244
    ds_write_b128 v16, v[212:215] offset:0
    ds_write_b128 v16, v[216:219] offset:1024
    ds_write_b128 v16, v[220:223] offset:2048
    s_waitcnt lgkmcnt(0)
    v_add_u32 v16, 12288, v16
    s_add_u32 s55, s55, 512
    s_add_u32 s59, s59, 512
    s_add_u32 s58, s58, 1
    s_cmp_lt_u32 s58, 8
    s_cbranch_scc1 L_fb_loop
    s_add_u32 s49, s51, 0
    buffer_load_dwordx4 a[0:3], v22, s[12:15], s49 offen offset:0 sc1
    buffer_load_dwordx4 a[96:99], v22, s[12:15], s49 offen offset:1024 sc1
    buffer_load_dwordx4 a[100:103], v22, s[12:15], s49 offen offset:2048 sc1
    buffer_load_dwordx4 a[4:7], v22, s[12:15], s49 offen offset:3072 sc1
    s_add_u32 s49, s51, 4096
    buffer_load_dwordx4 a[104:107], v22, s[12:15], s49 offen offset:0 sc1
    buffer_load_dwordx4 a[108:111], v22, s[12:15], s49 offen offset:1024 sc1
    buffer_load_dwordx4 a[8:11], v22, s[12:15], s49 offen offset:2048 sc1
    buffer_load_dwordx4 a[112:115], v22, s[12:15], s49 offen offset:3072 sc1
    s_add_u32 s49, s51, 8192
    buffer_load_dwordx4 a[116:119], v22, s[12:15], s49 offen offset:0 sc1
    buffer_load_dwordx4 a[12:15], v22, s[12:15], s49 offen offset:1024 sc1
    buffer_load_dwordx4 a[120:123], v22, s[12:15], s49 offen offset:2048 sc1
    buffer_load_dwordx4 a[124:127], v22, s[12:15], s49 offen offset:3072 sc1
    s_add_u32 s49, s51, 12288
    buffer_load_dwordx4 a[16:19], v22, s[12:15], s49 offen offset:0 sc1
    buffer_load_dwordx4 a[128:131], v22, s[12:15], s49 offen offset:1024 sc1
    buffer_load_dwordx4 a[132:135], v22, s[12:15], s49 offen offset:2048 sc1
    buffer_load_dwordx4 a[20:23], v22, s[12:15], s49 offen offset:3072 sc1
    s_add_u32 s49, s51, 16384
    buffer_load_dwordx4 a[136:139], v22, s[12:15], s49 offen offset:0 sc1
    buffer_load_dwordx4 a[140:143], v22, s[12:15], s49 offen offset:1024 sc1
    buffer_load_dwordx4 a[24:27], v22, s[12:15], s49 offen offset:2048 sc1
    buffer_load_dwordx4 a[144:147], v22, s[12:15], s49 offen offset:3072 sc1
    s_add_u32 s49, s51, 20480
    buffer_load_dwordx4 a[148:151], v22, s[12:15], s49 offen offset:0 sc1
    buffer_load_dwordx4 a[28:31], v22, s[12:15], s49 offen offset:1024 sc1
    buffer_load_dwordx4 a[152:155], v22, s[12:15], s49 offen offset:2048 sc1
    buffer_load_dwordx4 a[156:159], v22, s[12:15], s49 offen offset:3072 sc1
    s_add_u32 s49, s51, 24576
    buffer_load_dwordx4 a[32:35], v22, s[12:15], s49 offen offset:0 sc1
    s_waitcnt vmcnt(0)
    s_branch L_fb_ret
L_k3r_16:
    s_nop 7
    buffer_load_dwordx4 v[176:179], v22, s[12:15], s36 offen offset:0 sc1
    buffer_load_dwordx4 v[180:183], v22, s[12:15], s36 offen offset:1024 sc1
    buffer_load_dwordx4 v[184:187], v22, s[12:15], s36 offen offset:2048 sc1
    buffer_load_dwordx4 v[188:191], v22, s[12:15], s36 offen offset:3072 sc1
    buffer_load_dwordx2 v[192:193], v16, s[12:15], s36 offen offset:0 sc1
    buffer_load_dwordx2 v[194:195], v16, s[12:15], s36 offen offset:128 sc1
    buffer_load_dwordx4 v[196:199], v22, s[12:15], s37 offen offset:0 sc1
    buffer_load_dwordx4 v[200:203], v22, s[12:15], s37 offen offset:1024 sc1
    buffer_load_dwordx4 v[204:207], v22, s[12:15], s37 offen offset:2048 sc1
    buffer_load_dwordx4 v[208:211], v22, s[12:15], s37 offen offset:3072 sc1
    buffer_load_dwordx2 v[212:213], v16, s[12:15], s37 offen offset:0 sc1
    buffer_load_dwordx2 v[214:215], v16, s[12:15], s37 offen offset:128 sc1
    buffer_load_dwordx4 v[216:219], v22, s[12:15], s38 offen offset:0 sc1
    buffer_load_dwordx4 v[220:223], v22, s[12:15], s38 offen offset:1024 sc1
    s_waitcnt vmcnt(0)
    v_max_i32 v8, v176, v178
    v_max3_i32 v8, v8, v180, v182
    v_max3_i32 v8, v8, v184, v186
    v_max3_i32 v8, v8, v188, v190
    v_max3_i32 v8, v8, v192, v194
    v_cmp_eq_u32 vcc, s21, v8
    s_nop 4
    s_cbranch_vccz L_k3t_15
    s_sub_u32 s67, s67, 1
    s_cselect_b32 s21, 0x80000000, s21
    s_sleep 2
    s_branch L_k3r_16
L_k3r_18:
    s_nop 7
    buffer_load_dwordx4 v[196:199], v22, s[12:15], s37 offen offset:0 sc1
    buffer_load_dwordx4 v[200:203], v22, s[12:15], s37 offen offset:1024 sc1
    buffer_load_dwordx4 v[204:207], v22, s[12:15], s37 offen offset:2048 sc1
    buffer_load_dwordx4 v[208:211], v22, s[12:15], s37 offen offset:3072 sc1
    buffer_load_dwordx2 v[212:213], v16, s[12:15], s37 offen offset:0 sc1
    buffer_load_dwordx2 v[214:215], v16, s[12:15], s37 offen offset:128 sc1
    buffer_load_dwordx4 v[216:219], v22, s[12:15], s38 offen offset:0 sc1
    buffer_load_dwordx4 v[220:223], v22, s[12:15], s38 offen offset:1024 sc1
    buffer_load_dwordx4 v[224:227], v22, s[12:15], s38 offen offset:2048 sc1
    buffer_load_dwordx4 v[228:231], v22, s[12:15], s38 offen offset:3072 sc1
    buffer_load_dwordx2 v[232:233], v16, s[12:15], s38 offen offset:0 sc1
    buffer_load_dwordx2 v[234:235], v16, s[12:15], s38 offen offset:128 sc1
    buffer_load_dwordx4 v[236:239], v22, s[12:15], s39 offen offset:0 sc1
    buffer_load_dwordx4 v[240:243], v22, s[12:15], s39 offen offset:1024 sc1
    s_waitcnt vmcnt(0)
    v_max_i32 v8, v196, v198
    v_max3_i32 v8, v8, v200, v202
    v_max3_i32 v8, v8, v204, v206
    v_max3_i32 v8, v8, v208, v210
    v_max3_i32 v8, v8, v212, v214
    v_cmp_eq_u32 vcc, s21, v8
    s_nop 4
    s_cbranch_vccz L_k3t_17
    s_sub_u32 s67, s67, 1
    s_cselect_b32 s21, 0x80000000, s21
    s_sleep 2
    s_branch L_k3r_18
L_k3r_20:
    s_nop 7
    buffer_load_dwordx4 v[216:219], v22, s[12:15], s38 offen offset:0 sc1
    buffer_load_dwordx4 v[220:223], v22, s[12:15], s38 offen offset:1024 sc1
    buffer_load_dwordx4 v[224:227], v22, s[12:15], s38 offen offset:2048 sc1
    buffer_load_dwordx4 v[228:231], v22, s[12:15], s38 offen offset:3072 sc1
    buffer_load_dwordx2 v[232:233], v16, s[12:15], s38 offen offset:0 sc1
    buffer_load_dwordx2 v[234:235], v16, s[12:15], s38 offen offset:128 sc1
    buffer_load_dwordx4 v[236:239], v22, s[12:15], s39 offen offset:0 sc1
    buffer_load_dwordx4 v[240:243], v22, s[12:15], s39 offen offset:1024 sc1
    buffer_load_dwordx4 v[244:247], v22, s[12:15], s39 offen offset:2048 sc1
    buffer_load_dwordx4 v[248:251], v22, s[12:15], s39 offen offset:3072 sc1
    buffer_load_dwordx2 v[252:253], v16, s[12:15], s39 offen offset:0 sc1
    buffer_load_dwordx2 v[254:255], v16, s[12:15], s39 offen offset:128 sc1
    s_waitcnt vmcnt(0)
    v_max_i32 v8, v216, v218
    v_max3_i32 v8, v8, v220, v222
    v_max3_i32 v8, v8, v224, v226
    v_max3_i32 v8, v8, v228, v230
    v_max3_i32 v8, v8, v232, v234
    v_cmp_eq_u32 vcc, s21, v8
    s_nop 4
    s_cbranch_vccz L_k3t_19
    s_sub_u32 s67, s67, 1
    s_cselect_b32 s21, 0x80000000, s21
    s_sleep 2
    s_branch L_k3r_20
L_k3r_22:
    s_nop 7
    buffer_load_dwordx4 v[236:239], v22, s[12:15], s39 offen offset:0 sc1
    buffer_load_dwordx4 v[240:243], v22, s[12:15], s39 offen offset:1024 sc1
    buffer_load_dwordx4 v[244:247], v22, s[12:15], s39 offen offset:2048 sc1
    buffer_load_dwordx4 v[248:251], v22, s[12:15], s39 offen offset:3072 sc1
    buffer_load_dwordx2 v[252:253], v16, s[12:15], s39 offen offset:0 sc1
    buffer_load_dwordx2 v[254:255], v16, s[12:15], s39 offen offset:128 sc1
    s_waitcnt vmcnt(0)
    v_max_i32 v8, v236, v238
    v_max3_i32 v8, v8, v240, v242
    v_max3_i32 v8, v8, v244, v246
    v_max3_i32 v8, v8, v248, v250
    v_max3_i32 v8, v8, v252, v254
    v_cmp_eq_u32 vcc, s21, v8
    s_nop 4
    s_cbranch_vccz L_k3t_21
    s_sub_u32 s67, s67, 1
    s_cselect_b32 s21, 0x80000000, s21
    s_sleep 2
    s_branch L_k3r_22
L_ssr_24:
    buffer_load_dword v10, v14, s[12:15], s40 offen offset:0 sc1
    buffer_load_dword v11, v14, s[12:15], s40 offen offset:64 sc1
    buffer_load_dword v12, v14, s[12:15], s40 offen offset:128 sc1
    buffer_load_dword v13, v14, s[12:15], s40 offen offset:192 sc1
    s_waitcnt vmcnt(0)
    s_sub_u32 s67, s67, 1
    s_cselect_b32 s21, 0x80000000, s21
    s_sleep 2
    s_branch L_ss_23
L_k4r_26:
    s_nop 7
    buffer_load_dwordx4 v[176:179], v22, s[12:15], s36 offen offset:0 sc1
    buffer_load_dwordx4 v[180:183], v22, s[12:15], s36 offen offset:1024 sc1
    buffer_load_dwordx4 v[184:187], v22, s[12:15], s36 offen offset:2048 sc1
    buffer_load_dwordx4 v[188:191], v22, s[12:15], s36 offen offset:3072 sc1
    s_add_u32 s35, s36, 4096
    buffer_load_dwordx4 v[192:195], v22, s[12:15], s35 offen offset:0 sc1
    buffer_load_dwordx4 v[196:199], v22, s[12:15], s37 offen offset:0 sc1
    buffer_load_dwordx4 v[200:203], v22, s[12:15], s37 offen offset:1024 sc1
    buffer_load_dwordx4 v[204:207], v22, s[12:15], s37 offen offset:2048 sc1
    buffer_load_dwordx4 v[208:211], v22, s[12:15], s37 offen offset:3072 sc1
    s_add_u32 s35, s37, 4096
    buffer_load_dwordx4 v[212:215], v22, s[12:15], s35 offen offset:0 sc1
    s_waitcnt vmcnt(0)
    v_max_i32 v8, v176, v178
    v_max3_i32 v8, v8, v180, v182
    v_max3_i32 v8, v8, v184, v186
    v_max3_i32 v8, v8, v188, v190
    v_max3_i32 v8, v8, v192, v194
    v_cmp_eq_u32 vcc, s21, v8
    s_nop 4
    s_cbranch_vccz L_k4t_25
    s_sub_u32 s67, s67, 1
    s_cselect_b32 s21, 0x80000000, s21
    s_sleep 2
    s_branch L_k4r_26
L_k4r_28:
    s_nop 7
    buffer_load_dwordx4 v[196:199], v22, s[12:15], s37 offen offset:0 sc1
    buffer_load_dwordx4 v[200:203], v22, s[12:15], s37 offen offset:1024 sc1
    buffer_load_dwordx4 v[204:207], v22, s[12:15], s37 offen offset:2048 sc1
    buffer_load_dwordx4 v[208:211], v22, s[12:15], s37 offen offset:3072 sc1
    s_add_u32 s35, s37, 4096
    buffer_load_dwordx4 v[212:215], v22, s[12:15], s35 offen offset:0 sc1
    buffer_load_dwordx4 v[216:219], v22, s[12:15], s38 offen offset:0 sc1
    buffer_load_dwordx4 v[220:223], v22, s[12:15], s38 offen offset:1024 sc1
    buffer_load_dwordx4 v[224:227], v22, s[12:15], s38 offen offset:2048 sc1
    buffer_load_dwordx4 v[228:231], v22, s[12:15], s38 offen offset:3072 sc1
    s_add_u32 s35, s38, 4096
    buffer_load_dwordx4 v[232:235], v22, s[12:15], s35 offen offset:0 sc1
    s_waitcnt vmcnt(0)
    v_max_i32 v8, v196, v198
    v_max3_i32 v8, v8, v200, v202
    v_max3_i32 v8, v8, v204, v206
    v_max3_i32 v8, v8, v208, v210
    v_max3_i32 v8, v8, v212, v214
    v_cmp_eq_u32 vcc, s21, v8
    s_nop 4
    s_cbranch_vccz L_k4t_27
    s_sub_u32 s67, s67, 1
    s_cselect_b32 s21, 0x80000000, s21
    s_sleep 2
    s_branch L_k4r_28
L_k4r_30:
    s_nop 7
    buffer_load_dwordx4 v[216:219], v22, s[12:15], s38 offen offset:0 sc1
    buffer_load_dwordx4 v[220:223], v22, s[12:15], s38 offen offset:1024 sc1
    buffer_load_dwordx4 v[224:227], v22, s[12:15], s38 offen offset:2048 sc1
    buffer_load_dwordx4 v[228:231], v22, s[12:15], s38 offen offset:3072 sc1
    s_add_u32 s35, s38, 4096
    buffer_load_dwordx4 v[232:235], v22, s[12:15], s35 offen offset:0 sc1
    buffer_load_dwordx4 v[236:239], v22, s[12:15], s39 offen offset:0 sc1
    buffer_load_dwordx4 v[240:243], v22, s[12:15], s39 offen offset:1024 sc1
    buffer_load_dwordx4 v[244:247], v22, s[12:15], s39 offen offset:2048 sc1
    buffer_load_dwordx4 v[248:251], v22, s[12:15], s39 offen offset:3072 sc1
    s_add_u32 s35, s39, 4096
    buffer_load_dwordx4 v[252:255], v22, s[12:15], s35 offen offset:0 sc1
    s_waitcnt vmcnt(0)
    v_max_i32 v8, v216, v218
    v_max3_i32 v8, v8, v220, v222
    v_max3_i32 v8, v8, v224, v226
    v_max3_i32 v8, v8, v228, v230
    v_max3_i32 v8, v8, v232, v234
    v_cmp_eq_u32 vcc, s21, v8
    s_nop 4
    s_cbranch_vccz L_k4t_29
    s_sub_u32 s67, s67, 1
    s_cselect_b32 s21, 0x80000000, s21
    s_sleep 2
    s_branch L_k4r_30
L_k4r_32:
    s_nop 7
    buffer_load_dwordx4 v[236:239], v22, s[12:15], s39 offen offset:0 sc1
    buffer_load_dwordx4 v[240:243], v22, s[12:15], s39 offen offset:1024 sc1
    buffer_load_dwordx4 v[244:247], v22, s[12:15], s39 offen offset:2048 sc1
    buffer_load_dwordx4 v[248:251], v22, s[12:15], s39 offen offset:3072 sc1
    s_add_u32 s35, s39, 4096
    buffer_load_dwordx4 v[252:255], v22, s[12:15], s35 offen offset:0 sc1
    s_waitcnt vmcnt(0)
    v_max_i32 v8, v236, v238
    v_max3_i32 v8, v8, v240, v242
    v_max3_i32 v8, v8, v244, v246
    v_max3_i32 v8, v8, v248, v250
    v_max3_i32 v8, v8, v252, v254
    v_cmp_eq_u32 vcc, s21, v8
    s_nop 4
    s_cbranch_vccz L_k4t_31
    s_sub_u32 s67, s67, 1
    s_cselect_b32 s21, 0x80000000, s21
    s_sleep 2
    s_branch L_k4r_32
L_k5r_34:
    s_nop 7
    buffer_load_dwordx4 v[176:179], v12, s[12:15], s36 offen offset:0 sc1
    buffer_load_dwordx4 v[180:183], v12, s[12:15], s36 offen offset:1024 sc1
    buffer_load_dwordx4 v[184:187], v12, s[12:15], s36 offen offset:2048 sc1
    buffer_load_dwordx4 v[188:191], v12, s[12:15], s36 offen offset:3072 sc1
    s_add_u32 s35, s36, 4096
    buffer_load_dwordx4 v[192:195], v12, s[12:15], s35 offen offset:0 sc1
    buffer_load_dwordx4 v[196:199], v13, s[12:15], s37 offen offset:0 sc1
    buffer_load_dwordx4 v[200:203], v13, s[12:15], s37 offen offset:1024 sc1
    buffer_load_dwordx4 v[204:207], v13, s[12:15], s37 offen offset:2048 sc1
    buffer_load_dwordx4 v[208:211], v13, s[12:15], s37 offen offset:3072 sc1
    s_add_u32 s35, s37, 4096
    buffer_load_dwordx4 v[212:215], v13, s[12:15], s35 offen offset:0 sc1
    buffer_load_dwordx4 v[216:219], v14, s[12:15], s38 offen offset:0 sc1
    buffer_load_dwordx4 v[220:223], v14, s[12:15], s38 offen offset:1024 sc1
    s_waitcnt vmcnt(0)
    v_max_i32 v8, v176, v178
    v_max3_i32 v8, v8, v180, v182
    v_max3_i32 v8, v8, v184, v186
    v_max3_i32 v8, v8, v188, v190
    v_max3_i32 v8, v8, v192, v194
    v_cmp_eq_u32 vcc, s21, v8
    s_nop 4
    s_cbranch_vccz L_k5t_33
    s_sub_u32 s67, s67, 1
    s_cselect_b32 s21, 0x80000000, s21
    s_sleep 2
    s_branch L_k5r_34
L_k5r_36:
    s_nop 7
    buffer_load_dwordx4 v[196:199], v13, s[12:15], s37 offen offset:0 sc1
    buffer_load_dwordx4 v[200:203], v13, s[12:15], s37 offen offset:1024 sc1
    buffer_load_dwordx4 v[204:207], v13, s[12:15], s37 offen offset:2048 sc1
    buffer_load_dwordx4 v[208:211], v13, s[12:15], s37 offen offset:3072 sc1
    s_add_u32 s35, s37, 4096
    buffer_load_dwordx4 v[212:215], v13, s[12:15], s35 offen offset:0 sc1
    buffer_load_dwordx4 v[216:219], v14, s[12:15], s38 offen offset:0 sc1
    buffer_load_dwordx4 v[220:223], v14, s[12:15], s38 offen offset:1024 sc1
    buffer_load_dwordx4 v[224:227], v14, s[12:15], s38 offen offset:2048 sc1
    buffer_load_dwordx4 v[228:231], v14, s[12:15], s38 offen offset:3072 sc1
    s_add_u32 s35, s38, 4096
    buffer_load_dwordx4 v[232:235], v14, s[12:15], s35 offen offset:0 sc1
    buffer_load_dwordx4 v[236:239], v15, s[12:15], s39 offen offset:0 sc1
    buffer_load_dwordx4 v[240:243], v15, s[12:15], s39 offen offset:1024 sc1
    s_waitcnt vmcnt(0)
    v_max_i32 v8, v196, v198
    v_max3_i32 v8, v8, v200, v202
    v_max3_i32 v8, v8, v204, v206
    v_max3_i32 v8, v8, v208, v210
    v_max3_i32 v8, v8, v212, v214
    v_cmp_eq_u32 vcc, s21, v8
    s_nop 4
    s_cbranch_vccz L_k5t_35
    s_sub_u32 s67, s67, 1
    s_cselect_b32 s21, 0x80000000, s21
    s_sleep 2
    s_branch L_k5r_36
L_k5r_38:
    s_nop 7
    buffer_load_dwordx4 v[216:219], v14, s[12:15], s38 offen offset:0 sc1
    buffer_load_dwordx4 v[220:223], v14, s[12:15], s38 offen offset:1024 sc1
    buffer_load_dwordx4 v[224:227], v14, s[12:15], s38 offen offset:2048 sc1
    buffer_load_dwordx4 v[228:231], v14, s[12:15], s38 offen offset:3072 sc1
    s_add_u32 s35, s38, 4096
    buffer_load_dwordx4 v[232:235], v14, s[12:15], s35 offen offset:0 sc1
    buffer_load_dwordx4 v[236:239], v15, s[12:15], s39 offen offset:0 sc1
    buffer_load_dwordx4 v[240:243], v15, s[12:15], s39 offen offset:1024 sc1
    buffer_load_dwordx4 v[244:247], v15, s[12:15], s39 offen offset:2048 sc1
    buffer_load_dwordx4 v[248:251], v15, s[12:15], s39 offen offset:3072 sc1
    s_add_u32 s35, s39, 4096
    buffer_load_dwordx4 v[252:255], v15, s[12:15], s35 offen offset:0 sc1
    s_waitcnt vmcnt(0)
    v_max_i32 v8, v216, v218
    v_max3_i32 v8, v8, v220, v222
    v_max3_i32 v8, v8, v224, v226
    v_max3_i32 v8, v8, v228, v230
    v_max3_i32 v8, v8, v232, v234
    v_cmp_eq_u32 vcc, s21, v8
    s_nop 4
    s_cbranch_vccz L_k5t_37
    s_sub_u32 s67, s67, 1
    s_cselect_b32 s21, 0x80000000, s21
    s_sleep 2
    s_branch L_k5r_38
L_k5r_40:
    s_nop 7
    buffer_load_dwordx4 v[236:239], v15, s[12:15], s39 offen offset:0 sc1
    buffer_load_dwordx4 v[240:243], v15, s[12:15], s39 offen offset:1024 sc1
    buffer_load_dwordx4 v[244:247], v15, s[12:15], s39 offen offset:2048 sc1
    buffer_load_dwordx4 v[248:251], v15, s[12:15], s39 offen offset:3072 sc1
    s_add_u32 s35, s39, 4096
    buffer_load_dwordx4 v[252:255], v15, s[12:15], s35 offen offset:0 sc1
    s_waitcnt vmcnt(0)
    v_max_i32 v8, v236, v238
    v_max3_i32 v8, v8, v240, v242
    v_max3_i32 v8, v8, v244, v246
    v_max3_i32 v8, v8, v248, v250
    v_max3_i32 v8, v8, v252, v254
    v_cmp_eq_u32 vcc, s21, v8
    s_nop 4
    s_cbranch_vccz L_k5t_39
    s_sub_u32 s67, s67, 1
    s_cselect_b32 s21, 0x80000000, s21
    s_sleep 2
    s_branch L_k5r_40
L_k6r_42:
    s_waitcnt vmcnt(0)
    s_add_u32 s49, s60, 0
    buffer_load_dwordx4 a[224:227], v22, s[12:15], s49 offen offset:0 sc1
    buffer_load_dwordx4 a[228:231], v22, s[12:15], s49 offen offset:1024 sc1
    buffer_load_dwordx4 a[232:235], v22, s[12:15], s49 offen offset:2048 sc1
    buffer_load_dwordx4 a[236:239], v22, s[12:15], s49 offen offset:3072 sc1
    s_add_u32 s49, s60, 4096
    buffer_load_dwordx4 a[240:243], v22, s[12:15], s49 offen offset:0 sc1
    buffer_load_dwordx4 a[244:247], v22, s[12:15], s49 offen offset:1024 sc1
    buffer_load_dwordx4 a[248:251], v22, s[12:15], s49 offen offset:2048 sc1
    buffer_load_dwordx4 a[252:255], v22, s[12:15], s49 offen offset:3072 sc1
    s_add_u32 s49, s60, 8192
    buffer_load_dwordx4 a[200:203], v22, s[12:15], s49 offen offset:0 sc1
    buffer_load_dwordx4 a[204:207], v22, s[12:15], s49 offen offset:1024 sc1
    buffer_load_dwordx4 a[208:211], v22, s[12:15], s49 offen offset:2048 sc1
    buffer_load_dwordx4 a[212:215], v22, s[12:15], s49 offen offset:3072 sc1
    s_add_u32 s49, s60, 12288
    buffer_load_dwordx4 a[216:219], v22, s[12:15], s49 offen offset:0 sc1
    buffer_load_dwordx4 a[220:223], v22, s[12:15], s49 offen offset:1024 sc1
    buffer_load_dwordx4 a[0:3], v22, s[12:15], s49 offen offset:2048 sc1
    buffer_load_dwordx4 a[96:99], v22, s[12:15], s49 offen offset:3072 sc1
    s_add_u32 s49, s60, 16384
    buffer_load_dwordx4 a[100:103], v22, s[12:15], s49 offen offset:0 sc1
    buffer_load_dwordx4 a[4:7], v22, s[12:15], s49 offen offset:1024 sc1
    buffer_load_dwordx4 a[104:107], v22, s[12:15], s49 offen offset:2048 sc1
    buffer_load_dwordx4 a[108:111], v22, s[12:15], s49 offen offset:3072 sc1
    s_add_u32 s49, s60, 20480
    buffer_load_dwordx4 a[8:11], v22, s[12:15], s49 offen offset:0 sc1
    buffer_load_dwordx4 a[112:115], v22, s[12:15], s49 offen offset:1024 sc1
    buffer_load_dwordx4 a[116:119], v22, s[12:15], s49 offen offset:2048 sc1
    buffer_load_dwordx4 a[12:15], v22, s[12:15], s49 offen offset:3072 sc1
    s_add_u32 s49, s60, 24576
    buffer_load_dwordx4 a[120:123], v22, s[12:15], s49 offen offset:0 sc1
    buffer_load_dwordx4 a[124:127], v22, s[12:15], s49 offen offset:1024 sc1
    buffer_load_dwordx4 a[16:19], v22, s[12:15], s49 offen offset:2048 sc1
    buffer_load_dwordx4 a[128:131], v22, s[12:15], s49 offen offset:3072 sc1
    s_add_u32 s49, s60, 28672
    buffer_load_dwordx4 a[132:135], v22, s[12:15], s49 offen offset:0 sc1
    buffer_load_dwordx4 a[20:23], v22, s[12:15], s49 offen offset:1024 sc1
    buffer_load_dwordx4 a[136:139], v22, s[12:15], s49 offen offset:2048 sc1
    buffer_load_dwordx4 a[140:143], v22, s[12:15], s49 offen offset:3072 sc1
    s_add_u32 s49, s60, 32768
    buffer_load_dwordx4 a[24:27], v22, s[12:15], s49 offen offset:0 sc1
    buffer_load_dwordx4 a[144:147], v22, s[12:15], s49 offen offset:1024 sc1
    buffer_load_dwordx4 a[148:151], v22, s[12:15], s49 offen offset:2048 sc1
    buffer_load_dwordx4 a[188:191], v22, s[12:15], s49 offen offset:3072 sc1
    s_add_u32 s49, s60, 36864
    buffer_load_dwordx4 a[192:195], v22, s[12:15], s49 offen offset:0 sc1
    buffer_load_dwordx4 a[196:199], v22, s[12:15], s49 offen offset:1024 sc1
    s_waitcnt vmcnt(0)
    s_lshl_b32 s40, s27, 12
    s_lshl_b32 s41, s3, 8
    s_add_u32 s40, s40, s41
    s_add_u32 s40, s40, 524288
    v_lshrrev_b32 v14, 4, v1
    v_lshlrev_b32 v14, 10, v14
    v_and_b32 v15, 15, v1
    v_lshl_add_u32 v14, v15, 2, v14
    buffer_load_dword v10, v14, s[12:15], s40 offen offset:0 sc1
    buffer_load_dword v11, v14, s[12:15], s40 offen offset:64 sc1
    buffer_load_dword v12, v14, s[12:15], s40 offen offset:128 sc1
    buffer_load_dword v13, v14, s[12:15], s40 offen offset:192 sc1
    s_add_u32 m0, s37, 0
    s_add_u32 s35, s36, 0
    buffer_load_dwordx4 v22, s[12:15], s35 offen sc1 lds
    s_add_u32 m0, s37, 20480
    s_add_u32 s35, s36, 20480
    buffer_load_dwordx4 v22, s[12:15], s35 offen sc1 lds
    s_add_u32 m0, s37, 40960
    s_add_u32 s35, s36, 40960
    buffer_load_dwordx4 v22, s[12:15], s35 offen sc1 lds
    s_add_u32 m0, s37, 61440
    s_add_u32 s35, s36, 61440
    buffer_load_dwordx4 v22, s[12:15], s35 offen sc1 lds
    s_add_u32 m0, s37, 1024
    s_add_u32 s35, s36, 1024
    buffer_load_dwordx4 v22, s[12:15], s35 offen sc1 lds
    s_add_u32 m0, s37, 21504
    s_add_u32 s35, s36, 21504
    buffer_load_dwordx4 v22, s[12:15], s35 offen sc1 lds
    s_add_u32 m0, s37, 41984
    s_add_u32 s35, s36, 41984
    buffer_load_dwordx4 v22, s[12:15], s35 offen sc1 lds
    s_add_u32 m0, s37, 62464
    s_add_u32 s35, s36, 62464
    buffer_load_dwordx4 v22, s[12:15], s35 offen sc1 lds
    s_waitcnt vmcnt(0)
    s_sub_u32 s67, s67, 1
    s_cselect_b32 s21, 0x80000000, s21
    s_sleep 2
    s_branch L_k6_41
L_ssr_44:
    buffer_load_dword v10, v14, s[12:15], s40 offen offset:0 sc1
    buffer_load_dword v11, v14, s[12:15], s40 offen offset:64 sc1
    buffer_load_dword v12, v14, s[12:15], s40 offen offset:128 sc1
    buffer_load_dword v13, v14, s[12:15], s40 offen offset:192 sc1
    s_add_u32 m0, s37, 0
    s_add_u32 s35, s36, 0
    buffer_load_dwordx4 v22, s[12:15], s35 offen sc1 lds
    s_add_u32 m0, s37, 20480
    s_add_u32 s35, s36, 20480
    buffer_load_dwordx4 v22, s[12:15], s35 offen sc1 lds
    s_add_u32 m0, s37, 40960
    s_add_u32 s35, s36, 40960
    buffer_load_dwordx4 v22, s[12:15], s35 offen sc1 lds
    s_add_u32 m0, s37, 61440
    s_add_u32 s35, s36, 61440
    buffer_load_dwordx4 v22, s[12:15], s35 offen sc1 lds
    s_add_u32 m0, s37, 1024
    s_add_u32 s35, s36, 1024
    buffer_load_dwordx4 v22, s[12:15], s35 offen sc1 lds
    s_add_u32 m0, s37, 21504
    s_add_u32 s35, s36, 21504
    buffer_load_dwordx4 v22, s[12:15], s35 offen sc1 lds
    s_add_u32 m0, s37, 41984
    s_add_u32 s35, s36, 41984
    buffer_load_dwordx4 v22, s[12:15], s35 offen sc1 lds
    s_add_u32 m0, s37, 62464
    s_add_u32 s35, s36, 62464
    buffer_load_dwordx4 v22, s[12:15], s35 offen sc1 lds
    s_waitcnt vmcnt(0)
    s_sub_u32 s67, s67, 1
    s_cselect_b32 s21, 0x80000000, s21
    s_sleep 2
    s_branch L_ss_43
L_k7r_46:
    s_nop 7
    buffer_load_dwordx4 v[32:35], v22, s[12:15], s36 offen offset:0 sc1
    buffer_load_dwordx4 v[36:39], v22, s[12:15], s36 offen offset:1024 sc1
    buffer_load_dwordx4 v[40:43], v22, s[12:15], s36 offen offset:2048 sc1
    buffer_load_dwordx4 v[44:47], v22, s[12:15], s36 offen offset:3072 sc1
    s_add_u32 s35, s36, 4096
    buffer_load_dwordx4 v[48:51], v22, s[12:15], s35 offen offset:0 sc1
    buffer_load_dwordx4 v[52:55], v22, s[12:15], s35 offen offset:1024 sc1
    buffer_load_dwordx4 v[56:59], v22, s[12:15], s35 offen offset:2048 sc1
    buffer_load_dwordx4 v[60:63], v22, s[12:15], s35 offen offset:3072 sc1
    s_add_u32 s35, s36, 8192
    buffer_load_dwordx4 v[64:67], v22, s[12:15], s35 offen offset:0 sc1
    buffer_load_dwordx4 v[68:71], v22, s[12:15], s35 offen offset:1024 sc1
    buffer_load_dwordx4 v[72:75], v22, s[12:15], s35 offen offset:2048 sc1
    buffer_load_dwordx4 v[76:79], v22, s[12:15], s35 offen offset:3072 sc1
    s_waitcnt vmcnt(0)
    v_max_i32 v8, v32, v34
    v_max3_i32 v8, v8, v36, v38
    v_max3_i32 v8, v8, v40, v42
    v_max3_i32 v8, v8, v44, v46
    v_max3_i32 v8, v8, v48, v50
    v_max3_i32 v8, v8, v52, v54
    v_max3_i32 v8, v8, v56, v58
    v_max3_i32 v8, v8, v60, v62
    v_max3_i32 v8, v8, v64, v66
    v_max3_i32 v8, v8, v68, v70
    v_max3_i32 v8, v8, v72, v74
    v_max3_i32 v8, v8, v76, v78
    v_cmp_eq_u32 vcc, s21, v8
    s_nop 4
    s_cbranch_vccz L_k7t_45
    s_sub_u32 s67, s67, 1
    s_cselect_b32 s21, 0x80000000, s21
    s_sleep 2
    s_branch L_k7r_46
L_k7r_48:
    s_nop 7
    buffer_load_dwordx4 v[80:83], v22, s[12:15], s37 offen offset:0 sc1
    buffer_load_dwordx4 v[84:87], v22, s[12:15], s37 offen offset:1024 sc1
    buffer_load_dwordx4 v[88:91], v22, s[12:15], s37 offen offset:2048 sc1
    buffer_load_dwordx4 v[92:95], v22, s[12:15], s37 offen offset:3072 sc1
    s_add_u32 s35, s37, 4096
    buffer_load_dwordx4 v[96:99], v22, s[12:15], s35 offen offset:0 sc1
    buffer_load_dwordx4 v[100:103], v22, s[12:15], s35 offen offset:1024 sc1
    buffer_load_dwordx4 v[216:219], v22, s[12:15], s35 offen offset:2048 sc1
    buffer_load_dwordx4 v[220:223], v22, s[12:15], s35 offen offset:3072 sc1
    s_add_u32 s35, s37, 8192
    buffer_load_dwordx4 v[224:227], v22, s[12:15], s35 offen offset:0 sc1
    buffer_load_dwordx4 v[228:231], v22, s[12:15], s35 offen offset:1024 sc1
    buffer_load_dwordx4 v[232:235], v22, s[12:15], s35 offen offset:2048 sc1
    buffer_load_dwordx4 v[236:239], v22, s[12:15], s35 offen offset:3072 sc1
    s_waitcnt vmcnt(0)
    v_max_i32 v8, v80, v82
    v_max3_i32 v8, v8, v84, v86
    v_max3_i32 v8, v8, v88, v90
    v_max3_i32 v8, v8, v92, v94
    v_max3_i32 v8, v8, v96, v98
    v_max3_i32 v8, v8, v100, v102
    v_max3_i32 v8, v8, v216, v218
    v_max3_i32 v8, v8, v220, v222
    v_max3_i32 v8, v8, v224, v226
    v_max3_i32 v8, v8, v228, v230
    v_max3_i32 v8, v8, v232, v234
    v_max3_i32 v8, v8, v236, v238
    v_cmp_eq_u32 vcc, s21, v8
    s_nop 4
    s_cbranch_vccz L_k7t_47
    s_sub_u32 s67, s67, 1
    s_cselect_b32 s21, 0x80000000, s21
    s_sleep 2
    s_branch L_k7r_48
L_k7r_50:
    s_nop 7
    buffer_load_dwordx4 v[240:243], v22, s[12:15], s38 offen offset:0 sc1
    buffer_load_dwordx4 v[244:247], v22, s[12:15], s38 offen offset:1024 sc1
    buffer_load_dwordx4 v[248:251], v22, s[12:15], s38 offen offset:2048 sc1
    buffer_load_dwordx4 v[252:255], v22, s[12:15], s38 offen offset:3072 sc1
    s_add_u32 s35, s38, 4096
    buffer_load_dwordx4 v[32:35], v22, s[12:15], s35 offen offset:0 sc1
    buffer_load_dwordx4 v[36:39], v22, s[12:15], s35 offen offset:1024 sc1
    buffer_load_dwordx4 v[40:43], v22, s[12:15], s35 offen offset:2048 sc1
    buffer_load_dwordx4 v[44:47], v22, s[12:15], s35 offen offset:3072 sc1
    s_add_u32 s35, s38, 8192
    buffer_load_dwordx4 v[48:51], v22, s[12:15], s35 offen offset:0 sc1
    buffer_load_dwordx4 v[52:55], v22, s[12:15], s35 offen offset:1024 sc1
    buffer_load_dwordx4 v[56:59], v22, s[12:15], s35 offen offset:2048 sc1
    buffer_load_dwordx4 v[60:63], v22, s[12:15], s35 offen offset:3072 sc1
    s_waitcnt vmcnt(0)
    v_max_i32 v8, v240, v242
    v_max3_i32 v8, v8, v244, v246
    v_max3_i32 v8, v8, v248, v250
    v_max3_i32 v8, v8, v252, v254
    v_max3_i32 v8, v8, v32, v34
    v_max3_i32 v8, v8, v36, v38
    v_max3_i32 v8, v8, v40, v42
    v_max3_i32 v8, v8, v44, v46
    v_max3_i32 v8, v8, v48, v50
    v_max3_i32 v8, v8, v52, v54
    v_max3_i32 v8, v8, v56, v58
    v_max3_i32 v8, v8, v60, v62
    v_cmp_eq_u32 vcc, s21, v8
    s_nop 4
    s_cbranch_vccz L_k7t_49
    s_sub_u32 s67, s67, 1
    s_cselect_b32 s21, 0x80000000, s21
    s_sleep 2
    s_branch L_k7r_50
L_k7r_52:
    s_nop 7
    buffer_load_dwordx4 v[64:67], v22, s[12:15], s39 offen offset:0 sc1
    buffer_load_dwordx4 v[68:71], v22, s[12:15], s39 offen offset:1024 sc1
    buffer_load_dwordx4 v[72:75], v22, s[12:15], s39 offen offset:2048 sc1
    buffer_load_dwordx4 v[76:79], v22, s[12:15], s39 offen offset:3072 sc1
    s_add_u32 s35, s39, 4096
    buffer_load_dwordx4 v[80:83], v22, s[12:15], s35 offen offset:0 sc1
    buffer_load_dwordx4 v[84:87], v22, s[12:15], s35 offen offset:1024 sc1
    buffer_load_dwordx4 v[88:91], v22, s[12:15], s35 offen offset:2048 sc1
    buffer_load_dwordx4 v[92:95], v22, s[12:15], s35 offen offset:3072 sc1
    s_add_u32 s35, s39, 8192
    buffer_load_dwordx4 v[96:99], v22, s[12:15], s35 offen offset:0 sc1
    buffer_load_dwordx4 v[100:103], v22, s[12:15], s35 offen offset:1024 sc1
    buffer_load_dwordx4 v[216:219], v22, s[12:15], s35 offen offset:2048 sc1
    buffer_load_dwordx4 v[220:223], v22, s[12:15], s35 offen offset:3072 sc1
    s_waitcnt vmcnt(0)
    v_max_i32 v8, v64, v66
    v_max3_i32 v8, v8, v68, v70
    v_max3_i32 v8, v8, v72, v74
    v_max3_i32 v8, v8, v76, v78
    v_max3_i32 v8, v8, v80, v82
    v_max3_i32 v8, v8, v84, v86
    v_max3_i32 v8, v8, v88, v90
    v_max3_i32 v8, v8, v92, v94
    v_max3_i32 v8, v8, v96, v98
    v_max3_i32 v8, v8, v100, v102
    v_max3_i32 v8, v8, v216, v218
    v_max3_i32 v8, v8, v220, v222
    v_cmp_eq_u32 vcc, s21, v8
    s_nop 4
    s_cbranch_vccz L_k7t_51
    s_sub_u32 s67, s67, 1
    s_cselect_b32 s21, 0x80000000, s21
    s_sleep 2
    s_branch L_k7r_52
L_end:
.section .rodata,"a"
.p2align 6
.amdhsa_kernel sequential_preLN__softmax_full_mha__mixer_s_mlp__prompt_kernel
  .amdhsa_next_free_vgpr 512
  .amdhsa_next_free_sgpr 102
  .amdhsa_accum_offset 256
  .amdhsa_group_segment_fixed_size 0
  .amdhsa_kernarg_size 88
  .amdhsa_user_sgpr_count 2
  .amdhsa_user_sgpr_kernarg_segment_ptr 1
  .amdhsa_system_sgpr_workgroup_id_x 1
.end_amdhsa_kernel
```
